```python
import torch

def _softmax(x, axis=-1):
    return torch.softmax(x, dim=axis)
def _gelu(x):
    return torch.nn.functional.gelu(x, approximate="tanh")
def _silu(x):
    return torch.nn.functional.silu(x)
def _sigmoid(x):
    return torch.sigmoid(x)
def _layernorm(x, axis=-1, eps=1e-5):
    m = x.mean(dim=axis, keepdim=True)
    v = x.var(dim=axis, keepdim=True, unbiased=False)
    return (x - m) / torch.sqrt(v + eps)
def _scatter_add(tgt, idx, src, axis=0):
    return tgt.clone().index_add_(axis, idx, src)
def _segment_sum(src, seg, n):
    out = torch.zeros((n,) + src.shape[1:], dtype=src.dtype)
    return out.index_add_(0, seg, src)
def _pad(x, pw):
    flat = tuple(v for pair in reversed(pw) for v in pair)
    return torch.nn.functional.pad(x, flat)

kernel_name = 'parallel_sum__compressed_kv_cla__glu_gated_swiglu__prompt'

def setup_inputs():

    _w = (lambda a: (lambda t: t.to(torch.bfloat16) if t.is_floating_point() else t)(torch.as_tensor(a)))
    def _A_setup():
        B, H, Sq, Sk, D, M = 1, 32, 2048, 2048, 128, 512
        Dc = 4 * D
        return {
            "x": _w((lambda *s: torch.randn(*s, dtype=torch.bfloat16) * 0.05)(B, Sq, M)),
            "c_kv": _w((lambda *s: torch.randn(*s, dtype=torch.bfloat16) * 0.4)(B, Sk, Dc)),
            "w_q": _w((lambda *s: torch.randn(*s, dtype=torch.bfloat16) * 1.6)(M, H, D) * (M ** -0.5)),
            "w_uk": _w((lambda *s: torch.randn(*s, dtype=torch.bfloat16) * 1.6)(Dc, H, D) * (Dc ** -0.5)),
            "w_uv": _w((lambda *s: torch.randn(*s, dtype=torch.bfloat16) * 0.4)(Dc, H, D) * (Dc ** -0.5)),
            "w_o": _w((lambda *s: torch.randn(*s, dtype=torch.bfloat16) * 0.4)(H, D, M) * ((H * D) ** -0.5)),
        }
    _A_in = _A_setup()

    def _B_setup():
        B, S, D, F = 1, 2048, 512, 1376
        return {
            "x": _w((lambda *s: torch.randn(*s, dtype=torch.bfloat16) * 0.05)(B, S, D)),
            "w1": _w((lambda *s: torch.randn(*s, dtype=torch.bfloat16) * 0.2)(D, F) * (2.0 / D) ** 0.5),
            "w3": _w((lambda *s: torch.randn(*s, dtype=torch.bfloat16) * 0.2)(D, F) * (2.0 / D) ** 0.5),
            "w2": _w((lambda *s: torch.randn(*s, dtype=torch.bfloat16) * 0.2)(F, D) * (2.0 / F) ** 0.5),
        }
    _B_in = _B_setup()

    return {
        "A_x": _A_in["x"],
        "A_c_kv": _A_in["c_kv"],
        "A_w_q": _A_in["w_q"],
        "A_w_uk": _A_in["w_uk"],
        "A_w_uv": _A_in["w_uv"],
        "A_w_o": _A_in["w_o"],
        "B_x": _B_in["x"],
        "B_w1": _B_in["w1"],
        "B_w3": _B_in["w3"],
        "B_w2": _B_in["w2"],
    }

def reference(A_x, A_c_kv, A_w_q, A_w_uk, A_w_uv, A_w_o, B_x, B_w1, B_w3, B_w2):
    def _A_ref(x, c_kv, w_q, w_uk, w_uv, w_o):
        B, Sq, M = x.shape[0], x.shape[1], x.shape[2]
        Sk = c_kv.shape[1]
        H, D = w_q.shape[1], w_q.shape[2]
        q = torch.einsum("bqm,mhd->bhqd", x, w_q)
        k = torch.einsum("bkc,chd->bhkd", c_kv, w_uk)
        v = torch.einsum("bkc,chd->bhkd", c_kv, w_uv)
        scores = torch.einsum("bhqd,bhkd->bhqk", q, k) * (D ** -0.5)
        off = Sk - Sq
        qi = torch.arange(Sq)[:, None]
        kj = torch.arange(Sk)[None, :]
        cmask = kj <= (qi + off)
        scores = torch.where(cmask[None, None], scores, -1e9)
        p = _softmax(scores, axis=-1)
        ctx = torch.einsum("bhqk,bhkd->bhqd", p, v)
        return torch.einsum("bhqd,hdm->bqm", ctx, w_o)

    def _B_ref(x, w1, w3, w2):
        gate = torch.einsum("bsd,df->bsf", x, w1)
        up = torch.einsum("bsd,df->bsf", x, w3)
        h = _silu(gate) * up
        out = torch.einsum("bsf,fd->bsd", h, w2)
        return out

    x = A_x
    xn = _layernorm(x, axis=-1)
    return x + _A_ref(xn, A_c_kv, A_w_q, A_w_uk, A_w_uv, A_w_o) + _B_ref(xn, B_w1, B_w3, B_w2)
```

```asm
; @launch grid=(256,1,1) block=(256,1,1) lds=163840
.amdgcn_target "amdgcn-amd-amdhsa--gfx950"
.text
.globl parallel_sum__compressed_kv_cla__glu_gated_swiglu__prompt_kernel
.p2align 8
.type parallel_sum__compressed_kv_cla__glu_gated_swiglu__prompt_kernel,@function
parallel_sum__compressed_kv_cla__glu_gated_swiglu__prompt_kernel:
  s_cmp_ge_u32 s2, 256
  s_cbranch_scc1 L_end
  s_load_dwordx2 s[66:67], s[0:1], 0
  s_load_dwordx2 s[4:5], s[0:1], 8
  s_load_dwordx2 s[6:7], s[0:1], 24
  s_load_dwordx2 s[8:9], s[0:1], 32
  s_load_dwordx2 s[12:13], s[0:1], 96
  s_load_dwordx2 s[14:15], s[0:1], 56
  s_load_dwordx2 s[16:17], s[0:1], 64
  s_load_dwordx2 s[18:19], s[0:1], 16
  s_load_dwordx2 s[64:65], s[0:1], 88
  s_and_b32 s20, s2, 7
  s_lshl_b32 s20, s20, 2
  s_lshr_b32 s21, s2, 3
  s_and_b32 s21, s21, 3
  s_add_u32 s20, s20, s21
  s_lshr_b32 s21, s2, 5
  v_lshrrev_b32 v1, 6, v0
  s_nop 0
  v_readfirstlane_b32 s22, v1
  v_and_b32 v1, 63, v0
  s_getreg_b32 s3, hwreg(HW_REG_XCC_ID, 0, 4)
  s_and_b32 s3, s3, 7
  s_and_b32 s40, s20, 3
  s_lshl_b32 s40, s40, 1
  s_add_u32 s40, s40, s21
  s_lshl_b32 s40, s40, 1
  s_and_b32 s72, s40, 15
  s_and_b32 s50, s40, 0
  s_mov_b32 s73, 0
  v_lshlrev_b32 v4, 4, v1
  v_lshrrev_b32 v60, 3, v1
  v_bfe_u32 v61, v60, 1, 1
  s_and_b32 s40, s22, 1
  s_lshl_b32 s40, s40, 1
  v_or_b32 v61, s40, v61
  v_lshlrev_b32 v61, 1, v61
  v_and_b32 v2, 7, v1
  v_xor_b32 v2, v2, v61
  v_lshlrev_b32 v2, 4, v2
  s_lshl_b32 s40, s22, 3
  v_add_u32 v60, s40, v60
  s_mov_b32 s40, 8192
  v_mul_lo_u32 v60, v60, s40
  v_add_u32 v2, v2, v60
  v_lshrrev_b32 v60, 3, v1
  v_lshrrev_b32 v61, 1, v60
  v_and_b32 v62, 7, v1
  v_xor_b32 v63, v62, v61
  v_lshlrev_b32 v63, 4, v63
  v_lshlrev_b32 v60, 10, v60
  v_add_u32 v48, v63, v60
  v_or_b32 v61, 4, v61
  v_xor_b32 v63, v62, v61
  v_lshlrev_b32 v63, 4, v63
  v_add_u32 v49, v63, v60
  v_add_u32 v49, 0x2000, v49
  v_add_u32 v50, 16384, v48
  v_add_u32 v51, 16384, v49
  v_add_u32 v52, 32768, v48
  v_add_u32 v53, 32768, v49
  v_add_u32 v54, 49152, v48
  v_add_u32 v55, 49152, v49
  s_lshl_b32 s32, s22, 14
  s_add_u32 s32, s32, 98304
  s_lshl_b32 s23, s22, 10
  s_lshl_b32 s40, s2, 3
  s_lshl_b32 s41, s22, 1
  s_add_u32 s40, s40, s41
  s_lshl_b32 s40, s40, 10
  v_add_u32 v8, s40, v4
  s_waitcnt lgkmcnt(0)
  global_load_dwordx4 v[12:15], v8, s[66:67]
  global_load_dwordx4 v[16:19], v8, s[66:67] offset:1024
  s_mov_b64 s[28:29], s[4:5]
  s_mov_b64 s[30:31], s[6:7]
  s_mov_b64 s[38:39], s[8:9]
  s_lshl_b32 s40, s21, 8
  s_lshl_b32 s41, s22, 6
  s_add_u32 s40, s40, s41
  s_lshl_b32 s40, s40, 10
  s_add_u32 s4, s4, s40
  s_addc_u32 s5, s5, 0
  s_lshl_b32 s40, s20, 8
  s_add_u32 s6, s6, s40
  s_addc_u32 s7, s7, 0
  s_add_u32 s8, s8, s40
  s_addc_u32 s9, s9, 0
  s_add_u32 s18, s18, s40
  s_addc_u32 s19, s19, 0
  s_lshr_b32 s40, s2, 3
  s_lshl_b32 s41, s40, 6
  v_add_u32 v56, s41, v1
  v_lshlrev_b32 v56, 10, v56
  s_lshl_b32 s41, s40, 4
  v_and_b32 v57, 15, v1
  v_add_u32 v57, s41, v57
  v_lshlrev_b32 v57, 13, v57
  v_lshrrev_b32 v58, 4, v1
  s_and_b32 s41, s2, 7
  s_lshl_b32 s41, s41, 2
  v_add_u32 v58, s41, v58
  v_lshlrev_b32 v58, 8, v58
  v_add_u32 v57, v57, v58
  s_lshr_b32 s42, s50, 1
  s_add_u32 s42, s42, 0
  s_and_b32 s42, s42, 7
  s_lshl_b32 s42, s42, 7
  s_add_u32 s44, s4, s42
  s_addc_u32 s45, s5, 0
  s_add_u32 m0, s32, 0
  s_nop 0
  global_load_lds_dwordx4 v48, s[44:45]
  s_add_u32 m0, s32, 1024
  s_nop 0
  global_load_lds_dwordx4 v49, s[44:45]
  s_add_u32 m0, s32, 2048
  s_nop 0
  global_load_lds_dwordx4 v50, s[44:45]
  s_add_u32 m0, s32, 3072
  s_nop 0
  global_load_lds_dwordx4 v51, s[44:45]
  s_add_u32 m0, s32, 4096
  s_nop 0
  global_load_lds_dwordx4 v52, s[44:45]
  s_add_u32 m0, s32, 5120
  s_nop 0
  global_load_lds_dwordx4 v53, s[44:45]
  s_add_u32 m0, s32, 6144
  s_nop 0
  global_load_lds_dwordx4 v54, s[44:45]
  s_add_u32 m0, s32, 7168
  s_nop 0
  global_load_lds_dwordx4 v55, s[44:45]
  s_add_u32 s24, s6, 0
  s_addc_u32 s25, s7, 0
  s_add_u32 m0, s23, 0
  s_nop 0
  global_load_lds_dwordx4 v2, s[24:25]
  s_add_u32 s26, s6, 128
  s_addc_u32 s27, s7, 0
  s_add_u32 m0, s23, 4096
  s_nop 0
  global_load_lds_dwordx4 v2, s[26:27]
  s_add_u32 s24, s6, 262144
  s_addc_u32 s25, s7, 0
  s_add_u32 m0, s23, 8192
  s_nop 0
  global_load_lds_dwordx4 v2, s[24:25]
  s_add_u32 s26, s6, 262272
  s_addc_u32 s27, s7, 0
  s_add_u32 m0, s23, 12288
  s_nop 0
  global_load_lds_dwordx4 v2, s[26:27]
  s_add_u32 s24, s6, 524288
  s_addc_u32 s25, s7, 0
  s_add_u32 m0, s23, 16384
  s_nop 0
  global_load_lds_dwordx4 v2, s[24:25]
  s_add_u32 s26, s6, 524416
  s_addc_u32 s27, s7, 0
  s_add_u32 m0, s23, 20480
  s_nop 0
  global_load_lds_dwordx4 v2, s[26:27]
  s_add_u32 s24, s6, 786432
  s_addc_u32 s25, s7, 0
  s_add_u32 m0, s23, 24576
  s_nop 0
  global_load_lds_dwordx4 v2, s[24:25]
  s_add_u32 s26, s6, 786560
  s_addc_u32 s27, s7, 0
  s_add_u32 m0, s23, 28672
  s_nop 0
  global_load_lds_dwordx4 v2, s[26:27]
  s_lshl_b32 s40, s20, 6
  s_lshl_b32 s41, s21, 3
  s_add_u32 s40, s40, s41
  s_lshl_b32 s41, s22, 1
  s_add_u32 s40, s40, s41
  s_lshl_b32 s40, s40, 14
  s_add_u32 s40, s40, 2097152
  s_add_u32 s10, s12, s40
  s_addc_u32 s11, s13, 0
  s_add_u32 s60, s12, 0
  s_addc_u32 s61, s13, 0
  s_add_u32 s68, s12, 92274688
  s_addc_u32 s69, s13, 0
  s_mul_i32 s42, s20, 3
  s_lshl_b32 s40, s20, 1
  s_add_u32 s40, s40, 22
  s_cmp_lt_u32 s20, 22
  s_cselect_b32 s42, s42, s40
  s_cselect_b32 s37, 1, 0
  s_cselect_b32 s33, 5, 3
  s_and_b32 s41, s42, 1
  s_lshl_b32 s48, s41, 5
  s_mul_i32 s49, s41, 96
  s_lshl_b32 s40, s41, 1
  s_add_u32 s33, s33, s40
  s_sub_u32 s40, s42, s41
  s_lshl_b32 s40, s40, 5
  s_add_u32 s14, s14, s40
  s_addc_u32 s15, s15, 0
  s_add_u32 s16, s16, s40
  s_addc_u32 s17, s17, 0
  s_lshl_b32 s40, s42, 10
  s_add_u32 s40, s40, 35651584
  s_add_u32 s54, s12, s40
  s_addc_u32 s55, s13, 0
  s_lshl_b32 s40, s20, 12
  s_add_u32 s40, s40, 41943040
  s_add_u32 s62, s12, s40
  s_addc_u32 s63, s13, 0
  s_lshl_b32 s40, s20, 20
  s_lshl_b32 s41, s22, 12
  s_add_u32 s40, s40, s41
  s_add_u32 s40, s40, 2097152
  s_add_u32 s34, s12, s40
  s_addc_u32 s35, s13, 0
  s_add_u32 s36, s41, 98304
  s_sub_u32 s40, 15, s21
  s_lshl_b32 s40, s40, 3
  s_lshl_b32 s41, s22, 1
  s_add_u32 s56, s40, s41
  s_add_u32 s57, s56, 1
  s_lshl_b32 s40, s21, 3
  s_add_u32 s58, s40, s41
  s_add_u32 s59, s58, 1
  s_or_b32 s40, s2, s22
  s_cmp_eq_u32 s40, 0
  s_cbranch_scc0 L_np_skip
  s_memrealtime s[40:41]
  s_waitcnt lgkmcnt(0)
  s_and_b32 s40, s40, 0xfffffff0
  s_or_b32 s40, s40, 8
  s_mov_b64 exec, 1
  v_mov_b32 v60, 0
  v_mov_b32 v61, s40
  global_store_dword v60, v61, s[64:65] sc1
  s_mov_b64 exec, -1
L_np_skip:
  s_waitcnt vmcnt(16)
  v_lshlrev_b32 v20, 16, v12
  v_and_b32 v21, 0xffff0000, v12
  v_lshlrev_b32 v22, 16, v13
  v_and_b32 v23, 0xffff0000, v13
  v_lshlrev_b32 v24, 16, v14
  v_and_b32 v25, 0xffff0000, v14
  v_lshlrev_b32 v26, 16, v15
  v_and_b32 v27, 0xffff0000, v15
  v_lshlrev_b32 v28, 16, v16
  v_and_b32 v29, 0xffff0000, v16
  v_lshlrev_b32 v30, 16, v17
  v_and_b32 v31, 0xffff0000, v17
  v_lshlrev_b32 v32, 16, v18
  v_and_b32 v33, 0xffff0000, v18
  v_lshlrev_b32 v34, 16, v19
  v_and_b32 v35, 0xffff0000, v19
  v_add_f32 v36, v20, v21
  v_add_f32 v36, v36, v22
  v_add_f32 v36, v36, v23
  v_add_f32 v36, v36, v24
  v_add_f32 v36, v36, v25
  v_add_f32 v36, v36, v26
  v_add_f32 v36, v36, v27
  v_add_f32 v37, v28, v29
  v_add_f32 v37, v37, v30
  v_add_f32 v37, v37, v31
  v_add_f32 v37, v37, v32
  v_add_f32 v37, v37, v33
  v_add_f32 v37, v37, v34
  v_add_f32 v37, v37, v35
  s_nop 0
  s_nop 0
  v_add_f32_dpp v36, v36, v36 quad_perm:[1,0,3,2] row_mask:0xf bank_mask:0xf
  v_add_f32_dpp v37, v37, v37 quad_perm:[1,0,3,2] row_mask:0xf bank_mask:0xf
  s_nop 0
  v_add_f32_dpp v36, v36, v36 quad_perm:[2,3,0,1] row_mask:0xf bank_mask:0xf
  v_add_f32_dpp v37, v37, v37 quad_perm:[2,3,0,1] row_mask:0xf bank_mask:0xf
  s_nop 0
  v_add_f32_dpp v36, v36, v36 row_half_mirror row_mask:0xf bank_mask:0xf
  v_add_f32_dpp v37, v37, v37 row_half_mirror row_mask:0xf bank_mask:0xf
  s_nop 0
  v_add_f32_dpp v36, v36, v36 row_mirror row_mask:0xf bank_mask:0xf
  v_add_f32_dpp v37, v37, v37 row_mirror row_mask:0xf bank_mask:0xf
  v_mov_b32 v40, v36
  v_mov_b32 v41, v37
  s_nop 0
  v_permlane16_swap_b32 v36, v40
  v_permlane16_swap_b32 v37, v41
  s_nop 0
  v_add_f32 v36, v36, v40
  v_add_f32 v37, v37, v41
  v_mov_b32 v40, v36
  v_mov_b32 v41, v37
  s_nop 0
  v_permlane32_swap_b32 v36, v40
  v_permlane32_swap_b32 v37, v41
  s_nop 0
  v_add_f32 v36, v36, v40
  v_add_f32 v37, v37, v41
  v_mul_f32 v36, 0x3b000000, v36
  v_sub_f32 v20, v20, v36
  v_sub_f32 v21, v21, v36
  v_sub_f32 v22, v22, v36
  v_sub_f32 v23, v23, v36
  v_sub_f32 v24, v24, v36
  v_sub_f32 v25, v25, v36
  v_sub_f32 v26, v26, v36
  v_sub_f32 v27, v27, v36
  v_mul_f32 v38, v20, v20
  v_fmac_f32 v38, v21, v21
  v_fmac_f32 v38, v22, v22
  v_fmac_f32 v38, v23, v23
  v_fmac_f32 v38, v24, v24
  v_fmac_f32 v38, v25, v25
  v_fmac_f32 v38, v26, v26
  v_fmac_f32 v38, v27, v27
  v_mul_f32 v37, 0x3b000000, v37
  v_sub_f32 v28, v28, v37
  v_sub_f32 v29, v29, v37
  v_sub_f32 v30, v30, v37
  v_sub_f32 v31, v31, v37
  v_sub_f32 v32, v32, v37
  v_sub_f32 v33, v33, v37
  v_sub_f32 v34, v34, v37
  v_sub_f32 v35, v35, v37
  v_mul_f32 v39, v28, v28
  v_fmac_f32 v39, v29, v29
  v_fmac_f32 v39, v30, v30
  v_fmac_f32 v39, v31, v31
  v_fmac_f32 v39, v32, v32
  v_fmac_f32 v39, v33, v33
  v_fmac_f32 v39, v34, v34
  v_fmac_f32 v39, v35, v35
  s_nop 0
  s_nop 0
  v_add_f32_dpp v38, v38, v38 quad_perm:[1,0,3,2] row_mask:0xf bank_mask:0xf
  v_add_f32_dpp v39, v39, v39 quad_perm:[1,0,3,2] row_mask:0xf bank_mask:0xf
  s_nop 0
  v_add_f32_dpp v38, v38, v38 quad_perm:[2,3,0,1] row_mask:0xf bank_mask:0xf
  v_add_f32_dpp v39, v39, v39 quad_perm:[2,3,0,1] row_mask:0xf bank_mask:0xf
  s_nop 0
  v_add_f32_dpp v38, v38, v38 row_half_mirror row_mask:0xf bank_mask:0xf
  v_add_f32_dpp v39, v39, v39 row_half_mirror row_mask:0xf bank_mask:0xf
  s_nop 0
  v_add_f32_dpp v38, v38, v38 row_mirror row_mask:0xf bank_mask:0xf
  v_add_f32_dpp v39, v39, v39 row_mirror row_mask:0xf bank_mask:0xf
  v_mov_b32 v40, v38
  v_mov_b32 v41, v39
  s_nop 0
  v_permlane16_swap_b32 v38, v40
  v_permlane16_swap_b32 v39, v41
  s_nop 0
  v_add_f32 v38, v38, v40
  v_add_f32 v39, v39, v41
  v_mov_b32 v40, v38
  v_mov_b32 v41, v39
  s_nop 0
  v_permlane32_swap_b32 v38, v40
  v_permlane32_swap_b32 v39, v41
  s_nop 0
  v_add_f32 v38, v38, v40
  v_add_f32 v39, v39, v41
  v_mov_b32 v41, 0x3727c5ac
  v_fmac_f32 v41, 0x3b000000, v38
  v_rsq_f32 v41, v41
  s_nop 0
  v_mul_f32 v20, v20, v41
  v_mul_f32 v21, v21, v41
  v_mul_f32 v22, v22, v41
  v_mul_f32 v23, v23, v41
  v_mul_f32 v24, v24, v41
  v_mul_f32 v25, v25, v41
  v_mul_f32 v26, v26, v41
  v_mul_f32 v27, v27, v41
  v_cvt_pk_bf16_f32 v12, v20, v21
  v_cvt_pk_bf16_f32 v13, v22, v23
  v_cvt_pk_bf16_f32 v14, v24, v25
  v_cvt_pk_bf16_f32 v15, v26, v27
  v_mov_b32 v41, 0x3727c5ac
  v_fmac_f32 v41, 0x3b000000, v39
  v_rsq_f32 v41, v41
  s_nop 0
  v_mul_f32 v28, v28, v41
  v_mul_f32 v29, v29, v41
  v_mul_f32 v30, v30, v41
  v_mul_f32 v31, v31, v41
  v_mul_f32 v32, v32, v41
  v_mul_f32 v33, v33, v41
  v_mul_f32 v34, v34, v41
  v_mul_f32 v35, v35, v41
  v_cvt_pk_bf16_f32 v16, v28, v29
  v_cvt_pk_bf16_f32 v17, v30, v31
  v_cvt_pk_bf16_f32 v18, v32, v33
  v_cvt_pk_bf16_f32 v19, v34, v35
  s_lshl_b32 s41, s22, 5
  s_add_u32 s41, s41, 65536
  v_lshlrev_b32 v8, 7, v1
  v_add_u32 v8, s41, v8
  ds_write_b128 v8, v[12:15]
  ds_write_b128 v8, v[16:19] offset:16
  v_lshrrev_b32 v9, 3, v0
  v_lshlrev_b32 v9, 8, v9
  v_and_b32 v10, 7, v0
  v_lshlrev_b32 v10, 4, v10
  v_add_u32 v9, v9, v10
  s_lshr_b32 s40, s2, 1
  s_lshl_b32 s40, s40, 14
  s_and_b32 s41, s2, 1
  s_lshl_b32 s41, s41, 7
  s_add_u32 s40, s40, s41
  v_add_u32 v9, s40, v9
  v_add_u32 v10, 0x2000, v9
  v_lshlrev_b32 v8, 4, v0
  v_add_u32 v8, 65536, v8
  s_waitcnt lgkmcnt(0)
  s_barrier
  ds_read_b128 v[12:15], v8
  ds_read_b128 v[16:19], v8 offset:4096
  s_waitcnt lgkmcnt(0)
  global_store_dwordx4 v9, v[12:15], s[60:61] sc1
  global_store_dwordx4 v10, v[16:19], s[60:61] sc1
  v_mov_b32 v62, 0
  global_load_dword v63, v62, s[64:65] sc1
  s_lshr_b32 s42, s50, 1
  s_add_u32 s42, s42, 1
  s_and_b32 s42, s42, 7
  s_lshl_b32 s42, s42, 7
  s_add_u32 s46, s4, s42
  s_addc_u32 s47, s5, 0
  s_add_u32 m0, s32, 8192
  s_nop 0
  global_load_lds_dwordx4 v48, s[46:47]
  s_add_u32 m0, s32, 9216
  s_nop 0
  global_load_lds_dwordx4 v49, s[46:47]
  s_add_u32 m0, s32, 10240
  s_nop 0
  global_load_lds_dwordx4 v50, s[46:47]
  s_add_u32 m0, s32, 11264
  s_nop 0
  global_load_lds_dwordx4 v51, s[46:47]
  s_add_u32 m0, s32, 12288
  s_nop 0
  global_load_lds_dwordx4 v52, s[46:47]
  s_add_u32 m0, s32, 13312
  s_nop 0
  global_load_lds_dwordx4 v53, s[46:47]
  s_add_u32 m0, s32, 14336
  s_nop 0
  global_load_lds_dwordx4 v54, s[46:47]
  s_add_u32 m0, s32, 15360
  s_nop 0
  global_load_lds_dwordx4 v55, s[46:47]
  s_add_u32 s24, s6, 1048576
  s_addc_u32 s25, s7, 0
  s_add_u32 m0, s23, 32768
  s_nop 0
  global_load_lds_dwordx4 v2, s[24:25]
  s_add_u32 s26, s6, 1048704
  s_addc_u32 s27, s7, 0
  s_add_u32 m0, s23, 36864
  s_nop 0
  global_load_lds_dwordx4 v2, s[26:27]
  s_add_u32 s24, s6, 1310720
  s_addc_u32 s25, s7, 0
  s_add_u32 m0, s23, 40960
  s_nop 0
  global_load_lds_dwordx4 v2, s[24:25]
  s_add_u32 s26, s6, 1310848
  s_addc_u32 s27, s7, 0
  s_add_u32 m0, s23, 45056
  s_nop 0
  global_load_lds_dwordx4 v2, s[26:27]
  s_add_u32 s24, s6, 1572864
  s_addc_u32 s25, s7, 0
  s_add_u32 m0, s23, 49152
  s_nop 0
  global_load_lds_dwordx4 v2, s[24:25]
  s_add_u32 s26, s6, 1572992
  s_addc_u32 s27, s7, 0
  s_add_u32 m0, s23, 53248
  s_nop 0
  global_load_lds_dwordx4 v2, s[26:27]
  s_add_u32 s24, s6, 1835008
  s_addc_u32 s25, s7, 0
  s_add_u32 m0, s23, 57344
  s_nop 0
  global_load_lds_dwordx4 v2, s[24:25]
  s_add_u32 s26, s6, 1835136
  s_addc_u32 s27, s7, 0
  s_add_u32 m0, s23, 61440
  s_nop 0
  global_load_lds_dwordx4 v2, s[26:27]
  v_lshrrev_b32 v60, 4, v1
  v_bfe_u32 v61, v1, 2, 2
  v_lshlrev_b32 v62, 3, v60
  v_add_u32 v62, v62, v61
  v_and_b32 v60, 1, v60
  v_lshlrev_b32 v60, 1, v60
  v_lshrrev_b32 v61, 1, v61
  v_or_b32 v60, v60, v61
  v_lshlrev_b32 v62, 7, v62
  v_lshlrev_b32 v60, 5, v60
  v_add_u32 v62, v62, v60
  v_and_b32 v61, 3, v1
  v_lshlrev_b32 v61, 3, v61
  v_add_u32 v8, v62, v61
  v_xor_b32 v9, 32, v8
  v_xor_b32 v10, 64, v8
  v_xor_b32 v11, 96, v8
  v_add_u32 v12, 0x10000, v8
  v_add_u32 v13, 0x10000, v9
  v_add_u32 v14, 0x10000, v10
  v_add_u32 v15, 0x10000, v11
  v_lshrrev_b32 v60, 3, v1
  v_bfe_u32 v61, v60, 1, 1
  s_and_b32 s40, s22, 1
  s_lshl_b32 s40, s40, 1
  v_or_b32 v61, s40, v61
  v_lshlrev_b32 v61, 1, v61
  v_and_b32 v3, 7, v1
  v_xor_b32 v3, v3, v61
  v_min_u32 v3, s33, v3
  v_lshlrev_b32 v3, 4, v3
  s_lshl_b32 s40, s22, 3
  v_add_u32 v60, s40, v60
  s_mov_b32 s40, 2752
  v_mul_lo_u32 v60, v60, s40
  v_add_u32 v3, v3, v60
  v_and_b32 v60, 15, v1
  v_lshrrev_b32 v61, 4, v1
  v_lshrrev_b32 v62, 1, v60
  v_xor_b32 v61, v61, v62
  v_lshlrev_b32 v61, 4, v61
  v_lshlrev_b32 v60, 7, v60
  v_add_u32 v60, v60, v61
  v_add_u32 v5, s32, v60
  v_xor_b32 v6, 64, v5
  s_waitcnt vmcnt(27)
  ds_read_b128 a[0:3], v5 offset:0
  ds_read_b128 a[4:7], v5 offset:2048
  ds_read_b128 a[8:11], v5 offset:4096
  ds_read_b128 a[12:15], v5 offset:6144
  ds_read_b128 a[16:19], v6 offset:0
  ds_read_b128 a[20:23], v6 offset:2048
  ds_read_b128 a[24:27], v6 offset:4096
  ds_read_b128 a[28:31], v6 offset:6144
  s_waitcnt vmcnt(19)
  s_barrier
  ds_read_b64_tr_b16 v[16:17], v8 offset:0
  ds_read_b64_tr_b16 v[18:19], v8 offset:512
  ds_read_b64_tr_b16 v[20:21], v9 offset:0
  ds_read_b64_tr_b16 v[22:23], v9 offset:512
  ds_read_b64_tr_b16 v[24:25], v10 offset:0
  ds_read_b64_tr_b16 v[26:27], v10 offset:512
  s_waitcnt lgkmcnt(4)
  v_mfma_f32_16x16x32_bf16 v[128:131], v[16:19], a[0:3], 0
  s_lshr_b32 s42, s50, 1
  s_add_u32 s42, s42, 2
  ds_read_b64_tr_b16 v[28:29], v11 offset:0
  v_mfma_f32_16x16x32_bf16 v[132:135], v[16:19], a[4:7], 0
  s_and_b32 s42, s42, 7
  s_lshl_b32 s42, s42, 7
  ds_read_b64_tr_b16 v[30:31], v11 offset:512
  v_mfma_f32_16x16x32_bf16 v[136:139], v[16:19], a[8:11], 0
  s_add_u32 s44, s4, s42
  s_addc_u32 s45, s5, 0
  s_add_u32 m0, s32, 0
  v_mfma_f32_16x16x32_bf16 v[140:143], v[16:19], a[12:15], 0
  s_waitcnt lgkmcnt(4)
  global_load_lds_dwordx4 v48, s[44:45]
  v_mfma_f32_16x16x32_bf16 v[144:147], v[20:23], a[0:3], 0
  s_add_u32 m0, s32, 1024
  ds_read_b64_tr_b16 v[16:17], v8 offset:4096
  v_mfma_f32_16x16x32_bf16 v[148:151], v[20:23], a[4:7], 0
  ds_read_b64_tr_b16 v[18:19], v8 offset:4608
  v_mfma_f32_16x16x32_bf16 v[152:155], v[20:23], a[8:11], 0
  global_load_lds_dwordx4 v49, s[44:45]
  v_mfma_f32_16x16x32_bf16 v[156:159], v[20:23], a[12:15], 0
  s_waitcnt lgkmcnt(4)
  v_mfma_f32_16x16x32_bf16 v[160:163], v[24:27], a[0:3], 0
  s_add_u32 m0, s32, 2048
  ds_read_b64_tr_b16 v[20:21], v9 offset:4096
  v_mfma_f32_16x16x32_bf16 v[164:167], v[24:27], a[4:7], 0
  ds_read_b64_tr_b16 v[22:23], v9 offset:4608
  v_mfma_f32_16x16x32_bf16 v[168:171], v[24:27], a[8:11], 0
  global_load_lds_dwordx4 v50, s[44:45]
  v_mfma_f32_16x16x32_bf16 v[172:175], v[24:27], a[12:15], 0
  s_waitcnt lgkmcnt(4)
  v_mfma_f32_16x16x32_bf16 v[176:179], v[28:31], a[0:3], 0
  s_add_u32 m0, s32, 3072
  ds_read_b64_tr_b16 v[24:25], v10 offset:4096
  v_mfma_f32_16x16x32_bf16 v[180:183], v[28:31], a[4:7], 0
  ds_read_b64_tr_b16 v[26:27], v10 offset:4608
  v_mfma_f32_16x16x32_bf16 v[184:187], v[28:31], a[8:11], 0
  global_load_lds_dwordx4 v51, s[44:45]
  v_mfma_f32_16x16x32_bf16 v[188:191], v[28:31], a[12:15], 0
  s_waitcnt lgkmcnt(4)
  v_mfma_f32_16x16x32_bf16 v[192:195], v[16:19], a[0:3], 0
  s_add_u32 m0, s32, 4096
  ds_read_b64_tr_b16 v[28:29], v11 offset:4096
  v_mfma_f32_16x16x32_bf16 v[196:199], v[16:19], a[4:7], 0
  ds_read_b64_tr_b16 v[30:31], v11 offset:4608
  v_mfma_f32_16x16x32_bf16 v[200:203], v[16:19], a[8:11], 0
  global_load_lds_dwordx4 v52, s[44:45]
  v_mfma_f32_16x16x32_bf16 v[204:207], v[16:19], a[12:15], 0
  s_waitcnt lgkmcnt(4)
  v_mfma_f32_16x16x32_bf16 v[208:211], v[20:23], a[0:3], 0
  s_add_u32 m0, s32, 5120
  ds_read_b64_tr_b16 v[16:17], v8 offset:8192
  v_mfma_f32_16x16x32_bf16 v[212:215], v[20:23], a[4:7], 0
  ds_read_b64_tr_b16 v[18:19], v8 offset:8704
  v_mfma_f32_16x16x32_bf16 v[216:219], v[20:23], a[8:11], 0
  global_load_lds_dwordx4 v53, s[44:45]
  v_mfma_f32_16x16x32_bf16 v[220:223], v[20:23], a[12:15], 0
  s_waitcnt lgkmcnt(4)
  v_mfma_f32_16x16x32_bf16 v[224:227], v[24:27], a[0:3], 0
  s_add_u32 m0, s32, 6144
  ds_read_b64_tr_b16 v[20:21], v9 offset:8192
  v_mfma_f32_16x16x32_bf16 v[228:231], v[24:27], a[4:7], 0
  ds_read_b64_tr_b16 v[22:23], v9 offset:8704
  v_mfma_f32_16x16x32_bf16 v[232:235], v[24:27], a[8:11], 0
  global_load_lds_dwordx4 v54, s[44:45]
  v_mfma_f32_16x16x32_bf16 v[236:239], v[24:27], a[12:15], 0
  s_waitcnt lgkmcnt(4)
  v_mfma_f32_16x16x32_bf16 v[240:243], v[28:31], a[0:3], 0
  s_add_u32 m0, s32, 7168
  ds_read_b64_tr_b16 v[24:25], v10 offset:8192
  v_mfma_f32_16x16x32_bf16 v[244:247], v[28:31], a[4:7], 0
  ds_read_b64_tr_b16 v[26:27], v10 offset:8704
  v_mfma_f32_16x16x32_bf16 v[248:251], v[28:31], a[8:11], 0
  global_load_lds_dwordx4 v55, s[44:45]
  v_mfma_f32_16x16x32_bf16 v[252:255], v[28:31], a[12:15], 0
  s_waitcnt lgkmcnt(4)
  v_mfma_f32_16x16x32_bf16 v[128:131], v[16:19], a[16:19], v[128:131]
  ds_read_b64_tr_b16 v[28:29], v11 offset:8192
  s_waitcnt vmcnt(16)
  v_mfma_f32_16x16x32_bf16 v[132:135], v[16:19], a[20:23], v[132:135]
  ds_read_b64_tr_b16 v[30:31], v11 offset:8704
  ds_read_b128 a[32:35], v5 offset:8192
  v_mfma_f32_16x16x32_bf16 v[136:139], v[16:19], a[24:27], v[136:139]
  ds_read_b128 a[36:39], v5 offset:10240
  ds_read_b128 a[40:43], v5 offset:12288
  v_mfma_f32_16x16x32_bf16 v[140:143], v[16:19], a[28:31], v[140:143]
  s_waitcnt lgkmcnt(7)
  ds_read_b128 a[44:47], v5 offset:14336
  ds_read_b128 a[48:51], v6 offset:8192
  v_mfma_f32_16x16x32_bf16 v[144:147], v[20:23], a[16:19], v[144:147]
  ds_read_b64_tr_b16 v[16:17], v8 offset:12288
  ds_read_b128 a[52:55], v6 offset:10240
  v_mfma_f32_16x16x32_bf16 v[148:151], v[20:23], a[20:23], v[148:151]
  ds_read_b64_tr_b16 v[18:19], v8 offset:12800
  ds_read_b128 a[56:59], v6 offset:12288
  v_mfma_f32_16x16x32_bf16 v[152:155], v[20:23], a[24:27], v[152:155]
  ds_read_b128 a[60:63], v6 offset:14336
  v_mfma_f32_16x16x32_bf16 v[156:159], v[20:23], a[28:31], v[156:159]
  s_waitcnt lgkmcnt(12)
  v_mfma_f32_16x16x32_bf16 v[160:163], v[24:27], a[16:19], v[160:163]
  ds_read_b64_tr_b16 v[20:21], v9 offset:12288
  v_mfma_f32_16x16x32_bf16 v[164:167], v[24:27], a[20:23], v[164:167]
  ds_read_b64_tr_b16 v[22:23], v9 offset:12800
  v_mfma_f32_16x16x32_bf16 v[168:171], v[24:27], a[24:27], v[168:171]
  v_mfma_f32_16x16x32_bf16 v[172:175], v[24:27], a[28:31], v[172:175]
  s_waitcnt lgkmcnt(12)
  v_mfma_f32_16x16x32_bf16 v[176:179], v[28:31], a[16:19], v[176:179]
  ds_read_b64_tr_b16 v[24:25], v10 offset:12288
  v_mfma_f32_16x16x32_bf16 v[180:183], v[28:31], a[20:23], v[180:183]
  ds_read_b64_tr_b16 v[26:27], v10 offset:12800
  v_mfma_f32_16x16x32_bf16 v[184:187], v[28:31], a[24:27], v[184:187]
  v_mfma_f32_16x16x32_bf16 v[188:191], v[28:31], a[28:31], v[188:191]
  s_waitcnt lgkmcnt(6)
  v_mfma_f32_16x16x32_bf16 v[192:195], v[16:19], a[16:19], v[192:195]
  ds_read_b64_tr_b16 v[28:29], v11 offset:12288
  v_mfma_f32_16x16x32_bf16 v[196:199], v[16:19], a[20:23], v[196:199]
  ds_read_b64_tr_b16 v[30:31], v11 offset:12800
  v_mfma_f32_16x16x32_bf16 v[200:203], v[16:19], a[24:27], v[200:203]
  v_mfma_f32_16x16x32_bf16 v[204:207], v[16:19], a[28:31], v[204:207]
  s_waitcnt lgkmcnt(4)
  v_mfma_f32_16x16x32_bf16 v[208:211], v[20:23], a[16:19], v[208:211]
  ds_read_b64_tr_b16 v[16:17], v8 offset:16384
  v_mfma_f32_16x16x32_bf16 v[212:215], v[20:23], a[20:23], v[212:215]
  ds_read_b64_tr_b16 v[18:19], v8 offset:16896
  v_mfma_f32_16x16x32_bf16 v[216:219], v[20:23], a[24:27], v[216:219]
  v_mfma_f32_16x16x32_bf16 v[220:223], v[20:23], a[28:31], v[220:223]
  s_waitcnt lgkmcnt(4)
  v_mfma_f32_16x16x32_bf16 v[224:227], v[24:27], a[16:19], v[224:227]
  ds_read_b64_tr_b16 v[20:21], v9 offset:16384
  v_mfma_f32_16x16x32_bf16 v[228:231], v[24:27], a[20:23], v[228:231]
  ds_read_b64_tr_b16 v[22:23], v9 offset:16896
  v_mfma_f32_16x16x32_bf16 v[232:235], v[24:27], a[24:27], v[232:235]
  v_mfma_f32_16x16x32_bf16 v[236:239], v[24:27], a[28:31], v[236:239]
  s_waitcnt lgkmcnt(4)
  v_mfma_f32_16x16x32_bf16 v[240:243], v[28:31], a[16:19], v[240:243]
  ds_read_b64_tr_b16 v[24:25], v10 offset:16384
  v_mfma_f32_16x16x32_bf16 v[244:247], v[28:31], a[20:23], v[244:247]
  s_lshr_b32 s42, s50, 1
  s_add_u32 s42, s42, 3
  ds_read_b64_tr_b16 v[26:27], v10 offset:16896
  v_mfma_f32_16x16x32_bf16 v[248:251], v[28:31], a[24:27], v[248:251]
  s_and_b32 s42, s42, 7
  s_lshl_b32 s42, s42, 7
  v_mfma_f32_16x16x32_bf16 v[252:255], v[28:31], a[28:31], v[252:255]
  s_waitcnt lgkmcnt(4)
  s_waitcnt lgkmcnt(12)
  v_mfma_f32_16x16x32_bf16 v[128:131], v[16:19], a[32:35], v[128:131]
  s_add_u32 s46, s4, s42
  s_addc_u32 s47, s5, 0
  ds_read_b64_tr_b16 v[28:29], v11 offset:16384
  v_mfma_f32_16x16x32_bf16 v[132:135], v[16:19], a[36:39], v[132:135]
  s_add_u32 m0, s32, 8192
  ds_read_b64_tr_b16 v[30:31], v11 offset:16896
  v_mfma_f32_16x16x32_bf16 v[136:139], v[16:19], a[40:43], v[136:139]
  global_load_lds_dwordx4 v48, s[46:47]
  v_mfma_f32_16x16x32_bf16 v[140:143], v[16:19], a[44:47], v[140:143]
  s_waitcnt lgkmcnt(4)
  v_mfma_f32_16x16x32_bf16 v[144:147], v[20:23], a[32:35], v[144:147]
  s_add_u32 m0, s32, 9216
  ds_read_b64_tr_b16 v[16:17], v8 offset:20480
  v_mfma_f32_16x16x32_bf16 v[148:151], v[20:23], a[36:39], v[148:151]
  ds_read_b64_tr_b16 v[18:19], v8 offset:20992
  v_mfma_f32_16x16x32_bf16 v[152:155], v[20:23], a[40:43], v[152:155]
  global_load_lds_dwordx4 v49, s[46:47]
  v_mfma_f32_16x16x32_bf16 v[156:159], v[20:23], a[44:47], v[156:159]
  s_waitcnt lgkmcnt(4)
  v_mfma_f32_16x16x32_bf16 v[160:163], v[24:27], a[32:35], v[160:163]
  s_add_u32 m0, s32, 10240
  ds_read_b64_tr_b16 v[20:21], v9 offset:20480
  v_mfma_f32_16x16x32_bf16 v[164:167], v[24:27], a[36:39], v[164:167]
  ds_read_b64_tr_b16 v[22:23], v9 offset:20992
  v_mfma_f32_16x16x32_bf16 v[168:171], v[24:27], a[40:43], v[168:171]
  global_load_lds_dwordx4 v50, s[46:47]
  v_mfma_f32_16x16x32_bf16 v[172:175], v[24:27], a[44:47], v[172:175]
  s_waitcnt lgkmcnt(4)
  v_mfma_f32_16x16x32_bf16 v[176:179], v[28:31], a[32:35], v[176:179]
  s_add_u32 m0, s32, 11264
  ds_read_b64_tr_b16 v[24:25], v10 offset:20480
  v_mfma_f32_16x16x32_bf16 v[180:183], v[28:31], a[36:39], v[180:183]
  ds_read_b64_tr_b16 v[26:27], v10 offset:20992
  v_mfma_f32_16x16x32_bf16 v[184:187], v[28:31], a[40:43], v[184:187]
  global_load_lds_dwordx4 v51, s[46:47]
  v_mfma_f32_16x16x32_bf16 v[188:191], v[28:31], a[44:47], v[188:191]
  s_waitcnt lgkmcnt(4)
  v_mfma_f32_16x16x32_bf16 v[192:195], v[16:19], a[32:35], v[192:195]
  s_add_u32 m0, s32, 12288
  ds_read_b64_tr_b16 v[28:29], v11 offset:20480
  v_mfma_f32_16x16x32_bf16 v[196:199], v[16:19], a[36:39], v[196:199]
  ds_read_b64_tr_b16 v[30:31], v11 offset:20992
  v_mfma_f32_16x16x32_bf16 v[200:203], v[16:19], a[40:43], v[200:203]
  global_load_lds_dwordx4 v52, s[46:47]
  v_mfma_f32_16x16x32_bf16 v[204:207], v[16:19], a[44:47], v[204:207]
  s_waitcnt lgkmcnt(4)
  v_mfma_f32_16x16x32_bf16 v[208:211], v[20:23], a[32:35], v[208:211]
  s_add_u32 m0, s32, 13312
  ds_read_b64_tr_b16 v[16:17], v8 offset:24576
  v_mfma_f32_16x16x32_bf16 v[212:215], v[20:23], a[36:39], v[212:215]
  ds_read_b64_tr_b16 v[18:19], v8 offset:25088
  v_mfma_f32_16x16x32_bf16 v[216:219], v[20:23], a[40:43], v[216:219]
  global_load_lds_dwordx4 v53, s[46:47]
  v_mfma_f32_16x16x32_bf16 v[220:223], v[20:23], a[44:47], v[220:223]
  s_waitcnt lgkmcnt(4)
  v_mfma_f32_16x16x32_bf16 v[224:227], v[24:27], a[32:35], v[224:227]
  s_add_u32 m0, s32, 14336
  ds_read_b64_tr_b16 v[20:21], v9 offset:24576
  v_mfma_f32_16x16x32_bf16 v[228:231], v[24:27], a[36:39], v[228:231]
  ds_read_b64_tr_b16 v[22:23], v9 offset:25088
  v_mfma_f32_16x16x32_bf16 v[232:235], v[24:27], a[40:43], v[232:235]
  global_load_lds_dwordx4 v54, s[46:47]
  v_mfma_f32_16x16x32_bf16 v[236:239], v[24:27], a[44:47], v[236:239]
  s_waitcnt lgkmcnt(4)
  v_mfma_f32_16x16x32_bf16 v[240:243], v[28:31], a[32:35], v[240:243]
  s_add_u32 m0, s32, 15360
  ds_read_b64_tr_b16 v[24:25], v10 offset:24576
  v_mfma_f32_16x16x32_bf16 v[244:247], v[28:31], a[36:39], v[244:247]
  ds_read_b64_tr_b16 v[26:27], v10 offset:25088
  v_mfma_f32_16x16x32_bf16 v[248:251], v[28:31], a[40:43], v[248:251]
  global_load_lds_dwordx4 v55, s[46:47]
  v_mfma_f32_16x16x32_bf16 v[252:255], v[28:31], a[44:47], v[252:255]
  s_waitcnt lgkmcnt(4)
  v_mfma_f32_16x16x32_bf16 v[128:131], v[16:19], a[48:51], v[128:131]
  ds_read_b64_tr_b16 v[28:29], v11 offset:24576
  s_waitcnt vmcnt(8)
  v_mfma_f32_16x16x32_bf16 v[132:135], v[16:19], a[52:55], v[132:135]
  ds_read_b64_tr_b16 v[30:31], v11 offset:25088
  ds_read_b128 a[64:67], v5 offset:0
  v_mfma_f32_16x16x32_bf16 v[136:139], v[16:19], a[56:59], v[136:139]
  ds_read_b128 a[68:71], v5 offset:2048
  ds_read_b128 a[72:75], v5 offset:4096
  v_mfma_f32_16x16x32_bf16 v[140:143], v[16:19], a[60:63], v[140:143]
  s_waitcnt lgkmcnt(7)
  ds_read_b128 a[76:79], v5 offset:6144
  ds_read_b128 a[80:83], v6 offset:0
  v_mfma_f32_16x16x32_bf16 v[144:147], v[20:23], a[48:51], v[144:147]
  ds_read_b64_tr_b16 v[16:17], v8 offset:28672
  ds_read_b128 a[84:87], v6 offset:2048
  v_mfma_f32_16x16x32_bf16 v[148:151], v[20:23], a[52:55], v[148:151]
  ds_read_b64_tr_b16 v[18:19], v8 offset:29184
  ds_read_b128 a[88:91], v6 offset:4096
  v_mfma_f32_16x16x32_bf16 v[152:155], v[20:23], a[56:59], v[152:155]
  ds_read_b128 a[92:95], v6 offset:6144
  v_mfma_f32_16x16x32_bf16 v[156:159], v[20:23], a[60:63], v[156:159]
  s_waitcnt lgkmcnt(12)
  v_mfma_f32_16x16x32_bf16 v[160:163], v[24:27], a[48:51], v[160:163]
  ds_read_b64_tr_b16 v[20:21], v9 offset:28672
  v_mfma_f32_16x16x32_bf16 v[164:167], v[24:27], a[52:55], v[164:167]
  ds_read_b64_tr_b16 v[22:23], v9 offset:29184
  v_mfma_f32_16x16x32_bf16 v[168:171], v[24:27], a[56:59], v[168:171]
  v_mfma_f32_16x16x32_bf16 v[172:175], v[24:27], a[60:63], v[172:175]
  s_waitcnt lgkmcnt(12)
  v_mfma_f32_16x16x32_bf16 v[176:179], v[28:31], a[48:51], v[176:179]
  ds_read_b64_tr_b16 v[24:25], v10 offset:28672
  v_mfma_f32_16x16x32_bf16 v[180:183], v[28:31], a[52:55], v[180:183]
  ds_read_b64_tr_b16 v[26:27], v10 offset:29184
  v_mfma_f32_16x16x32_bf16 v[184:187], v[28:31], a[56:59], v[184:187]
  v_mfma_f32_16x16x32_bf16 v[188:191], v[28:31], a[60:63], v[188:191]
  s_waitcnt lgkmcnt(6)
  v_mfma_f32_16x16x32_bf16 v[192:195], v[16:19], a[48:51], v[192:195]
  ds_read_b64_tr_b16 v[28:29], v11 offset:28672
  v_mfma_f32_16x16x32_bf16 v[196:199], v[16:19], a[52:55], v[196:199]
  ds_read_b64_tr_b16 v[30:31], v11 offset:29184
  v_mfma_f32_16x16x32_bf16 v[200:203], v[16:19], a[56:59], v[200:203]
  v_mfma_f32_16x16x32_bf16 v[204:207], v[16:19], a[60:63], v[204:207]
  s_waitcnt lgkmcnt(4)
  v_mfma_f32_16x16x32_bf16 v[208:211], v[20:23], a[48:51], v[208:211]
  s_waitcnt vmcnt(32)
  s_nop 0
  v_readfirstlane_b32 s71, v63
  s_nop 0
  s_cmp_lg_u32 s71, 0
  s_cbranch_scc0 L_spin1
L_back1:
  s_nop 0
  s_waitcnt vmcnt(16)
  s_barrier
  v_mfma_f32_16x16x32_bf16 v[212:215], v[20:23], a[52:55], v[212:215]
  ds_read_b64_tr_b16 v[16:17], v8 offset:32768
  v_mfma_f32_16x16x32_bf16 v[216:219], v[20:23], a[56:59], v[216:219]
  ds_read_b64_tr_b16 v[18:19], v8 offset:33280
  v_mfma_f32_16x16x32_bf16 v[220:223], v[20:23], a[60:63], v[220:223]
  s_waitcnt lgkmcnt(4)
  s_add_u32 s24, s6, 2097152
  s_addc_u32 s25, s7, 0
  v_mfma_f32_16x16x32_bf16 v[224:227], v[24:27], a[48:51], v[224:227]
  s_add_u32 m0, s23, 65536
  ds_read_b64_tr_b16 v[20:21], v9 offset:32768
  v_mfma_f32_16x16x32_bf16 v[228:231], v[24:27], a[52:55], v[228:231]
  ds_read_b64_tr_b16 v[22:23], v9 offset:33280
  v_mfma_f32_16x16x32_bf16 v[232:235], v[24:27], a[56:59], v[232:235]
  global_load_lds_dwordx4 v2, s[24:25]
  v_mfma_f32_16x16x32_bf16 v[236:239], v[24:27], a[60:63], v[236:239]
  s_waitcnt lgkmcnt(4)
  s_add_u32 s26, s6, 2097280
  s_addc_u32 s27, s7, 0
  v_mfma_f32_16x16x32_bf16 v[240:243], v[28:31], a[48:51], v[240:243]
  s_add_u32 m0, s23, 69632
  ds_read_b64_tr_b16 v[24:25], v10 offset:32768
  v_mfma_f32_16x16x32_bf16 v[244:247], v[28:31], a[52:55], v[244:247]
  ds_read_b64_tr_b16 v[26:27], v10 offset:33280
  v_mfma_f32_16x16x32_bf16 v[248:251], v[28:31], a[56:59], v[248:251]
  global_load_lds_dwordx4 v2, s[26:27]
  v_mfma_f32_16x16x32_bf16 v[252:255], v[28:31], a[60:63], v[252:255]
  s_waitcnt lgkmcnt(4)
  s_waitcnt lgkmcnt(12)
  v_mfma_f32_16x16x32_bf16 v[128:131], v[16:19], a[64:67], v[128:131]
  s_add_u32 s24, s6, 2359296
  s_addc_u32 s25, s7, 0
  ds_read_b64_tr_b16 v[28:29], v11 offset:32768
  v_mfma_f32_16x16x32_bf16 v[132:135], v[16:19], a[68:71], v[132:135]
  s_add_u32 m0, s23, 73728
  ds_read_b64_tr_b16 v[30:31], v11 offset:33280
  v_mfma_f32_16x16x32_bf16 v[136:139], v[16:19], a[72:75], v[136:139]
  global_load_lds_dwordx4 v2, s[24:25]
  v_mfma_f32_16x16x32_bf16 v[140:143], v[16:19], a[76:79], v[140:143]
  s_waitcnt lgkmcnt(4)
  s_lshr_b32 s42, s50, 1
  s_add_u32 s42, s42, 4
  v_mfma_f32_16x16x32_bf16 v[144:147], v[20:23], a[64:67], v[144:147]
  s_and_b32 s42, s42, 7
  s_lshl_b32 s42, s42, 7
  ds_read_b64_tr_b16 v[16:17], v8 offset:36864
  v_mfma_f32_16x16x32_bf16 v[148:151], v[20:23], a[68:71], v[148:151]
  s_add_u32 s44, s4, s42
  s_addc_u32 s45, s5, 0
  s_add_u32 m0, s32, 0
  ds_read_b64_tr_b16 v[18:19], v8 offset:37376
  v_mfma_f32_16x16x32_bf16 v[152:155], v[20:23], a[72:75], v[152:155]
  global_load_lds_dwordx4 v48, s[44:45]
  v_mfma_f32_16x16x32_bf16 v[156:159], v[20:23], a[76:79], v[156:159]
  s_waitcnt lgkmcnt(4)
  s_add_u32 s26, s6, 2359424
  s_addc_u32 s27, s7, 0
  v_mfma_f32_16x16x32_bf16 v[160:163], v[24:27], a[64:67], v[160:163]
  s_add_u32 m0, s23, 77824
  ds_read_b64_tr_b16 v[20:21], v9 offset:36864
  v_mfma_f32_16x16x32_bf16 v[164:167], v[24:27], a[68:71], v[164:167]
  ds_read_b64_tr_b16 v[22:23], v9 offset:37376
  v_mfma_f32_16x16x32_bf16 v[168:171], v[24:27], a[72:75], v[168:171]
  global_load_lds_dwordx4 v2, s[26:27]
  v_mfma_f32_16x16x32_bf16 v[172:175], v[24:27], a[76:79], v[172:175]
  s_waitcnt lgkmcnt(4)
  v_mfma_f32_16x16x32_bf16 v[176:179], v[28:31], a[64:67], v[176:179]
  s_add_u32 m0, s32, 1024
  ds_read_b64_tr_b16 v[24:25], v10 offset:36864
  v_mfma_f32_16x16x32_bf16 v[180:183], v[28:31], a[68:71], v[180:183]
  ds_read_b64_tr_b16 v[26:27], v10 offset:37376
  v_mfma_f32_16x16x32_bf16 v[184:187], v[28:31], a[72:75], v[184:187]
  global_load_lds_dwordx4 v49, s[44:45]
  v_mfma_f32_16x16x32_bf16 v[188:191], v[28:31], a[76:79], v[188:191]
  s_waitcnt lgkmcnt(4)
  s_add_u32 s24, s6, 2621440
  s_addc_u32 s25, s7, 0
  v_mfma_f32_16x16x32_bf16 v[192:195], v[16:19], a[64:67], v[192:195]
  s_add_u32 m0, s23, 81920
  ds_read_b64_tr_b16 v[28:29], v11 offset:36864
  v_mfma_f32_16x16x32_bf16 v[196:199], v[16:19], a[68:71], v[196:199]
  ds_read_b64_tr_b16 v[30:31], v11 offset:37376
  v_mfma_f32_16x16x32_bf16 v[200:203], v[16:19], a[72:75], v[200:203]
  global_load_lds_dwordx4 v2, s[24:25]
  v_mfma_f32_16x16x32_bf16 v[204:207], v[16:19], a[76:79], v[204:207]
  s_waitcnt lgkmcnt(4)
  v_mfma_f32_16x16x32_bf16 v[208:211], v[20:23], a[64:67], v[208:211]
  s_add_u32 m0, s32, 2048
  ds_read_b64_tr_b16 v[16:17], v8 offset:40960
  v_mfma_f32_16x16x32_bf16 v[212:215], v[20:23], a[68:71], v[212:215]
  ds_read_b64_tr_b16 v[18:19], v8 offset:41472
  v_mfma_f32_16x16x32_bf16 v[216:219], v[20:23], a[72:75], v[216:219]
  global_load_lds_dwordx4 v50, s[44:45]
  v_mfma_f32_16x16x32_bf16 v[220:223], v[20:23], a[76:79], v[220:223]
  s_waitcnt lgkmcnt(4)
  v_mfma_f32_16x16x32_bf16 v[224:227], v[24:27], a[64:67], v[224:227]
  s_add_u32 m0, s32, 3072
  ds_read_b64_tr_b16 v[20:21], v9 offset:40960
  v_mfma_f32_16x16x32_bf16 v[228:231], v[24:27], a[68:71], v[228:231]
  ds_read_b64_tr_b16 v[22:23], v9 offset:41472
  v_mfma_f32_16x16x32_bf16 v[232:235], v[24:27], a[72:75], v[232:235]
  global_load_lds_dwordx4 v51, s[44:45]
  v_mfma_f32_16x16x32_bf16 v[236:239], v[24:27], a[76:79], v[236:239]
  s_waitcnt lgkmcnt(4)
  s_add_u32 s26, s6, 2621568
  s_addc_u32 s27, s7, 0
  v_mfma_f32_16x16x32_bf16 v[240:243], v[28:31], a[64:67], v[240:243]
  s_add_u32 m0, s23, 86016
  ds_read_b64_tr_b16 v[24:25], v10 offset:40960
  v_mfma_f32_16x16x32_bf16 v[244:247], v[28:31], a[68:71], v[244:247]
  ds_read_b64_tr_b16 v[26:27], v10 offset:41472
  v_mfma_f32_16x16x32_bf16 v[248:251], v[28:31], a[72:75], v[248:251]
  global_load_lds_dwordx4 v2, s[26:27]
  v_mfma_f32_16x16x32_bf16 v[252:255], v[28:31], a[76:79], v[252:255]
  s_waitcnt lgkmcnt(4)
  v_mfma_f32_16x16x32_bf16 v[128:131], v[16:19], a[80:83], v[128:131]
  s_add_u32 m0, s32, 4096
  ds_read_b64_tr_b16 v[28:29], v11 offset:40960
  s_waitcnt vmcnt(10)
  v_mfma_f32_16x16x32_bf16 v[132:135], v[16:19], a[84:87], v[132:135]
  ds_read_b64_tr_b16 v[30:31], v11 offset:41472
  ds_read_b128 a[96:99], v5 offset:8192
  v_mfma_f32_16x16x32_bf16 v[136:139], v[16:19], a[88:91], v[136:139]
  global_load_lds_dwordx4 v52, s[44:45]
  ds_read_b128 a[100:103], v5 offset:10240
  v_mfma_f32_16x16x32_bf16 v[140:143], v[16:19], a[92:95], v[140:143]
  s_waitcnt lgkmcnt(6)
  s_add_u32 s24, s6, 2883584
  s_addc_u32 s25, s7, 0
  v_mfma_f32_16x16x32_bf16 v[144:147], v[20:23], a[80:83], v[144:147]
  s_add_u32 m0, s23, 90112
  ds_read_b64_tr_b16 v[16:17], v8 offset:45056
  ds_read_b128 a[104:107], v5 offset:12288
  v_mfma_f32_16x16x32_bf16 v[148:151], v[20:23], a[84:87], v[148:151]
  ds_read_b64_tr_b16 v[18:19], v8 offset:45568
  ds_read_b128 a[108:111], v5 offset:14336
  v_mfma_f32_16x16x32_bf16 v[152:155], v[20:23], a[88:91], v[152:155]
  global_load_lds_dwordx4 v2, s[24:25]
  ds_read_b128 a[112:115], v6 offset:8192
  v_mfma_f32_16x16x32_bf16 v[156:159], v[20:23], a[92:95], v[156:159]
  s_waitcnt lgkmcnt(9)
  ds_read_b128 a[116:119], v6 offset:10240
  ds_read_b128 a[120:123], v6 offset:12288
  v_mfma_f32_16x16x32_bf16 v[160:163], v[24:27], a[80:83], v[160:163]
  s_add_u32 m0, s32, 5120
  ds_read_b64_tr_b16 v[20:21], v9 offset:45056
  ds_read_b128 a[124:127], v6 offset:14336
  v_mfma_f32_16x16x32_bf16 v[164:167], v[24:27], a[84:87], v[164:167]
  ds_read_b64_tr_b16 v[22:23], v9 offset:45568
  v_mfma_f32_16x16x32_bf16 v[168:171], v[24:27], a[88:91], v[168:171]
  global_load_lds_dwordx4 v53, s[44:45]
  v_mfma_f32_16x16x32_bf16 v[172:175], v[24:27], a[92:95], v[172:175]
  s_waitcnt lgkmcnt(12)
  s_add_u32 s26, s6, 2883712
  s_addc_u32 s27, s7, 0
  v_mfma_f32_16x16x32_bf16 v[176:179], v[28:31], a[80:83], v[176:179]
  s_add_u32 m0, s23, 94208
  ds_read_b64_tr_b16 v[24:25], v10 offset:45056
  v_mfma_f32_16x16x32_bf16 v[180:183], v[28:31], a[84:87], v[180:183]
  ds_read_b64_tr_b16 v[26:27], v10 offset:45568
  v_mfma_f32_16x16x32_bf16 v[184:187], v[28:31], a[88:91], v[184:187]
  global_load_lds_dwordx4 v2, s[26:27]
  v_mfma_f32_16x16x32_bf16 v[188:191], v[28:31], a[92:95], v[188:191]
  s_waitcnt lgkmcnt(9)
  v_mfma_f32_16x16x32_bf16 v[192:195], v[16:19], a[80:83], v[192:195]
  s_add_u32 m0, s32, 6144
  ds_read_b64_tr_b16 v[28:29], v11 offset:45056
  v_mfma_f32_16x16x32_bf16 v[196:199], v[16:19], a[84:87], v[196:199]
  ds_read_b64_tr_b16 v[30:31], v11 offset:45568
  v_mfma_f32_16x16x32_bf16 v[200:203], v[16:19], a[88:91], v[200:203]
  global_load_lds_dwordx4 v54, s[44:45]
  v_mfma_f32_16x16x32_bf16 v[204:207], v[16:19], a[92:95], v[204:207]
  s_waitcnt lgkmcnt(4)
  v_mfma_f32_16x16x32_bf16 v[208:211], v[20:23], a[80:83], v[208:211]
  s_add_u32 m0, s32, 7168
  ds_read_b64_tr_b16 v[16:17], v8 offset:49152
  v_mfma_f32_16x16x32_bf16 v[212:215], v[20:23], a[84:87], v[212:215]
  ds_read_b64_tr_b16 v[18:19], v8 offset:49664
  v_mfma_f32_16x16x32_bf16 v[216:219], v[20:23], a[88:91], v[216:219]
  global_load_lds_dwordx4 v55, s[44:45]
  v_mfma_f32_16x16x32_bf16 v[220:223], v[20:23], a[92:95], v[220:223]
  s_waitcnt lgkmcnt(4)
  v_mfma_f32_16x16x32_bf16 v[224:227], v[24:27], a[80:83], v[224:227]
  ds_read_b64_tr_b16 v[20:21], v9 offset:49152
  v_mfma_f32_16x16x32_bf16 v[228:231], v[24:27], a[84:87], v[228:231]
  ds_read_b64_tr_b16 v[22:23], v9 offset:49664
  v_mfma_f32_16x16x32_bf16 v[232:235], v[24:27], a[88:91], v[232:235]
  v_mfma_f32_16x16x32_bf16 v[236:239], v[24:27], a[92:95], v[236:239]
  s_waitcnt lgkmcnt(4)
  v_mfma_f32_16x16x32_bf16 v[240:243], v[28:31], a[80:83], v[240:243]
  ds_read_b64_tr_b16 v[24:25], v10 offset:49152
  v_mfma_f32_16x16x32_bf16 v[244:247], v[28:31], a[84:87], v[244:247]
  s_lshr_b32 s42, s50, 1
  s_add_u32 s42, s42, 5
  ds_read_b64_tr_b16 v[26:27], v10 offset:49664
  v_mfma_f32_16x16x32_bf16 v[248:251], v[28:31], a[88:91], v[248:251]
  s_and_b32 s42, s42, 7
  s_lshl_b32 s42, s42, 7
  v_mfma_f32_16x16x32_bf16 v[252:255], v[28:31], a[92:95], v[252:255]
  s_waitcnt lgkmcnt(4)
  s_waitcnt lgkmcnt(11)
  v_mfma_f32_16x16x32_bf16 v[128:131], v[16:19], a[96:99], v[128:131]
  s_add_u32 s46, s4, s42
  s_addc_u32 s47, s5, 0
  ds_read_b64_tr_b16 v[28:29], v11 offset:49152
  v_mfma_f32_16x16x32_bf16 v[132:135], v[16:19], a[100:103], v[132:135]
  s_add_u32 m0, s32, 8192
  ds_read_b64_tr_b16 v[30:31], v11 offset:49664
  v_mfma_f32_16x16x32_bf16 v[136:139], v[16:19], a[104:107], v[136:139]
  global_load_lds_dwordx4 v48, s[46:47]
  v_mfma_f32_16x16x32_bf16 v[140:143], v[16:19], a[108:111], v[140:143]
  s_waitcnt lgkmcnt(4)
  v_mfma_f32_16x16x32_bf16 v[144:147], v[20:23], a[96:99], v[144:147]
  s_add_u32 m0, s32, 9216
  ds_read_b64_tr_b16 v[16:17], v8 offset:53248
  v_mfma_f32_16x16x32_bf16 v[148:151], v[20:23], a[100:103], v[148:151]
  ds_read_b64_tr_b16 v[18:19], v8 offset:53760
  v_mfma_f32_16x16x32_bf16 v[152:155], v[20:23], a[104:107], v[152:155]
  global_load_lds_dwordx4 v49, s[46:47]
  v_mfma_f32_16x16x32_bf16 v[156:159], v[20:23], a[108:111], v[156:159]
  s_waitcnt lgkmcnt(4)
  v_mfma_f32_16x16x32_bf16 v[160:163], v[24:27], a[96:99], v[160:163]
  s_add_u32 m0, s32, 10240
  ds_read_b64_tr_b16 v[20:21], v9 offset:53248
  v_mfma_f32_16x16x32_bf16 v[164:167], v[24:27], a[100:103], v[164:167]
  ds_read_b64_tr_b16 v[22:23], v9 offset:53760
  v_mfma_f32_16x16x32_bf16 v[168:171], v[24:27], a[104:107], v[168:171]
  global_load_lds_dwordx4 v50, s[46:47]
  v_mfma_f32_16x16x32_bf16 v[172:175], v[24:27], a[108:111], v[172:175]
  s_waitcnt lgkmcnt(4)
  v_mfma_f32_16x16x32_bf16 v[176:179], v[28:31], a[96:99], v[176:179]
  s_add_u32 m0, s32, 11264
  ds_read_b64_tr_b16 v[24:25], v10 offset:53248
  v_mfma_f32_16x16x32_bf16 v[180:183], v[28:31], a[100:103], v[180:183]
  ds_read_b64_tr_b16 v[26:27], v10 offset:53760
  v_mfma_f32_16x16x32_bf16 v[184:187], v[28:31], a[104:107], v[184:187]
  global_load_lds_dwordx4 v51, s[46:47]
  v_mfma_f32_16x16x32_bf16 v[188:191], v[28:31], a[108:111], v[188:191]
  s_waitcnt lgkmcnt(4)
  v_mfma_f32_16x16x32_bf16 v[192:195], v[16:19], a[96:99], v[192:195]
  s_add_u32 m0, s32, 12288
  ds_read_b64_tr_b16 v[28:29], v11 offset:53248
  v_mfma_f32_16x16x32_bf16 v[196:199], v[16:19], a[100:103], v[196:199]
  ds_read_b64_tr_b16 v[30:31], v11 offset:53760
  v_mfma_f32_16x16x32_bf16 v[200:203], v[16:19], a[104:107], v[200:203]
  global_load_lds_dwordx4 v52, s[46:47]
  v_mfma_f32_16x16x32_bf16 v[204:207], v[16:19], a[108:111], v[204:207]
  s_waitcnt lgkmcnt(4)
  v_mfma_f32_16x16x32_bf16 v[208:211], v[20:23], a[96:99], v[208:211]
  s_add_u32 m0, s32, 13312
  ds_read_b64_tr_b16 v[16:17], v8 offset:57344
  v_mfma_f32_16x16x32_bf16 v[212:215], v[20:23], a[100:103], v[212:215]
  ds_read_b64_tr_b16 v[18:19], v8 offset:57856
  v_mfma_f32_16x16x32_bf16 v[216:219], v[20:23], a[104:107], v[216:219]
  global_load_lds_dwordx4 v53, s[46:47]
  v_mfma_f32_16x16x32_bf16 v[220:223], v[20:23], a[108:111], v[220:223]
  s_waitcnt lgkmcnt(4)
  v_mfma_f32_16x16x32_bf16 v[224:227], v[24:27], a[96:99], v[224:227]
  s_add_u32 m0, s32, 14336
  ds_read_b64_tr_b16 v[20:21], v9 offset:57344
  v_mfma_f32_16x16x32_bf16 v[228:231], v[24:27], a[100:103], v[228:231]
  ds_read_b64_tr_b16 v[22:23], v9 offset:57856
  v_mfma_f32_16x16x32_bf16 v[232:235], v[24:27], a[104:107], v[232:235]
  global_load_lds_dwordx4 v54, s[46:47]
  v_mfma_f32_16x16x32_bf16 v[236:239], v[24:27], a[108:111], v[236:239]
  s_waitcnt lgkmcnt(4)
  v_mfma_f32_16x16x32_bf16 v[240:243], v[28:31], a[96:99], v[240:243]
  s_add_u32 m0, s32, 15360
  ds_read_b64_tr_b16 v[24:25], v10 offset:57344
  v_mfma_f32_16x16x32_bf16 v[244:247], v[28:31], a[100:103], v[244:247]
  ds_read_b64_tr_b16 v[26:27], v10 offset:57856
  v_mfma_f32_16x16x32_bf16 v[248:251], v[28:31], a[104:107], v[248:251]
  global_load_lds_dwordx4 v55, s[46:47]
  v_mfma_f32_16x16x32_bf16 v[252:255], v[28:31], a[108:111], v[252:255]
  s_waitcnt lgkmcnt(4)
  v_mfma_f32_16x16x32_bf16 v[128:131], v[16:19], a[112:115], v[128:131]
  ds_read_b64_tr_b16 v[28:29], v11 offset:57344
  s_waitcnt vmcnt(8)
  v_mfma_f32_16x16x32_bf16 v[132:135], v[16:19], a[116:119], v[132:135]
  ds_read_b64_tr_b16 v[30:31], v11 offset:57856
  ds_read_b128 a[128:131], v5 offset:0
  v_mfma_f32_16x16x32_bf16 v[136:139], v[16:19], a[120:123], v[136:139]
  ds_read_b128 a[132:135], v5 offset:2048
  ds_read_b128 a[136:139], v5 offset:4096
  v_mfma_f32_16x16x32_bf16 v[140:143], v[16:19], a[124:127], v[140:143]
  s_waitcnt lgkmcnt(7)
  ds_read_b128 a[140:143], v5 offset:6144
  ds_read_b128 a[144:147], v6 offset:0
  v_mfma_f32_16x16x32_bf16 v[144:147], v[20:23], a[112:115], v[144:147]
  ds_read_b64_tr_b16 v[16:17], v8 offset:61440
  ds_read_b128 a[148:151], v6 offset:2048
  v_mfma_f32_16x16x32_bf16 v[148:151], v[20:23], a[116:119], v[148:151]
  ds_read_b64_tr_b16 v[18:19], v8 offset:61952
  ds_read_b128 a[152:155], v6 offset:4096
  v_mfma_f32_16x16x32_bf16 v[152:155], v[20:23], a[120:123], v[152:155]
  ds_read_b128 a[156:159], v6 offset:6144
  v_mfma_f32_16x16x32_bf16 v[156:159], v[20:23], a[124:127], v[156:159]
  s_waitcnt lgkmcnt(12)
  v_mfma_f32_16x16x32_bf16 v[160:163], v[24:27], a[112:115], v[160:163]
  ds_read_b64_tr_b16 v[20:21], v9 offset:61440
  v_mfma_f32_16x16x32_bf16 v[164:167], v[24:27], a[116:119], v[164:167]
  ds_read_b64_tr_b16 v[22:23], v9 offset:61952
  v_mfma_f32_16x16x32_bf16 v[168:171], v[24:27], a[120:123], v[168:171]
  v_mfma_f32_16x16x32_bf16 v[172:175], v[24:27], a[124:127], v[172:175]
  s_waitcnt lgkmcnt(12)
  v_mfma_f32_16x16x32_bf16 v[176:179], v[28:31], a[112:115], v[176:179]
  ds_read_b64_tr_b16 v[24:25], v10 offset:61440
  v_mfma_f32_16x16x32_bf16 v[180:183], v[28:31], a[116:119], v[180:183]
  ds_read_b64_tr_b16 v[26:27], v10 offset:61952
  v_mfma_f32_16x16x32_bf16 v[184:187], v[28:31], a[120:123], v[184:187]
  v_mfma_f32_16x16x32_bf16 v[188:191], v[28:31], a[124:127], v[188:191]
  s_waitcnt lgkmcnt(6)
  v_mfma_f32_16x16x32_bf16 v[192:195], v[16:19], a[112:115], v[192:195]
  ds_read_b64_tr_b16 v[28:29], v11 offset:61440
  v_mfma_f32_16x16x32_bf16 v[196:199], v[16:19], a[116:119], v[196:199]
  ds_read_b64_tr_b16 v[30:31], v11 offset:61952
  v_mfma_f32_16x16x32_bf16 v[200:203], v[16:19], a[120:123], v[200:203]
  v_mfma_f32_16x16x32_bf16 v[204:207], v[16:19], a[124:127], v[204:207]
  s_waitcnt lgkmcnt(4)
  v_mfma_f32_16x16x32_bf16 v[208:211], v[20:23], a[112:115], v[208:211]
  s_waitcnt vmcnt(57)
  s_waitcnt vmcnt(10)
  s_barrier
  v_mfma_f32_16x16x32_bf16 v[212:215], v[20:23], a[116:119], v[212:215]
  ds_read_b64_tr_b16 v[16:17], v12 offset:0
  s_cmp_eq_u32 s22, 0
  s_cbranch_scc0 L_sf2
  s_lshr_b32 s40, s2, 4
  s_lshl_b32 s40, s40, 7
  s_and_b32 s41, s2, 15
  s_lshl_b32 s41, s41, 2
  s_add_u32 s40, s40, s41
  s_add_u32 s40, s40, 69632
  v_mov_b32 v60, s40
  v_mov_b32 v61, s71
  s_mov_b64 exec, 1
  global_store_dword v60, v61, s[68:69] sc1
  s_mov_b64 exec, -1
L_sf2:
  v_mfma_f32_16x16x32_bf16 v[216:219], v[20:23], a[120:123], v[216:219]
  ds_read_b64_tr_b16 v[18:19], v12 offset:512
  v_mfma_f32_16x16x32_bf16 v[220:223], v[20:23], a[124:127], v[220:223]
  s_waitcnt lgkmcnt(4)
  s_add_u32 s24, s6, 3145728
  s_addc_u32 s25, s7, 0
  v_mfma_f32_16x16x32_bf16 v[224:227], v[24:27], a[112:115], v[224:227]
  s_add_u32 m0, s23, 0
  ds_read_b64_tr_b16 v[20:21], v13 offset:0
  v_mfma_f32_16x16x32_bf16 v[228:231], v[24:27], a[116:119], v[228:231]
  ds_read_b64_tr_b16 v[22:23], v13 offset:512
  v_mfma_f32_16x16x32_bf16 v[232:235], v[24:27], a[120:123], v[232:235]
  global_load_lds_dwordx4 v2, s[24:25]
  v_mfma_f32_16x16x32_bf16 v[236:239], v[24:27], a[124:127], v[236:239]
  s_waitcnt lgkmcnt(4)
  s_add_u32 s26, s6, 3145856
  s_addc_u32 s27, s7, 0
  v_mfma_f32_16x16x32_bf16 v[240:243], v[28:31], a[112:115], v[240:243]
  s_add_u32 m0, s23, 4096
  ds_read_b64_tr_b16 v[24:25], v14 offset:0
  v_mfma_f32_16x16x32_bf16 v[244:247], v[28:31], a[116:119], v[244:247]
  ds_read_b64_tr_b16 v[26:27], v14 offset:512
  v_mfma_f32_16x16x32_bf16 v[248:251], v[28:31], a[120:123], v[248:251]
  global_load_lds_dwordx4 v2, s[26:27]
  v_mfma_f32_16x16x32_bf16 v[252:255], v[28:31], a[124:127], v[252:255]
  s_waitcnt lgkmcnt(4)
  s_waitcnt lgkmcnt(12)
  v_mfma_f32_16x16x32_bf16 v[128:131], v[16:19], a[128:131], v[128:131]
  s_add_u32 s24, s6, 3407872
  s_addc_u32 s25, s7, 0
  ds_read_b64_tr_b16 v[28:29], v15 offset:0
  v_mfma_f32_16x16x32_bf16 v[132:135], v[16:19], a[132:135], v[132:135]
  s_add_u32 m0, s23, 8192
  ds_read_b64_tr_b16 v[30:31], v15 offset:512
  v_mfma_f32_16x16x32_bf16 v[136:139], v[16:19], a[136:139], v[136:139]
  global_load_lds_dwordx4 v2, s[24:25]
  v_mfma_f32_16x16x32_bf16 v[140:143], v[16:19], a[140:143], v[140:143]
  s_waitcnt lgkmcnt(4)
  s_lshr_b32 s42, s50, 1
  s_add_u32 s42, s42, 6
  v_mfma_f32_16x16x32_bf16 v[144:147], v[20:23], a[128:131], v[144:147]
  s_and_b32 s42, s42, 7
  s_lshl_b32 s42, s42, 7
  ds_read_b64_tr_b16 v[16:17], v12 offset:4096
  v_mfma_f32_16x16x32_bf16 v[148:151], v[20:23], a[132:135], v[148:151]
  s_add_u32 s44, s4, s42
  s_addc_u32 s45, s5, 0
  s_add_u32 m0, s32, 0
  ds_read_b64_tr_b16 v[18:19], v12 offset:4608
  v_mfma_f32_16x16x32_bf16 v[152:155], v[20:23], a[136:139], v[152:155]
  global_load_lds_dwordx4 v48, s[44:45]
  v_mfma_f32_16x16x32_bf16 v[156:159], v[20:23], a[140:143], v[156:159]
  s_waitcnt lgkmcnt(4)
  s_add_u32 s26, s6, 3408000
  s_addc_u32 s27, s7, 0
  v_mfma_f32_16x16x32_bf16 v[160:163], v[24:27], a[128:131], v[160:163]
  s_add_u32 m0, s23, 12288
  ds_read_b64_tr_b16 v[20:21], v13 offset:4096
  v_mfma_f32_16x16x32_bf16 v[164:167], v[24:27], a[132:135], v[164:167]
  ds_read_b64_tr_b16 v[22:23], v13 offset:4608
  v_mfma_f32_16x16x32_bf16 v[168:171], v[24:27], a[136:139], v[168:171]
  global_load_lds_dwordx4 v2, s[26:27]
  v_mfma_f32_16x16x32_bf16 v[172:175], v[24:27], a[140:143], v[172:175]
  s_waitcnt lgkmcnt(4)
  v_mfma_f32_16x16x32_bf16 v[176:179], v[28:31], a[128:131], v[176:179]
  s_add_u32 m0, s32, 1024
  ds_read_b64_tr_b16 v[24:25], v14 offset:4096
  v_mfma_f32_16x16x32_bf16 v[180:183], v[28:31], a[132:135], v[180:183]
  ds_read_b64_tr_b16 v[26:27], v14 offset:4608
  v_mfma_f32_16x16x32_bf16 v[184:187], v[28:31], a[136:139], v[184:187]
  global_load_lds_dwordx4 v49, s[44:45]
  v_mfma_f32_16x16x32_bf16 v[188:191], v[28:31], a[140:143], v[188:191]
  s_waitcnt lgkmcnt(4)
  s_add_u32 s24, s6, 3670016
  s_addc_u32 s25, s7, 0
  v_mfma_f32_16x16x32_bf16 v[192:195], v[16:19], a[128:131], v[192:195]
  s_add_u32 m0, s23, 16384
  ds_read_b64_tr_b16 v[28:29], v15 offset:4096
  v_mfma_f32_16x16x32_bf16 v[196:199], v[16:19], a[132:135], v[196:199]
  ds_read_b64_tr_b16 v[30:31], v15 offset:4608
  v_mfma_f32_16x16x32_bf16 v[200:203], v[16:19], a[136:139], v[200:203]
  global_load_lds_dwordx4 v2, s[24:25]
  v_mfma_f32_16x16x32_bf16 v[204:207], v[16:19], a[140:143], v[204:207]
  s_waitcnt lgkmcnt(4)
  v_mfma_f32_16x16x32_bf16 v[208:211], v[20:23], a[128:131], v[208:211]
  s_add_u32 m0, s32, 2048
  ds_read_b64_tr_b16 v[16:17], v12 offset:8192
  v_mfma_f32_16x16x32_bf16 v[212:215], v[20:23], a[132:135], v[212:215]
  ds_read_b64_tr_b16 v[18:19], v12 offset:8704
  v_mfma_f32_16x16x32_bf16 v[216:219], v[20:23], a[136:139], v[216:219]
  global_load_lds_dwordx4 v50, s[44:45]
  v_mfma_f32_16x16x32_bf16 v[220:223], v[20:23], a[140:143], v[220:223]
  s_waitcnt lgkmcnt(4)
  v_mfma_f32_16x16x32_bf16 v[224:227], v[24:27], a[128:131], v[224:227]
  s_add_u32 m0, s32, 3072
  ds_read_b64_tr_b16 v[20:21], v13 offset:8192
  v_mfma_f32_16x16x32_bf16 v[228:231], v[24:27], a[132:135], v[228:231]
  ds_read_b64_tr_b16 v[22:23], v13 offset:8704
  v_mfma_f32_16x16x32_bf16 v[232:235], v[24:27], a[136:139], v[232:235]
  global_load_lds_dwordx4 v51, s[44:45]
  v_mfma_f32_16x16x32_bf16 v[236:239], v[24:27], a[140:143], v[236:239]
  s_waitcnt lgkmcnt(4)
  s_add_u32 s26, s6, 3670144
  s_addc_u32 s27, s7, 0
  v_mfma_f32_16x16x32_bf16 v[240:243], v[28:31], a[128:131], v[240:243]
  s_add_u32 m0, s23, 20480
  ds_read_b64_tr_b16 v[24:25], v14 offset:8192
  v_mfma_f32_16x16x32_bf16 v[244:247], v[28:31], a[132:135], v[244:247]
  ds_read_b64_tr_b16 v[26:27], v14 offset:8704
  v_mfma_f32_16x16x32_bf16 v[248:251], v[28:31], a[136:139], v[248:251]
  global_load_lds_dwordx4 v2, s[26:27]
  v_mfma_f32_16x16x32_bf16 v[252:255], v[28:31], a[140:143], v[252:255]
  s_waitcnt lgkmcnt(4)
  v_mfma_f32_16x16x32_bf16 v[128:131], v[16:19], a[144:147], v[128:131]
  s_add_u32 m0, s32, 4096
  ds_read_b64_tr_b16 v[28:29], v15 offset:8192
  s_waitcnt vmcnt(10)
  v_mfma_f32_16x16x32_bf16 v[132:135], v[16:19], a[148:151], v[132:135]
  ds_read_b64_tr_b16 v[30:31], v15 offset:8704
  ds_read_b128 a[160:163], v5 offset:8192
  v_mfma_f32_16x16x32_bf16 v[136:139], v[16:19], a[152:155], v[136:139]
  global_load_lds_dwordx4 v52, s[44:45]
  ds_read_b128 a[164:167], v5 offset:10240
  v_mfma_f32_16x16x32_bf16 v[140:143], v[16:19], a[156:159], v[140:143]
  s_waitcnt lgkmcnt(6)
  s_add_u32 s24, s6, 3932160
  s_addc_u32 s25, s7, 0
  v_mfma_f32_16x16x32_bf16 v[144:147], v[20:23], a[144:147], v[144:147]
  s_add_u32 m0, s23, 24576
  ds_read_b64_tr_b16 v[16:17], v12 offset:12288
  ds_read_b128 a[168:171], v5 offset:12288
  v_mfma_f32_16x16x32_bf16 v[148:151], v[20:23], a[148:151], v[148:151]
  ds_read_b64_tr_b16 v[18:19], v12 offset:12800
  ds_read_b128 a[172:175], v5 offset:14336
  v_mfma_f32_16x16x32_bf16 v[152:155], v[20:23], a[152:155], v[152:155]
  global_load_lds_dwordx4 v2, s[24:25]
  ds_read_b128 a[176:179], v6 offset:8192
  v_mfma_f32_16x16x32_bf16 v[156:159], v[20:23], a[156:159], v[156:159]
  s_waitcnt lgkmcnt(9)
  ds_read_b128 a[180:183], v6 offset:10240
  ds_read_b128 a[184:187], v6 offset:12288
  v_mfma_f32_16x16x32_bf16 v[160:163], v[24:27], a[144:147], v[160:163]
  s_add_u32 m0, s32, 5120
  ds_read_b64_tr_b16 v[20:21], v13 offset:12288
  ds_read_b128 a[188:191], v6 offset:14336
  v_mfma_f32_16x16x32_bf16 v[164:167], v[24:27], a[148:151], v[164:167]
  ds_read_b64_tr_b16 v[22:23], v13 offset:12800
  v_mfma_f32_16x16x32_bf16 v[168:171], v[24:27], a[152:155], v[168:171]
  global_load_lds_dwordx4 v53, s[44:45]
  v_mfma_f32_16x16x32_bf16 v[172:175], v[24:27], a[156:159], v[172:175]
  s_waitcnt lgkmcnt(12)
  s_add_u32 s26, s6, 3932288
  s_addc_u32 s27, s7, 0
  v_mfma_f32_16x16x32_bf16 v[176:179], v[28:31], a[144:147], v[176:179]
  s_add_u32 m0, s23, 28672
  ds_read_b64_tr_b16 v[24:25], v14 offset:12288
  v_mfma_f32_16x16x32_bf16 v[180:183], v[28:31], a[148:151], v[180:183]
  ds_read_b64_tr_b16 v[26:27], v14 offset:12800
  v_mfma_f32_16x16x32_bf16 v[184:187], v[28:31], a[152:155], v[184:187]
  global_load_lds_dwordx4 v2, s[26:27]
  v_mfma_f32_16x16x32_bf16 v[188:191], v[28:31], a[156:159], v[188:191]
  s_waitcnt lgkmcnt(9)
  v_mfma_f32_16x16x32_bf16 v[192:195], v[16:19], a[144:147], v[192:195]
  s_add_u32 m0, s32, 6144
  ds_read_b64_tr_b16 v[28:29], v15 offset:12288
  v_mfma_f32_16x16x32_bf16 v[196:199], v[16:19], a[148:151], v[196:199]
  ds_read_b64_tr_b16 v[30:31], v15 offset:12800
  v_mfma_f32_16x16x32_bf16 v[200:203], v[16:19], a[152:155], v[200:203]
  global_load_lds_dwordx4 v54, s[44:45]
  v_mfma_f32_16x16x32_bf16 v[204:207], v[16:19], a[156:159], v[204:207]
  s_waitcnt lgkmcnt(4)
  v_mfma_f32_16x16x32_bf16 v[208:211], v[20:23], a[144:147], v[208:211]
  s_add_u32 m0, s32, 7168
  ds_read_b64_tr_b16 v[16:17], v12 offset:16384
  v_mfma_f32_16x16x32_bf16 v[212:215], v[20:23], a[148:151], v[212:215]
  ds_read_b64_tr_b16 v[18:19], v12 offset:16896
  v_mfma_f32_16x16x32_bf16 v[216:219], v[20:23], a[152:155], v[216:219]
  global_load_lds_dwordx4 v55, s[44:45]
  v_mfma_f32_16x16x32_bf16 v[220:223], v[20:23], a[156:159], v[220:223]
  s_waitcnt lgkmcnt(4)
  v_mfma_f32_16x16x32_bf16 v[224:227], v[24:27], a[144:147], v[224:227]
  ds_read_b64_tr_b16 v[20:21], v13 offset:16384
  v_mfma_f32_16x16x32_bf16 v[228:231], v[24:27], a[148:151], v[228:231]
  ds_read_b64_tr_b16 v[22:23], v13 offset:16896
  v_mfma_f32_16x16x32_bf16 v[232:235], v[24:27], a[152:155], v[232:235]
  v_mfma_f32_16x16x32_bf16 v[236:239], v[24:27], a[156:159], v[236:239]
  s_waitcnt lgkmcnt(4)
  v_mfma_f32_16x16x32_bf16 v[240:243], v[28:31], a[144:147], v[240:243]
  ds_read_b64_tr_b16 v[24:25], v14 offset:16384
  v_mfma_f32_16x16x32_bf16 v[244:247], v[28:31], a[148:151], v[244:247]
  s_lshr_b32 s42, s50, 1
  s_add_u32 s42, s42, 7
  ds_read_b64_tr_b16 v[26:27], v14 offset:16896
  v_mfma_f32_16x16x32_bf16 v[248:251], v[28:31], a[152:155], v[248:251]
  s_and_b32 s42, s42, 7
  s_lshl_b32 s42, s42, 7
  v_mfma_f32_16x16x32_bf16 v[252:255], v[28:31], a[156:159], v[252:255]
  s_waitcnt lgkmcnt(4)
  s_waitcnt lgkmcnt(11)
  v_mfma_f32_16x16x32_bf16 v[128:131], v[16:19], a[160:163], v[128:131]
  s_add_u32 s46, s4, s42
  s_addc_u32 s47, s5, 0
  ds_read_b64_tr_b16 v[28:29], v15 offset:16384
  v_mfma_f32_16x16x32_bf16 v[132:135], v[16:19], a[164:167], v[132:135]
  s_add_u32 m0, s32, 8192
  ds_read_b64_tr_b16 v[30:31], v15 offset:16896
  v_mfma_f32_16x16x32_bf16 v[136:139], v[16:19], a[168:171], v[136:139]
  global_load_lds_dwordx4 v48, s[46:47]
  v_mfma_f32_16x16x32_bf16 v[140:143], v[16:19], a[172:175], v[140:143]
  s_waitcnt lgkmcnt(4)
  v_mfma_f32_16x16x32_bf16 v[144:147], v[20:23], a[160:163], v[144:147]
  s_add_u32 m0, s32, 9216
  ds_read_b64_tr_b16 v[16:17], v12 offset:20480
  v_mfma_f32_16x16x32_bf16 v[148:151], v[20:23], a[164:167], v[148:151]
  ds_read_b64_tr_b16 v[18:19], v12 offset:20992
  v_mfma_f32_16x16x32_bf16 v[152:155], v[20:23], a[168:171], v[152:155]
  global_load_lds_dwordx4 v49, s[46:47]
  v_mfma_f32_16x16x32_bf16 v[156:159], v[20:23], a[172:175], v[156:159]
  s_waitcnt lgkmcnt(4)
  v_mfma_f32_16x16x32_bf16 v[160:163], v[24:27], a[160:163], v[160:163]
  s_add_u32 m0, s32, 10240
  ds_read_b64_tr_b16 v[20:21], v13 offset:20480
  v_mfma_f32_16x16x32_bf16 v[164:167], v[24:27], a[164:167], v[164:167]
  ds_read_b64_tr_b16 v[22:23], v13 offset:20992
  v_mfma_f32_16x16x32_bf16 v[168:171], v[24:27], a[168:171], v[168:171]
  global_load_lds_dwordx4 v50, s[46:47]
  v_mfma_f32_16x16x32_bf16 v[172:175], v[24:27], a[172:175], v[172:175]
  s_waitcnt lgkmcnt(4)
  v_mfma_f32_16x16x32_bf16 v[176:179], v[28:31], a[160:163], v[176:179]
  s_add_u32 m0, s32, 11264
  ds_read_b64_tr_b16 v[24:25], v14 offset:20480
  v_mfma_f32_16x16x32_bf16 v[180:183], v[28:31], a[164:167], v[180:183]
  ds_read_b64_tr_b16 v[26:27], v14 offset:20992
  v_mfma_f32_16x16x32_bf16 v[184:187], v[28:31], a[168:171], v[184:187]
  global_load_lds_dwordx4 v51, s[46:47]
  v_mfma_f32_16x16x32_bf16 v[188:191], v[28:31], a[172:175], v[188:191]
  s_waitcnt lgkmcnt(4)
  v_mfma_f32_16x16x32_bf16 v[192:195], v[16:19], a[160:163], v[192:195]
  s_add_u32 m0, s32, 12288
  ds_read_b64_tr_b16 v[28:29], v15 offset:20480
  v_mfma_f32_16x16x32_bf16 v[196:199], v[16:19], a[164:167], v[196:199]
  ds_read_b64_tr_b16 v[30:31], v15 offset:20992
  v_mfma_f32_16x16x32_bf16 v[200:203], v[16:19], a[168:171], v[200:203]
  global_load_lds_dwordx4 v52, s[46:47]
  v_mfma_f32_16x16x32_bf16 v[204:207], v[16:19], a[172:175], v[204:207]
  s_waitcnt lgkmcnt(4)
  v_mfma_f32_16x16x32_bf16 v[208:211], v[20:23], a[160:163], v[208:211]
  s_add_u32 m0, s32, 13312
  ds_read_b64_tr_b16 v[16:17], v12 offset:24576
  v_mfma_f32_16x16x32_bf16 v[212:215], v[20:23], a[164:167], v[212:215]
  ds_read_b64_tr_b16 v[18:19], v12 offset:25088
  v_mfma_f32_16x16x32_bf16 v[216:219], v[20:23], a[168:171], v[216:219]
  global_load_lds_dwordx4 v53, s[46:47]
  v_mfma_f32_16x16x32_bf16 v[220:223], v[20:23], a[172:175], v[220:223]
  s_waitcnt lgkmcnt(4)
  v_mfma_f32_16x16x32_bf16 v[224:227], v[24:27], a[160:163], v[224:227]
  s_add_u32 m0, s32, 14336
  ds_read_b64_tr_b16 v[20:21], v13 offset:24576
  v_mfma_f32_16x16x32_bf16 v[228:231], v[24:27], a[164:167], v[228:231]
  ds_read_b64_tr_b16 v[22:23], v13 offset:25088
  v_mfma_f32_16x16x32_bf16 v[232:235], v[24:27], a[168:171], v[232:235]
  global_load_lds_dwordx4 v54, s[46:47]
  v_mfma_f32_16x16x32_bf16 v[236:239], v[24:27], a[172:175], v[236:239]
  s_waitcnt lgkmcnt(4)
  v_mfma_f32_16x16x32_bf16 v[240:243], v[28:31], a[160:163], v[240:243]
  s_add_u32 m0, s32, 15360
  ds_read_b64_tr_b16 v[24:25], v14 offset:24576
  v_mfma_f32_16x16x32_bf16 v[244:247], v[28:31], a[164:167], v[244:247]
  ds_read_b64_tr_b16 v[26:27], v14 offset:25088
  v_mfma_f32_16x16x32_bf16 v[248:251], v[28:31], a[168:171], v[248:251]
  global_load_lds_dwordx4 v55, s[46:47]
  v_mfma_f32_16x16x32_bf16 v[252:255], v[28:31], a[172:175], v[252:255]
  s_waitcnt lgkmcnt(4)
  v_mfma_f32_16x16x32_bf16 v[128:131], v[16:19], a[176:179], v[128:131]
  ds_read_b64_tr_b16 v[28:29], v15 offset:24576
  s_waitcnt vmcnt(8)
  v_mfma_f32_16x16x32_bf16 v[132:135], v[16:19], a[180:183], v[132:135]
  ds_read_b64_tr_b16 v[30:31], v15 offset:25088
  ds_read_b128 a[192:195], v5 offset:0
  v_mfma_f32_16x16x32_bf16 v[136:139], v[16:19], a[184:187], v[136:139]
  ds_read_b128 a[196:199], v5 offset:2048
  ds_read_b128 a[200:203], v5 offset:4096
  v_mfma_f32_16x16x32_bf16 v[140:143], v[16:19], a[188:191], v[140:143]
  s_waitcnt lgkmcnt(7)
  ds_read_b128 a[204:207], v5 offset:6144
  ds_read_b128 a[208:211], v6 offset:0
  v_mfma_f32_16x16x32_bf16 v[144:147], v[20:23], a[176:179], v[144:147]
  ds_read_b64_tr_b16 v[16:17], v12 offset:28672
  ds_read_b128 a[212:215], v6 offset:2048
  v_mfma_f32_16x16x32_bf16 v[148:151], v[20:23], a[180:183], v[148:151]
  ds_read_b64_tr_b16 v[18:19], v12 offset:29184
  ds_read_b128 a[216:219], v6 offset:4096
  v_mfma_f32_16x16x32_bf16 v[152:155], v[20:23], a[184:187], v[152:155]
  ds_read_b128 a[220:223], v6 offset:6144
  v_mfma_f32_16x16x32_bf16 v[156:159], v[20:23], a[188:191], v[156:159]
  s_waitcnt lgkmcnt(12)
  v_mfma_f32_16x16x32_bf16 v[160:163], v[24:27], a[176:179], v[160:163]
  ds_read_b64_tr_b16 v[20:21], v13 offset:28672
  v_mfma_f32_16x16x32_bf16 v[164:167], v[24:27], a[180:183], v[164:167]
  ds_read_b64_tr_b16 v[22:23], v13 offset:29184
  v_mfma_f32_16x16x32_bf16 v[168:171], v[24:27], a[184:187], v[168:171]
  v_mfma_f32_16x16x32_bf16 v[172:175], v[24:27], a[188:191], v[172:175]
  s_waitcnt lgkmcnt(12)
  v_mfma_f32_16x16x32_bf16 v[176:179], v[28:31], a[176:179], v[176:179]
  ds_read_b64_tr_b16 v[24:25], v14 offset:28672
  v_mfma_f32_16x16x32_bf16 v[180:183], v[28:31], a[180:183], v[180:183]
  ds_read_b64_tr_b16 v[26:27], v14 offset:29184
  v_mfma_f32_16x16x32_bf16 v[184:187], v[28:31], a[184:187], v[184:187]
  v_mfma_f32_16x16x32_bf16 v[188:191], v[28:31], a[188:191], v[188:191]
  s_waitcnt lgkmcnt(6)
  v_mfma_f32_16x16x32_bf16 v[192:195], v[16:19], a[176:179], v[192:195]
  ds_read_b64_tr_b16 v[28:29], v15 offset:28672
  v_mfma_f32_16x16x32_bf16 v[196:199], v[16:19], a[180:183], v[196:199]
  ds_read_b64_tr_b16 v[30:31], v15 offset:29184
  v_mfma_f32_16x16x32_bf16 v[200:203], v[16:19], a[184:187], v[200:203]
  v_mfma_f32_16x16x32_bf16 v[204:207], v[16:19], a[188:191], v[204:207]
  s_waitcnt lgkmcnt(4)
  v_mfma_f32_16x16x32_bf16 v[208:211], v[20:23], a[176:179], v[208:211]
  s_waitcnt vmcnt(10)
  s_barrier
  v_mfma_f32_16x16x32_bf16 v[212:215], v[20:23], a[180:183], v[212:215]
  ds_read_b64_tr_b16 v[16:17], v8 offset:0
  v_mfma_f32_16x16x32_bf16 v[216:219], v[20:23], a[184:187], v[216:219]
  ds_read_b64_tr_b16 v[18:19], v8 offset:512
  v_mfma_f32_16x16x32_bf16 v[220:223], v[20:23], a[188:191], v[220:223]
  s_waitcnt lgkmcnt(4)
  s_add_u32 s24, s8, 0
  s_addc_u32 s25, s9, 0
  v_mfma_f32_16x16x32_bf16 v[224:227], v[24:27], a[176:179], v[224:227]
  s_add_u32 m0, s23, 32768
  ds_read_b64_tr_b16 v[20:21], v9 offset:0
  v_mfma_f32_16x16x32_bf16 v[228:231], v[24:27], a[180:183], v[228:231]
  ds_read_b64_tr_b16 v[22:23], v9 offset:512
  v_mfma_f32_16x16x32_bf16 v[232:235], v[24:27], a[184:187], v[232:235]
  global_load_lds_dwordx4 v2, s[24:25]
  v_mfma_f32_16x16x32_bf16 v[236:239], v[24:27], a[188:191], v[236:239]
  s_waitcnt lgkmcnt(4)
  s_add_u32 s26, s8, 262144
  s_addc_u32 s27, s9, 0
  v_mfma_f32_16x16x32_bf16 v[240:243], v[28:31], a[176:179], v[240:243]
  s_add_u32 m0, s23, 36864
  ds_read_b64_tr_b16 v[24:25], v10 offset:0
  v_mfma_f32_16x16x32_bf16 v[244:247], v[28:31], a[180:183], v[244:247]
  ds_read_b64_tr_b16 v[26:27], v10 offset:512
  v_mfma_f32_16x16x32_bf16 v[248:251], v[28:31], a[184:187], v[248:251]
  global_load_lds_dwordx4 v2, s[26:27]
  v_mfma_f32_16x16x32_bf16 v[252:255], v[28:31], a[188:191], v[252:255]
  s_waitcnt lgkmcnt(4)
  s_waitcnt lgkmcnt(12)
  v_mfma_f32_16x16x32_bf16 v[128:131], v[16:19], a[192:195], v[128:131]
  s_add_u32 s24, s8, 524288
  s_addc_u32 s25, s9, 0
  ds_read_b64_tr_b16 v[28:29], v11 offset:0
  v_mfma_f32_16x16x32_bf16 v[132:135], v[16:19], a[196:199], v[132:135]
  s_add_u32 m0, s23, 40960
  ds_read_b64_tr_b16 v[30:31], v11 offset:512
  v_mfma_f32_16x16x32_bf16 v[136:139], v[16:19], a[200:203], v[136:139]
  global_load_lds_dwordx4 v2, s[24:25]
  v_mfma_f32_16x16x32_bf16 v[140:143], v[16:19], a[204:207], v[140:143]
  s_waitcnt lgkmcnt(4)
  s_add_u32 s26, s8, 786432
  s_addc_u32 s27, s9, 0
  v_mfma_f32_16x16x32_bf16 v[144:147], v[20:23], a[192:195], v[144:147]
  s_add_u32 m0, s23, 45056
  ds_read_b64_tr_b16 v[16:17], v8 offset:4096
  v_mfma_f32_16x16x32_bf16 v[148:151], v[20:23], a[196:199], v[148:151]
  ds_read_b64_tr_b16 v[18:19], v8 offset:4608
  v_mfma_f32_16x16x32_bf16 v[152:155], v[20:23], a[200:203], v[152:155]
  global_load_lds_dwordx4 v2, s[26:27]
  v_mfma_f32_16x16x32_bf16 v[156:159], v[20:23], a[204:207], v[156:159]
  s_waitcnt lgkmcnt(4)
  s_add_u32 s24, s8, 1048576
  s_addc_u32 s25, s9, 0
  v_mfma_f32_16x16x32_bf16 v[160:163], v[24:27], a[192:195], v[160:163]
  s_add_u32 m0, s23, 49152
  ds_read_b64_tr_b16 v[20:21], v9 offset:4096
  v_mfma_f32_16x16x32_bf16 v[164:167], v[24:27], a[196:199], v[164:167]
  ds_read_b64_tr_b16 v[22:23], v9 offset:4608
  v_mfma_f32_16x16x32_bf16 v[168:171], v[24:27], a[200:203], v[168:171]
  global_load_lds_dwordx4 v2, s[24:25]
  v_mfma_f32_16x16x32_bf16 v[172:175], v[24:27], a[204:207], v[172:175]
  s_waitcnt lgkmcnt(4)
  s_add_u32 s26, s8, 1310720
  s_addc_u32 s27, s9, 0
  v_mfma_f32_16x16x32_bf16 v[176:179], v[28:31], a[192:195], v[176:179]
  s_add_u32 m0, s23, 53248
  ds_read_b64_tr_b16 v[24:25], v10 offset:4096
  v_mfma_f32_16x16x32_bf16 v[180:183], v[28:31], a[196:199], v[180:183]
  ds_read_b64_tr_b16 v[26:27], v10 offset:4608
  v_mfma_f32_16x16x32_bf16 v[184:187], v[28:31], a[200:203], v[184:187]
  global_load_lds_dwordx4 v2, s[26:27]
  v_mfma_f32_16x16x32_bf16 v[188:191], v[28:31], a[204:207], v[188:191]
  s_waitcnt lgkmcnt(4)
  s_add_u32 s24, s8, 1572864
  s_addc_u32 s25, s9, 0
  v_mfma_f32_16x16x32_bf16 v[192:195], v[16:19], a[192:195], v[192:195]
  s_add_u32 m0, s23, 57344
  ds_read_b64_tr_b16 v[28:29], v11 offset:4096
  v_mfma_f32_16x16x32_bf16 v[196:199], v[16:19], a[196:199], v[196:199]
  ds_read_b64_tr_b16 v[30:31], v11 offset:4608
  v_mfma_f32_16x16x32_bf16 v[200:203], v[16:19], a[200:203], v[200:203]
  global_load_lds_dwordx4 v2, s[24:25]
  v_mfma_f32_16x16x32_bf16 v[204:207], v[16:19], a[204:207], v[204:207]
  s_waitcnt lgkmcnt(4)
  s_add_u32 s26, s8, 1835008
  s_addc_u32 s27, s9, 0
  v_mfma_f32_16x16x32_bf16 v[208:211], v[20:23], a[192:195], v[208:211]
  s_add_u32 m0, s23, 61440
  ds_read_b64_tr_b16 v[16:17], v8 offset:8192
  v_mfma_f32_16x16x32_bf16 v[212:215], v[20:23], a[196:199], v[212:215]
  ds_read_b64_tr_b16 v[18:19], v8 offset:8704
  v_mfma_f32_16x16x32_bf16 v[216:219], v[20:23], a[200:203], v[216:219]
  global_load_lds_dwordx4 v2, s[26:27]
  v_mfma_f32_16x16x32_bf16 v[220:223], v[20:23], a[204:207], v[220:223]
  s_waitcnt lgkmcnt(4)
  v_mfma_f32_16x16x32_bf16 v[224:227], v[24:27], a[192:195], v[224:227]
  ds_read_b64_tr_b16 v[20:21], v9 offset:8192
  v_mfma_f32_16x16x32_bf16 v[228:231], v[24:27], a[196:199], v[228:231]
  ds_read_b64_tr_b16 v[22:23], v9 offset:8704
  v_mfma_f32_16x16x32_bf16 v[232:235], v[24:27], a[200:203], v[232:235]
  v_mfma_f32_16x16x32_bf16 v[236:239], v[24:27], a[204:207], v[236:239]
  s_waitcnt lgkmcnt(4)
  v_mfma_f32_16x16x32_bf16 v[240:243], v[28:31], a[192:195], v[240:243]
  ds_read_b64_tr_b16 v[24:25], v10 offset:8192
  v_mfma_f32_16x16x32_bf16 v[244:247], v[28:31], a[196:199], v[244:247]
  ds_read_b64_tr_b16 v[26:27], v10 offset:8704
  v_mfma_f32_16x16x32_bf16 v[248:251], v[28:31], a[200:203], v[248:251]
  v_mfma_f32_16x16x32_bf16 v[252:255], v[28:31], a[204:207], v[252:255]
  s_waitcnt lgkmcnt(4)
  v_mfma_f32_16x16x32_bf16 v[128:131], v[16:19], a[208:211], v[128:131]
  ds_read_b64_tr_b16 v[28:29], v11 offset:8192
  s_waitcnt vmcnt(8)
  v_mfma_f32_16x16x32_bf16 v[132:135], v[16:19], a[212:215], v[132:135]
  ds_read_b64_tr_b16 v[30:31], v11 offset:8704
  ds_read_b128 a[224:227], v5 offset:8192
  v_mfma_f32_16x16x32_bf16 v[136:139], v[16:19], a[216:219], v[136:139]
  ds_read_b128 a[228:231], v5 offset:10240
  ds_read_b128 a[232:235], v5 offset:12288
  v_mfma_f32_16x16x32_bf16 v[140:143], v[16:19], a[220:223], v[140:143]
  s_waitcnt lgkmcnt(7)
  ds_read_b128 a[236:239], v5 offset:14336
  ds_read_b128 a[240:243], v6 offset:8192
  v_mfma_f32_16x16x32_bf16 v[144:147], v[20:23], a[208:211], v[144:147]
  ds_read_b64_tr_b16 v[16:17], v8 offset:12288
  ds_read_b128 a[244:247], v6 offset:10240
  v_mfma_f32_16x16x32_bf16 v[148:151], v[20:23], a[212:215], v[148:151]
  ds_read_b64_tr_b16 v[18:19], v8 offset:12800
  ds_read_b128 a[248:251], v6 offset:12288
  v_mfma_f32_16x16x32_bf16 v[152:155], v[20:23], a[216:219], v[152:155]
  ds_read_b128 a[252:255], v6 offset:14336
  v_mfma_f32_16x16x32_bf16 v[156:159], v[20:23], a[220:223], v[156:159]
  s_waitcnt lgkmcnt(12)
  v_mfma_f32_16x16x32_bf16 v[160:163], v[24:27], a[208:211], v[160:163]
  ds_read_b64_tr_b16 v[20:21], v9 offset:12288
  v_mfma_f32_16x16x32_bf16 v[164:167], v[24:27], a[212:215], v[164:167]
  ds_read_b64_tr_b16 v[22:23], v9 offset:12800
  v_mfma_f32_16x16x32_bf16 v[168:171], v[24:27], a[216:219], v[168:171]
  v_mfma_f32_16x16x32_bf16 v[172:175], v[24:27], a[220:223], v[172:175]
  s_waitcnt lgkmcnt(12)
  v_mfma_f32_16x16x32_bf16 v[176:179], v[28:31], a[208:211], v[176:179]
  ds_read_b64_tr_b16 v[24:25], v10 offset:12288
  v_mfma_f32_16x16x32_bf16 v[180:183], v[28:31], a[212:215], v[180:183]
  ds_read_b64_tr_b16 v[26:27], v10 offset:12800
  v_mfma_f32_16x16x32_bf16 v[184:187], v[28:31], a[216:219], v[184:187]
  v_mfma_f32_16x16x32_bf16 v[188:191], v[28:31], a[220:223], v[188:191]
  s_waitcnt lgkmcnt(6)
  v_mfma_f32_16x16x32_bf16 v[192:195], v[16:19], a[208:211], v[192:195]
  ds_read_b64_tr_b16 v[28:29], v11 offset:12288
  v_mfma_f32_16x16x32_bf16 v[196:199], v[16:19], a[212:215], v[196:199]
  ds_read_b64_tr_b16 v[30:31], v11 offset:12800
  v_mfma_f32_16x16x32_bf16 v[200:203], v[16:19], a[216:219], v[200:203]
  v_mfma_f32_16x16x32_bf16 v[204:207], v[16:19], a[220:223], v[204:207]
  s_waitcnt lgkmcnt(4)
  v_mfma_f32_16x16x32_bf16 v[208:211], v[20:23], a[208:211], v[208:211]
  ds_read_b64_tr_b16 v[16:17], v8 offset:16384
  v_mfma_f32_16x16x32_bf16 v[212:215], v[20:23], a[212:215], v[212:215]
  ds_read_b64_tr_b16 v[18:19], v8 offset:16896
  v_mfma_f32_16x16x32_bf16 v[216:219], v[20:23], a[216:219], v[216:219]
  v_mfma_f32_16x16x32_bf16 v[220:223], v[20:23], a[220:223], v[220:223]
  s_waitcnt lgkmcnt(4)
  v_mfma_f32_16x16x32_bf16 v[224:227], v[24:27], a[208:211], v[224:227]
  ds_read_b64_tr_b16 v[20:21], v9 offset:16384
  v_mfma_f32_16x16x32_bf16 v[228:231], v[24:27], a[212:215], v[228:231]
  ds_read_b64_tr_b16 v[22:23], v9 offset:16896
  v_mfma_f32_16x16x32_bf16 v[232:235], v[24:27], a[216:219], v[232:235]
  v_mfma_f32_16x16x32_bf16 v[236:239], v[24:27], a[220:223], v[236:239]
  s_waitcnt lgkmcnt(4)
  v_mfma_f32_16x16x32_bf16 v[240:243], v[28:31], a[208:211], v[240:243]
  ds_read_b64_tr_b16 v[24:25], v10 offset:16384
  v_mfma_f32_16x16x32_bf16 v[244:247], v[28:31], a[212:215], v[244:247]
  ds_read_b64_tr_b16 v[26:27], v10 offset:16896
  v_mfma_f32_16x16x32_bf16 v[248:251], v[28:31], a[216:219], v[248:251]
  v_mfma_f32_16x16x32_bf16 v[252:255], v[28:31], a[220:223], v[252:255]
  s_waitcnt lgkmcnt(4)
  s_waitcnt lgkmcnt(12)
  v_mfma_f32_16x16x32_bf16 v[128:131], v[16:19], a[224:227], v[128:131]
  ds_read_b64_tr_b16 v[28:29], v11 offset:16384
  v_mfma_f32_16x16x32_bf16 v[132:135], v[16:19], a[228:231], v[132:135]
  ds_read_b64_tr_b16 v[30:31], v11 offset:16896
  v_mfma_f32_16x16x32_bf16 v[136:139], v[16:19], a[232:235], v[136:139]
  v_mfma_f32_16x16x32_bf16 v[140:143], v[16:19], a[236:239], v[140:143]
  s_waitcnt lgkmcnt(4)
  v_mfma_f32_16x16x32_bf16 v[144:147], v[20:23], a[224:227], v[144:147]
  ds_read_b64_tr_b16 v[16:17], v8 offset:20480
  v_mfma_f32_16x16x32_bf16 v[148:151], v[20:23], a[228:231], v[148:151]
  ds_read_b64_tr_b16 v[18:19], v8 offset:20992
  v_mfma_f32_16x16x32_bf16 v[152:155], v[20:23], a[232:235], v[152:155]
  v_mfma_f32_16x16x32_bf16 v[156:159], v[20:23], a[236:239], v[156:159]
  s_waitcnt lgkmcnt(4)
  v_mfma_f32_16x16x32_bf16 v[160:163], v[24:27], a[224:227], v[160:163]
  ds_read_b64_tr_b16 v[20:21], v9 offset:20480
  v_mfma_f32_16x16x32_bf16 v[164:167], v[24:27], a[228:231], v[164:167]
  ds_read_b64_tr_b16 v[22:23], v9 offset:20992
  v_mfma_f32_16x16x32_bf16 v[168:171], v[24:27], a[232:235], v[168:171]
  v_mfma_f32_16x16x32_bf16 v[172:175], v[24:27], a[236:239], v[172:175]
  s_waitcnt lgkmcnt(4)
  v_mfma_f32_16x16x32_bf16 v[176:179], v[28:31], a[224:227], v[176:179]
  ds_read_b64_tr_b16 v[24:25], v10 offset:20480
  v_mfma_f32_16x16x32_bf16 v[180:183], v[28:31], a[228:231], v[180:183]
  ds_read_b64_tr_b16 v[26:27], v10 offset:20992
  v_mfma_f32_16x16x32_bf16 v[184:187], v[28:31], a[232:235], v[184:187]
  v_mfma_f32_16x16x32_bf16 v[188:191], v[28:31], a[236:239], v[188:191]
  s_waitcnt lgkmcnt(4)
  v_mfma_f32_16x16x32_bf16 v[192:195], v[16:19], a[224:227], v[192:195]
  ds_read_b64_tr_b16 v[28:29], v11 offset:20480
  v_mfma_f32_16x16x32_bf16 v[196:199], v[16:19], a[228:231], v[196:199]
  ds_read_b64_tr_b16 v[30:31], v11 offset:20992
  v_mfma_f32_16x16x32_bf16 v[200:203], v[16:19], a[232:235], v[200:203]
  v_mfma_f32_16x16x32_bf16 v[204:207], v[16:19], a[236:239], v[204:207]
  s_waitcnt lgkmcnt(4)
  v_mfma_f32_16x16x32_bf16 v[208:211], v[20:23], a[224:227], v[208:211]
  ds_read_b64_tr_b16 v[16:17], v8 offset:24576
  v_mfma_f32_16x16x32_bf16 v[212:215], v[20:23], a[228:231], v[212:215]
  ds_read_b64_tr_b16 v[18:19], v8 offset:25088
  v_mfma_f32_16x16x32_bf16 v[216:219], v[20:23], a[232:235], v[216:219]
  v_mfma_f32_16x16x32_bf16 v[220:223], v[20:23], a[236:239], v[220:223]
  s_waitcnt lgkmcnt(4)
  v_mfma_f32_16x16x32_bf16 v[224:227], v[24:27], a[224:227], v[224:227]
  ds_read_b64_tr_b16 v[20:21], v9 offset:24576
  v_mfma_f32_16x16x32_bf16 v[228:231], v[24:27], a[228:231], v[228:231]
  ds_read_b64_tr_b16 v[22:23], v9 offset:25088
  v_mfma_f32_16x16x32_bf16 v[232:235], v[24:27], a[232:235], v[232:235]
  v_mfma_f32_16x16x32_bf16 v[236:239], v[24:27], a[236:239], v[236:239]
  s_waitcnt lgkmcnt(4)
  v_mfma_f32_16x16x32_bf16 v[240:243], v[28:31], a[224:227], v[240:243]
  ds_read_b64_tr_b16 v[24:25], v10 offset:24576
  v_mfma_f32_16x16x32_bf16 v[244:247], v[28:31], a[228:231], v[244:247]
  ds_read_b64_tr_b16 v[26:27], v10 offset:25088
  v_mfma_f32_16x16x32_bf16 v[248:251], v[28:31], a[232:235], v[248:251]
  v_mfma_f32_16x16x32_bf16 v[252:255], v[28:31], a[236:239], v[252:255]
  s_waitcnt lgkmcnt(4)
  v_mfma_f32_16x16x32_bf16 v[128:131], v[16:19], a[240:243], v[128:131]
  ds_read_b64_tr_b16 v[28:29], v11 offset:24576
  v_mfma_f32_16x16x32_bf16 v[132:135], v[16:19], a[244:247], v[132:135]
  ds_read_b64_tr_b16 v[30:31], v11 offset:25088
  v_mfma_f32_16x16x32_bf16 v[136:139], v[16:19], a[248:251], v[136:139]
  v_mfma_f32_16x16x32_bf16 v[140:143], v[16:19], a[252:255], v[140:143]
  s_waitcnt lgkmcnt(4)
  v_mfma_f32_16x16x32_bf16 v[144:147], v[20:23], a[240:243], v[144:147]
  ds_read_b64_tr_b16 v[16:17], v8 offset:28672
  v_mfma_f32_16x16x32_bf16 v[148:151], v[20:23], a[244:247], v[148:151]
  ds_read_b64_tr_b16 v[18:19], v8 offset:29184
  v_mfma_f32_16x16x32_bf16 v[152:155], v[20:23], a[248:251], v[152:155]
  v_mfma_f32_16x16x32_bf16 v[156:159], v[20:23], a[252:255], v[156:159]
  s_waitcnt lgkmcnt(4)
  v_mfma_f32_16x16x32_bf16 v[160:163], v[24:27], a[240:243], v[160:163]
  ds_read_b64_tr_b16 v[20:21], v9 offset:28672
  v_mfma_f32_16x16x32_bf16 v[164:167], v[24:27], a[244:247], v[164:167]
  ds_read_b64_tr_b16 v[22:23], v9 offset:29184
  v_mfma_f32_16x16x32_bf16 v[168:171], v[24:27], a[248:251], v[168:171]
  v_mfma_f32_16x16x32_bf16 v[172:175], v[24:27], a[252:255], v[172:175]
  s_waitcnt lgkmcnt(4)
  v_mfma_f32_16x16x32_bf16 v[176:179], v[28:31], a[240:243], v[176:179]
  ds_read_b64_tr_b16 v[24:25], v10 offset:28672
  v_mfma_f32_16x16x32_bf16 v[180:183], v[28:31], a[244:247], v[180:183]
  ds_read_b64_tr_b16 v[26:27], v10 offset:29184
  v_mfma_f32_16x16x32_bf16 v[184:187], v[28:31], a[248:251], v[184:187]
  v_mfma_f32_16x16x32_bf16 v[188:191], v[28:31], a[252:255], v[188:191]
  s_waitcnt lgkmcnt(4)
  v_mfma_f32_16x16x32_bf16 v[192:195], v[16:19], a[240:243], v[192:195]
  ds_read_b64_tr_b16 v[28:29], v11 offset:28672
  v_mfma_f32_16x16x32_bf16 v[196:199], v[16:19], a[244:247], v[196:199]
  ds_read_b64_tr_b16 v[30:31], v11 offset:29184
  v_mfma_f32_16x16x32_bf16 v[200:203], v[16:19], a[248:251], v[200:203]
  v_mfma_f32_16x16x32_bf16 v[204:207], v[16:19], a[252:255], v[204:207]
  s_waitcnt lgkmcnt(4)
  v_mfma_f32_16x16x32_bf16 v[208:211], v[20:23], a[240:243], v[208:211]
  s_waitcnt vmcnt(0)
  s_barrier
  v_mfma_f32_16x16x32_bf16 v[212:215], v[20:23], a[244:247], v[212:215]
  ds_read_b64_tr_b16 v[16:17], v8 offset:32768
  v_mfma_f32_16x16x32_bf16 v[216:219], v[20:23], a[248:251], v[216:219]
  ds_read_b64_tr_b16 v[18:19], v8 offset:33280
  v_mfma_f32_16x16x32_bf16 v[220:223], v[20:23], a[252:255], v[220:223]
  s_waitcnt lgkmcnt(4)
  s_add_u32 s24, s8, 2097152
  s_addc_u32 s25, s9, 0
  v_mfma_f32_16x16x32_bf16 v[224:227], v[24:27], a[240:243], v[224:227]
  s_add_u32 m0, s23, 65536
  ds_read_b64_tr_b16 v[20:21], v9 offset:32768
  v_mfma_f32_16x16x32_bf16 v[228:231], v[24:27], a[244:247], v[228:231]
  ds_read_b64_tr_b16 v[22:23], v9 offset:33280
  v_mfma_f32_16x16x32_bf16 v[232:235], v[24:27], a[248:251], v[232:235]
  global_load_lds_dwordx4 v2, s[24:25]
  v_mfma_f32_16x16x32_bf16 v[236:239], v[24:27], a[252:255], v[236:239]
  s_waitcnt lgkmcnt(4)
  s_add_u32 s26, s8, 2359296
  s_addc_u32 s27, s9, 0
  v_mfma_f32_16x16x32_bf16 v[240:243], v[28:31], a[240:243], v[240:243]
  s_add_u32 m0, s23, 69632
  ds_read_b64_tr_b16 v[24:25], v10 offset:32768
  v_mfma_f32_16x16x32_bf16 v[244:247], v[28:31], a[244:247], v[244:247]
  ds_read_b64_tr_b16 v[26:27], v10 offset:33280
  v_mfma_f32_16x16x32_bf16 v[248:251], v[28:31], a[248:251], v[248:251]
  global_load_lds_dwordx4 v2, s[26:27]
  v_mfma_f32_16x16x32_bf16 v[252:255], v[28:31], a[252:255], v[252:255]
  s_waitcnt lgkmcnt(4)
  s_add_u32 s24, s8, 2621440
  s_addc_u32 s25, s9, 0
  v_mfma_f32_16x16x32_bf16 v[64:67], a[0:3], v[16:19], 0
  s_add_u32 m0, s23, 73728
  ds_read_b64_tr_b16 v[28:29], v11 offset:32768
  v_mfma_f32_16x16x32_bf16 v[68:71], a[4:7], v[16:19], 0
  ds_read_b64_tr_b16 v[30:31], v11 offset:33280
  v_mfma_f32_16x16x32_bf16 v[72:75], a[8:11], v[16:19], 0
  global_load_lds_dwordx4 v2, s[24:25]
  s_lshl_b32 s40, s56, 14
  v_add_u32 v48, s40, v4
  s_lshr_b32 s41, s56, 1
  s_mul_i32 s41, s41, 88064
  v_add_u32 v52, s41, v4
  v_mfma_f32_16x16x32_bf16 v[76:79], a[12:15], v[16:19], 0
  s_waitcnt lgkmcnt(4)
  s_add_u32 s26, s8, 2883584
  s_addc_u32 s27, s9, 0
  v_mfma_f32_16x16x32_bf16 v[80:83], a[0:3], v[20:23], 0
  s_add_u32 m0, s23, 77824
  ds_read_b64_tr_b16 v[16:17], v8 offset:36864
  s_lshl_b32 s40, s57, 14
  v_add_u32 v49, s40, v4
  s_lshr_b32 s41, s57, 1
  s_mul_i32 s41, s41, 88064
  v_add_u32 v53, s41, v4
  v_mfma_f32_16x16x32_bf16 v[84:87], a[4:7], v[20:23], 0
  ds_read_b64_tr_b16 v[18:19], v8 offset:37376
  v_mfma_f32_16x16x32_bf16 v[88:91], a[8:11], v[20:23], 0
  global_load_lds_dwordx4 v2, s[26:27]
  s_lshl_b32 s40, s58, 14
  v_add_u32 v50, s40, v4
  s_lshr_b32 s41, s58, 1
  s_mul_i32 s41, s41, 88064
  v_add_u32 v54, s41, v4
  v_mfma_f32_16x16x32_bf16 v[92:95], a[12:15], v[20:23], 0
  s_waitcnt lgkmcnt(4)
  s_add_u32 s24, s8, 3145728
  s_addc_u32 s25, s9, 0
  v_mfma_f32_16x16x32_bf16 v[96:99], a[0:3], v[24:27], 0
  s_add_u32 m0, s23, 81920
  ds_read_b64_tr_b16 v[20:21], v9 offset:36864
  s_lshl_b32 s40, s59, 14
  v_add_u32 v51, s40, v4
  s_lshr_b32 s41, s59, 1
  s_mul_i32 s41, s41, 88064
  v_add_u32 v55, s41, v4
  v_mfma_f32_16x16x32_bf16 v[100:103], a[4:7], v[24:27], 0
  global_load_lds_dwordx4 v2, s[24:25]
  ds_read_b64_tr_b16 v[22:23], v9 offset:37376
  v_mfma_f32_16x16x32_bf16 v[104:107], a[8:11], v[24:27], 0
  v_mul_f32 v128, 0x3e0293ee, v128
  v_mul_f32 v129, 0x3e0293ee, v129
  v_mfma_f32_16x16x32_bf16 v[108:111], a[12:15], v[24:27], 0
  s_waitcnt lgkmcnt(4)
  v_mul_f32 v130, 0x3e0293ee, v130
  v_mul_f32 v131, 0x3e0293ee, v131
  v_mfma_f32_16x16x32_bf16 v[112:115], a[0:3], v[28:31], 0
  ds_read_b64_tr_b16 v[24:25], v10 offset:36864
  v_mul_f32 v144, 0x3e0293ee, v144
  v_mfma_f32_16x16x32_bf16 v[116:119], a[4:7], v[28:31], 0
  ds_read_b64_tr_b16 v[26:27], v10 offset:37376
  v_mul_f32 v145, 0x3e0293ee, v145
  v_mfma_f32_16x16x32_bf16 v[120:123], a[8:11], v[28:31], 0
  v_mul_f32 v146, 0x3e0293ee, v146
  v_mul_f32 v147, 0x3e0293ee, v147
  v_mfma_f32_16x16x32_bf16 v[124:127], a[12:15], v[28:31], 0
  s_waitcnt lgkmcnt(4)
  v_cvt_pk_bf16_f32 v128, v128, v129
  v_cvt_pk_bf16_f32 v129, v130, v131
  v_mfma_f32_16x16x32_bf16 v[64:67], a[16:19], v[16:19], v[64:67]
  ds_read_b64_tr_b16 v[28:29], v11 offset:36864
  v_cvt_pk_bf16_f32 v130, v144, v145
  v_mfma_f32_16x16x32_bf16 v[68:71], a[20:23], v[16:19], v[68:71]
  s_add_u32 s26, s8, 3407872
  s_addc_u32 s27, s9, 0
  s_add_u32 m0, s23, 86016
  ds_read_b64_tr_b16 v[30:31], v11 offset:37376
  v_cvt_pk_bf16_f32 v131, v146, v147
  v_mfma_f32_16x16x32_bf16 v[72:75], a[24:27], v[16:19], v[72:75]
  global_load_lds_dwordx4 v2, s[26:27]
  v_mfma_f32_16x16x32_bf16 v[76:79], a[28:31], v[16:19], v[76:79]
  s_waitcnt lgkmcnt(4)
  s_add_u32 s24, s8, 3670016
  s_addc_u32 s25, s9, 0
  v_mfma_f32_16x16x32_bf16 v[80:83], a[16:19], v[20:23], v[80:83]
  s_add_u32 m0, s23, 90112
  ds_read_b64_tr_b16 v[16:17], v8 offset:40960
  v_mfma_f32_16x16x32_bf16 v[84:87], a[20:23], v[20:23], v[84:87]
  ds_read_b64_tr_b16 v[18:19], v8 offset:41472
  v_mfma_f32_16x16x32_bf16 v[88:91], a[24:27], v[20:23], v[88:91]
  global_load_lds_dwordx4 v2, s[24:25]
  v_mfma_f32_16x16x32_bf16 v[92:95], a[28:31], v[20:23], v[92:95]
  s_waitcnt lgkmcnt(4)
  v_mul_f32 v160, 0x3e0293ee, v160
  v_mul_f32 v161, 0x3e0293ee, v161
  v_mfma_f32_16x16x32_bf16 v[96:99], a[16:19], v[24:27], v[96:99]
  ds_read_b64_tr_b16 v[20:21], v9 offset:40960
  v_mul_f32 v162, 0x3e0293ee, v162
  v_mfma_f32_16x16x32_bf16 v[100:103], a[20:23], v[24:27], v[100:103]
  ds_read_b64_tr_b16 v[22:23], v9 offset:41472
  v_mul_f32 v163, 0x3e0293ee, v163
  v_mfma_f32_16x16x32_bf16 v[104:107], a[24:27], v[24:27], v[104:107]
  v_mul_f32 v176, 0x3e0293ee, v176
  v_mul_f32 v177, 0x3e0293ee, v177
  v_mfma_f32_16x16x32_bf16 v[108:111], a[28:31], v[24:27], v[108:111]
  s_waitcnt lgkmcnt(4)
  v_mul_f32 v178, 0x3e0293ee, v178
  v_mul_f32 v179, 0x3e0293ee, v179
  v_mfma_f32_16x16x32_bf16 v[112:115], a[16:19], v[28:31], v[112:115]
  ds_read_b64_tr_b16 v[24:25], v10 offset:40960
  v_cvt_pk_bf16_f32 v160, v160, v161
  v_mfma_f32_16x16x32_bf16 v[116:119], a[20:23], v[28:31], v[116:119]
  ds_read_b64_tr_b16 v[26:27], v10 offset:41472
  v_cvt_pk_bf16_f32 v161, v162, v163
  v_mfma_f32_16x16x32_bf16 v[120:123], a[24:27], v[28:31], v[120:123]
  s_add_u32 s26, s8, 3932160
  s_addc_u32 s27, s9, 0
  s_add_u32 m0, s23, 94208
  v_cvt_pk_bf16_f32 v162, v176, v177
  v_cvt_pk_bf16_f32 v163, v178, v179
  v_mfma_f32_16x16x32_bf16 v[124:127], a[28:31], v[28:31], v[124:127]
  s_waitcnt lgkmcnt(4)
  global_load_lds_dwordx4 v2, s[26:27]
  v_mfma_f32_16x16x32_bf16 v[64:67], a[32:35], v[16:19], v[64:67]
  s_add_u32 s24, s8, 128
  s_addc_u32 s25, s9, 0
  ds_read_b64_tr_b16 v[28:29], v11 offset:40960
  v_mfma_f32_16x16x32_bf16 v[68:71], a[36:39], v[16:19], v[68:71]
  s_add_u32 m0, s23, 98304
  ds_read_b64_tr_b16 v[30:31], v11 offset:41472
  v_mfma_f32_16x16x32_bf16 v[72:75], a[40:43], v[16:19], v[72:75]
  global_load_lds_dwordx4 v2, s[24:25]
  v_mfma_f32_16x16x32_bf16 v[76:79], a[44:47], v[16:19], v[76:79]
  s_waitcnt lgkmcnt(4)
  v_mfma_f32_16x16x32_bf16 v[80:83], a[32:35], v[20:23], v[80:83]
  ds_read_b64_tr_b16 v[16:17], v8 offset:45056
  v_mul_f32 v192, 0x3e0293ee, v192
  v_mfma_f32_16x16x32_bf16 v[84:87], a[36:39], v[20:23], v[84:87]
  ds_read_b64_tr_b16 v[18:19], v8 offset:45568
  v_mul_f32 v193, 0x3e0293ee, v193
  v_mfma_f32_16x16x32_bf16 v[88:91], a[40:43], v[20:23], v[88:91]
  v_mul_f32 v194, 0x3e0293ee, v194
  v_mul_f32 v195, 0x3e0293ee, v195
  v_mfma_f32_16x16x32_bf16 v[92:95], a[44:47], v[20:23], v[92:95]
  s_waitcnt lgkmcnt(4)
  v_mul_f32 v208, 0x3e0293ee, v208
  v_mul_f32 v209, 0x3e0293ee, v209
  v_mfma_f32_16x16x32_bf16 v[96:99], a[32:35], v[24:27], v[96:99]
  ds_read_b64_tr_b16 v[20:21], v9 offset:45056
  v_mul_f32 v210, 0x3e0293ee, v210
  v_mfma_f32_16x16x32_bf16 v[100:103], a[36:39], v[24:27], v[100:103]
  ds_read_b64_tr_b16 v[22:23], v9 offset:45568
  v_mul_f32 v211, 0x3e0293ee, v211
  v_mfma_f32_16x16x32_bf16 v[104:107], a[40:43], v[24:27], v[104:107]
  v_cvt_pk_bf16_f32 v192, v192, v193
  v_cvt_pk_bf16_f32 v193, v194, v195
  v_mfma_f32_16x16x32_bf16 v[108:111], a[44:47], v[24:27], v[108:111]
  s_waitcnt lgkmcnt(4)
  v_cvt_pk_bf16_f32 v194, v208, v209
  v_cvt_pk_bf16_f32 v195, v210, v211
  v_mfma_f32_16x16x32_bf16 v[112:115], a[32:35], v[28:31], v[112:115]
  s_add_u32 s26, s8, 262272
  s_addc_u32 s27, s9, 0
  ds_read_b64_tr_b16 v[24:25], v10 offset:45056
  v_mfma_f32_16x16x32_bf16 v[116:119], a[36:39], v[28:31], v[116:119]
  s_add_u32 m0, s23, 102400
  ds_read_b64_tr_b16 v[26:27], v10 offset:45568
  v_mfma_f32_16x16x32_bf16 v[120:123], a[40:43], v[28:31], v[120:123]
  global_load_lds_dwordx4 v2, s[26:27]
  v_mfma_f32_16x16x32_bf16 v[124:127], a[44:47], v[28:31], v[124:127]
  s_waitcnt lgkmcnt(4)
  s_add_u32 s28, s10, 0
  s_addc_u32 s29, s11, 0
  v_mfma_f32_16x16x32_bf16 v[64:67], a[48:51], v[16:19], v[64:67]
  global_store_dwordx4 v4, v[128:131], s[28:29] offset:0 sc1
  ds_read_b64_tr_b16 v[28:29], v11 offset:45056
  v_mfma_f32_16x16x32_bf16 v[68:71], a[52:55], v[16:19], v[68:71]
  ds_read_b64_tr_b16 v[30:31], v11 offset:45568
  v_mul_f32 v224, 0x3e0293ee, v224
  v_mfma_f32_16x16x32_bf16 v[72:75], a[56:59], v[16:19], v[72:75]
  v_mul_f32 v225, 0x3e0293ee, v225
  v_mul_f32 v226, 0x3e0293ee, v226
  v_mfma_f32_16x16x32_bf16 v[76:79], a[60:63], v[16:19], v[76:79]
  s_waitcnt lgkmcnt(4)
  v_mul_f32 v227, 0x3e0293ee, v227
  v_mul_f32 v240, 0x3e0293ee, v240
  v_mfma_f32_16x16x32_bf16 v[80:83], a[48:51], v[20:23], v[80:83]
  ds_read_b64_tr_b16 v[16:17], v8 offset:49152
  v_mul_f32 v241, 0x3e0293ee, v241
  v_mfma_f32_16x16x32_bf16 v[84:87], a[52:55], v[20:23], v[84:87]
  ds_read_b64_tr_b16 v[18:19], v8 offset:49664
  v_mul_f32 v242, 0x3e0293ee, v242
  v_mfma_f32_16x16x32_bf16 v[88:91], a[56:59], v[20:23], v[88:91]
  v_mul_f32 v243, 0x3e0293ee, v243
  v_cvt_pk_bf16_f32 v224, v224, v225
  v_mfma_f32_16x16x32_bf16 v[92:95], a[60:63], v[20:23], v[92:95]
  s_waitcnt lgkmcnt(4)
  v_cvt_pk_bf16_f32 v225, v226, v227
  v_cvt_pk_bf16_f32 v226, v240, v241
  v_mfma_f32_16x16x32_bf16 v[96:99], a[48:51], v[24:27], v[96:99]
  ds_read_b64_tr_b16 v[20:21], v9 offset:49152
  v_cvt_pk_bf16_f32 v227, v242, v243
  v_mfma_f32_16x16x32_bf16 v[100:103], a[52:55], v[24:27], v[100:103]
  s_add_u32 s24, s8, 524416
  s_addc_u32 s25, s9, 0
  s_add_u32 m0, s23, 106496
  ds_read_b64_tr_b16 v[22:23], v9 offset:49664
  v_mfma_f32_16x16x32_bf16 v[104:107], a[56:59], v[24:27], v[104:107]
  global_load_lds_dwordx4 v2, s[24:25]
  v_mfma_f32_16x16x32_bf16 v[108:111], a[60:63], v[24:27], v[108:111]
  s_waitcnt lgkmcnt(4)
  s_add_u32 s26, s8, 786560
  s_addc_u32 s27, s9, 0
  v_mfma_f32_16x16x32_bf16 v[112:115], a[48:51], v[28:31], v[112:115]
  s_add_u32 m0, s23, 110592
  ds_read_b64_tr_b16 v[24:25], v10 offset:49152
  v_mfma_f32_16x16x32_bf16 v[116:119], a[52:55], v[28:31], v[116:119]
  global_load_lds_dwordx4 v2, s[26:27]
  ds_read_b64_tr_b16 v[26:27], v10 offset:49664
  v_mfma_f32_16x16x32_bf16 v[120:123], a[56:59], v[28:31], v[120:123]
  v_mul_f32 v132, 0x3e0293ee, v132
  v_mul_f32 v133, 0x3e0293ee, v133
  v_mfma_f32_16x16x32_bf16 v[124:127], a[60:63], v[28:31], v[124:127]
  s_waitcnt lgkmcnt(4)
  v_mul_f32 v134, 0x3e0293ee, v134
  v_mul_f32 v135, 0x3e0293ee, v135
  v_mfma_f32_16x16x32_bf16 v[64:67], a[64:67], v[16:19], v[64:67]
  ds_read_b64_tr_b16 v[28:29], v11 offset:49152
  v_mul_f32 v148, 0x3e0293ee, v148
  v_mfma_f32_16x16x32_bf16 v[68:71], a[68:71], v[16:19], v[68:71]
  ds_read_b64_tr_b16 v[30:31], v11 offset:49664
  v_mul_f32 v149, 0x3e0293ee, v149
  v_mfma_f32_16x16x32_bf16 v[72:75], a[72:75], v[16:19], v[72:75]
  v_mul_f32 v150, 0x3e0293ee, v150
  v_mul_f32 v151, 0x3e0293ee, v151
  v_mfma_f32_16x16x32_bf16 v[76:79], a[76:79], v[16:19], v[76:79]
  s_waitcnt lgkmcnt(4)
  v_cvt_pk_bf16_f32 v132, v132, v133
  v_cvt_pk_bf16_f32 v133, v134, v135
  v_mfma_f32_16x16x32_bf16 v[80:83], a[64:67], v[20:23], v[80:83]
  ds_read_b64_tr_b16 v[16:17], v8 offset:53248
  v_cvt_pk_bf16_f32 v134, v148, v149
  v_mfma_f32_16x16x32_bf16 v[84:87], a[68:71], v[20:23], v[84:87]
  s_add_u32 s24, s8, 1048704
  s_addc_u32 s25, s9, 0
  s_add_u32 m0, s23, 114688
  ds_read_b64_tr_b16 v[18:19], v8 offset:53760
  v_cvt_pk_bf16_f32 v135, v150, v151
  v_mfma_f32_16x16x32_bf16 v[88:91], a[72:75], v[20:23], v[88:91]
  global_load_lds_dwordx4 v2, s[24:25]
  v_mfma_f32_16x16x32_bf16 v[92:95], a[76:79], v[20:23], v[92:95]
  s_waitcnt lgkmcnt(4)
  s_add_u32 s26, s8, 1310848
  s_addc_u32 s27, s9, 0
  v_mfma_f32_16x16x32_bf16 v[96:99], a[64:67], v[24:27], v[96:99]
  s_add_u32 m0, s23, 118784
  ds_read_b64_tr_b16 v[20:21], v9 offset:53248
  v_mfma_f32_16x16x32_bf16 v[100:103], a[68:71], v[24:27], v[100:103]
  ds_read_b64_tr_b16 v[22:23], v9 offset:53760
  v_mfma_f32_16x16x32_bf16 v[104:107], a[72:75], v[24:27], v[104:107]
  global_load_lds_dwordx4 v2, s[26:27]
  v_mfma_f32_16x16x32_bf16 v[108:111], a[76:79], v[24:27], v[108:111]
  s_waitcnt lgkmcnt(4)
  v_mul_f32 v164, 0x3e0293ee, v164
  v_mul_f32 v165, 0x3e0293ee, v165
  v_mfma_f32_16x16x32_bf16 v[112:115], a[64:67], v[28:31], v[112:115]
  ds_read_b64_tr_b16 v[24:25], v10 offset:53248
  v_mul_f32 v166, 0x3e0293ee, v166
  v_mfma_f32_16x16x32_bf16 v[116:119], a[68:71], v[28:31], v[116:119]
  ds_read_b64_tr_b16 v[26:27], v10 offset:53760
  v_mul_f32 v167, 0x3e0293ee, v167
  v_mfma_f32_16x16x32_bf16 v[120:123], a[72:75], v[28:31], v[120:123]
  v_mul_f32 v180, 0x3e0293ee, v180
  v_mul_f32 v181, 0x3e0293ee, v181
  v_mfma_f32_16x16x32_bf16 v[124:127], a[76:79], v[28:31], v[124:127]
  s_waitcnt lgkmcnt(4)
  v_mul_f32 v182, 0x3e0293ee, v182
  v_mul_f32 v183, 0x3e0293ee, v183
  v_mfma_f32_16x16x32_bf16 v[64:67], a[80:83], v[16:19], v[64:67]
  ds_read_b64_tr_b16 v[28:29], v11 offset:53248
  v_cvt_pk_bf16_f32 v164, v164, v165
  v_mfma_f32_16x16x32_bf16 v[68:71], a[84:87], v[16:19], v[68:71]
  ds_read_b64_tr_b16 v[30:31], v11 offset:53760
  v_cvt_pk_bf16_f32 v165, v166, v167
  v_mfma_f32_16x16x32_bf16 v[72:75], a[88:91], v[16:19], v[72:75]
  s_add_u32 s30, s10, 0
  s_addc_u32 s31, s11, 0
  v_cvt_pk_bf16_f32 v166, v180, v181
  v_cvt_pk_bf16_f32 v167, v182, v183
  v_mfma_f32_16x16x32_bf16 v[76:79], a[92:95], v[16:19], v[76:79]
  s_waitcnt lgkmcnt(4)
  global_store_dwordx4 v4, v[160:163], s[30:31] offset:1024 sc1
  v_mfma_f32_16x16x32_bf16 v[80:83], a[80:83], v[20:23], v[80:83]
  s_add_u32 s24, s8, 1572992
  s_addc_u32 s25, s9, 0
  ds_read_b64_tr_b16 v[16:17], v8 offset:57344
  v_mfma_f32_16x16x32_bf16 v[84:87], a[84:87], v[20:23], v[84:87]
  s_add_u32 m0, s23, 122880
  ds_read_b64_tr_b16 v[18:19], v8 offset:57856
  v_mfma_f32_16x16x32_bf16 v[88:91], a[88:91], v[20:23], v[88:91]
  global_load_lds_dwordx4 v2, s[24:25]
  v_mfma_f32_16x16x32_bf16 v[92:95], a[92:95], v[20:23], v[92:95]
  s_waitcnt lgkmcnt(4)
  v_mfma_f32_16x16x32_bf16 v[96:99], a[80:83], v[24:27], v[96:99]
  ds_read_b64_tr_b16 v[20:21], v9 offset:57344
  v_mul_f32 v196, 0x3e0293ee, v196
  v_mfma_f32_16x16x32_bf16 v[100:103], a[84:87], v[24:27], v[100:103]
  ds_read_b64_tr_b16 v[22:23], v9 offset:57856
  v_mul_f32 v197, 0x3e0293ee, v197
  v_mfma_f32_16x16x32_bf16 v[104:107], a[88:91], v[24:27], v[104:107]
  v_mul_f32 v198, 0x3e0293ee, v198
  v_mul_f32 v199, 0x3e0293ee, v199
  v_mfma_f32_16x16x32_bf16 v[108:111], a[92:95], v[24:27], v[108:111]
  s_waitcnt lgkmcnt(4)
  v_mul_f32 v212, 0x3e0293ee, v212
  v_mul_f32 v213, 0x3e0293ee, v213
  v_mfma_f32_16x16x32_bf16 v[112:115], a[80:83], v[28:31], v[112:115]
  ds_read_b64_tr_b16 v[24:25], v10 offset:57344
  v_mul_f32 v214, 0x3e0293ee, v214
  v_mfma_f32_16x16x32_bf16 v[116:119], a[84:87], v[28:31], v[116:119]
  ds_read_b64_tr_b16 v[26:27], v10 offset:57856
  v_mul_f32 v215, 0x3e0293ee, v215
  v_mfma_f32_16x16x32_bf16 v[120:123], a[88:91], v[28:31], v[120:123]
  v_cvt_pk_bf16_f32 v196, v196, v197
  v_cvt_pk_bf16_f32 v197, v198, v199
  v_mfma_f32_16x16x32_bf16 v[124:127], a[92:95], v[28:31], v[124:127]
  s_waitcnt lgkmcnt(4)
  v_cvt_pk_bf16_f32 v198, v212, v213
  v_cvt_pk_bf16_f32 v199, v214, v215
  v_mfma_f32_16x16x32_bf16 v[64:67], a[96:99], v[16:19], v[64:67]
  s_add_u32 s26, s8, 1835136
  s_addc_u32 s27, s9, 0
  ds_read_b64_tr_b16 v[28:29], v11 offset:57344
  v_mfma_f32_16x16x32_bf16 v[68:71], a[100:103], v[16:19], v[68:71]
  s_add_u32 m0, s23, 126976
  ds_read_b64_tr_b16 v[30:31], v11 offset:57856
  v_mfma_f32_16x16x32_bf16 v[72:75], a[104:107], v[16:19], v[72:75]
  global_load_lds_dwordx4 v2, s[26:27]
  v_mfma_f32_16x16x32_bf16 v[76:79], a[108:111], v[16:19], v[76:79]
  s_waitcnt lgkmcnt(4)
  s_add_u32 s28, s10, 0
  s_addc_u32 s29, s11, 0
  v_mfma_f32_16x16x32_bf16 v[80:83], a[96:99], v[20:23], v[80:83]
  global_store_dwordx4 v4, v[192:195], s[28:29] offset:2048 sc1
  ds_read_b64_tr_b16 v[16:17], v8 offset:61440
  v_mfma_f32_16x16x32_bf16 v[84:87], a[100:103], v[20:23], v[84:87]
  ds_read_b64_tr_b16 v[18:19], v8 offset:61952
  v_mul_f32 v228, 0x3e0293ee, v228
  v_mfma_f32_16x16x32_bf16 v[88:91], a[104:107], v[20:23], v[88:91]
  v_mul_f32 v229, 0x3e0293ee, v229
  v_mul_f32 v230, 0x3e0293ee, v230
  v_mfma_f32_16x16x32_bf16 v[92:95], a[108:111], v[20:23], v[92:95]
  s_waitcnt lgkmcnt(4)
  v_mul_f32 v231, 0x3e0293ee, v231
  v_mul_f32 v244, 0x3e0293ee, v244
  v_mfma_f32_16x16x32_bf16 v[96:99], a[96:99], v[24:27], v[96:99]
  ds_read_b64_tr_b16 v[20:21], v9 offset:61440
  v_mul_f32 v245, 0x3e0293ee, v245
  v_mfma_f32_16x16x32_bf16 v[100:103], a[100:103], v[24:27], v[100:103]
  ds_read_b64_tr_b16 v[22:23], v9 offset:61952
  v_mul_f32 v246, 0x3e0293ee, v246
  v_mfma_f32_16x16x32_bf16 v[104:107], a[104:107], v[24:27], v[104:107]
  v_mul_f32 v247, 0x3e0293ee, v247
  v_cvt_pk_bf16_f32 v228, v228, v229
  v_mfma_f32_16x16x32_bf16 v[108:111], a[108:111], v[24:27], v[108:111]
  s_waitcnt lgkmcnt(4)
  v_cvt_pk_bf16_f32 v229, v230, v231
  v_cvt_pk_bf16_f32 v230, v244, v245
  v_mfma_f32_16x16x32_bf16 v[112:115], a[96:99], v[28:31], v[112:115]
  ds_read_b64_tr_b16 v[24:25], v10 offset:61440
  v_cvt_pk_bf16_f32 v231, v246, v247
  v_mfma_f32_16x16x32_bf16 v[116:119], a[100:103], v[28:31], v[116:119]
  s_add_u32 s30, s10, 0
  s_addc_u32 s31, s11, 0
  ds_read_b64_tr_b16 v[26:27], v10 offset:61952
  v_mfma_f32_16x16x32_bf16 v[120:123], a[104:107], v[28:31], v[120:123]
  global_store_dwordx4 v4, v[224:227], s[30:31] offset:3072 sc1
  v_mfma_f32_16x16x32_bf16 v[124:127], a[108:111], v[28:31], v[124:127]
  s_waitcnt lgkmcnt(4)
  s_add_u32 s28, s10, 4096
  s_addc_u32 s29, s11, 0
  v_mfma_f32_16x16x32_bf16 v[64:67], a[112:115], v[16:19], v[64:67]
  global_store_dwordx4 v4, v[132:135], s[28:29] offset:0 sc1
  ds_read_b64_tr_b16 v[28:29], v11 offset:61440
  v_mfma_f32_16x16x32_bf16 v[68:71], a[116:119], v[16:19], v[68:71]
  ds_read_b64_tr_b16 v[30:31], v11 offset:61952
  v_mfma_f32_16x16x32_bf16 v[72:75], a[120:123], v[16:19], v[72:75]
  v_mul_f32 v136, 0x3e0293ee, v136
  v_mul_f32 v137, 0x3e0293ee, v137
  v_mfma_f32_16x16x32_bf16 v[76:79], a[124:127], v[16:19], v[76:79]
  s_waitcnt lgkmcnt(4)
  v_mul_f32 v138, 0x3e0293ee, v138
  v_mul_f32 v139, 0x3e0293ee, v139
  v_mfma_f32_16x16x32_bf16 v[80:83], a[112:115], v[20:23], v[80:83]
  s_waitcnt vmcnt(13)
  s_barrier
  v_mul_f32 v152, 0x3e0293ee, v152
  v_mfma_f32_16x16x32_bf16 v[84:87], a[116:119], v[20:23], v[84:87]
  ds_read_b64_tr_b16 v[16:17], v12 offset:0
  v_mul_f32 v153, 0x3e0293ee, v153
  v_mfma_f32_16x16x32_bf16 v[88:91], a[120:123], v[20:23], v[88:91]
  ds_read_b64_tr_b16 v[18:19], v12 offset:512
  v_mul_f32 v154, 0x3e0293ee, v154
  v_mfma_f32_16x16x32_bf16 v[92:95], a[124:127], v[20:23], v[92:95]
  s_waitcnt lgkmcnt(4)
  v_mul_f32 v155, 0x3e0293ee, v155
  v_cvt_pk_bf16_f32 v136, v136, v137
  v_mfma_f32_16x16x32_bf16 v[96:99], a[112:115], v[24:27], v[96:99]
  ds_read_b64_tr_b16 v[20:21], v13 offset:0
  v_cvt_pk_bf16_f32 v137, v138, v139
  v_mfma_f32_16x16x32_bf16 v[100:103], a[116:119], v[24:27], v[100:103]
  ds_read_b64_tr_b16 v[22:23], v13 offset:512
  v_cvt_pk_bf16_f32 v138, v152, v153
  v_mfma_f32_16x16x32_bf16 v[104:107], a[120:123], v[24:27], v[104:107]
  s_add_u32 s30, s10, 4096
  s_addc_u32 s31, s11, 0
  v_cvt_pk_bf16_f32 v139, v154, v155
  v_mfma_f32_16x16x32_bf16 v[108:111], a[124:127], v[24:27], v[108:111]
  s_waitcnt lgkmcnt(4)
  global_store_dwordx4 v4, v[164:167], s[30:31] offset:1024 sc1
  v_mfma_f32_16x16x32_bf16 v[112:115], a[112:115], v[28:31], v[112:115]
  s_add_u32 s24, s8, 2097280
  s_addc_u32 s25, s9, 0
  ds_read_b64_tr_b16 v[24:25], v14 offset:0
  v_mfma_f32_16x16x32_bf16 v[116:119], a[116:119], v[28:31], v[116:119]
  s_add_u32 m0, s23, 0
  ds_read_b64_tr_b16 v[26:27], v14 offset:512
  v_mfma_f32_16x16x32_bf16 v[120:123], a[120:123], v[28:31], v[120:123]
  global_load_lds_dwordx4 v2, s[24:25]
  v_mfma_f32_16x16x32_bf16 v[124:127], a[124:127], v[28:31], v[124:127]
  s_waitcnt lgkmcnt(4)
  v_mul_f32 v168, 0x3e0293ee, v168
  v_mul_f32 v169, 0x3e0293ee, v169
  v_mfma_f32_16x16x32_bf16 v[64:67], a[128:131], v[16:19], v[64:67]
  ds_read_b64_tr_b16 v[28:29], v15 offset:0
  v_mul_f32 v170, 0x3e0293ee, v170
  v_mfma_f32_16x16x32_bf16 v[68:71], a[132:135], v[16:19], v[68:71]
  ds_read_b64_tr_b16 v[30:31], v15 offset:512
  v_mul_f32 v171, 0x3e0293ee, v171
  v_mfma_f32_16x16x32_bf16 v[72:75], a[136:139], v[16:19], v[72:75]
  v_mul_f32 v184, 0x3e0293ee, v184
  v_mul_f32 v185, 0x3e0293ee, v185
  v_mfma_f32_16x16x32_bf16 v[76:79], a[140:143], v[16:19], v[76:79]
  s_waitcnt lgkmcnt(4)
  v_mul_f32 v186, 0x3e0293ee, v186
  v_mul_f32 v187, 0x3e0293ee, v187
  v_mfma_f32_16x16x32_bf16 v[80:83], a[128:131], v[20:23], v[80:83]
  ds_read_b64_tr_b16 v[16:17], v12 offset:4096
  v_cvt_pk_bf16_f32 v168, v168, v169
  v_mfma_f32_16x16x32_bf16 v[84:87], a[132:135], v[20:23], v[84:87]
  ds_read_b64_tr_b16 v[18:19], v12 offset:4608
  v_cvt_pk_bf16_f32 v169, v170, v171
  v_mfma_f32_16x16x32_bf16 v[88:91], a[136:139], v[20:23], v[88:91]
  s_add_u32 s28, s10, 4096
  s_addc_u32 s29, s11, 0
  v_cvt_pk_bf16_f32 v170, v184, v185
  v_cvt_pk_bf16_f32 v171, v186, v187
  v_mfma_f32_16x16x32_bf16 v[92:95], a[140:143], v[20:23], v[92:95]
  s_waitcnt lgkmcnt(4)
  global_store_dwordx4 v4, v[196:199], s[28:29] offset:2048 sc1
  v_mfma_f32_16x16x32_bf16 v[96:99], a[128:131], v[24:27], v[96:99]
  s_add_u32 s26, s8, 2359424
  s_addc_u32 s27, s9, 0
  ds_read_b64_tr_b16 v[20:21], v13 offset:4096
  v_mfma_f32_16x16x32_bf16 v[100:103], a[132:135], v[24:27], v[100:103]
  s_add_u32 m0, s23, 4096
  ds_read_b64_tr_b16 v[22:23], v13 offset:4608
  v_mfma_f32_16x16x32_bf16 v[104:107], a[136:139], v[24:27], v[104:107]
  global_load_lds_dwordx4 v2, s[26:27]
  v_mfma_f32_16x16x32_bf16 v[108:111], a[140:143], v[24:27], v[108:111]
  s_waitcnt lgkmcnt(4)
  v_mfma_f32_16x16x32_bf16 v[112:115], a[128:131], v[28:31], v[112:115]
  ds_read_b64_tr_b16 v[24:25], v14 offset:4096
  v_mul_f32 v200, 0x3e0293ee, v200
  v_mfma_f32_16x16x32_bf16 v[116:119], a[132:135], v[28:31], v[116:119]
  ds_read_b64_tr_b16 v[26:27], v14 offset:4608
  v_mul_f32 v201, 0x3e0293ee, v201
  v_mfma_f32_16x16x32_bf16 v[120:123], a[136:139], v[28:31], v[120:123]
  v_mul_f32 v202, 0x3e0293ee, v202
  v_mul_f32 v203, 0x3e0293ee, v203
  v_mfma_f32_16x16x32_bf16 v[124:127], a[140:143], v[28:31], v[124:127]
  s_waitcnt lgkmcnt(4)
  v_mul_f32 v216, 0x3e0293ee, v216
  v_mul_f32 v217, 0x3e0293ee, v217
  v_mfma_f32_16x16x32_bf16 v[64:67], a[144:147], v[16:19], v[64:67]
  ds_read_b64_tr_b16 v[28:29], v15 offset:4096
  v_mul_f32 v218, 0x3e0293ee, v218
  v_mfma_f32_16x16x32_bf16 v[68:71], a[148:151], v[16:19], v[68:71]
  ds_read_b64_tr_b16 v[30:31], v15 offset:4608
  v_mul_f32 v219, 0x3e0293ee, v219
  v_mfma_f32_16x16x32_bf16 v[72:75], a[152:155], v[16:19], v[72:75]
  v_cvt_pk_bf16_f32 v200, v200, v201
  v_cvt_pk_bf16_f32 v201, v202, v203
  v_mfma_f32_16x16x32_bf16 v[76:79], a[156:159], v[16:19], v[76:79]
  s_waitcnt lgkmcnt(4)
  v_cvt_pk_bf16_f32 v202, v216, v217
  v_cvt_pk_bf16_f32 v203, v218, v219
  v_mfma_f32_16x16x32_bf16 v[80:83], a[144:147], v[20:23], v[80:83]
  s_add_u32 s24, s8, 2621568
  s_addc_u32 s25, s9, 0
  ds_read_b64_tr_b16 v[16:17], v12 offset:8192
  v_mfma_f32_16x16x32_bf16 v[84:87], a[148:151], v[20:23], v[84:87]
  s_add_u32 m0, s23, 8192
  ds_read_b64_tr_b16 v[18:19], v12 offset:8704
  v_mfma_f32_16x16x32_bf16 v[88:91], a[152:155], v[20:23], v[88:91]
  global_load_lds_dwordx4 v2, s[24:25]
  v_and_b32 v60, 15, v1
  v_lshlrev_b32 v60, 2, v60
  s_sub_u32 s40, 15, s21
  s_lshl_b32 s40, s40, 7
  s_lshl_b32 s41, s21, 7
  v_mov_b32 v62, s40
  v_mov_b32 v63, s41
  v_cmp_gt_u32 vcc, 32, v1
  s_nop 1
  v_cndmask_b32 v62, v63, v62, vcc
  v_add_u32 v60, v60, v62
  v_add_u32 v60, 69632, v60
  global_load_dword v61, v60, s[68:69] sc1
  v_mfma_f32_16x16x32_bf16 v[92:95], a[156:159], v[20:23], v[92:95]
  s_waitcnt lgkmcnt(4)
  v_mfma_f32_16x16x32_bf16 v[96:99], a[144:147], v[24:27], v[96:99]
  ds_read_b64_tr_b16 v[20:21], v13 offset:8192
  v_mfma_f32_16x16x32_bf16 v[100:103], a[148:151], v[24:27], v[100:103]
  ds_read_b64_tr_b16 v[22:23], v13 offset:8704
  v_mul_f32 v232, 0x3e0293ee, v232
  v_mfma_f32_16x16x32_bf16 v[104:107], a[152:155], v[24:27], v[104:107]
  v_mul_f32 v233, 0x3e0293ee, v233
  v_mul_f32 v234, 0x3e0293ee, v234
  v_mfma_f32_16x16x32_bf16 v[108:111], a[156:159], v[24:27], v[108:111]
  s_waitcnt lgkmcnt(4)
  v_mul_f32 v235, 0x3e0293ee, v235
  v_mul_f32 v248, 0x3e0293ee, v248
  v_mfma_f32_16x16x32_bf16 v[112:115], a[144:147], v[28:31], v[112:115]
  ds_read_b64_tr_b16 v[24:25], v14 offset:8192
  v_mul_f32 v249, 0x3e0293ee, v249
  v_mfma_f32_16x16x32_bf16 v[116:119], a[148:151], v[28:31], v[116:119]
  ds_read_b64_tr_b16 v[26:27], v14 offset:8704
  v_mul_f32 v250, 0x3e0293ee, v250
  v_mfma_f32_16x16x32_bf16 v[120:123], a[152:155], v[28:31], v[120:123]
  v_mul_f32 v251, 0x3e0293ee, v251
  v_cvt_pk_bf16_f32 v232, v232, v233
  v_mfma_f32_16x16x32_bf16 v[124:127], a[156:159], v[28:31], v[124:127]
  s_waitcnt lgkmcnt(4)
  v_cvt_pk_bf16_f32 v233, v234, v235
  v_cvt_pk_bf16_f32 v234, v248, v249
  v_mfma_f32_16x16x32_bf16 v[64:67], a[160:163], v[16:19], v[64:67]
  ds_read_b64_tr_b16 v[28:29], v15 offset:8192
  v_cvt_pk_bf16_f32 v235, v250, v251
  v_mfma_f32_16x16x32_bf16 v[68:71], a[164:167], v[16:19], v[68:71]
  s_add_u32 s26, s8, 2883712
  s_addc_u32 s27, s9, 0
  s_add_u32 m0, s23, 12288
  ds_read_b64_tr_b16 v[30:31], v15 offset:8704
  v_mfma_f32_16x16x32_bf16 v[72:75], a[168:171], v[16:19], v[72:75]
  global_load_lds_dwordx4 v2, s[26:27]
  v_mfma_f32_16x16x32_bf16 v[76:79], a[172:175], v[16:19], v[76:79]
  s_waitcnt lgkmcnt(4)
  s_add_u32 s24, s8, 3145856
  s_addc_u32 s25, s9, 0
  v_mfma_f32_16x16x32_bf16 v[80:83], a[160:163], v[20:23], v[80:83]
  s_add_u32 m0, s23, 16384
  ds_read_b64_tr_b16 v[16:17], v12 offset:12288
  v_mfma_f32_16x16x32_bf16 v[84:87], a[164:167], v[20:23], v[84:87]
  global_load_lds_dwordx4 v2, s[24:25]
  ds_read_b64_tr_b16 v[18:19], v12 offset:12800
  v_mfma_f32_16x16x32_bf16 v[88:91], a[168:171], v[20:23], v[88:91]
  v_mul_f32 v140, 0x3e0293ee, v140
  v_mul_f32 v141, 0x3e0293ee, v141
  v_mfma_f32_16x16x32_bf16 v[92:95], a[172:175], v[20:23], v[92:95]
  s_waitcnt lgkmcnt(4)
  v_mul_f32 v142, 0x3e0293ee, v142
  v_mul_f32 v143, 0x3e0293ee, v143
  v_mfma_f32_16x16x32_bf16 v[96:99], a[160:163], v[24:27], v[96:99]
  ds_read_b64_tr_b16 v[20:21], v13 offset:12288
  v_mul_f32 v156, 0x3e0293ee, v156
  v_mfma_f32_16x16x32_bf16 v[100:103], a[164:167], v[24:27], v[100:103]
  ds_read_b64_tr_b16 v[22:23], v13 offset:12800
  v_mul_f32 v157, 0x3e0293ee, v157
  v_mfma_f32_16x16x32_bf16 v[104:107], a[168:171], v[24:27], v[104:107]
  v_mul_f32 v158, 0x3e0293ee, v158
  v_mul_f32 v159, 0x3e0293ee, v159
  v_mfma_f32_16x16x32_bf16 v[108:111], a[172:175], v[24:27], v[108:111]
  s_waitcnt lgkmcnt(4)
  v_cvt_pk_bf16_f32 v140, v140, v141
  v_cvt_pk_bf16_f32 v141, v142, v143
  v_mfma_f32_16x16x32_bf16 v[112:115], a[160:163], v[28:31], v[112:115]
  ds_read_b64_tr_b16 v[24:25], v14 offset:12288
  v_cvt_pk_bf16_f32 v142, v156, v157
  v_mfma_f32_16x16x32_bf16 v[116:119], a[164:167], v[28:31], v[116:119]
  s_add_u32 s30, s10, 4096
  s_addc_u32 s31, s11, 0
  ds_read_b64_tr_b16 v[26:27], v14 offset:12800
  v_cvt_pk_bf16_f32 v143, v158, v159
  v_mfma_f32_16x16x32_bf16 v[120:123], a[168:171], v[28:31], v[120:123]
  global_store_dwordx4 v4, v[228:231], s[30:31] offset:3072 sc1
  v_mfma_f32_16x16x32_bf16 v[124:127], a[172:175], v[28:31], v[124:127]
  s_waitcnt lgkmcnt(4)
  s_add_u32 s26, s8, 3408000
  s_addc_u32 s27, s9, 0
  v_mfma_f32_16x16x32_bf16 v[64:67], a[176:179], v[16:19], v[64:67]
  s_add_u32 m0, s23, 20480
  ds_read_b64_tr_b16 v[28:29], v15 offset:12288
  v_mfma_f32_16x16x32_bf16 v[68:71], a[180:183], v[16:19], v[68:71]
  ds_read_b64_tr_b16 v[30:31], v15 offset:12800
  v_mfma_f32_16x16x32_bf16 v[72:75], a[184:187], v[16:19], v[72:75]
  global_load_lds_dwordx4 v2, s[26:27]
  v_mfma_f32_16x16x32_bf16 v[76:79], a[188:191], v[16:19], v[76:79]
  s_waitcnt lgkmcnt(4)
  v_mul_f32 v172, 0x3e0293ee, v172
  v_mul_f32 v173, 0x3e0293ee, v173
  v_mfma_f32_16x16x32_bf16 v[80:83], a[176:179], v[20:23], v[80:83]
  ds_read_b64_tr_b16 v[16:17], v12 offset:16384
  v_mul_f32 v174, 0x3e0293ee, v174
  v_mfma_f32_16x16x32_bf16 v[84:87], a[180:183], v[20:23], v[84:87]
  ds_read_b64_tr_b16 v[18:19], v12 offset:16896
  v_mul_f32 v175, 0x3e0293ee, v175
  v_mfma_f32_16x16x32_bf16 v[88:91], a[184:187], v[20:23], v[88:91]
  v_mul_f32 v188, 0x3e0293ee, v188
  v_mul_f32 v189, 0x3e0293ee, v189
  v_mfma_f32_16x16x32_bf16 v[92:95], a[188:191], v[20:23], v[92:95]
  s_waitcnt lgkmcnt(4)
  v_mul_f32 v190, 0x3e0293ee, v190
  v_mul_f32 v191, 0x3e0293ee, v191
  v_mfma_f32_16x16x32_bf16 v[96:99], a[176:179], v[24:27], v[96:99]
  ds_read_b64_tr_b16 v[20:21], v13 offset:16384
  v_cvt_pk_bf16_f32 v172, v172, v173
  v_mfma_f32_16x16x32_bf16 v[100:103], a[180:183], v[24:27], v[100:103]
  ds_read_b64_tr_b16 v[22:23], v13 offset:16896
  v_cvt_pk_bf16_f32 v173, v174, v175
  v_mfma_f32_16x16x32_bf16 v[104:107], a[184:187], v[24:27], v[104:107]
  s_add_u32 s24, s8, 3670144
  s_addc_u32 s25, s9, 0
  s_add_u32 m0, s23, 24576
  v_cvt_pk_bf16_f32 v174, v188, v189
  v_cvt_pk_bf16_f32 v175, v190, v191
  v_mfma_f32_16x16x32_bf16 v[108:111], a[188:191], v[24:27], v[108:111]
  s_waitcnt lgkmcnt(4)
  global_load_lds_dwordx4 v2, s[24:25]
  v_mfma_f32_16x16x32_bf16 v[112:115], a[176:179], v[28:31], v[112:115]
  s_add_u32 s26, s8, 3932288
  s_addc_u32 s27, s9, 0
  ds_read_b64_tr_b16 v[24:25], v14 offset:16384
  v_mfma_f32_16x16x32_bf16 v[116:119], a[180:183], v[28:31], v[116:119]
  s_add_u32 m0, s23, 28672
  ds_read_b64_tr_b16 v[26:27], v14 offset:16896
  v_mfma_f32_16x16x32_bf16 v[120:123], a[184:187], v[28:31], v[120:123]
  global_load_lds_dwordx4 v2, s[26:27]
  v_mfma_f32_16x16x32_bf16 v[124:127], a[188:191], v[28:31], v[124:127]
  s_waitcnt lgkmcnt(4)
  v_mfma_f32_16x16x32_bf16 v[64:67], a[192:195], v[16:19], v[64:67]
  ds_read_b64_tr_b16 v[28:29], v15 offset:16384
  v_mul_f32 v204, 0x3e0293ee, v204
  v_mfma_f32_16x16x32_bf16 v[68:71], a[196:199], v[16:19], v[68:71]
  ds_read_b64_tr_b16 v[30:31], v15 offset:16896
  v_mul_f32 v205, 0x3e0293ee, v205
  v_mfma_f32_16x16x32_bf16 v[72:75], a[200:203], v[16:19], v[72:75]
  v_mul_f32 v206, 0x3e0293ee, v206
  v_mul_f32 v207, 0x3e0293ee, v207
  v_mfma_f32_16x16x32_bf16 v[76:79], a[204:207], v[16:19], v[76:79]
  s_waitcnt lgkmcnt(4)
  v_mul_f32 v220, 0x3e0293ee, v220
  v_mul_f32 v221, 0x3e0293ee, v221
  v_mfma_f32_16x16x32_bf16 v[80:83], a[192:195], v[20:23], v[80:83]
  ds_read_b64_tr_b16 v[16:17], v12 offset:20480
  v_mul_f32 v222, 0x3e0293ee, v222
  v_mfma_f32_16x16x32_bf16 v[84:87], a[196:199], v[20:23], v[84:87]
  ds_read_b64_tr_b16 v[18:19], v12 offset:20992
  v_mul_f32 v223, 0x3e0293ee, v223
  v_mfma_f32_16x16x32_bf16 v[88:91], a[200:203], v[20:23], v[88:91]
  v_cvt_pk_bf16_f32 v204, v204, v205
  v_cvt_pk_bf16_f32 v205, v206, v207
  v_mfma_f32_16x16x32_bf16 v[92:95], a[204:207], v[20:23], v[92:95]
  s_waitcnt lgkmcnt(4)
  v_cvt_pk_bf16_f32 v206, v220, v221
  v_cvt_pk_bf16_f32 v207, v222, v223
  v_mfma_f32_16x16x32_bf16 v[96:99], a[192:195], v[24:27], v[96:99]
  s_add_u32 s28, s10, 16384
  s_addc_u32 s29, s11, 0
  ds_read_b64_tr_b16 v[20:21], v13 offset:20480
  v_mfma_f32_16x16x32_bf16 v[100:103], a[196:199], v[24:27], v[100:103]
  ds_read_b64_tr_b16 v[22:23], v13 offset:20992
  v_mfma_f32_16x16x32_bf16 v[104:107], a[200:203], v[24:27], v[104:107]
  global_store_dwordx4 v4, v[136:139], s[28:29] offset:0 sc1
  v_mfma_f32_16x16x32_bf16 v[108:111], a[204:207], v[24:27], v[108:111]
  s_waitcnt lgkmcnt(4)
  s_add_u32 s30, s10, 16384
  s_addc_u32 s31, s11, 0
  v_mfma_f32_16x16x32_bf16 v[112:115], a[192:195], v[28:31], v[112:115]
  global_store_dwordx4 v4, v[168:171], s[30:31] offset:1024 sc1
  ds_read_b64_tr_b16 v[24:25], v14 offset:20480
  v_mfma_f32_16x16x32_bf16 v[116:119], a[196:199], v[28:31], v[116:119]
  ds_read_b64_tr_b16 v[26:27], v14 offset:20992
  v_mul_f32 v236, 0x3e0293ee, v236
  v_mfma_f32_16x16x32_bf16 v[120:123], a[200:203], v[28:31], v[120:123]
  v_mul_f32 v237, 0x3e0293ee, v237
  v_mul_f32 v238, 0x3e0293ee, v238
  v_mfma_f32_16x16x32_bf16 v[124:127], a[204:207], v[28:31], v[124:127]
  s_waitcnt lgkmcnt(4)
  v_mul_f32 v239, 0x3e0293ee, v239
  v_mul_f32 v252, 0x3e0293ee, v252
  v_mfma_f32_16x16x32_bf16 v[64:67], a[208:211], v[16:19], v[64:67]
  ds_read_b64_tr_b16 v[28:29], v15 offset:20480
  v_mul_f32 v253, 0x3e0293ee, v253
  v_mfma_f32_16x16x32_bf16 v[68:71], a[212:215], v[16:19], v[68:71]
  ds_read_b64_tr_b16 v[30:31], v15 offset:20992
  v_mul_f32 v254, 0x3e0293ee, v254
  v_mfma_f32_16x16x32_bf16 v[72:75], a[216:219], v[16:19], v[72:75]
  v_mul_f32 v255, 0x3e0293ee, v255
  v_cvt_pk_bf16_f32 v236, v236, v237
  v_mfma_f32_16x16x32_bf16 v[76:79], a[220:223], v[16:19], v[76:79]
  s_waitcnt lgkmcnt(4)
  v_cvt_pk_bf16_f32 v237, v238, v239
  v_cvt_pk_bf16_f32 v238, v252, v253
  v_mfma_f32_16x16x32_bf16 v[80:83], a[208:211], v[20:23], v[80:83]
  ds_read_b64_tr_b16 v[16:17], v12 offset:24576
  v_cvt_pk_bf16_f32 v239, v254, v255
  v_mfma_f32_16x16x32_bf16 v[84:87], a[212:215], v[20:23], v[84:87]
  s_add_u32 s28, s10, 16384
  s_addc_u32 s29, s11, 0
  ds_read_b64_tr_b16 v[18:19], v12 offset:25088
  v_mfma_f32_16x16x32_bf16 v[88:91], a[216:219], v[20:23], v[88:91]
  global_store_dwordx4 v4, v[200:203], s[28:29] offset:2048 sc1
  v_mfma_f32_16x16x32_bf16 v[92:95], a[220:223], v[20:23], v[92:95]
  s_waitcnt lgkmcnt(4)
  v_mfma_f32_16x16x32_bf16 v[96:99], a[208:211], v[24:27], v[96:99]
  s_add_u32 s30, s10, 16384
  s_addc_u32 s31, s11, 0
  ds_read_b64_tr_b16 v[20:21], v13 offset:24576
  v_mfma_f32_16x16x32_bf16 v[100:103], a[212:215], v[24:27], v[100:103]
  ds_read_b64_tr_b16 v[22:23], v13 offset:25088
  v_mfma_f32_16x16x32_bf16 v[104:107], a[216:219], v[24:27], v[104:107]
  global_store_dwordx4 v4, v[232:235], s[30:31] offset:3072 sc1
  v_mfma_f32_16x16x32_bf16 v[108:111], a[220:223], v[24:27], v[108:111]
  s_waitcnt lgkmcnt(4)
  v_mfma_f32_16x16x32_bf16 v[112:115], a[208:211], v[28:31], v[112:115]
  s_add_u32 s28, s10, 20480
  s_addc_u32 s29, s11, 0
  ds_read_b64_tr_b16 v[24:25], v14 offset:24576
  v_mfma_f32_16x16x32_bf16 v[116:119], a[212:215], v[28:31], v[116:119]
  ds_read_b64_tr_b16 v[26:27], v14 offset:25088
  v_mfma_f32_16x16x32_bf16 v[120:123], a[216:219], v[28:31], v[120:123]
  global_store_dwordx4 v4, v[140:143], s[28:29] offset:0 sc1
  v_mfma_f32_16x16x32_bf16 v[124:127], a[220:223], v[28:31], v[124:127]
  s_waitcnt lgkmcnt(4)
  v_mfma_f32_16x16x32_bf16 v[64:67], a[224:227], v[16:19], v[64:67]
  s_add_u32 s30, s10, 20480
  s_addc_u32 s31, s11, 0
  ds_read_b64_tr_b16 v[28:29], v15 offset:24576
  v_mfma_f32_16x16x32_bf16 v[68:71], a[228:231], v[16:19], v[68:71]
  ds_read_b64_tr_b16 v[30:31], v15 offset:25088
  v_mfma_f32_16x16x32_bf16 v[72:75], a[232:235], v[16:19], v[72:75]
  global_store_dwordx4 v4, v[172:175], s[30:31] offset:1024 sc1
  v_mfma_f32_16x16x32_bf16 v[76:79], a[236:239], v[16:19], v[76:79]
  s_waitcnt lgkmcnt(4)
  v_mfma_f32_16x16x32_bf16 v[80:83], a[224:227], v[20:23], v[80:83]
  ds_read_b64_tr_b16 v[16:17], v12 offset:28672
  v_mfma_f32_16x16x32_bf16 v[84:87], a[228:231], v[20:23], v[84:87]
  ds_read_b64_tr_b16 v[18:19], v12 offset:29184
  v_mfma_f32_16x16x32_bf16 v[88:91], a[232:235], v[20:23], v[88:91]
  v_mfma_f32_16x16x32_bf16 v[92:95], a[236:239], v[20:23], v[92:95]
  s_waitcnt lgkmcnt(4)
  v_mfma_f32_16x16x32_bf16 v[96:99], a[224:227], v[24:27], v[96:99]
  ds_read_b64_tr_b16 v[20:21], v13 offset:28672
  v_mfma_f32_16x16x32_bf16 v[100:103], a[228:231], v[24:27], v[100:103]
  ds_read_b64_tr_b16 v[22:23], v13 offset:29184
  v_mfma_f32_16x16x32_bf16 v[104:107], a[232:235], v[24:27], v[104:107]
  v_mfma_f32_16x16x32_bf16 v[108:111], a[236:239], v[24:27], v[108:111]
  s_waitcnt lgkmcnt(4)
  v_mfma_f32_16x16x32_bf16 v[112:115], a[224:227], v[28:31], v[112:115]
  ds_read_b64_tr_b16 v[24:25], v14 offset:28672
  v_mfma_f32_16x16x32_bf16 v[116:119], a[228:231], v[28:31], v[116:119]
  ds_read_b64_tr_b16 v[26:27], v14 offset:29184
  v_mfma_f32_16x16x32_bf16 v[120:123], a[232:235], v[28:31], v[120:123]
  v_mfma_f32_16x16x32_bf16 v[124:127], a[236:239], v[28:31], v[124:127]
  s_waitcnt lgkmcnt(4)
  v_mfma_f32_16x16x32_bf16 v[64:67], a[240:243], v[16:19], v[64:67]
  s_add_u32 s28, s10, 20480
  s_addc_u32 s29, s11, 0
  ds_read_b64_tr_b16 v[28:29], v15 offset:28672
  v_mfma_f32_16x16x32_bf16 v[68:71], a[244:247], v[16:19], v[68:71]
  ds_read_b64_tr_b16 v[30:31], v15 offset:29184
  v_mfma_f32_16x16x32_bf16 v[72:75], a[248:251], v[16:19], v[72:75]
  global_store_dwordx4 v4, v[204:207], s[28:29] offset:2048 sc1
  v_mfma_f32_16x16x32_bf16 v[76:79], a[252:255], v[16:19], v[76:79]
  s_waitcnt lgkmcnt(4)
  v_mfma_f32_16x16x32_bf16 v[80:83], a[240:243], v[20:23], v[80:83]
  s_waitcnt vmcnt(22)
  s_barrier
  v_mfma_f32_16x16x32_bf16 v[84:87], a[244:247], v[20:23], v[84:87]
  ds_read_b64_tr_b16 v[16:17], v12 offset:32768
  v_mfma_f32_16x16x32_bf16 v[88:91], a[248:251], v[20:23], v[88:91]
  s_add_u32 s42, s72, 0
  s_and_b32 s42, s42, 15
  ds_read_b64_tr_b16 v[18:19], v12 offset:33280
  v_mfma_f32_16x16x32_bf16 v[92:95], a[252:255], v[20:23], v[92:95]
  s_waitcnt lgkmcnt(4)
  s_mul_i32 s42, s42, 88064
  v_mfma_f32_16x16x32_bf16 v[96:99], a[240:243], v[24:27], v[96:99]
  s_add_u32 s24, s14, s42
  s_addc_u32 s25, s15, 0
  ds_read_b64_tr_b16 v[20:21], v13 offset:32768
  v_mfma_f32_16x16x32_bf16 v[100:103], a[244:247], v[24:27], v[100:103]
  s_add_u32 m0, s23, 32768
  ds_read_b64_tr_b16 v[22:23], v13 offset:33280
  v_mfma_f32_16x16x32_bf16 v[104:107], a[248:251], v[24:27], v[104:107]
  global_load_lds_dwordx4 v3, s[24:25]
  v_mfma_f32_16x16x32_bf16 v[108:111], a[252:255], v[24:27], v[108:111]
  s_waitcnt lgkmcnt(4)
  s_add_u32 s26, s16, s42
  s_addc_u32 s27, s17, 0
  v_mfma_f32_16x16x32_bf16 v[112:115], a[240:243], v[28:31], v[112:115]
  s_add_u32 m0, s23, 36864
  ds_read_b64_tr_b16 v[24:25], v14 offset:32768
  v_mfma_f32_16x16x32_bf16 v[116:119], a[244:247], v[28:31], v[116:119]
  ds_read_b64_tr_b16 v[26:27], v14 offset:33280
  v_mfma_f32_16x16x32_bf16 v[120:123], a[248:251], v[28:31], v[120:123]
  global_load_lds_dwordx4 v3, s[26:27]
  v_mfma_f32_16x16x32_bf16 v[124:127], a[252:255], v[28:31], v[124:127]
  s_waitcnt lgkmcnt(4)
  s_add_u32 s43, s72, 1
  s_and_b32 s43, s43, 15
  v_mfma_f32_16x16x32_bf16 v[144:147], a[0:3], v[16:19], 0
  s_mul_i32 s43, s43, 88064
  ds_read_b64_tr_b16 v[28:29], v15 offset:32768
  v_mfma_f32_16x16x32_bf16 v[148:151], a[4:7], v[16:19], 0
  s_add_u32 s24, s14, s43
  s_addc_u32 s25, s15, 0
  s_add_u32 m0, s23, 40960
  ds_read_b64_tr_b16 v[30:31], v15 offset:33280
  v_mfma_f32_16x16x32_bf16 v[152:155], a[8:11], v[16:19], 0
  global_load_lds_dwordx4 v3, s[24:25]
  v_mfma_f32_16x16x32_bf16 v[156:159], a[12:15], v[16:19], 0
  s_waitcnt lgkmcnt(4)
  v_mfma_f32_16x16x32_bf16 v[176:179], a[0:3], v[20:23], 0
  s_add_u32 s30, s10, 20480
  s_addc_u32 s31, s11, 0
  ds_read_b64_tr_b16 v[16:17], v12 offset:36864
  s_waitcnt vmcnt(16)
  v_cmp_ne_u32 vcc, s71, v61
  s_nop 3
  s_cmp_eq_u64 vcc, 0
  s_cbranch_scc0 L_spin3
L_back3:
  v_mfma_f32_16x16x32_bf16 v[180:183], a[4:7], v[20:23], 0
  ds_read_b64_tr_b16 v[18:19], v12 offset:37376
  v_mfma_f32_16x16x32_bf16 v[184:187], a[8:11], v[20:23], 0
  global_store_dwordx4 v4, v[236:239], s[30:31] offset:3072 sc1
  v_mfma_f32_16x16x32_bf16 v[188:191], a[12:15], v[20:23], 0
  s_waitcnt lgkmcnt(4)
  s_add_u32 s26, s16, s43
  s_addc_u32 s27, s17, 0
  v_mfma_f32_16x16x32_bf16 v[208:211], a[0:3], v[24:27], 0
  s_add_u32 m0, s23, 45056
  ds_read_b64_tr_b16 v[20:21], v13 offset:36864
  v_mfma_f32_16x16x32_bf16 v[212:215], a[4:7], v[24:27], 0
  global_load_lds_dwordx4 v3, s[26:27]
  ds_read_b64_tr_b16 v[22:23], v13 offset:37376
  v_mfma_f32_16x16x32_bf16 v[216:219], a[8:11], v[24:27], 0
  s_add_u32 s42, s72, 2
  s_and_b32 s42, s42, 15
  v_cvt_pk_bf16_f32 v64, v64, v65
  v_mfma_f32_16x16x32_bf16 v[220:223], a[12:15], v[24:27], 0
  s_waitcnt lgkmcnt(4)
  s_mul_i32 s42, s42, 88064
  v_cvt_pk_bf16_f32 v65, v66, v67
  v_mfma_f32_16x16x32_bf16 v[240:243], a[0:3], v[28:31], 0
  ds_read_b64_tr_b16 v[24:25], v14 offset:36864
  v_cvt_pk_bf16_f32 v66, v68, v69
  v_mfma_f32_16x16x32_bf16 v[244:247], a[4:7], v[28:31], 0
  s_add_u32 s24, s14, s42
  s_addc_u32 s25, s15, 0
  s_add_u32 m0, s23, 49152
  ds_read_b64_tr_b16 v[26:27], v14 offset:37376
  v_cvt_pk_bf16_f32 v67, v70, v71
  v_mfma_f32_16x16x32_bf16 v[248:251], a[8:11], v[28:31], 0
  global_load_lds_dwordx4 v3, s[24:25]
  v_mfma_f32_16x16x32_bf16 v[252:255], a[12:15], v[28:31], 0
  s_waitcnt lgkmcnt(4)
  s_add_u32 s26, s16, s42
  s_addc_u32 s27, s17, 0
  v_mfma_f32_16x16x32_bf16 v[144:147], a[16:19], v[16:19], v[144:147]
  s_add_u32 m0, s23, 53248
  ds_read_b64_tr_b16 v[28:29], v15 offset:36864
  v_cvt_pk_bf16_f32 v80, v80, v81
  v_mfma_f32_16x16x32_bf16 v[148:151], a[20:23], v[16:19], v[148:151]
  ds_read_b64_tr_b16 v[30:31], v15 offset:37376
  v_cvt_pk_bf16_f32 v81, v82, v83
  v_mfma_f32_16x16x32_bf16 v[152:155], a[24:27], v[16:19], v[152:155]
  global_load_lds_dwordx4 v3, s[26:27]
  v_cvt_pk_bf16_f32 v82, v84, v85
  v_mfma_f32_16x16x32_bf16 v[156:159], a[28:31], v[16:19], v[156:159]
  s_waitcnt lgkmcnt(4)
  s_add_u32 s43, s72, 3
  v_cvt_pk_bf16_f32 v83, v86, v87
  v_mfma_f32_16x16x32_bf16 v[176:179], a[16:19], v[20:23], v[176:179]
  s_and_b32 s43, s43, 15
  s_mul_i32 s43, s43, 88064
  ds_read_b64_tr_b16 v[16:17], v12 offset:40960
  v_mfma_f32_16x16x32_bf16 v[180:183], a[20:23], v[20:23], v[180:183]
  s_add_u32 s24, s14, s43
  s_addc_u32 s25, s15, 0
  s_add_u32 m0, s23, 57344
  ds_read_b64_tr_b16 v[18:19], v12 offset:41472
  v_mfma_f32_16x16x32_bf16 v[184:187], a[24:27], v[20:23], v[184:187]
  global_load_lds_dwordx4 v3, s[24:25]
  v_cvt_pk_bf16_f32 v96, v96, v97
  v_mfma_f32_16x16x32_bf16 v[188:191], a[28:31], v[20:23], v[188:191]
  s_waitcnt lgkmcnt(4)
  v_cvt_pk_bf16_f32 v97, v98, v99
  v_mfma_f32_16x16x32_bf16 v[208:211], a[16:19], v[24:27], v[208:211]
  ds_read_b64_tr_b16 v[20:21], v13 offset:40960
  v_cvt_pk_bf16_f32 v98, v100, v101
  v_mfma_f32_16x16x32_bf16 v[212:215], a[20:23], v[24:27], v[212:215]
  s_add_u32 s26, s16, s43
  s_addc_u32 s27, s17, 0
  s_add_u32 m0, s23, 61440
  ds_read_b64_tr_b16 v[22:23], v13 offset:41472
  v_cvt_pk_bf16_f32 v99, v102, v103
  v_mfma_f32_16x16x32_bf16 v[216:219], a[24:27], v[24:27], v[216:219]
  global_load_lds_dwordx4 v3, s[26:27]
  v_mfma_f32_16x16x32_bf16 v[220:223], a[28:31], v[24:27], v[220:223]
  s_waitcnt lgkmcnt(4)
  s_add_u32 s38, s72, 0
  s_and_b32 s38, s38, 15
  v_mfma_f32_16x16x32_bf16 v[240:243], a[16:19], v[28:31], v[240:243]
  s_lshl_b32 s38, s38, 10
  ds_read_b64_tr_b16 v[24:25], v14 offset:40960
  v_cvt_pk_bf16_f32 v112, v112, v113
  v_mfma_f32_16x16x32_bf16 v[244:247], a[20:23], v[28:31], v[244:247]
  s_add_u32 s38, s60, s38
  s_addc_u32 s39, s61, 0
  ds_read_b64_tr_b16 v[26:27], v14 offset:41472
  v_cvt_pk_bf16_f32 v113, v114, v115
  v_mfma_f32_16x16x32_bf16 v[248:251], a[24:27], v[28:31], v[248:251]
  global_load_dwordx4 a[0:3], v48, s[38:39]
  v_cvt_pk_bf16_f32 v114, v116, v117
  v_mfma_f32_16x16x32_bf16 v[252:255], a[28:31], v[28:31], v[252:255]
  s_waitcnt lgkmcnt(4)
  global_load_dwordx4 a[4:7], v49, s[38:39]
  v_cvt_pk_bf16_f32 v115, v118, v119
  v_mfma_f32_16x16x32_bf16 v[144:147], a[32:35], v[16:19], v[144:147]
  ds_read_b64_tr_b16 v[28:29], v15 offset:40960
  v_mfma_f32_16x16x32_bf16 v[148:151], a[36:39], v[16:19], v[148:151]
  ds_read_b64_tr_b16 v[30:31], v15 offset:41472
  v_mfma_f32_16x16x32_bf16 v[152:155], a[40:43], v[16:19], v[152:155]
  v_cvt_pk_bf16_f32 v72, v72, v73
  v_mfma_f32_16x16x32_bf16 v[156:159], a[44:47], v[16:19], v[156:159]
  s_waitcnt lgkmcnt(4)
  v_cvt_pk_bf16_f32 v73, v74, v75
  v_mfma_f32_16x16x32_bf16 v[176:179], a[32:35], v[20:23], v[176:179]
  ds_read_b64_tr_b16 v[16:17], v12 offset:45056
  v_cvt_pk_bf16_f32 v74, v76, v77
  v_mfma_f32_16x16x32_bf16 v[180:183], a[36:39], v[20:23], v[180:183]
  ds_read_b64_tr_b16 v[18:19], v12 offset:45568
  v_cvt_pk_bf16_f32 v75, v78, v79
  v_mfma_f32_16x16x32_bf16 v[184:187], a[40:43], v[20:23], v[184:187]
  global_load_dwordx4 a[8:11], v50, s[38:39]
  v_mfma_f32_16x16x32_bf16 v[188:191], a[44:47], v[20:23], v[188:191]
  s_waitcnt lgkmcnt(4)
  v_mfma_f32_16x16x32_bf16 v[208:211], a[32:35], v[24:27], v[208:211]
  ds_read_b64_tr_b16 v[20:21], v13 offset:45056
  v_cvt_pk_bf16_f32 v88, v88, v89
  v_mfma_f32_16x16x32_bf16 v[212:215], a[36:39], v[24:27], v[212:215]
  ds_read_b64_tr_b16 v[22:23], v13 offset:45568
  v_cvt_pk_bf16_f32 v89, v90, v91
  v_mfma_f32_16x16x32_bf16 v[216:219], a[40:43], v[24:27], v[216:219]
  global_load_dwordx4 a[12:15], v51, s[38:39]
  v_cvt_pk_bf16_f32 v90, v92, v93
  v_mfma_f32_16x16x32_bf16 v[220:223], a[44:47], v[24:27], v[220:223]
  s_waitcnt lgkmcnt(4)
  s_add_u32 s46, s72, 1
  v_cvt_pk_bf16_f32 v91, v94, v95
  v_mfma_f32_16x16x32_bf16 v[240:243], a[32:35], v[28:31], v[240:243]
  s_and_b32 s46, s46, 15
  s_lshl_b32 s46, s46, 10
  s_add_u32 s46, s60, s46
  s_addc_u32 s47, s61, 0
  ds_read_b64_tr_b16 v[24:25], v14 offset:45056
  v_mfma_f32_16x16x32_bf16 v[244:247], a[36:39], v[28:31], v[244:247]
  global_load_dwordx4 a[16:19], v48, s[46:47]
  ds_read_b64_tr_b16 v[26:27], v14 offset:45568
  v_mfma_f32_16x16x32_bf16 v[248:251], a[40:43], v[28:31], v[248:251]
  v_cvt_pk_bf16_f32 v104, v104, v105
  v_mfma_f32_16x16x32_bf16 v[252:255], a[44:47], v[28:31], v[252:255]
  s_waitcnt lgkmcnt(4)
  v_cvt_pk_bf16_f32 v105, v106, v107
  v_mfma_f32_16x16x32_bf16 v[144:147], a[48:51], v[16:19], v[144:147]
  ds_read_b64_tr_b16 v[28:29], v15 offset:45056
  v_cvt_pk_bf16_f32 v106, v108, v109
  v_mfma_f32_16x16x32_bf16 v[148:151], a[52:55], v[16:19], v[148:151]
  ds_read_b64_tr_b16 v[30:31], v15 offset:45568
  v_cvt_pk_bf16_f32 v107, v110, v111
  v_mfma_f32_16x16x32_bf16 v[152:155], a[56:59], v[16:19], v[152:155]
  global_load_dwordx4 a[20:23], v49, s[46:47]
  v_mfma_f32_16x16x32_bf16 v[156:159], a[60:63], v[16:19], v[156:159]
  s_waitcnt lgkmcnt(4)
  v_mfma_f32_16x16x32_bf16 v[176:179], a[48:51], v[20:23], v[176:179]
  ds_read_b64_tr_b16 v[16:17], v12 offset:49152
  v_cvt_pk_bf16_f32 v120, v120, v121
  v_mfma_f32_16x16x32_bf16 v[180:183], a[52:55], v[20:23], v[180:183]
  ds_read_b64_tr_b16 v[18:19], v12 offset:49664
  v_cvt_pk_bf16_f32 v121, v122, v123
  v_mfma_f32_16x16x32_bf16 v[184:187], a[56:59], v[20:23], v[184:187]
  v_cvt_pk_bf16_f32 v122, v124, v125
  v_mfma_f32_16x16x32_bf16 v[188:191], a[60:63], v[20:23], v[188:191]
  s_waitcnt lgkmcnt(4)
  v_cvt_pk_bf16_f32 v123, v126, v127
  v_mfma_f32_16x16x32_bf16 v[208:211], a[48:51], v[24:27], v[208:211]
  ds_read_b64_tr_b16 v[20:21], v13 offset:49152
  v_mfma_f32_16x16x32_bf16 v[212:215], a[52:55], v[24:27], v[212:215]
  ds_read_b64_tr_b16 v[22:23], v13 offset:49664
  v_mfma_f32_16x16x32_bf16 v[216:219], a[56:59], v[24:27], v[216:219]
  global_load_dwordx4 a[24:27], v50, s[46:47]
  v_mfma_f32_16x16x32_bf16 v[220:223], a[60:63], v[24:27], v[220:223]
  s_waitcnt lgkmcnt(4)
  v_mfma_f32_16x16x32_bf16 v[240:243], a[48:51], v[28:31], v[240:243]
  ds_read_b64_tr_b16 v[24:25], v14 offset:49152
  v_mfma_f32_16x16x32_bf16 v[244:247], a[52:55], v[28:31], v[244:247]
  ds_read_b64_tr_b16 v[26:27], v14 offset:49664
  v_mfma_f32_16x16x32_bf16 v[248:251], a[56:59], v[28:31], v[248:251]
  global_load_dwordx4 a[28:31], v51, s[46:47]
  v_mfma_f32_16x16x32_bf16 v[252:255], a[60:63], v[28:31], v[252:255]
  s_waitcnt lgkmcnt(4)
  v_mfma_f32_16x16x32_bf16 v[144:147], a[64:67], v[16:19], v[144:147]
  ds_read_b64_tr_b16 v[28:29], v15 offset:49152
  v_mfma_f32_16x16x32_bf16 v[148:151], a[68:71], v[16:19], v[148:151]
  ds_read_b64_tr_b16 v[30:31], v15 offset:49664
  v_mfma_f32_16x16x32_bf16 v[152:155], a[72:75], v[16:19], v[152:155]
  v_mfma_f32_16x16x32_bf16 v[156:159], a[76:79], v[16:19], v[156:159]
  s_waitcnt lgkmcnt(4)
  v_mfma_f32_16x16x32_bf16 v[176:179], a[64:67], v[20:23], v[176:179]
  ds_read_b64_tr_b16 v[16:17], v12 offset:53248
  v_mfma_f32_16x16x32_bf16 v[180:183], a[68:71], v[20:23], v[180:183]
  ds_read_b64_tr_b16 v[18:19], v12 offset:53760
  v_mfma_f32_16x16x32_bf16 v[184:187], a[72:75], v[20:23], v[184:187]
  v_mfma_f32_16x16x32_bf16 v[188:191], a[76:79], v[20:23], v[188:191]
  s_waitcnt lgkmcnt(4)
  s_add_u32 s44, s72, 2
  s_and_b32 s44, s44, 15
  v_mfma_f32_16x16x32_bf16 v[208:211], a[64:67], v[24:27], v[208:211]
  s_lshl_b32 s44, s44, 10
  ds_read_b64_tr_b16 v[20:21], v13 offset:53248
  v_mfma_f32_16x16x32_bf16 v[212:215], a[68:71], v[24:27], v[212:215]
  s_add_u32 s44, s60, s44
  s_addc_u32 s45, s61, 0
  ds_read_b64_tr_b16 v[22:23], v13 offset:53760
  v_mfma_f32_16x16x32_bf16 v[216:219], a[72:75], v[24:27], v[216:219]
  v_mfma_f32_16x16x32_bf16 v[220:223], a[76:79], v[24:27], v[220:223]
  s_waitcnt lgkmcnt(4)
  global_load_dwordx4 a[32:35], v48, s[44:45]
  v_mfma_f32_16x16x32_bf16 v[240:243], a[64:67], v[28:31], v[240:243]
  ds_read_b64_tr_b16 v[24:25], v14 offset:53248
  v_mfma_f32_16x16x32_bf16 v[244:247], a[68:71], v[28:31], v[244:247]
  ds_read_b64_tr_b16 v[26:27], v14 offset:53760
  v_mfma_f32_16x16x32_bf16 v[248:251], a[72:75], v[28:31], v[248:251]
  v_mfma_f32_16x16x32_bf16 v[252:255], a[76:79], v[28:31], v[252:255]
  s_waitcnt lgkmcnt(4)
  v_mfma_f32_16x16x32_bf16 v[144:147], a[80:83], v[16:19], v[144:147]
  ds_read_b64_tr_b16 v[28:29], v15 offset:53248
  v_mfma_f32_16x16x32_bf16 v[148:151], a[84:87], v[16:19], v[148:151]
  ds_read_b64_tr_b16 v[30:31], v15 offset:53760
  v_mfma_f32_16x16x32_bf16 v[152:155], a[88:91], v[16:19], v[152:155]
  global_load_dwordx4 a[36:39], v49, s[44:45]
  v_mfma_f32_16x16x32_bf16 v[156:159], a[92:95], v[16:19], v[156:159]
  s_waitcnt lgkmcnt(4)
  v_mfma_f32_16x16x32_bf16 v[176:179], a[80:83], v[20:23], v[176:179]
  ds_read_b64_tr_b16 v[16:17], v12 offset:57344
  v_mfma_f32_16x16x32_bf16 v[180:183], a[84:87], v[20:23], v[180:183]
  ds_read_b64_tr_b16 v[18:19], v12 offset:57856
  v_mfma_f32_16x16x32_bf16 v[184:187], a[88:91], v[20:23], v[184:187]
  v_mfma_f32_16x16x32_bf16 v[188:191], a[92:95], v[20:23], v[188:191]
  s_waitcnt lgkmcnt(4)
  global_load_dwordx4 a[40:43], v50, s[44:45]
  v_mfma_f32_16x16x32_bf16 v[208:211], a[80:83], v[24:27], v[208:211]
  ds_read_b64_tr_b16 v[20:21], v13 offset:57344
  v_mfma_f32_16x16x32_bf16 v[212:215], a[84:87], v[24:27], v[212:215]
  ds_read_b64_tr_b16 v[22:23], v13 offset:57856
  v_mfma_f32_16x16x32_bf16 v[216:219], a[88:91], v[24:27], v[216:219]
  v_mfma_f32_16x16x32_bf16 v[220:223], a[92:95], v[24:27], v[220:223]
  s_waitcnt lgkmcnt(4)
  v_mfma_f32_16x16x32_bf16 v[240:243], a[80:83], v[28:31], v[240:243]
  ds_read_b64_tr_b16 v[24:25], v14 offset:57344
  v_mfma_f32_16x16x32_bf16 v[244:247], a[84:87], v[28:31], v[244:247]
  ds_read_b64_tr_b16 v[26:27], v14 offset:57856
  v_mfma_f32_16x16x32_bf16 v[248:251], a[88:91], v[28:31], v[248:251]
  global_load_dwordx4 a[44:47], v51, s[44:45]
  v_mfma_f32_16x16x32_bf16 v[252:255], a[92:95], v[28:31], v[252:255]
  s_waitcnt lgkmcnt(4)
  v_mfma_f32_16x16x32_bf16 v[144:147], a[96:99], v[16:19], v[144:147]
  ds_read_b64_tr_b16 v[28:29], v15 offset:57344
  v_mfma_f32_16x16x32_bf16 v[148:151], a[100:103], v[16:19], v[148:151]
  ds_read_b64_tr_b16 v[30:31], v15 offset:57856
  v_mfma_f32_16x16x32_bf16 v[152:155], a[104:107], v[16:19], v[152:155]
  v_mfma_f32_16x16x32_bf16 v[156:159], a[108:111], v[16:19], v[156:159]
  s_waitcnt lgkmcnt(4)
  v_mfma_f32_16x16x32_bf16 v[176:179], a[96:99], v[20:23], v[176:179]
  ds_read_b64_tr_b16 v[16:17], v12 offset:61440
  v_mfma_f32_16x16x32_bf16 v[180:183], a[100:103], v[20:23], v[180:183]
  ds_read_b64_tr_b16 v[18:19], v12 offset:61952
  v_mfma_f32_16x16x32_bf16 v[184:187], a[104:107], v[20:23], v[184:187]
  s_add_u32 s52, s72, 3
  s_and_b32 s52, s52, 15
  s_lshl_b32 s52, s52, 10
  v_mfma_f32_16x16x32_bf16 v[188:191], a[108:111], v[20:23], v[188:191]
  s_waitcnt lgkmcnt(4)
  s_add_u32 s52, s60, s52
  s_addc_u32 s53, s61, 0
  v_mfma_f32_16x16x32_bf16 v[208:211], a[96:99], v[24:27], v[208:211]
  ds_read_b64_tr_b16 v[20:21], v13 offset:61440
  v_mfma_f32_16x16x32_bf16 v[212:215], a[100:103], v[24:27], v[212:215]
  ds_read_b64_tr_b16 v[22:23], v13 offset:61952
  v_mfma_f32_16x16x32_bf16 v[216:219], a[104:107], v[24:27], v[216:219]
  global_load_dwordx4 a[48:51], v48, s[52:53]
  v_mfma_f32_16x16x32_bf16 v[220:223], a[108:111], v[24:27], v[220:223]
  s_waitcnt lgkmcnt(4)
  v_mfma_f32_16x16x32_bf16 v[240:243], a[96:99], v[28:31], v[240:243]
  ds_read_b64_tr_b16 v[24:25], v14 offset:61440
  v_mfma_f32_16x16x32_bf16 v[244:247], a[100:103], v[28:31], v[244:247]
  ds_read_b64_tr_b16 v[26:27], v14 offset:61952
  v_mfma_f32_16x16x32_bf16 v[248:251], a[104:107], v[28:31], v[248:251]
  v_mfma_f32_16x16x32_bf16 v[252:255], a[108:111], v[28:31], v[252:255]
  s_waitcnt lgkmcnt(4)
  v_mfma_f32_16x16x32_bf16 v[144:147], a[112:115], v[16:19], v[144:147]
  ds_read_b64_tr_b16 v[28:29], v15 offset:61440
  v_mfma_f32_16x16x32_bf16 v[148:151], a[116:119], v[16:19], v[148:151]
  ds_read_b64_tr_b16 v[30:31], v15 offset:61952
  v_mfma_f32_16x16x32_bf16 v[152:155], a[120:123], v[16:19], v[152:155]
  global_load_dwordx4 a[52:55], v49, s[52:53]
  v_mfma_f32_16x16x32_bf16 v[156:159], a[124:127], v[16:19], v[156:159]
  s_waitcnt lgkmcnt(4)
  v_mfma_f32_16x16x32_bf16 v[176:179], a[112:115], v[20:23], v[176:179]
  s_waitcnt vmcnt(30)
  s_barrier
  v_mfma_f32_16x16x32_bf16 v[180:183], a[116:119], v[20:23], v[180:183]
  ds_read_b64_tr_b16 v[16:17], v8 offset:0
  v_mfma_f32_16x16x32_bf16 v[184:187], a[120:123], v[20:23], v[184:187]
  ds_read_b64_tr_b16 v[18:19], v8 offset:512
  v_mfma_f32_16x16x32_bf16 v[188:191], a[124:127], v[20:23], v[188:191]
  s_waitcnt lgkmcnt(4)
  global_load_dwordx4 a[56:59], v50, s[52:53]
  v_mfma_f32_16x16x32_bf16 v[208:211], a[112:115], v[24:27], v[208:211]
  s_add_u32 s42, s72, 4
  s_and_b32 s42, s42, 15
  ds_read_b64_tr_b16 v[20:21], v9 offset:0
  v_mfma_f32_16x16x32_bf16 v[212:215], a[116:119], v[24:27], v[212:215]
  s_mul_i32 s42, s42, 88064
  ds_read_b64_tr_b16 v[22:23], v9 offset:512
  v_mfma_f32_16x16x32_bf16 v[216:219], a[120:123], v[24:27], v[216:219]
  s_add_u32 s24, s14, s42
  s_addc_u32 s25, s15, 0
  s_add_u32 m0, s23, 65536
  v_mfma_f32_16x16x32_bf16 v[220:223], a[124:127], v[24:27], v[220:223]
  s_waitcnt lgkmcnt(4)
  global_load_lds_dwordx4 v3, s[24:25]
  v_mfma_f32_16x16x32_bf16 v[240:243], a[112:115], v[28:31], v[240:243]
  s_add_u32 s26, s16, s42
  s_addc_u32 s27, s17, 0
  ds_read_b64_tr_b16 v[24:25], v10 offset:0
  v_mfma_f32_16x16x32_bf16 v[244:247], a[116:119], v[28:31], v[244:247]
  s_add_u32 m0, s23, 69632
  ds_read_b64_tr_b16 v[26:27], v10 offset:512
  v_mfma_f32_16x16x32_bf16 v[248:251], a[120:123], v[28:31], v[248:251]
  global_load_lds_dwordx4 v3, s[26:27]
  v_mfma_f32_16x16x32_bf16 v[252:255], a[124:127], v[28:31], v[252:255]
  s_waitcnt lgkmcnt(4)
  global_load_dwordx4 a[60:63], v51, s[52:53]
  v_mfma_f32_16x16x32_bf16 v[144:147], a[128:131], v[16:19], v[144:147]
  s_add_u32 s43, s72, 5
  s_and_b32 s43, s43, 15
  ds_read_b64_tr_b16 v[28:29], v11 offset:0
  v_mfma_f32_16x16x32_bf16 v[148:151], a[132:135], v[16:19], v[148:151]
  s_mul_i32 s43, s43, 88064
  ds_read_b64_tr_b16 v[30:31], v11 offset:512
  v_mfma_f32_16x16x32_bf16 v[152:155], a[136:139], v[16:19], v[152:155]
  s_add_u32 s24, s14, s43
  s_addc_u32 s25, s15, 0
  s_add_u32 m0, s23, 73728
  v_mfma_f32_16x16x32_bf16 v[156:159], a[140:143], v[16:19], v[156:159]
  s_waitcnt lgkmcnt(4)
  global_load_lds_dwordx4 v3, s[24:25]
  v_mfma_f32_16x16x32_bf16 v[176:179], a[128:131], v[20:23], v[176:179]
  s_add_u32 s26, s16, s43
  s_addc_u32 s27, s17, 0
  ds_read_b64_tr_b16 v[16:17], v8 offset:4096
  v_mfma_f32_16x16x32_bf16 v[180:183], a[132:135], v[20:23], v[180:183]
  s_add_u32 m0, s23, 77824
  ds_read_b64_tr_b16 v[18:19], v8 offset:4608
  v_mfma_f32_16x16x32_bf16 v[184:187], a[136:139], v[20:23], v[184:187]
  global_load_lds_dwordx4 v3, s[26:27]
  v_mfma_f32_16x16x32_bf16 v[188:191], a[140:143], v[20:23], v[188:191]
  s_waitcnt lgkmcnt(4)
  s_add_u32 s42, s72, 6
  s_and_b32 s42, s42, 15
  v_mfma_f32_16x16x32_bf16 v[208:211], a[128:131], v[24:27], v[208:211]
  s_mul_i32 s42, s42, 88064
  ds_read_b64_tr_b16 v[20:21], v9 offset:4096
  v_mfma_f32_16x16x32_bf16 v[212:215], a[132:135], v[24:27], v[212:215]
  s_add_u32 s24, s14, s42
  s_addc_u32 s25, s15, 0
  s_add_u32 m0, s23, 81920
  ds_read_b64_tr_b16 v[22:23], v9 offset:4608
  v_mfma_f32_16x16x32_bf16 v[216:219], a[136:139], v[24:27], v[216:219]
  global_load_lds_dwordx4 v3, s[24:25]
  v_mfma_f32_16x16x32_bf16 v[220:223], a[140:143], v[24:27], v[220:223]
  s_waitcnt lgkmcnt(4)
  s_add_u32 s38, s72, 4
  s_and_b32 s38, s38, 15
  v_mfma_f32_16x16x32_bf16 v[240:243], a[128:131], v[28:31], v[240:243]
  s_lshl_b32 s38, s38, 10
  ds_read_b64_tr_b16 v[24:25], v10 offset:4096
  v_mfma_f32_16x16x32_bf16 v[244:247], a[132:135], v[28:31], v[244:247]
  s_add_u32 s38, s60, s38
  s_addc_u32 s39, s61, 0
  ds_read_b64_tr_b16 v[26:27], v10 offset:4608
  v_mfma_f32_16x16x32_bf16 v[248:251], a[136:139], v[28:31], v[248:251]
  global_load_dwordx4 a[64:67], v48, s[38:39]
  v_mfma_f32_16x16x32_bf16 v[252:255], a[140:143], v[28:31], v[252:255]
  s_waitcnt lgkmcnt(4)
  s_add_u32 s26, s16, s42
  s_addc_u32 s27, s17, 0
  v_mfma_f32_16x16x32_bf16 v[144:147], a[144:147], v[16:19], v[144:147]
  s_add_u32 m0, s23, 86016
  ds_read_b64_tr_b16 v[28:29], v11 offset:4096
  v_mfma_f32_16x16x32_bf16 v[148:151], a[148:151], v[16:19], v[148:151]
  ds_read_b64_tr_b16 v[30:31], v11 offset:4608
  v_mfma_f32_16x16x32_bf16 v[152:155], a[152:155], v[16:19], v[152:155]
  global_load_lds_dwordx4 v3, s[26:27]
  v_mfma_f32_16x16x32_bf16 v[156:159], a[156:159], v[16:19], v[156:159]
  s_waitcnt lgkmcnt(4)
  s_add_u32 s43, s72, 7
  s_and_b32 s43, s43, 15
  v_mfma_f32_16x16x32_bf16 v[176:179], a[144:147], v[20:23], v[176:179]
  s_mul_i32 s43, s43, 88064
  ds_read_b64_tr_b16 v[16:17], v8 offset:8192
  v_mfma_f32_16x16x32_bf16 v[180:183], a[148:151], v[20:23], v[180:183]
  s_add_u32 s24, s14, s43
  s_addc_u32 s25, s15, 0
  s_add_u32 m0, s23, 90112
  ds_read_b64_tr_b16 v[18:19], v8 offset:8704
  v_mfma_f32_16x16x32_bf16 v[184:187], a[152:155], v[20:23], v[184:187]
  global_load_lds_dwordx4 v3, s[24:25]
  v_mfma_f32_16x16x32_bf16 v[188:191], a[156:159], v[20:23], v[188:191]
  s_waitcnt lgkmcnt(4)
  global_load_dwordx4 a[68:71], v49, s[38:39]
  v_mfma_f32_16x16x32_bf16 v[208:211], a[144:147], v[24:27], v[208:211]
  s_add_u32 s26, s16, s43
  s_addc_u32 s27, s17, 0
  ds_read_b64_tr_b16 v[20:21], v9 offset:8192
  v_mfma_f32_16x16x32_bf16 v[212:215], a[148:151], v[24:27], v[212:215]
  s_add_u32 m0, s23, 94208
  ds_read_b64_tr_b16 v[22:23], v9 offset:8704
  v_mfma_f32_16x16x32_bf16 v[216:219], a[152:155], v[24:27], v[216:219]
  global_load_lds_dwordx4 v3, s[26:27]
  v_mfma_f32_16x16x32_bf16 v[220:223], a[156:159], v[24:27], v[220:223]
  s_waitcnt lgkmcnt(4)
  global_load_dwordx4 a[72:75], v50, s[38:39]
  v_mfma_f32_16x16x32_bf16 v[240:243], a[144:147], v[28:31], v[240:243]
  ds_read_b64_tr_b16 v[24:25], v10 offset:8192
  v_mfma_f32_16x16x32_bf16 v[244:247], a[148:151], v[28:31], v[244:247]
  ds_read_b64_tr_b16 v[26:27], v10 offset:8704
  v_mfma_f32_16x16x32_bf16 v[248:251], a[152:155], v[28:31], v[248:251]
  global_load_dwordx4 a[76:79], v51, s[38:39]
  v_mfma_f32_16x16x32_bf16 v[252:255], a[156:159], v[28:31], v[252:255]
  s_waitcnt lgkmcnt(4)
  v_mfma_f32_16x16x32_bf16 v[144:147], a[160:163], v[16:19], v[144:147]
  ds_read_b64_tr_b16 v[28:29], v11 offset:8192
  v_mfma_f32_16x16x32_bf16 v[148:151], a[164:167], v[16:19], v[148:151]
  ds_read_b64_tr_b16 v[30:31], v11 offset:8704
  v_mfma_f32_16x16x32_bf16 v[152:155], a[168:171], v[16:19], v[152:155]
  v_mfma_f32_16x16x32_bf16 v[156:159], a[172:175], v[16:19], v[156:159]
  s_waitcnt lgkmcnt(4)
  v_mfma_f32_16x16x32_bf16 v[176:179], a[160:163], v[20:23], v[176:179]
  ds_read_b64_tr_b16 v[16:17], v8 offset:12288
  v_mfma_f32_16x16x32_bf16 v[180:183], a[164:167], v[20:23], v[180:183]
  ds_read_b64_tr_b16 v[18:19], v8 offset:12800
  v_mfma_f32_16x16x32_bf16 v[184:187], a[168:171], v[20:23], v[184:187]
  s_add_u32 s46, s72, 5
  s_and_b32 s46, s46, 15
  s_lshl_b32 s46, s46, 10
  v_mfma_f32_16x16x32_bf16 v[188:191], a[172:175], v[20:23], v[188:191]
  s_waitcnt lgkmcnt(4)
  s_add_u32 s46, s60, s46
  s_addc_u32 s47, s61, 0
  v_mfma_f32_16x16x32_bf16 v[208:211], a[160:163], v[24:27], v[208:211]
  ds_read_b64_tr_b16 v[20:21], v9 offset:12288
  v_mfma_f32_16x16x32_bf16 v[212:215], a[164:167], v[24:27], v[212:215]
  ds_read_b64_tr_b16 v[22:23], v9 offset:12800
  v_mfma_f32_16x16x32_bf16 v[216:219], a[168:171], v[24:27], v[216:219]
  global_load_dwordx4 a[80:83], v48, s[46:47]
  v_mfma_f32_16x16x32_bf16 v[220:223], a[172:175], v[24:27], v[220:223]
  s_waitcnt lgkmcnt(4)
  v_mfma_f32_16x16x32_bf16 v[240:243], a[160:163], v[28:31], v[240:243]
  ds_read_b64_tr_b16 v[24:25], v10 offset:12288
  v_mfma_f32_16x16x32_bf16 v[244:247], a[164:167], v[28:31], v[244:247]
  ds_read_b64_tr_b16 v[26:27], v10 offset:12800
  v_mfma_f32_16x16x32_bf16 v[248:251], a[168:171], v[28:31], v[248:251]
  v_mfma_f32_16x16x32_bf16 v[252:255], a[172:175], v[28:31], v[252:255]
  s_waitcnt lgkmcnt(4)
  global_load_dwordx4 a[84:87], v49, s[46:47]
  v_mfma_f32_16x16x32_bf16 v[144:147], a[176:179], v[16:19], v[144:147]
  ds_read_b64_tr_b16 v[28:29], v11 offset:12288
  v_mfma_f32_16x16x32_bf16 v[148:151], a[180:183], v[16:19], v[148:151]
  ds_read_b64_tr_b16 v[30:31], v11 offset:12800
  v_mfma_f32_16x16x32_bf16 v[152:155], a[184:187], v[16:19], v[152:155]
  v_mfma_f32_16x16x32_bf16 v[156:159], a[188:191], v[16:19], v[156:159]
  s_waitcnt lgkmcnt(4)
  v_mfma_f32_16x16x32_bf16 v[176:179], a[176:179], v[20:23], v[176:179]
  ds_read_b64_tr_b16 v[16:17], v8 offset:16384
  v_mfma_f32_16x16x32_bf16 v[180:183], a[180:183], v[20:23], v[180:183]
  ds_read_b64_tr_b16 v[18:19], v8 offset:16896
  v_mfma_f32_16x16x32_bf16 v[184:187], a[184:187], v[20:23], v[184:187]
  global_load_dwordx4 a[88:91], v50, s[46:47]
  v_mfma_f32_16x16x32_bf16 v[188:191], a[188:191], v[20:23], v[188:191]
  s_waitcnt lgkmcnt(4)
  v_mfma_f32_16x16x32_bf16 v[208:211], a[176:179], v[24:27], v[208:211]
  ds_read_b64_tr_b16 v[20:21], v9 offset:16384
  v_mfma_f32_16x16x32_bf16 v[212:215], a[180:183], v[24:27], v[212:215]
  ds_read_b64_tr_b16 v[22:23], v9 offset:16896
  v_mfma_f32_16x16x32_bf16 v[216:219], a[184:187], v[24:27], v[216:219]
  v_mfma_f32_16x16x32_bf16 v[220:223], a[188:191], v[24:27], v[220:223]
  s_waitcnt lgkmcnt(4)
  global_load_dwordx4 a[92:95], v51, s[46:47]
  v_mfma_f32_16x16x32_bf16 v[240:243], a[176:179], v[28:31], v[240:243]
  ds_read_b64_tr_b16 v[24:25], v10 offset:16384
  v_mfma_f32_16x16x32_bf16 v[244:247], a[180:183], v[28:31], v[244:247]
  ds_read_b64_tr_b16 v[26:27], v10 offset:16896
  v_mfma_f32_16x16x32_bf16 v[248:251], a[184:187], v[28:31], v[248:251]
  v_mfma_f32_16x16x32_bf16 v[252:255], a[188:191], v[28:31], v[252:255]
  s_waitcnt lgkmcnt(4)
  v_mfma_f32_16x16x32_bf16 v[144:147], a[192:195], v[16:19], v[144:147]
  ds_read_b64_tr_b16 v[28:29], v11 offset:16384
  v_mfma_f32_16x16x32_bf16 v[148:151], a[196:199], v[16:19], v[148:151]
  ds_read_b64_tr_b16 v[30:31], v11 offset:16896
  v_mfma_f32_16x16x32_bf16 v[152:155], a[200:203], v[16:19], v[152:155]
  v_mfma_f32_16x16x32_bf16 v[156:159], a[204:207], v[16:19], v[156:159]
  s_waitcnt lgkmcnt(4)
  v_mfma_f32_16x16x32_bf16 v[176:179], a[192:195], v[20:23], v[176:179]
  ds_read_b64_tr_b16 v[16:17], v8 offset:20480
  v_mfma_f32_16x16x32_bf16 v[180:183], a[196:199], v[20:23], v[180:183]
  ds_read_b64_tr_b16 v[18:19], v8 offset:20992
  v_mfma_f32_16x16x32_bf16 v[184:187], a[200:203], v[20:23], v[184:187]
  s_add_u32 s44, s72, 6
  s_and_b32 s44, s44, 15
  s_lshl_b32 s44, s44, 10
  v_mfma_f32_16x16x32_bf16 v[188:191], a[204:207], v[20:23], v[188:191]
  s_waitcnt lgkmcnt(4)
  s_add_u32 s44, s60, s44
  s_addc_u32 s45, s61, 0
  v_mfma_f32_16x16x32_bf16 v[208:211], a[192:195], v[24:27], v[208:211]
  ds_read_b64_tr_b16 v[20:21], v9 offset:20480
  v_mfma_f32_16x16x32_bf16 v[212:215], a[196:199], v[24:27], v[212:215]
  ds_read_b64_tr_b16 v[22:23], v9 offset:20992
  v_mfma_f32_16x16x32_bf16 v[216:219], a[200:203], v[24:27], v[216:219]
  global_load_dwordx4 a[96:99], v48, s[44:45]
  v_mfma_f32_16x16x32_bf16 v[220:223], a[204:207], v[24:27], v[220:223]
  s_waitcnt lgkmcnt(4)
  v_mfma_f32_16x16x32_bf16 v[240:243], a[192:195], v[28:31], v[240:243]
  ds_read_b64_tr_b16 v[24:25], v10 offset:20480
  v_mfma_f32_16x16x32_bf16 v[244:247], a[196:199], v[28:31], v[244:247]
  ds_read_b64_tr_b16 v[26:27], v10 offset:20992
  v_mfma_f32_16x16x32_bf16 v[248:251], a[200:203], v[28:31], v[248:251]
  global_load_dwordx4 a[100:103], v49, s[44:45]
  v_mfma_f32_16x16x32_bf16 v[252:255], a[204:207], v[28:31], v[252:255]
  s_waitcnt lgkmcnt(4)
  v_mfma_f32_16x16x32_bf16 v[144:147], a[208:211], v[16:19], v[144:147]
  ds_read_b64_tr_b16 v[28:29], v11 offset:20480
  v_mfma_f32_16x16x32_bf16 v[148:151], a[212:215], v[16:19], v[148:151]
  ds_read_b64_tr_b16 v[30:31], v11 offset:20992
  v_mfma_f32_16x16x32_bf16 v[152:155], a[216:219], v[16:19], v[152:155]
  v_mfma_f32_16x16x32_bf16 v[156:159], a[220:223], v[16:19], v[156:159]
  s_waitcnt lgkmcnt(4)
  v_mfma_f32_16x16x32_bf16 v[176:179], a[208:211], v[20:23], v[176:179]
  ds_read_b64_tr_b16 v[16:17], v8 offset:24576
  v_mfma_f32_16x16x32_bf16 v[180:183], a[212:215], v[20:23], v[180:183]
  ds_read_b64_tr_b16 v[18:19], v8 offset:25088
  v_mfma_f32_16x16x32_bf16 v[184:187], a[216:219], v[20:23], v[184:187]
  global_load_dwordx4 a[104:107], v50, s[44:45]
  v_mfma_f32_16x16x32_bf16 v[188:191], a[220:223], v[20:23], v[188:191]
  s_waitcnt lgkmcnt(4)
  v_mfma_f32_16x16x32_bf16 v[208:211], a[208:211], v[24:27], v[208:211]
  s_add_u32 s28, s10, 8192
  s_addc_u32 s29, s11, 0
  ds_read_b64_tr_b16 v[20:21], v9 offset:24576
  v_mfma_f32_16x16x32_bf16 v[212:215], a[212:215], v[24:27], v[212:215]
  ds_read_b64_tr_b16 v[22:23], v9 offset:25088
  v_mfma_f32_16x16x32_bf16 v[216:219], a[216:219], v[24:27], v[216:219]
  global_store_dwordx4 v4, v[64:67], s[28:29] offset:0 sc1
  v_mfma_f32_16x16x32_bf16 v[220:223], a[220:223], v[24:27], v[220:223]
  s_waitcnt lgkmcnt(4)
  global_load_dwordx4 a[108:111], v51, s[44:45]
  v_mfma_f32_16x16x32_bf16 v[240:243], a[208:211], v[28:31], v[240:243]
  ds_read_b64_tr_b16 v[24:25], v10 offset:24576
  v_mfma_f32_16x16x32_bf16 v[244:247], a[212:215], v[28:31], v[244:247]
  ds_read_b64_tr_b16 v[26:27], v10 offset:25088
  v_mfma_f32_16x16x32_bf16 v[248:251], a[216:219], v[28:31], v[248:251]
  v_mfma_f32_16x16x32_bf16 v[252:255], a[220:223], v[28:31], v[252:255]
  s_waitcnt lgkmcnt(4)
  v_mfma_f32_16x16x32_bf16 v[144:147], a[224:227], v[16:19], v[144:147]
  ds_read_b64_tr_b16 v[28:29], v11 offset:24576
  v_mfma_f32_16x16x32_bf16 v[148:151], a[228:231], v[16:19], v[148:151]
  ds_read_b64_tr_b16 v[30:31], v11 offset:25088
  v_mfma_f32_16x16x32_bf16 v[152:155], a[232:235], v[16:19], v[152:155]
  v_mfma_f32_16x16x32_bf16 v[156:159], a[236:239], v[16:19], v[156:159]
  s_waitcnt lgkmcnt(4)
  s_add_u32 s52, s72, 7
  s_and_b32 s52, s52, 15
  v_mfma_f32_16x16x32_bf16 v[176:179], a[224:227], v[20:23], v[176:179]
  s_lshl_b32 s52, s52, 10
  ds_read_b64_tr_b16 v[16:17], v8 offset:28672
  v_mfma_f32_16x16x32_bf16 v[180:183], a[228:231], v[20:23], v[180:183]
  s_add_u32 s52, s60, s52
  s_addc_u32 s53, s61, 0
  ds_read_b64_tr_b16 v[18:19], v8 offset:29184
  v_mfma_f32_16x16x32_bf16 v[184:187], a[232:235], v[20:23], v[184:187]
  v_mfma_f32_16x16x32_bf16 v[188:191], a[236:239], v[20:23], v[188:191]
  s_waitcnt lgkmcnt(4)
  global_load_dwordx4 a[112:115], v48, s[52:53]
  v_mfma_f32_16x16x32_bf16 v[208:211], a[224:227], v[24:27], v[208:211]
  ds_read_b64_tr_b16 v[20:21], v9 offset:28672
  v_mfma_f32_16x16x32_bf16 v[212:215], a[228:231], v[24:27], v[212:215]
  ds_read_b64_tr_b16 v[22:23], v9 offset:29184
  v_mfma_f32_16x16x32_bf16 v[216:219], a[232:235], v[24:27], v[216:219]
  v_mfma_f32_16x16x32_bf16 v[220:223], a[236:239], v[24:27], v[220:223]
  s_waitcnt lgkmcnt(4)
  v_mfma_f32_16x16x32_bf16 v[240:243], a[224:227], v[28:31], v[240:243]
  s_add_u32 s30, s10, 8192
  s_addc_u32 s31, s11, 0
  ds_read_b64_tr_b16 v[24:25], v10 offset:28672
  v_mfma_f32_16x16x32_bf16 v[244:247], a[228:231], v[28:31], v[244:247]
  ds_read_b64_tr_b16 v[26:27], v10 offset:29184
  v_mfma_f32_16x16x32_bf16 v[248:251], a[232:235], v[28:31], v[248:251]
  global_store_dwordx4 v4, v[80:83], s[30:31] offset:1024 sc1
  v_mfma_f32_16x16x32_bf16 v[252:255], a[236:239], v[28:31], v[252:255]
  s_waitcnt lgkmcnt(4)
  global_load_dwordx4 a[116:119], v49, s[52:53]
  v_mfma_f32_16x16x32_bf16 v[144:147], a[240:243], v[16:19], v[144:147]
  ds_read_b64_tr_b16 v[28:29], v11 offset:28672
  v_mfma_f32_16x16x32_bf16 v[148:151], a[244:247], v[16:19], v[148:151]
  ds_read_b64_tr_b16 v[30:31], v11 offset:29184
  v_mfma_f32_16x16x32_bf16 v[152:155], a[248:251], v[16:19], v[152:155]
  v_mfma_f32_16x16x32_bf16 v[156:159], a[252:255], v[16:19], v[156:159]
  s_waitcnt lgkmcnt(4)
  global_load_dwordx4 a[120:123], v50, s[52:53]
  v_mfma_f32_16x16x32_bf16 v[176:179], a[240:243], v[20:23], v[176:179]
  s_waitcnt vmcnt(41)
  s_barrier
  v_xor_b32 v8, s48, v8
  v_xor_b32 v9, s49, v9
  v_xor_b32 v10, s48, v10
  v_xor_b32 v12, s48, v12
  v_xor_b32 v13, s49, v13
  v_xor_b32 v14, s48, v14
  v_mfma_f32_16x16x32_bf16 v[180:183], a[244:247], v[20:23], v[180:183]
  ds_read_b64_tr_b16 v[16:17], v8 offset:32768
  v_mfma_f32_16x16x32_bf16 v[184:187], a[248:251], v[20:23], v[184:187]
  s_add_u32 s42, s72, 8
  s_and_b32 s42, s42, 15
  ds_read_b64_tr_b16 v[18:19], v8 offset:33280
  v_mfma_f32_16x16x32_bf16 v[188:191], a[252:255], v[20:23], v[188:191]
  s_waitcnt lgkmcnt(4)
  s_mul_i32 s42, s42, 88064
  v_mfma_f32_16x16x32_bf16 v[208:211], a[240:243], v[24:27], v[208:211]
  s_add_u32 s24, s14, s42
  s_addc_u32 s25, s15, 0
  ds_read_b64_tr_b16 v[20:21], v9 offset:32768
  v_mfma_f32_16x16x32_bf16 v[212:215], a[244:247], v[24:27], v[212:215]
  s_add_u32 m0, s23, 98304
  ds_read_b64_tr_b16 v[22:23], v9 offset:33280
  v_mfma_f32_16x16x32_bf16 v[216:219], a[248:251], v[24:27], v[216:219]
  global_load_lds_dwordx4 v3, s[24:25]
  v_mfma_f32_16x16x32_bf16 v[220:223], a[252:255], v[24:27], v[220:223]
  s_waitcnt lgkmcnt(4)
  global_load_dwordx4 a[124:127], v51, s[52:53]
  v_mfma_f32_16x16x32_bf16 v[240:243], a[240:243], v[28:31], v[240:243]
  s_add_u32 s26, s16, s42
  s_addc_u32 s27, s17, 0
  ds_read_b64_tr_b16 v[24:25], v10 offset:32768
  v_mfma_f32_16x16x32_bf16 v[244:247], a[244:247], v[28:31], v[244:247]
  s_add_u32 m0, s23, 102400
  ds_read_b64_tr_b16 v[26:27], v10 offset:33280
  v_mfma_f32_16x16x32_bf16 v[248:251], a[248:251], v[28:31], v[248:251]
  global_load_lds_dwordx4 v3, s[26:27]
  v_mfma_f32_16x16x32_bf16 v[252:255], a[252:255], v[28:31], v[252:255]
  s_waitcnt lgkmcnt(4)
  s_waitcnt vmcnt(40)
  s_add_u32 s43, s72, 9
  v_mfma_f32_16x16x32_bf16 v[128:131], v[16:19], a[0:3], 0
  s_and_b32 s43, s43, 15
  s_mul_i32 s43, s43, 88064
  ds_read_b64_tr_b16 v[28:29], v8 offset:36864
  v_mfma_f32_16x16x32_bf16 v[132:135], v[16:19], a[4:7], 0
  s_add_u32 s24, s14, s43
  s_addc_u32 s25, s15, 0
  s_add_u32 m0, s23, 106496
  ds_read_b64_tr_b16 v[30:31], v8 offset:37376
  v_mfma_f32_16x16x32_bf16 v[136:139], v[16:19], a[8:11], 0
  global_load_lds_dwordx4 v3, s[24:25]
  v_mfma_f32_16x16x32_bf16 v[140:143], v[16:19], a[12:15], 0
  s_waitcnt lgkmcnt(4)
  v_mfma_f32_16x16x32_bf16 v[192:195], v[20:23], a[0:3], 0
  s_add_u32 s28, s10, 8192
  s_addc_u32 s29, s11, 0
  ds_read_b64_tr_b16 v[16:17], v9 offset:36864
  v_mfma_f32_16x16x32_bf16 v[196:199], v[20:23], a[4:7], 0
  ds_read_b64_tr_b16 v[18:19], v9 offset:37376
  v_mfma_f32_16x16x32_bf16 v[200:203], v[20:23], a[8:11], 0
  global_store_dwordx4 v4, v[96:99], s[28:29] offset:2048 sc1
  v_mfma_f32_16x16x32_bf16 v[204:207], v[20:23], a[12:15], 0
  s_waitcnt lgkmcnt(4)
  s_add_u32 s26, s16, s43
  s_addc_u32 s27, s17, 0
  v_mfma_f32_16x16x32_bf16 v[68:71], v[24:27], a[0:3], 0
  s_add_u32 m0, s23, 110592
  ds_read_b64_tr_b16 v[20:21], v10 offset:36864
  v_mfma_f32_16x16x32_bf16 v[76:79], v[24:27], a[4:7], 0
  global_load_lds_dwordx4 v3, s[26:27]
  ds_read_b64_tr_b16 v[22:23], v10 offset:37376
  v_mfma_f32_16x16x32_bf16 v[84:87], v[24:27], a[8:11], 0
  s_add_u32 s38, s72, 8
  s_and_b32 s38, s38, 15
  v_cvt_pk_bf16_f32 v144, v144, v145
  v_mfma_f32_16x16x32_bf16 v[92:95], v[24:27], a[12:15], 0
  s_waitcnt lgkmcnt(4)
  s_lshl_b32 s38, s38, 10
  v_cvt_pk_bf16_f32 v145, v146, v147
  v_mfma_f32_16x16x32_bf16 v[160:163], v[28:31], a[0:3], 0
  ds_read_b64_tr_b16 v[24:25], v8 offset:40960
  v_cvt_pk_bf16_f32 v146, v148, v149
  v_mfma_f32_16x16x32_bf16 v[164:167], v[28:31], a[4:7], 0
  s_add_u32 s38, s60, s38
  s_addc_u32 s39, s61, 0
  ds_read_b64_tr_b16 v[26:27], v8 offset:41472
  v_cvt_pk_bf16_f32 v147, v150, v151
  v_mfma_f32_16x16x32_bf16 v[168:171], v[28:31], a[8:11], 0
  global_load_dwordx4 a[128:131], v48, s[38:39]
  v_mfma_f32_16x16x32_bf16 v[172:175], v[28:31], a[12:15], 0
  s_waitcnt lgkmcnt(4)
  s_add_u32 s42, s72, 10
  s_and_b32 s42, s42, 15
  v_mfma_f32_16x16x32_bf16 v[224:227], v[16:19], a[0:3], 0
  s_mul_i32 s42, s42, 88064
  ds_read_b64_tr_b16 v[28:29], v9 offset:40960
  v_cvt_pk_bf16_f32 v176, v176, v177
  v_mfma_f32_16x16x32_bf16 v[228:231], v[16:19], a[4:7], 0
  s_add_u32 s24, s14, s42
  s_addc_u32 s25, s15, 0
  s_add_u32 m0, s23, 114688
  ds_read_b64_tr_b16 v[30:31], v9 offset:41472
  v_cvt_pk_bf16_f32 v177, v178, v179
  v_mfma_f32_16x16x32_bf16 v[232:235], v[16:19], a[8:11], 0
  global_load_lds_dwordx4 v3, s[24:25]
  v_cvt_pk_bf16_f32 v178, v180, v181
  v_mfma_f32_16x16x32_bf16 v[236:239], v[16:19], a[12:15], 0
  s_waitcnt lgkmcnt(4)
  global_load_dwordx4 a[132:135], v49, s[38:39]
  v_cvt_pk_bf16_f32 v179, v182, v183
  v_mfma_f32_16x16x32_bf16 v[100:103], v[20:23], a[0:3], 0
  s_add_u32 s26, s16, s42
  s_addc_u32 s27, s17, 0
  ds_read_b64_tr_b16 v[16:17], v10 offset:40960
  v_mfma_f32_16x16x32_bf16 v[108:111], v[20:23], a[4:7], 0
  s_add_u32 m0, s23, 118784
  ds_read_b64_tr_b16 v[18:19], v10 offset:41472
  v_mfma_f32_16x16x32_bf16 v[116:119], v[20:23], a[8:11], 0
  global_load_lds_dwordx4 v3, s[26:27]
  v_cvt_pk_bf16_f32 v208, v208, v209
  v_mfma_f32_16x16x32_bf16 v[124:127], v[20:23], a[12:15], 0
  s_waitcnt lgkmcnt(4)
  s_waitcnt vmcnt(43)
  v_cvt_pk_bf16_f32 v209, v210, v211
  v_mfma_f32_16x16x32_bf16 v[128:131], v[24:27], a[16:19], v[128:131]
  s_add_u32 s43, s72, 11
  ds_read_b64_tr_b16 v[20:21], v8 offset:45056
  v_cvt_pk_bf16_f32 v210, v212, v213
  v_mfma_f32_16x16x32_bf16 v[132:135], v[24:27], a[20:23], v[132:135]
  s_and_b32 s43, s43, 15
  s_mul_i32 s43, s43, 88064
  s_add_u32 s24, s14, s43
  s_addc_u32 s25, s15, 0
  s_add_u32 m0, s23, 122880
  ds_read_b64_tr_b16 v[22:23], v8 offset:45568
  v_cvt_pk_bf16_f32 v211, v214, v215
  v_mfma_f32_16x16x32_bf16 v[136:139], v[24:27], a[24:27], v[136:139]
  global_load_lds_dwordx4 v3, s[24:25]
  v_mfma_f32_16x16x32_bf16 v[140:143], v[24:27], a[28:31], v[140:143]
  s_waitcnt lgkmcnt(4)
  global_load_dwordx4 a[136:139], v50, s[38:39]
  v_mfma_f32_16x16x32_bf16 v[192:195], v[28:31], a[16:19], v[192:195]
  ds_read_b64_tr_b16 v[24:25], v9 offset:45056
  v_cvt_pk_bf16_f32 v240, v240, v241
  v_mfma_f32_16x16x32_bf16 v[196:199], v[28:31], a[20:23], v[196:199]
  s_add_u32 s26, s16, s43
  s_addc_u32 s27, s17, 0
  s_add_u32 m0, s23, 126976
  ds_read_b64_tr_b16 v[26:27], v9 offset:45568
  v_cvt_pk_bf16_f32 v241, v242, v243
  v_mfma_f32_16x16x32_bf16 v[200:203], v[28:31], a[24:27], v[200:203]
  global_load_lds_dwordx4 v3, s[26:27]
  v_cvt_pk_bf16_f32 v242, v244, v245
  v_mfma_f32_16x16x32_bf16 v[204:207], v[28:31], a[28:31], v[204:207]
  s_waitcnt lgkmcnt(4)
  s_add_u32 s30, s10, 8192
  s_addc_u32 s31, s11, 0
  v_cvt_pk_bf16_f32 v243, v246, v247
  v_mfma_f32_16x16x32_bf16 v[68:71], v[16:19], a[16:19], v[68:71]
  global_store_dwordx4 v4, v[112:115], s[30:31] offset:3072 sc1
  ds_read_b64_tr_b16 v[28:29], v10 offset:45056
  v_mfma_f32_16x16x32_bf16 v[76:79], v[16:19], a[20:23], v[76:79]
  global_load_dwordx4 a[140:143], v51, s[38:39]
  ds_read_b64_tr_b16 v[30:31], v10 offset:45568
  v_mfma_f32_16x16x32_bf16 v[84:87], v[16:19], a[24:27], v[84:87]
  s_add_u32 s46, s72, 9
  s_and_b32 s46, s46, 15
  v_cvt_pk_bf16_f32 v152, v152, v153
  v_mfma_f32_16x16x32_bf16 v[92:95], v[16:19], a[28:31], v[92:95]
  s_waitcnt lgkmcnt(4)
  s_lshl_b32 s46, s46, 10
  v_cvt_pk_bf16_f32 v153, v154, v155
  v_mfma_f32_16x16x32_bf16 v[160:163], v[20:23], a[16:19], v[160:163]
  ds_read_b64_tr_b16 v[16:17], v8 offset:49152
  v_cvt_pk_bf16_f32 v154, v156, v157
  v_mfma_f32_16x16x32_bf16 v[164:167], v[20:23], a[20:23], v[164:167]
  s_add_u32 s46, s60, s46
  s_addc_u32 s47, s61, 0
  ds_read_b64_tr_b16 v[18:19], v8 offset:49664
  v_cvt_pk_bf16_f32 v155, v158, v159
  v_mfma_f32_16x16x32_bf16 v[168:171], v[20:23], a[24:27], v[168:171]
  global_load_dwordx4 a[144:147], v48, s[46:47]
  v_mfma_f32_16x16x32_bf16 v[172:175], v[20:23], a[28:31], v[172:175]
  s_waitcnt lgkmcnt(4)
  global_load_dwordx4 a[148:151], v49, s[46:47]
  v_mfma_f32_16x16x32_bf16 v[224:227], v[24:27], a[16:19], v[224:227]
  ds_read_b64_tr_b16 v[20:21], v9 offset:49152
  v_cvt_pk_bf16_f32 v184, v184, v185
  v_mfma_f32_16x16x32_bf16 v[228:231], v[24:27], a[20:23], v[228:231]
  s_add_u32 s28, s10, 24576
  s_addc_u32 s29, s11, 0
  ds_read_b64_tr_b16 v[22:23], v9 offset:49664
  v_cvt_pk_bf16_f32 v185, v186, v187
  v_mfma_f32_16x16x32_bf16 v[232:235], v[24:27], a[24:27], v[232:235]
  global_store_dwordx4 v4, v[72:75], s[28:29] offset:0 sc1
  v_cvt_pk_bf16_f32 v186, v188, v189
  v_mfma_f32_16x16x32_bf16 v[236:239], v[24:27], a[28:31], v[236:239]
  s_waitcnt lgkmcnt(4)
  global_load_dwordx4 a[152:155], v50, s[46:47]
  v_cvt_pk_bf16_f32 v187, v190, v191
  v_mfma_f32_16x16x32_bf16 v[100:103], v[28:31], a[16:19], v[100:103]
  ds_read_b64_tr_b16 v[24:25], v10 offset:49152
  v_mfma_f32_16x16x32_bf16 v[108:111], v[28:31], a[20:23], v[108:111]
  ds_read_b64_tr_b16 v[26:27], v10 offset:49664
  v_mfma_f32_16x16x32_bf16 v[116:119], v[28:31], a[24:27], v[116:119]
  global_load_dwordx4 a[156:159], v51, s[46:47]
  v_cvt_pk_bf16_f32 v216, v216, v217
  v_mfma_f32_16x16x32_bf16 v[124:127], v[28:31], a[28:31], v[124:127]
  s_waitcnt lgkmcnt(4)
  s_waitcnt vmcnt(49)
  v_cvt_pk_bf16_f32 v217, v218, v219
  v_mfma_f32_16x16x32_bf16 v[128:131], v[16:19], a[32:35], v[128:131]
  ds_read_b64_tr_b16 v[28:29], v8 offset:53248
  v_cvt_pk_bf16_f32 v218, v220, v221
  v_mfma_f32_16x16x32_bf16 v[132:135], v[16:19], a[36:39], v[132:135]
  ds_read_b64_tr_b16 v[30:31], v8 offset:53760
  v_cvt_pk_bf16_f32 v219, v222, v223
  v_mfma_f32_16x16x32_bf16 v[136:139], v[16:19], a[40:43], v[136:139]
  v_mfma_f32_16x16x32_bf16 v[140:143], v[16:19], a[44:47], v[140:143]
  s_waitcnt lgkmcnt(4)
  v_mfma_f32_16x16x32_bf16 v[192:195], v[20:23], a[32:35], v[192:195]
  ds_read_b64_tr_b16 v[16:17], v9 offset:53248
  v_cvt_pk_bf16_f32 v248, v248, v249
  v_mfma_f32_16x16x32_bf16 v[196:199], v[20:23], a[36:39], v[196:199]
  ds_read_b64_tr_b16 v[18:19], v9 offset:53760
  v_cvt_pk_bf16_f32 v249, v250, v251
  v_mfma_f32_16x16x32_bf16 v[200:203], v[20:23], a[40:43], v[200:203]
  s_add_u32 s44, s72, 10
  s_and_b32 s44, s44, 15
  v_cvt_pk_bf16_f32 v250, v252, v253
  v_mfma_f32_16x16x32_bf16 v[204:207], v[20:23], a[44:47], v[204:207]
  s_waitcnt lgkmcnt(4)
  s_lshl_b32 s44, s44, 10
  v_cvt_pk_bf16_f32 v251, v254, v255
  v_mfma_f32_16x16x32_bf16 v[68:71], v[24:27], a[32:35], v[68:71]
  s_add_u32 s44, s60, s44
  s_addc_u32 s45, s61, 0
  ds_read_b64_tr_b16 v[20:21], v10 offset:53248
  v_mfma_f32_16x16x32_bf16 v[76:79], v[24:27], a[36:39], v[76:79]
  ds_read_b64_tr_b16 v[22:23], v10 offset:53760
  v_mfma_f32_16x16x32_bf16 v[84:87], v[24:27], a[40:43], v[84:87]
  global_load_dwordx4 a[160:163], v48, s[44:45]
  v_mfma_f32_16x16x32_bf16 v[92:95], v[24:27], a[44:47], v[92:95]
  s_waitcnt lgkmcnt(4)
  v_mfma_f32_16x16x32_bf16 v[160:163], v[28:31], a[32:35], v[160:163]
  s_add_u32 s30, s10, 24576
  s_addc_u32 s31, s11, 0
  ds_read_b64_tr_b16 v[24:25], v8 offset:57344
  v_mfma_f32_16x16x32_bf16 v[164:167], v[28:31], a[36:39], v[164:167]
  ds_read_b64_tr_b16 v[26:27], v8 offset:57856
  v_mfma_f32_16x16x32_bf16 v[168:171], v[28:31], a[40:43], v[168:171]
  global_store_dwordx4 v4, v[88:91], s[30:31] offset:1024 sc1
  v_mfma_f32_16x16x32_bf16 v[172:175], v[28:31], a[44:47], v[172:175]
  s_waitcnt lgkmcnt(4)
  global_load_dwordx4 a[164:167], v49, s[44:45]
  v_mfma_f32_16x16x32_bf16 v[224:227], v[16:19], a[32:35], v[224:227]
  ds_read_b64_tr_b16 v[28:29], v9 offset:57344
  v_mfma_f32_16x16x32_bf16 v[228:231], v[16:19], a[36:39], v[228:231]
  ds_read_b64_tr_b16 v[30:31], v9 offset:57856
  v_mfma_f32_16x16x32_bf16 v[232:235], v[16:19], a[40:43], v[232:235]
  global_load_dwordx4 a[168:171], v50, s[44:45]
  v_mfma_f32_16x16x32_bf16 v[236:239], v[16:19], a[44:47], v[236:239]
  s_waitcnt lgkmcnt(4)
  v_mfma_f32_16x16x32_bf16 v[100:103], v[20:23], a[32:35], v[100:103]
  ds_read_b64_tr_b16 v[16:17], v10 offset:57344
  v_mfma_f32_16x16x32_bf16 v[108:111], v[20:23], a[36:39], v[108:111]
  ds_read_b64_tr_b16 v[18:19], v10 offset:57856
  v_mfma_f32_16x16x32_bf16 v[116:119], v[20:23], a[40:43], v[116:119]
  v_mfma_f32_16x16x32_bf16 v[124:127], v[20:23], a[44:47], v[124:127]
  s_waitcnt lgkmcnt(4)
  s_waitcnt vmcnt(47)
  global_load_dwordx4 a[172:175], v51, s[44:45]
  v_mfma_f32_16x16x32_bf16 v[128:131], v[24:27], a[48:51], v[128:131]
  ds_read_b64_tr_b16 v[20:21], v8 offset:61440
  v_mfma_f32_16x16x32_bf16 v[132:135], v[24:27], a[52:55], v[132:135]
  ds_read_b64_tr_b16 v[22:23], v8 offset:61952
  v_mfma_f32_16x16x32_bf16 v[136:139], v[24:27], a[56:59], v[136:139]
  v_mfma_f32_16x16x32_bf16 v[140:143], v[24:27], a[60:63], v[140:143]
  s_waitcnt lgkmcnt(4)
  v_mfma_f32_16x16x32_bf16 v[192:195], v[28:31], a[48:51], v[192:195]
  ds_read_b64_tr_b16 v[24:25], v9 offset:61440
  v_mfma_f32_16x16x32_bf16 v[196:199], v[28:31], a[52:55], v[196:199]
  ds_read_b64_tr_b16 v[26:27], v9 offset:61952
  v_mfma_f32_16x16x32_bf16 v[200:203], v[28:31], a[56:59], v[200:203]
  v_mfma_f32_16x16x32_bf16 v[204:207], v[28:31], a[60:63], v[204:207]
  s_waitcnt lgkmcnt(4)
  v_mfma_f32_16x16x32_bf16 v[68:71], v[16:19], a[48:51], v[68:71]
  s_add_u32 s28, s10, 24576
  s_addc_u32 s29, s11, 0
  ds_read_b64_tr_b16 v[28:29], v10 offset:61440
  v_mfma_f32_16x16x32_bf16 v[76:79], v[16:19], a[52:55], v[76:79]
  ds_read_b64_tr_b16 v[30:31], v10 offset:61952
  v_mfma_f32_16x16x32_bf16 v[84:87], v[16:19], a[56:59], v[84:87]
  global_store_dwordx4 v4, v[104:107], s[28:29] offset:2048 sc1
  v_mfma_f32_16x16x32_bf16 v[92:95], v[16:19], a[60:63], v[92:95]
  s_waitcnt lgkmcnt(4)
  s_add_u32 s52, s72, 11
  s_and_b32 s52, s52, 15
  v_mfma_f32_16x16x32_bf16 v[160:163], v[20:23], a[48:51], v[160:163]
  s_waitcnt vmcnt(41)
  s_barrier
  s_lshl_b32 s52, s52, 10
  v_mfma_f32_16x16x32_bf16 v[164:167], v[20:23], a[52:55], v[164:167]
  s_add_u32 s52, s60, s52
  s_addc_u32 s53, s61, 0
  ds_read_b64_tr_b16 v[16:17], v12 offset:0
  v_mfma_f32_16x16x32_bf16 v[168:171], v[20:23], a[56:59], v[168:171]
  ds_read_b64_tr_b16 v[18:19], v12 offset:512
  v_mfma_f32_16x16x32_bf16 v[172:175], v[20:23], a[60:63], v[172:175]
  s_waitcnt lgkmcnt(4)
  global_load_dwordx4 a[176:179], v48, s[52:53]
  v_mfma_f32_16x16x32_bf16 v[224:227], v[24:27], a[48:51], v[224:227]
  ds_read_b64_tr_b16 v[20:21], v13 offset:0
  v_mfma_f32_16x16x32_bf16 v[228:231], v[24:27], a[52:55], v[228:231]
  ds_read_b64_tr_b16 v[22:23], v13 offset:512
  v_mfma_f32_16x16x32_bf16 v[232:235], v[24:27], a[56:59], v[232:235]
  global_load_dwordx4 a[180:183], v49, s[52:53]
  v_mfma_f32_16x16x32_bf16 v[236:239], v[24:27], a[60:63], v[236:239]
  s_waitcnt lgkmcnt(4)
  s_add_u32 s42, s72, 12
  s_and_b32 s42, s42, 15
  v_mfma_f32_16x16x32_bf16 v[100:103], v[28:31], a[48:51], v[100:103]
  s_mul_i32 s42, s42, 88064
  ds_read_b64_tr_b16 v[24:25], v14 offset:0
  v_mfma_f32_16x16x32_bf16 v[108:111], v[28:31], a[52:55], v[108:111]
  s_add_u32 s24, s14, s42
  s_addc_u32 s25, s15, 0
  s_add_u32 m0, s23, 0
  ds_read_b64_tr_b16 v[26:27], v14 offset:512
  v_mfma_f32_16x16x32_bf16 v[116:119], v[28:31], a[56:59], v[116:119]
  global_load_lds_dwordx4 v3, s[24:25]
  v_mfma_f32_16x16x32_bf16 v[124:127], v[28:31], a[60:63], v[124:127]
  s_waitcnt lgkmcnt(4)
  s_waitcnt vmcnt(42)
  global_load_dwordx4 a[184:187], v50, s[52:53]
  v_mfma_f32_16x16x32_bf16 v[128:131], v[16:19], a[64:67], v[128:131]
  s_add_u32 s26, s16, s42
  s_addc_u32 s27, s17, 0
  ds_read_b64_tr_b16 v[28:29], v12 offset:4096
  v_mfma_f32_16x16x32_bf16 v[132:135], v[16:19], a[68:71], v[132:135]
  s_add_u32 m0, s23, 4096
  ds_read_b64_tr_b16 v[30:31], v12 offset:4608
  v_mfma_f32_16x16x32_bf16 v[136:139], v[16:19], a[72:75], v[136:139]
  global_load_lds_dwordx4 v3, s[26:27]
  v_mfma_f32_16x16x32_bf16 v[140:143], v[16:19], a[76:79], v[140:143]
  s_waitcnt lgkmcnt(4)
  s_add_u32 s43, s72, 13
  s_and_b32 s43, s43, 15
  v_mfma_f32_16x16x32_bf16 v[192:195], v[20:23], a[64:67], v[192:195]
  s_mul_i32 s43, s43, 88064
  ds_read_b64_tr_b16 v[16:17], v13 offset:4096
  v_mfma_f32_16x16x32_bf16 v[196:199], v[20:23], a[68:71], v[196:199]
  s_add_u32 s24, s14, s43
  s_addc_u32 s25, s15, 0
  s_add_u32 m0, s23, 8192
  ds_read_b64_tr_b16 v[18:19], v13 offset:4608
  v_mfma_f32_16x16x32_bf16 v[200:203], v[20:23], a[72:75], v[200:203]
  global_load_lds_dwordx4 v3, s[24:25]
  v_mfma_f32_16x16x32_bf16 v[204:207], v[20:23], a[76:79], v[204:207]
  s_waitcnt lgkmcnt(4)
  global_load_dwordx4 a[188:191], v51, s[52:53]
  v_mfma_f32_16x16x32_bf16 v[68:71], v[24:27], a[64:67], v[68:71]
  s_add_u32 s26, s16, s43
  s_addc_u32 s27, s17, 0
  ds_read_b64_tr_b16 v[20:21], v14 offset:4096
  v_mfma_f32_16x16x32_bf16 v[76:79], v[24:27], a[68:71], v[76:79]
  s_add_u32 m0, s23, 12288
  ds_read_b64_tr_b16 v[22:23], v14 offset:4608
  v_mfma_f32_16x16x32_bf16 v[84:87], v[24:27], a[72:75], v[84:87]
  global_load_lds_dwordx4 v3, s[26:27]
  v_mfma_f32_16x16x32_bf16 v[92:95], v[24:27], a[76:79], v[92:95]
  s_waitcnt lgkmcnt(4)
  v_mfma_f32_16x16x32_bf16 v[160:163], v[28:31], a[64:67], v[160:163]
  s_add_u32 s30, s10, 24576
  s_addc_u32 s31, s11, 0
  ds_read_b64_tr_b16 v[24:25], v12 offset:8192
  v_mfma_f32_16x16x32_bf16 v[164:167], v[28:31], a[68:71], v[164:167]
  ds_read_b64_tr_b16 v[26:27], v12 offset:8704
  v_mfma_f32_16x16x32_bf16 v[168:171], v[28:31], a[72:75], v[168:171]
  global_store_dwordx4 v4, v[120:123], s[30:31] offset:3072 sc1
  v_mfma_f32_16x16x32_bf16 v[172:175], v[28:31], a[76:79], v[172:175]
  s_waitcnt lgkmcnt(4)
  s_add_u32 s42, s72, 14
  s_and_b32 s42, s42, 15
  v_mfma_f32_16x16x32_bf16 v[224:227], v[16:19], a[64:67], v[224:227]
  s_mul_i32 s42, s42, 88064
  ds_read_b64_tr_b16 v[28:29], v13 offset:8192
  v_mfma_f32_16x16x32_bf16 v[228:231], v[16:19], a[68:71], v[228:231]
  s_add_u32 s24, s14, s42
  s_addc_u32 s25, s15, 0
  s_add_u32 m0, s23, 16384
  ds_read_b64_tr_b16 v[30:31], v13 offset:8704
  v_mfma_f32_16x16x32_bf16 v[232:235], v[16:19], a[72:75], v[232:235]
  global_load_lds_dwordx4 v3, s[24:25]
  v_mfma_f32_16x16x32_bf16 v[236:239], v[16:19], a[76:79], v[236:239]
  s_waitcnt lgkmcnt(4)
  s_add_u32 s38, s72, 12
  s_and_b32 s38, s38, 15
  v_mfma_f32_16x16x32_bf16 v[100:103], v[20:23], a[64:67], v[100:103]
  s_lshl_b32 s38, s38, 10
  ds_read_b64_tr_b16 v[16:17], v14 offset:8192
  v_mfma_f32_16x16x32_bf16 v[108:111], v[20:23], a[68:71], v[108:111]
  s_add_u32 s38, s60, s38
  s_addc_u32 s39, s61, 0
  ds_read_b64_tr_b16 v[18:19], v14 offset:8704
  v_mfma_f32_16x16x32_bf16 v[116:119], v[20:23], a[72:75], v[116:119]
  global_load_dwordx4 a[192:195], v48, s[38:39]
  v_mfma_f32_16x16x32_bf16 v[124:127], v[20:23], a[76:79], v[124:127]
  s_waitcnt lgkmcnt(4)
  s_waitcnt vmcnt(46)
  v_mfma_f32_16x16x32_bf16 v[128:131], v[24:27], a[80:83], v[128:131]
  s_add_u32 s26, s16, s42
  s_addc_u32 s27, s17, 0
  ds_read_b64_tr_b16 v[20:21], v12 offset:12288
  v_mfma_f32_16x16x32_bf16 v[132:135], v[24:27], a[84:87], v[132:135]
  s_add_u32 m0, s23, 20480
  ds_read_b64_tr_b16 v[22:23], v12 offset:12800
  v_mfma_f32_16x16x32_bf16 v[136:139], v[24:27], a[88:91], v[136:139]
  global_load_lds_dwordx4 v3, s[26:27]
  v_mfma_f32_16x16x32_bf16 v[140:143], v[24:27], a[92:95], v[140:143]
  s_waitcnt lgkmcnt(4)
  global_load_dwordx4 a[196:199], v49, s[38:39]
  v_mfma_f32_16x16x32_bf16 v[192:195], v[28:31], a[80:83], v[192:195]
  s_add_u32 s43, s72, 15
  s_and_b32 s43, s43, 15
  ds_read_b64_tr_b16 v[24:25], v13 offset:12288
  v_mfma_f32_16x16x32_bf16 v[196:199], v[28:31], a[84:87], v[196:199]
  s_mul_i32 s43, s43, 88064
  ds_read_b64_tr_b16 v[26:27], v13 offset:12800
  v_mfma_f32_16x16x32_bf16 v[200:203], v[28:31], a[88:91], v[200:203]
  s_add_u32 s24, s14, s43
  s_addc_u32 s25, s15, 0
  s_add_u32 m0, s23, 24576
  v_mfma_f32_16x16x32_bf16 v[204:207], v[28:31], a[92:95], v[204:207]
  s_waitcnt lgkmcnt(4)
  global_load_lds_dwordx4 v3, s[24:25]
  v_mfma_f32_16x16x32_bf16 v[68:71], v[16:19], a[80:83], v[68:71]
  s_add_u32 s26, s16, s43
  s_addc_u32 s27, s17, 0
  ds_read_b64_tr_b16 v[28:29], v14 offset:12288
  v_mfma_f32_16x16x32_bf16 v[76:79], v[16:19], a[84:87], v[76:79]
  s_add_u32 m0, s23, 28672
  ds_read_b64_tr_b16 v[30:31], v14 offset:12800
  v_mfma_f32_16x16x32_bf16 v[84:87], v[16:19], a[88:91], v[84:87]
  global_load_lds_dwordx4 v3, s[26:27]
  v_mfma_f32_16x16x32_bf16 v[92:95], v[16:19], a[92:95], v[92:95]
  s_waitcnt lgkmcnt(4)
  global_load_dwordx4 a[200:203], v50, s[38:39]
  v_mfma_f32_16x16x32_bf16 v[160:163], v[20:23], a[80:83], v[160:163]
  ds_read_b64_tr_b16 v[16:17], v12 offset:16384
  v_mfma_f32_16x16x32_bf16 v[164:167], v[20:23], a[84:87], v[164:167]
  ds_read_b64_tr_b16 v[18:19], v12 offset:16896
  v_mfma_f32_16x16x32_bf16 v[168:171], v[20:23], a[88:91], v[168:171]
  global_load_dwordx4 a[204:207], v51, s[38:39]
  v_mfma_f32_16x16x32_bf16 v[172:175], v[20:23], a[92:95], v[172:175]
  s_waitcnt lgkmcnt(4)
  s_add_u32 s46, s72, 13
  s_and_b32 s46, s46, 15
  v_mfma_f32_16x16x32_bf16 v[224:227], v[24:27], a[80:83], v[224:227]
  s_lshl_b32 s46, s46, 10
  ds_read_b64_tr_b16 v[20:21], v13 offset:16384
  v_mfma_f32_16x16x32_bf16 v[228:231], v[24:27], a[84:87], v[228:231]
  s_add_u32 s46, s60, s46
  s_addc_u32 s47, s61, 0
  ds_read_b64_tr_b16 v[22:23], v13 offset:16896
  v_mfma_f32_16x16x32_bf16 v[232:235], v[24:27], a[88:91], v[232:235]
  global_load_dwordx4 a[208:211], v48, s[46:47]
  v_mfma_f32_16x16x32_bf16 v[236:239], v[24:27], a[92:95], v[236:239]
  s_waitcnt lgkmcnt(4)
  global_load_dwordx4 a[212:215], v49, s[46:47]
  v_mfma_f32_16x16x32_bf16 v[100:103], v[28:31], a[80:83], v[100:103]
  ds_read_b64_tr_b16 v[24:25], v14 offset:16384
  v_mfma_f32_16x16x32_bf16 v[108:111], v[28:31], a[84:87], v[108:111]
  ds_read_b64_tr_b16 v[26:27], v14 offset:16896
  v_mfma_f32_16x16x32_bf16 v[116:119], v[28:31], a[88:91], v[116:119]
  global_load_dwordx4 a[216:219], v50, s[46:47]
  v_mfma_f32_16x16x32_bf16 v[124:127], v[28:31], a[92:95], v[124:127]
  s_waitcnt lgkmcnt(4)
  s_waitcnt vmcnt(50)
  v_mfma_f32_16x16x32_bf16 v[128:131], v[16:19], a[96:99], v[128:131]
  ds_read_b64_tr_b16 v[28:29], v12 offset:20480
  v_mfma_f32_16x16x32_bf16 v[132:135], v[16:19], a[100:103], v[132:135]
  ds_read_b64_tr_b16 v[30:31], v12 offset:20992
  v_mfma_f32_16x16x32_bf16 v[136:139], v[16:19], a[104:107], v[136:139]
  global_load_dwordx4 a[220:223], v51, s[46:47]
  v_mfma_f32_16x16x32_bf16 v[140:143], v[16:19], a[108:111], v[140:143]
  s_waitcnt lgkmcnt(4)
  v_mfma_f32_16x16x32_bf16 v[192:195], v[20:23], a[96:99], v[192:195]
  ds_read_b64_tr_b16 v[16:17], v13 offset:20480
  v_mfma_f32_16x16x32_bf16 v[196:199], v[20:23], a[100:103], v[196:199]
  ds_read_b64_tr_b16 v[18:19], v13 offset:20992
  v_mfma_f32_16x16x32_bf16 v[200:203], v[20:23], a[104:107], v[200:203]
  v_mfma_f32_16x16x32_bf16 v[204:207], v[20:23], a[108:111], v[204:207]
  s_waitcnt lgkmcnt(4)
  v_mfma_f32_16x16x32_bf16 v[68:71], v[24:27], a[96:99], v[68:71]
  ds_read_b64_tr_b16 v[20:21], v14 offset:20480
  v_mfma_f32_16x16x32_bf16 v[76:79], v[24:27], a[100:103], v[76:79]
  ds_read_b64_tr_b16 v[22:23], v14 offset:20992
  v_mfma_f32_16x16x32_bf16 v[84:87], v[24:27], a[104:107], v[84:87]
  s_add_u32 s44, s72, 14
  s_and_b32 s44, s44, 15
  s_lshl_b32 s44, s44, 10
  v_mfma_f32_16x16x32_bf16 v[92:95], v[24:27], a[108:111], v[92:95]
  s_waitcnt lgkmcnt(4)
  s_add_u32 s44, s60, s44
  s_addc_u32 s45, s61, 0
  v_mfma_f32_16x16x32_bf16 v[160:163], v[28:31], a[96:99], v[160:163]
  ds_read_b64_tr_b16 v[24:25], v12 offset:24576
  v_mfma_f32_16x16x32_bf16 v[164:167], v[28:31], a[100:103], v[164:167]
  ds_read_b64_tr_b16 v[26:27], v12 offset:25088
  v_mfma_f32_16x16x32_bf16 v[168:171], v[28:31], a[104:107], v[168:171]
  global_load_dwordx4 a[224:227], v48, s[44:45]
  v_mfma_f32_16x16x32_bf16 v[172:175], v[28:31], a[108:111], v[172:175]
  s_waitcnt lgkmcnt(4)
  v_mfma_f32_16x16x32_bf16 v[224:227], v[16:19], a[96:99], v[224:227]
  ds_read_b64_tr_b16 v[28:29], v13 offset:24576
  v_mfma_f32_16x16x32_bf16 v[228:231], v[16:19], a[100:103], v[228:231]
  ds_read_b64_tr_b16 v[30:31], v13 offset:25088
  v_mfma_f32_16x16x32_bf16 v[232:235], v[16:19], a[104:107], v[232:235]
  global_load_dwordx4 a[228:231], v49, s[44:45]
  v_mfma_f32_16x16x32_bf16 v[236:239], v[16:19], a[108:111], v[236:239]
  s_waitcnt lgkmcnt(4)
  v_mfma_f32_16x16x32_bf16 v[100:103], v[20:23], a[96:99], v[100:103]
  ds_read_b64_tr_b16 v[16:17], v14 offset:24576
  v_mfma_f32_16x16x32_bf16 v[108:111], v[20:23], a[100:103], v[108:111]
  ds_read_b64_tr_b16 v[18:19], v14 offset:25088
  v_mfma_f32_16x16x32_bf16 v[116:119], v[20:23], a[104:107], v[116:119]
  global_load_dwordx4 a[232:235], v50, s[44:45]
  v_mfma_f32_16x16x32_bf16 v[124:127], v[20:23], a[108:111], v[124:127]
  s_waitcnt lgkmcnt(4)
  s_waitcnt vmcnt(48)
  v_mfma_f32_16x16x32_bf16 v[128:131], v[24:27], a[112:115], v[128:131]
  ds_read_b64_tr_b16 v[20:21], v12 offset:28672
  v_mfma_f32_16x16x32_bf16 v[132:135], v[24:27], a[116:119], v[132:135]
  ds_read_b64_tr_b16 v[22:23], v12 offset:29184
  v_mfma_f32_16x16x32_bf16 v[136:139], v[24:27], a[120:123], v[136:139]
  v_mfma_f32_16x16x32_bf16 v[140:143], v[24:27], a[124:127], v[140:143]
  s_waitcnt lgkmcnt(4)
  global_load_dwordx4 a[236:239], v51, s[44:45]
  v_mfma_f32_16x16x32_bf16 v[192:195], v[28:31], a[112:115], v[192:195]
  ds_read_b64_tr_b16 v[24:25], v13 offset:28672
  v_mfma_f32_16x16x32_bf16 v[196:199], v[28:31], a[116:119], v[196:199]
  ds_read_b64_tr_b16 v[26:27], v13 offset:29184
  v_mfma_f32_16x16x32_bf16 v[200:203], v[28:31], a[120:123], v[200:203]
  v_mfma_f32_16x16x32_bf16 v[204:207], v[28:31], a[124:127], v[204:207]
  s_waitcnt lgkmcnt(4)
  v_mfma_f32_16x16x32_bf16 v[68:71], v[16:19], a[112:115], v[68:71]
  ds_read_b64_tr_b16 v[28:29], v14 offset:28672
  v_mfma_f32_16x16x32_bf16 v[76:79], v[16:19], a[116:119], v[76:79]
  ds_read_b64_tr_b16 v[30:31], v14 offset:29184
  v_mfma_f32_16x16x32_bf16 v[84:87], v[16:19], a[120:123], v[84:87]
  v_mfma_f32_16x16x32_bf16 v[92:95], v[16:19], a[124:127], v[92:95]
  s_waitcnt lgkmcnt(4)
  s_add_u32 s52, s72, 15
  s_and_b32 s52, s52, 15
  v_mfma_f32_16x16x32_bf16 v[160:163], v[20:23], a[112:115], v[160:163]
  s_waitcnt vmcnt(38)
  s_barrier
  s_lshl_b32 s52, s52, 10
  v_mfma_f32_16x16x32_bf16 v[164:167], v[20:23], a[116:119], v[164:167]
  s_add_u32 s52, s60, s52
  s_addc_u32 s53, s61, 0
  ds_read_b64_tr_b16 v[16:17], v12 offset:32768
  v_mfma_f32_16x16x32_bf16 v[168:171], v[20:23], a[120:123], v[168:171]
  ds_read_b64_tr_b16 v[18:19], v12 offset:33280
  v_mfma_f32_16x16x32_bf16 v[172:175], v[20:23], a[124:127], v[172:175]
  s_waitcnt lgkmcnt(4)
  global_load_dwordx4 a[240:243], v48, s[52:53]
  v_mfma_f32_16x16x32_bf16 v[224:227], v[24:27], a[112:115], v[224:227]
  s_add_u32 s42, s72, 0
  s_and_b32 s42, s42, 15
  ds_read_b64_tr_b16 v[20:21], v13 offset:32768
  v_mfma_f32_16x16x32_bf16 v[228:231], v[24:27], a[116:119], v[228:231]
  s_mul_i32 s42, s42, 262144
  ds_read_b64_tr_b16 v[22:23], v13 offset:33280
  v_mfma_f32_16x16x32_bf16 v[232:235], v[24:27], a[120:123], v[232:235]
  s_add_u32 s24, s18, s42
  s_addc_u32 s25, s19, 0
  s_add_u32 m0, s23, 32768
  v_mfma_f32_16x16x32_bf16 v[236:239], v[24:27], a[124:127], v[236:239]
  s_waitcnt lgkmcnt(4)
  global_load_lds_dwordx4 v2, s[24:25]
  v_mfma_f32_16x16x32_bf16 v[100:103], v[28:31], a[112:115], v[100:103]
  ds_read_b64_tr_b16 v[24:25], v14 offset:32768
  v_mfma_f32_16x16x32_bf16 v[108:111], v[28:31], a[116:119], v[108:111]
  ds_read_b64_tr_b16 v[26:27], v14 offset:33280
  v_mfma_f32_16x16x32_bf16 v[116:119], v[28:31], a[120:123], v[116:119]
  global_load_dwordx4 a[244:247], v49, s[52:53]
  v_mfma_f32_16x16x32_bf16 v[124:127], v[28:31], a[124:127], v[124:127]
  s_waitcnt lgkmcnt(4)
  s_waitcnt vmcnt(39)
  s_add_u32 s43, s72, 1
  v_mfma_f32_16x16x32_bf16 v[128:131], v[16:19], a[128:131], v[128:131]
  s_and_b32 s43, s43, 15
  s_mul_i32 s43, s43, 262144
  ds_read_b64_tr_b16 v[28:29], v12 offset:36864
  v_mfma_f32_16x16x32_bf16 v[132:135], v[16:19], a[132:135], v[132:135]
  s_add_u32 s26, s18, s43
  s_addc_u32 s27, s19, 0
  s_add_u32 m0, s23, 36864
  ds_read_b64_tr_b16 v[30:31], v12 offset:37376
  v_mfma_f32_16x16x32_bf16 v[136:139], v[16:19], a[136:139], v[136:139]
  global_load_lds_dwordx4 v2, s[26:27]
  v_mfma_f32_16x16x32_bf16 v[140:143], v[16:19], a[140:143], v[140:143]
  s_waitcnt lgkmcnt(4)
  global_load_dwordx4 a[248:251], v50, s[52:53]
  v_mfma_f32_16x16x32_bf16 v[192:195], v[20:23], a[128:131], v[192:195]
  s_add_u32 s42, s72, 2
  s_and_b32 s42, s42, 15
  ds_read_b64_tr_b16 v[16:17], v13 offset:36864
  v_mfma_f32_16x16x32_bf16 v[196:199], v[20:23], a[132:135], v[196:199]
  s_mul_i32 s42, s42, 262144
  ds_read_b64_tr_b16 v[18:19], v13 offset:37376
  v_mfma_f32_16x16x32_bf16 v[200:203], v[20:23], a[136:139], v[200:203]
  s_add_u32 s24, s18, s42
  s_addc_u32 s25, s19, 0
  s_add_u32 m0, s23, 40960
  v_mfma_f32_16x16x32_bf16 v[204:207], v[20:23], a[140:143], v[204:207]
  s_waitcnt lgkmcnt(4)
  global_load_lds_dwordx4 v2, s[24:25]
  v_mfma_f32_16x16x32_bf16 v[68:71], v[24:27], a[128:131], v[68:71]
  s_add_u32 s28, s10, 12288
  s_addc_u32 s29, s11, 0
  ds_read_b64_tr_b16 v[20:21], v14 offset:36864
  v_mfma_f32_16x16x32_bf16 v[76:79], v[24:27], a[132:135], v[76:79]
  ds_read_b64_tr_b16 v[22:23], v14 offset:37376
  v_mfma_f32_16x16x32_bf16 v[84:87], v[24:27], a[136:139], v[84:87]
  global_store_dwordx4 v4, v[144:147], s[28:29] offset:0 sc1
  v_mfma_f32_16x16x32_bf16 v[92:95], v[24:27], a[140:143], v[92:95]
  s_waitcnt lgkmcnt(4)
  s_add_u32 s43, s72, 3
  s_and_b32 s43, s43, 15
  v_mfma_f32_16x16x32_bf16 v[160:163], v[28:31], a[128:131], v[160:163]
  s_mul_i32 s43, s43, 262144
  ds_read_b64_tr_b16 v[24:25], v12 offset:40960
  v_mfma_f32_16x16x32_bf16 v[164:167], v[28:31], a[132:135], v[164:167]
  s_add_u32 s26, s18, s43
  s_addc_u32 s27, s19, 0
  s_add_u32 m0, s23, 45056
  ds_read_b64_tr_b16 v[26:27], v12 offset:41472
  v_mfma_f32_16x16x32_bf16 v[168:171], v[28:31], a[136:139], v[168:171]
  global_load_lds_dwordx4 v2, s[26:27]
  v_mfma_f32_16x16x32_bf16 v[172:175], v[28:31], a[140:143], v[172:175]
  s_waitcnt lgkmcnt(4)
  global_load_dwordx4 a[252:255], v51, s[52:53]
  v_mfma_f32_16x16x32_bf16 v[224:227], v[16:19], a[128:131], v[224:227]
  s_add_u32 s42, s72, 4
  s_and_b32 s42, s42, 15
  ds_read_b64_tr_b16 v[28:29], v13 offset:40960
  v_mfma_f32_16x16x32_bf16 v[228:231], v[16:19], a[132:135], v[228:231]
  s_mul_i32 s42, s42, 262144
  ds_read_b64_tr_b16 v[30:31], v13 offset:41472
  v_mfma_f32_16x16x32_bf16 v[232:235], v[16:19], a[136:139], v[232:235]
  s_add_u32 s24, s18, s42
  s_addc_u32 s25, s19, 0
  s_add_u32 m0, s23, 49152
  v_mfma_f32_16x16x32_bf16 v[236:239], v[16:19], a[140:143], v[236:239]
  s_waitcnt lgkmcnt(4)
  global_load_lds_dwordx4 v2, s[24:25]
  v_mfma_f32_16x16x32_bf16 v[100:103], v[20:23], a[128:131], v[100:103]
  s_add_u32 s43, s72, 5
  s_and_b32 s43, s43, 15
  ds_read_b64_tr_b16 v[16:17], v14 offset:40960
  v_mfma_f32_16x16x32_bf16 v[108:111], v[20:23], a[132:135], v[108:111]
  s_mul_i32 s43, s43, 262144
  ds_read_b64_tr_b16 v[18:19], v14 offset:41472
  v_mfma_f32_16x16x32_bf16 v[116:119], v[20:23], a[136:139], v[116:119]
  s_add_u32 s26, s18, s43
  s_addc_u32 s27, s19, 0
  s_add_u32 m0, s23, 53248
  v_mfma_f32_16x16x32_bf16 v[124:127], v[20:23], a[140:143], v[124:127]
  s_waitcnt lgkmcnt(4)
  s_waitcnt vmcnt(41)
  global_load_lds_dwordx4 v2, s[26:27]
  v_mfma_f32_16x16x32_bf16 v[128:131], v[24:27], a[144:147], v[128:131]
  s_add_u32 s42, s72, 6
  s_and_b32 s42, s42, 15
  ds_read_b64_tr_b16 v[20:21], v12 offset:45056
  v_mfma_f32_16x16x32_bf16 v[132:135], v[24:27], a[148:151], v[132:135]
  s_mul_i32 s42, s42, 262144
  ds_read_b64_tr_b16 v[22:23], v12 offset:45568
  v_mfma_f32_16x16x32_bf16 v[136:139], v[24:27], a[152:155], v[136:139]
  s_add_u32 s24, s18, s42
  s_addc_u32 s25, s19, 0
  s_add_u32 m0, s23, 57344
  v_mfma_f32_16x16x32_bf16 v[140:143], v[24:27], a[156:159], v[140:143]
  s_waitcnt lgkmcnt(4)
  global_load_lds_dwordx4 v2, s[24:25]
  v_mfma_f32_16x16x32_bf16 v[192:195], v[28:31], a[144:147], v[192:195]
  s_add_u32 s43, s72, 7
  s_and_b32 s43, s43, 15
  ds_read_b64_tr_b16 v[24:25], v13 offset:45056
  v_mfma_f32_16x16x32_bf16 v[196:199], v[28:31], a[148:151], v[196:199]
  s_mul_i32 s43, s43, 262144
  ds_read_b64_tr_b16 v[26:27], v13 offset:45568
  v_mfma_f32_16x16x32_bf16 v[200:203], v[28:31], a[152:155], v[200:203]
  s_add_u32 s26, s18, s43
  s_addc_u32 s27, s19, 0
  s_add_u32 m0, s23, 61440
  v_mfma_f32_16x16x32_bf16 v[204:207], v[28:31], a[156:159], v[204:207]
  s_waitcnt lgkmcnt(4)
  global_load_lds_dwordx4 v2, s[26:27]
  v_mfma_f32_16x16x32_bf16 v[68:71], v[16:19], a[144:147], v[68:71]
  s_add_u32 s30, s10, 12288
  s_addc_u32 s31, s11, 0
  ds_read_b64_tr_b16 v[28:29], v14 offset:45056
  v_mfma_f32_16x16x32_bf16 v[76:79], v[16:19], a[148:151], v[76:79]
  ds_read_b64_tr_b16 v[30:31], v14 offset:45568
  v_mfma_f32_16x16x32_bf16 v[84:87], v[16:19], a[152:155], v[84:87]
  global_store_dwordx4 v4, v[176:179], s[30:31] offset:1024 sc1
  v_mfma_f32_16x16x32_bf16 v[92:95], v[16:19], a[156:159], v[92:95]
  s_waitcnt lgkmcnt(4)
  v_mfma_f32_16x16x32_bf16 v[160:163], v[20:23], a[144:147], v[160:163]
  ds_read_b64_tr_b16 v[16:17], v12 offset:49152
  v_mfma_f32_16x16x32_bf16 v[164:167], v[20:23], a[148:151], v[164:167]
  ds_read_b64_tr_b16 v[18:19], v12 offset:49664
  v_mfma_f32_16x16x32_bf16 v[168:171], v[20:23], a[152:155], v[168:171]
  v_mfma_f32_16x16x32_bf16 v[172:175], v[20:23], a[156:159], v[172:175]
  s_waitcnt lgkmcnt(4)
  v_mfma_f32_16x16x32_bf16 v[224:227], v[24:27], a[144:147], v[224:227]
  ds_read_b64_tr_b16 v[20:21], v13 offset:49152
  v_mfma_f32_16x16x32_bf16 v[228:231], v[24:27], a[148:151], v[228:231]
  s_add_u32 s28, s10, 12288
  s_addc_u32 s29, s11, 0
  ds_read_b64_tr_b16 v[22:23], v13 offset:49664
  v_mfma_f32_16x16x32_bf16 v[232:235], v[24:27], a[152:155], v[232:235]
  v_mfma_f32_16x16x32_bf16 v[236:239], v[24:27], a[156:159], v[236:239]
  s_waitcnt lgkmcnt(4)
  global_store_dwordx4 v4, v[208:211], s[28:29] offset:2048 sc1
  v_mfma_f32_16x16x32_bf16 v[100:103], v[28:31], a[144:147], v[100:103]
  ds_read_b64_tr_b16 v[24:25], v14 offset:49152
  v_mfma_f32_16x16x32_bf16 v[108:111], v[28:31], a[148:151], v[108:111]
  ds_read_b64_tr_b16 v[26:27], v14 offset:49664
  v_mfma_f32_16x16x32_bf16 v[116:119], v[28:31], a[152:155], v[116:119]
  v_mfma_f32_16x16x32_bf16 v[124:127], v[28:31], a[156:159], v[124:127]
  s_waitcnt lgkmcnt(4)
  s_waitcnt vmcnt(41)
  v_mfma_f32_16x16x32_bf16 v[128:131], v[16:19], a[160:163], v[128:131]
  ds_read_b64_tr_b16 v[28:29], v12 offset:53248
  v_mfma_f32_16x16x32_bf16 v[132:135], v[16:19], a[164:167], v[132:135]
  ds_read_b64_tr_b16 v[30:31], v12 offset:53760
  v_mfma_f32_16x16x32_bf16 v[136:139], v[16:19], a[168:171], v[136:139]
  v_mfma_f32_16x16x32_bf16 v[140:143], v[16:19], a[172:175], v[140:143]
  s_waitcnt lgkmcnt(4)
  v_mfma_f32_16x16x32_bf16 v[192:195], v[20:23], a[160:163], v[192:195]
  ds_read_b64_tr_b16 v[16:17], v13 offset:53248
  v_mfma_f32_16x16x32_bf16 v[196:199], v[20:23], a[164:167], v[196:199]
  ds_read_b64_tr_b16 v[18:19], v13 offset:53760
  v_mfma_f32_16x16x32_bf16 v[200:203], v[20:23], a[168:171], v[200:203]
  v_mfma_f32_16x16x32_bf16 v[204:207], v[20:23], a[172:175], v[204:207]
  s_waitcnt lgkmcnt(4)
  v_mfma_f32_16x16x32_bf16 v[68:71], v[24:27], a[160:163], v[68:71]
  ds_read_b64_tr_b16 v[20:21], v14 offset:53248
  v_mfma_f32_16x16x32_bf16 v[76:79], v[24:27], a[164:167], v[76:79]
  ds_read_b64_tr_b16 v[22:23], v14 offset:53760
  v_mfma_f32_16x16x32_bf16 v[84:87], v[24:27], a[168:171], v[84:87]
  v_mfma_f32_16x16x32_bf16 v[92:95], v[24:27], a[172:175], v[92:95]
  s_waitcnt lgkmcnt(4)
  v_mfma_f32_16x16x32_bf16 v[160:163], v[28:31], a[160:163], v[160:163]
  ds_read_b64_tr_b16 v[24:25], v12 offset:57344
  v_mfma_f32_16x16x32_bf16 v[164:167], v[28:31], a[164:167], v[164:167]
  s_add_u32 s30, s10, 12288
  s_addc_u32 s31, s11, 0
  ds_read_b64_tr_b16 v[26:27], v12 offset:57856
  v_mfma_f32_16x16x32_bf16 v[168:171], v[28:31], a[168:171], v[168:171]
  v_mfma_f32_16x16x32_bf16 v[172:175], v[28:31], a[172:175], v[172:175]
  s_waitcnt lgkmcnt(4)
  global_store_dwordx4 v4, v[240:243], s[30:31] offset:3072 sc1
  v_mfma_f32_16x16x32_bf16 v[224:227], v[16:19], a[160:163], v[224:227]
  ds_read_b64_tr_b16 v[28:29], v13 offset:57344
  v_mfma_f32_16x16x32_bf16 v[228:231], v[16:19], a[164:167], v[228:231]
  ds_read_b64_tr_b16 v[30:31], v13 offset:57856
  v_mfma_f32_16x16x32_bf16 v[232:235], v[16:19], a[168:171], v[232:235]
  v_mfma_f32_16x16x32_bf16 v[236:239], v[16:19], a[172:175], v[236:239]
  s_waitcnt lgkmcnt(4)
  v_mfma_f32_16x16x32_bf16 v[100:103], v[20:23], a[160:163], v[100:103]
  ds_read_b64_tr_b16 v[16:17], v14 offset:57344
  v_mfma_f32_16x16x32_bf16 v[108:111], v[20:23], a[164:167], v[108:111]
  ds_read_b64_tr_b16 v[18:19], v14 offset:57856
  v_mfma_f32_16x16x32_bf16 v[116:119], v[20:23], a[168:171], v[116:119]
  v_mfma_f32_16x16x32_bf16 v[124:127], v[20:23], a[172:175], v[124:127]
  s_waitcnt lgkmcnt(4)
  s_waitcnt vmcnt(34)
  v_mfma_f32_16x16x32_bf16 v[128:131], v[24:27], a[176:179], v[128:131]
  ds_read_b64_tr_b16 v[20:21], v12 offset:61440
  v_mfma_f32_16x16x32_bf16 v[132:135], v[24:27], a[180:183], v[132:135]
  ds_read_b64_tr_b16 v[22:23], v12 offset:61952
  v_mfma_f32_16x16x32_bf16 v[136:139], v[24:27], a[184:187], v[136:139]
  v_mfma_f32_16x16x32_bf16 v[140:143], v[24:27], a[188:191], v[140:143]
  s_waitcnt lgkmcnt(4)
  v_mfma_f32_16x16x32_bf16 v[192:195], v[28:31], a[176:179], v[192:195]
  ds_read_b64_tr_b16 v[24:25], v13 offset:61440
  v_mfma_f32_16x16x32_bf16 v[196:199], v[28:31], a[180:183], v[196:199]
  ds_read_b64_tr_b16 v[26:27], v13 offset:61952
  v_mfma_f32_16x16x32_bf16 v[200:203], v[28:31], a[184:187], v[200:203]
  v_mfma_f32_16x16x32_bf16 v[204:207], v[28:31], a[188:191], v[204:207]
  s_waitcnt lgkmcnt(4)
  v_mfma_f32_16x16x32_bf16 v[68:71], v[16:19], a[176:179], v[68:71]
  ds_read_b64_tr_b16 v[28:29], v14 offset:61440
  v_mfma_f32_16x16x32_bf16 v[76:79], v[16:19], a[180:183], v[76:79]
  s_add_u32 s28, s10, 28672
  s_addc_u32 s29, s11, 0
  ds_read_b64_tr_b16 v[30:31], v14 offset:61952
  v_mfma_f32_16x16x32_bf16 v[84:87], v[16:19], a[184:187], v[84:87]
  v_mfma_f32_16x16x32_bf16 v[92:95], v[16:19], a[188:191], v[92:95]
  s_waitcnt lgkmcnt(4)
  global_store_dwordx4 v4, v[152:155], s[28:29] offset:0 sc1
  v_mfma_f32_16x16x32_bf16 v[160:163], v[20:23], a[176:179], v[160:163]
  s_waitcnt vmcnt(27)
  s_barrier
  v_mfma_f32_16x16x32_bf16 v[164:167], v[20:23], a[180:183], v[164:167]
  ds_read_b64_tr_b16 v[16:17], v8 offset:0
  v_mfma_f32_16x16x32_bf16 v[168:171], v[20:23], a[184:187], v[168:171]
  s_add_u32 s42, s72, 8
  s_and_b32 s42, s42, 15
  ds_read_b64_tr_b16 v[18:19], v8 offset:512
  v_mfma_f32_16x16x32_bf16 v[172:175], v[20:23], a[188:191], v[172:175]
  s_waitcnt lgkmcnt(4)
  s_mul_i32 s42, s42, 262144
  v_mfma_f32_16x16x32_bf16 v[224:227], v[24:27], a[176:179], v[224:227]
  s_add_u32 s24, s18, s42
  s_addc_u32 s25, s19, 0
  ds_read_b64_tr_b16 v[20:21], v9 offset:0
  v_mfma_f32_16x16x32_bf16 v[228:231], v[24:27], a[180:183], v[228:231]
  s_add_u32 m0, s23, 65536
  ds_read_b64_tr_b16 v[22:23], v9 offset:512
  v_mfma_f32_16x16x32_bf16 v[232:235], v[24:27], a[184:187], v[232:235]
  global_load_lds_dwordx4 v2, s[24:25]
  v_mfma_f32_16x16x32_bf16 v[236:239], v[24:27], a[188:191], v[236:239]
  s_waitcnt lgkmcnt(4)
  s_add_u32 s43, s72, 9
  s_and_b32 s43, s43, 15
  v_mfma_f32_16x16x32_bf16 v[100:103], v[28:31], a[176:179], v[100:103]
  s_mul_i32 s43, s43, 262144
  ds_read_b64_tr_b16 v[24:25], v10 offset:0
  v_mfma_f32_16x16x32_bf16 v[108:111], v[28:31], a[180:183], v[108:111]
  s_add_u32 s26, s18, s43
  s_addc_u32 s27, s19, 0
  s_add_u32 m0, s23, 69632
  ds_read_b64_tr_b16 v[26:27], v10 offset:512
  v_mfma_f32_16x16x32_bf16 v[116:119], v[28:31], a[184:187], v[116:119]
  global_load_lds_dwordx4 v2, s[26:27]
  v_mfma_f32_16x16x32_bf16 v[124:127], v[28:31], a[188:191], v[124:127]
  s_waitcnt lgkmcnt(4)
  s_waitcnt vmcnt(27)
  s_add_u32 s42, s72, 10
  v_mfma_f32_16x16x32_bf16 v[128:131], v[16:19], a[192:195], v[128:131]
  s_and_b32 s42, s42, 15
  s_mul_i32 s42, s42, 262144
  ds_read_b64_tr_b16 v[28:29], v8 offset:4096
  v_mfma_f32_16x16x32_bf16 v[132:135], v[16:19], a[196:199], v[132:135]
  s_add_u32 s24, s18, s42
  s_addc_u32 s25, s19, 0
  s_add_u32 m0, s23, 73728
  ds_read_b64_tr_b16 v[30:31], v8 offset:4608
  v_mfma_f32_16x16x32_bf16 v[136:139], v[16:19], a[200:203], v[136:139]
  global_load_lds_dwordx4 v2, s[24:25]
  v_mfma_f32_16x16x32_bf16 v[140:143], v[16:19], a[204:207], v[140:143]
  s_waitcnt lgkmcnt(4)
  s_add_u32 s43, s72, 11
  s_and_b32 s43, s43, 15
  v_mfma_f32_16x16x32_bf16 v[192:195], v[20:23], a[192:195], v[192:195]
  s_mul_i32 s43, s43, 262144
  ds_read_b64_tr_b16 v[16:17], v9 offset:4096
  v_mfma_f32_16x16x32_bf16 v[196:199], v[20:23], a[196:199], v[196:199]
  s_add_u32 s26, s18, s43
  s_addc_u32 s27, s19, 0
  s_add_u32 m0, s23, 77824
  ds_read_b64_tr_b16 v[18:19], v9 offset:4608
  v_mfma_f32_16x16x32_bf16 v[200:203], v[20:23], a[200:203], v[200:203]
  global_load_lds_dwordx4 v2, s[26:27]
  v_mfma_f32_16x16x32_bf16 v[204:207], v[20:23], a[204:207], v[204:207]
  s_waitcnt lgkmcnt(4)
  v_mfma_f32_16x16x32_bf16 v[68:71], v[24:27], a[192:195], v[68:71]
  s_add_u32 s30, s10, 28672
  s_addc_u32 s31, s11, 0
  ds_read_b64_tr_b16 v[20:21], v10 offset:4096
  v_mfma_f32_16x16x32_bf16 v[76:79], v[24:27], a[196:199], v[76:79]
  ds_read_b64_tr_b16 v[22:23], v10 offset:4608
  v_mfma_f32_16x16x32_bf16 v[84:87], v[24:27], a[200:203], v[84:87]
  global_store_dwordx4 v4, v[184:187], s[30:31] offset:1024 sc1
  v_mfma_f32_16x16x32_bf16 v[92:95], v[24:27], a[204:207], v[92:95]
  s_waitcnt lgkmcnt(4)
  s_add_u32 s42, s72, 12
  s_and_b32 s42, s42, 15
  v_mfma_f32_16x16x32_bf16 v[160:163], v[28:31], a[192:195], v[160:163]
  s_mul_i32 s42, s42, 262144
  ds_read_b64_tr_b16 v[24:25], v8 offset:8192
  v_mfma_f32_16x16x32_bf16 v[164:167], v[28:31], a[196:199], v[164:167]
  s_add_u32 s24, s18, s42
  s_addc_u32 s25, s19, 0
  s_add_u32 m0, s23, 81920
  ds_read_b64_tr_b16 v[26:27], v8 offset:8704
  v_mfma_f32_16x16x32_bf16 v[168:171], v[28:31], a[200:203], v[168:171]
  global_load_lds_dwordx4 v2, s[24:25]
  v_mfma_f32_16x16x32_bf16 v[172:175], v[28:31], a[204:207], v[172:175]
  s_waitcnt lgkmcnt(4)
  s_add_u32 s43, s72, 13
  s_and_b32 s43, s43, 15
  v_mfma_f32_16x16x32_bf16 v[224:227], v[16:19], a[192:195], v[224:227]
  s_mul_i32 s43, s43, 262144
  ds_read_b64_tr_b16 v[28:29], v9 offset:8192
  v_mfma_f32_16x16x32_bf16 v[228:231], v[16:19], a[196:199], v[228:231]
  s_add_u32 s26, s18, s43
  s_addc_u32 s27, s19, 0
  s_add_u32 m0, s23, 86016
  ds_read_b64_tr_b16 v[30:31], v9 offset:8704
  v_mfma_f32_16x16x32_bf16 v[232:235], v[16:19], a[200:203], v[232:235]
  global_load_lds_dwordx4 v2, s[26:27]
  v_mfma_f32_16x16x32_bf16 v[236:239], v[16:19], a[204:207], v[236:239]
  s_waitcnt lgkmcnt(4)
  s_add_u32 s42, s72, 14
  s_and_b32 s42, s42, 15
  v_mfma_f32_16x16x32_bf16 v[100:103], v[20:23], a[192:195], v[100:103]
  s_mul_i32 s42, s42, 262144
  ds_read_b64_tr_b16 v[16:17], v10 offset:8192
  v_mfma_f32_16x16x32_bf16 v[108:111], v[20:23], a[196:199], v[108:111]
  s_add_u32 s24, s18, s42
  s_addc_u32 s25, s19, 0
  s_add_u32 m0, s23, 90112
  ds_read_b64_tr_b16 v[18:19], v10 offset:8704
  v_mfma_f32_16x16x32_bf16 v[116:119], v[20:23], a[200:203], v[116:119]
  global_load_lds_dwordx4 v2, s[24:25]
  v_mfma_f32_16x16x32_bf16 v[124:127], v[20:23], a[204:207], v[124:127]
  s_waitcnt lgkmcnt(4)
  s_waitcnt vmcnt(29)
  s_add_u32 s43, s72, 15
  v_mfma_f32_16x16x32_bf16 v[128:131], v[24:27], a[208:211], v[128:131]
  s_and_b32 s43, s43, 15
  s_mul_i32 s43, s43, 262144
  ds_read_b64_tr_b16 v[20:21], v8 offset:12288
  v_mfma_f32_16x16x32_bf16 v[132:135], v[24:27], a[212:215], v[132:135]
  s_add_u32 s26, s18, s43
  s_addc_u32 s27, s19, 0
  s_add_u32 m0, s23, 94208
  ds_read_b64_tr_b16 v[22:23], v8 offset:12800
  v_mfma_f32_16x16x32_bf16 v[136:139], v[24:27], a[216:219], v[136:139]
  global_load_lds_dwordx4 v2, s[26:27]
  v_mfma_f32_16x16x32_bf16 v[140:143], v[24:27], a[220:223], v[140:143]
  s_waitcnt lgkmcnt(4)
  v_mfma_f32_16x16x32_bf16 v[192:195], v[28:31], a[208:211], v[192:195]
  s_add_u32 s28, s10, 28672
  s_addc_u32 s29, s11, 0
  ds_read_b64_tr_b16 v[24:25], v9 offset:12288
  v_mfma_f32_16x16x32_bf16 v[196:199], v[28:31], a[212:215], v[196:199]
  ds_read_b64_tr_b16 v[26:27], v9 offset:12800
  v_mfma_f32_16x16x32_bf16 v[200:203], v[28:31], a[216:219], v[200:203]
  global_store_dwordx4 v4, v[216:219], s[28:29] offset:2048 sc1
  v_mfma_f32_16x16x32_bf16 v[204:207], v[28:31], a[220:223], v[204:207]
  s_waitcnt lgkmcnt(4)
  v_mfma_f32_16x16x32_bf16 v[68:71], v[16:19], a[208:211], v[68:71]
  ds_read_b64_tr_b16 v[28:29], v10 offset:12288
  v_mfma_f32_16x16x32_bf16 v[76:79], v[16:19], a[212:215], v[76:79]
  ds_read_b64_tr_b16 v[30:31], v10 offset:12800
  v_mfma_f32_16x16x32_bf16 v[84:87], v[16:19], a[216:219], v[84:87]
  v_mfma_f32_16x16x32_bf16 v[92:95], v[16:19], a[220:223], v[92:95]
  s_waitcnt lgkmcnt(4)
  v_mfma_f32_16x16x32_bf16 v[160:163], v[20:23], a[208:211], v[160:163]
  ds_read_b64_tr_b16 v[16:17], v8 offset:16384
  v_mfma_f32_16x16x32_bf16 v[164:167], v[20:23], a[212:215], v[164:167]
  ds_read_b64_tr_b16 v[18:19], v8 offset:16896
  v_mfma_f32_16x16x32_bf16 v[168:171], v[20:23], a[216:219], v[168:171]
  v_mfma_f32_16x16x32_bf16 v[172:175], v[20:23], a[220:223], v[172:175]
  s_waitcnt lgkmcnt(4)
  v_mfma_f32_16x16x32_bf16 v[224:227], v[24:27], a[208:211], v[224:227]
  ds_read_b64_tr_b16 v[20:21], v9 offset:16384
  v_mfma_f32_16x16x32_bf16 v[228:231], v[24:27], a[212:215], v[228:231]
  ds_read_b64_tr_b16 v[22:23], v9 offset:16896
  v_mfma_f32_16x16x32_bf16 v[232:235], v[24:27], a[216:219], v[232:235]
  v_mfma_f32_16x16x32_bf16 v[236:239], v[24:27], a[220:223], v[236:239]
  s_waitcnt lgkmcnt(4)
  v_mfma_f32_16x16x32_bf16 v[100:103], v[28:31], a[208:211], v[100:103]
  ds_read_b64_tr_b16 v[24:25], v10 offset:16384
  v_mfma_f32_16x16x32_bf16 v[108:111], v[28:31], a[212:215], v[108:111]
  s_add_u32 s30, s10, 28672
  s_addc_u32 s31, s11, 0
  ds_read_b64_tr_b16 v[26:27], v10 offset:16896
  v_mfma_f32_16x16x32_bf16 v[116:119], v[28:31], a[216:219], v[116:119]
  v_mfma_f32_16x16x32_bf16 v[124:127], v[28:31], a[220:223], v[124:127]
  s_waitcnt lgkmcnt(4)
  s_waitcnt vmcnt(27)
  global_store_dwordx4 v4, v[248:251], s[30:31] offset:3072 sc1
  v_mfma_f32_16x16x32_bf16 v[128:131], v[16:19], a[224:227], v[128:131]
  ds_read_b64_tr_b16 v[28:29], v8 offset:20480
  v_mfma_f32_16x16x32_bf16 v[132:135], v[16:19], a[228:231], v[132:135]
  ds_read_b64_tr_b16 v[30:31], v8 offset:20992
  v_mfma_f32_16x16x32_bf16 v[136:139], v[16:19], a[232:235], v[136:139]
  v_mfma_f32_16x16x32_bf16 v[140:143], v[16:19], a[236:239], v[140:143]
  s_waitcnt lgkmcnt(4)
  v_mfma_f32_16x16x32_bf16 v[192:195], v[20:23], a[224:227], v[192:195]
  ds_read_b64_tr_b16 v[16:17], v9 offset:20480
  v_mfma_f32_16x16x32_bf16 v[196:199], v[20:23], a[228:231], v[196:199]
  ds_read_b64_tr_b16 v[18:19], v9 offset:20992
  v_mfma_f32_16x16x32_bf16 v[200:203], v[20:23], a[232:235], v[200:203]
  v_mfma_f32_16x16x32_bf16 v[204:207], v[20:23], a[236:239], v[204:207]
  s_waitcnt lgkmcnt(4)
  v_mfma_f32_16x16x32_bf16 v[68:71], v[24:27], a[224:227], v[68:71]
  ds_read_b64_tr_b16 v[20:21], v10 offset:20480
  v_mfma_f32_16x16x32_bf16 v[76:79], v[24:27], a[228:231], v[76:79]
  ds_read_b64_tr_b16 v[22:23], v10 offset:20992
  v_mfma_f32_16x16x32_bf16 v[84:87], v[24:27], a[232:235], v[84:87]
  v_mfma_f32_16x16x32_bf16 v[92:95], v[24:27], a[236:239], v[92:95]
  s_waitcnt lgkmcnt(4)
  v_mfma_f32_16x16x32_bf16 v[160:163], v[28:31], a[224:227], v[160:163]
  ds_read_b64_tr_b16 v[24:25], v8 offset:24576
  v_mfma_f32_16x16x32_bf16 v[164:167], v[28:31], a[228:231], v[164:167]
  ds_read_b64_tr_b16 v[26:27], v8 offset:25088
  v_mfma_f32_16x16x32_bf16 v[168:171], v[28:31], a[232:235], v[168:171]
  v_mfma_f32_16x16x32_bf16 v[172:175], v[28:31], a[236:239], v[172:175]
  s_waitcnt lgkmcnt(4)
  v_mfma_f32_16x16x32_bf16 v[224:227], v[16:19], a[224:227], v[224:227]
  ds_read_b64_tr_b16 v[28:29], v9 offset:24576
  v_mfma_f32_16x16x32_bf16 v[228:231], v[16:19], a[228:231], v[228:231]
  ds_read_b64_tr_b16 v[30:31], v9 offset:25088
  v_mfma_f32_16x16x32_bf16 v[232:235], v[16:19], a[232:235], v[232:235]
  v_mfma_f32_16x16x32_bf16 v[236:239], v[16:19], a[236:239], v[236:239]
  s_waitcnt lgkmcnt(4)
  v_mfma_f32_16x16x32_bf16 v[100:103], v[20:23], a[224:227], v[100:103]
  ds_read_b64_tr_b16 v[16:17], v10 offset:24576
  v_mfma_f32_16x16x32_bf16 v[108:111], v[20:23], a[228:231], v[108:111]
  ds_read_b64_tr_b16 v[18:19], v10 offset:25088
  v_mfma_f32_16x16x32_bf16 v[116:119], v[20:23], a[232:235], v[116:119]
  v_mfma_f32_16x16x32_bf16 v[124:127], v[20:23], a[236:239], v[124:127]
  s_waitcnt lgkmcnt(4)
  s_waitcnt vmcnt(19)
  v_mfma_f32_16x16x32_bf16 v[128:131], v[24:27], a[240:243], v[128:131]
  ds_read_b64_tr_b16 v[20:21], v8 offset:28672
  v_mfma_f32_16x16x32_bf16 v[132:135], v[24:27], a[244:247], v[132:135]
  ds_read_b64_tr_b16 v[22:23], v8 offset:29184
  v_mfma_f32_16x16x32_bf16 v[136:139], v[24:27], a[248:251], v[136:139]
  v_mfma_f32_16x16x32_bf16 v[140:143], v[24:27], a[252:255], v[140:143]
  s_waitcnt lgkmcnt(4)
  v_mfma_f32_16x16x32_bf16 v[192:195], v[28:31], a[240:243], v[192:195]
  ds_read_b64_tr_b16 v[24:25], v9 offset:28672
  v_mfma_f32_16x16x32_bf16 v[196:199], v[28:31], a[244:247], v[196:199]
  ds_read_b64_tr_b16 v[26:27], v9 offset:29184
  v_mfma_f32_16x16x32_bf16 v[200:203], v[28:31], a[248:251], v[200:203]
  v_mfma_f32_16x16x32_bf16 v[204:207], v[28:31], a[252:255], v[204:207]
  s_waitcnt lgkmcnt(4)
  v_mfma_f32_16x16x32_bf16 v[68:71], v[16:19], a[240:243], v[68:71]
  ds_read_b64_tr_b16 v[28:29], v10 offset:28672
  v_mfma_f32_16x16x32_bf16 v[76:79], v[16:19], a[244:247], v[76:79]
  ds_read_b64_tr_b16 v[30:31], v10 offset:29184
  v_mfma_f32_16x16x32_bf16 v[84:87], v[16:19], a[248:251], v[84:87]
  v_mfma_f32_16x16x32_bf16 v[92:95], v[16:19], a[252:255], v[92:95]
  s_waitcnt lgkmcnt(4)
  v_mfma_f32_16x16x32_bf16 v[160:163], v[20:23], a[240:243], v[160:163]
  s_waitcnt vmcnt(15)
  s_barrier
  v_xor_b32 v8, s48, v8
  v_xor_b32 v9, s49, v9
  v_xor_b32 v10, s48, v10
  v_xor_b32 v12, s48, v12
  v_xor_b32 v13, s49, v13
  v_xor_b32 v14, s48, v14
  v_mfma_f32_16x16x32_bf16 v[164:167], v[20:23], a[244:247], v[164:167]
  ds_read_b64_tr_b16 v[16:17], v8 offset:32768
  v_mfma_f32_16x16x32_bf16 v[168:171], v[20:23], a[248:251], v[168:171]
  ds_read_b64_tr_b16 v[18:19], v8 offset:33280
  v_mfma_f32_16x16x32_bf16 v[172:175], v[20:23], a[252:255], v[172:175]
  s_waitcnt lgkmcnt(4)
  v_mfma_f32_16x16x32_bf16 v[224:227], v[24:27], a[240:243], v[224:227]
  ds_read_b64_tr_b16 v[20:21], v9 offset:32768
  v_mfma_f32_16x16x32_bf16 v[228:231], v[24:27], a[244:247], v[228:231]
  ds_read_b64_tr_b16 v[22:23], v9 offset:33280
  v_mfma_f32_16x16x32_bf16 v[232:235], v[24:27], a[248:251], v[232:235]
  v_mfma_f32_16x16x32_bf16 v[236:239], v[24:27], a[252:255], v[236:239]
  s_waitcnt lgkmcnt(4)
  v_mfma_f32_16x16x32_bf16 v[100:103], v[28:31], a[240:243], v[100:103]
  ds_read_b64_tr_b16 v[24:25], v10 offset:32768
  v_mfma_f32_16x16x32_bf16 v[108:111], v[28:31], a[244:247], v[108:111]
  ds_read_b64_tr_b16 v[26:27], v10 offset:33280
  v_mfma_f32_16x16x32_bf16 v[116:119], v[28:31], a[248:251], v[116:119]
  v_mfma_f32_16x16x32_bf16 v[124:127], v[28:31], a[252:255], v[124:127]
  s_waitcnt lgkmcnt(4)
  v_mfma_f32_16x16x32_bf16 v[148:151], v[16:19], a[0:3], 0
  ds_read_b64_tr_b16 v[28:29], v11 offset:32768
  v_mfma_f32_16x16x32_bf16 v[156:159], v[16:19], a[4:7], 0
  ds_read_b64_tr_b16 v[30:31], v11 offset:33280
  v_mfma_f32_16x16x32_bf16 v[180:183], v[16:19], a[8:11], 0
  v_mfma_f32_16x16x32_bf16 v[188:191], v[16:19], a[12:15], 0
  s_waitcnt lgkmcnt(4)
  v_mfma_f32_16x16x32_bf16 v[212:215], v[20:23], a[0:3], 0
  ds_read_b64_tr_b16 v[16:17], v8 offset:36864
  v_mfma_f32_16x16x32_bf16 v[220:223], v[20:23], a[4:7], 0
  ds_read_b64_tr_b16 v[18:19], v8 offset:37376
  v_mfma_f32_16x16x32_bf16 v[244:247], v[20:23], a[8:11], 0
  v_mfma_f32_16x16x32_bf16 v[252:255], v[20:23], a[12:15], 0
  s_waitcnt lgkmcnt(4)
  v_mfma_f32_16x16x32_bf16 v[64:67], v[24:27], a[0:3], 0
  ds_read_b64_tr_b16 v[20:21], v9 offset:36864
  v_mul_f32 v56, 0xbfb8aa3b, v128
  v_mfma_f32_16x16x32_bf16 v[72:75], v[24:27], a[4:7], 0
  ds_read_b64_tr_b16 v[22:23], v9 offset:37376
  v_mul_f32 v57, 0xbfb8aa3b, v129
  v_mfma_f32_16x16x32_bf16 v[80:83], v[24:27], a[8:11], 0
  v_mul_f32 v58, 0xbfb8aa3b, v130
  v_mul_f32 v59, 0xbfb8aa3b, v131
  v_mfma_f32_16x16x32_bf16 v[88:91], v[24:27], a[12:15], 0
  s_waitcnt lgkmcnt(4)
  v_exp_f32 v56, v56
  v_mfma_f32_16x16x32_bf16 v[96:99], v[28:31], a[0:3], 0
  ds_read_b64_tr_b16 v[24:25], v10 offset:36864
  v_mfma_f32_16x16x32_bf16 v[104:107], v[28:31], a[4:7], 0
  ds_read_b64_tr_b16 v[26:27], v10 offset:37376
  v_mfma_f32_16x16x32_bf16 v[112:115], v[28:31], a[8:11], 0
  v_exp_f32 v57, v57
  v_mfma_f32_16x16x32_bf16 v[120:123], v[28:31], a[12:15], 0
  s_waitcnt lgkmcnt(4)
  v_exp_f32 v58, v58
  v_mfma_f32_16x16x32_bf16 v[148:151], v[16:19], a[16:19], v[148:151]
  ds_read_b64_tr_b16 v[28:29], v11 offset:36864
  v_mfma_f32_16x16x32_bf16 v[156:159], v[16:19], a[20:23], v[156:159]
  ds_read_b64_tr_b16 v[30:31], v11 offset:37376
  v_mfma_f32_16x16x32_bf16 v[180:183], v[16:19], a[24:27], v[180:183]
  v_exp_f32 v59, v59
  v_mfma_f32_16x16x32_bf16 v[188:191], v[16:19], a[28:31], v[188:191]
  s_waitcnt lgkmcnt(4)
  v_add_f32 v56, 1.0, v56
  v_add_f32 v57, 1.0, v57
  v_mfma_f32_16x16x32_bf16 v[212:215], v[20:23], a[16:19], v[212:215]
  ds_read_b64_tr_b16 v[16:17], v8 offset:40960
  v_add_f32 v58, 1.0, v58
  v_mfma_f32_16x16x32_bf16 v[220:223], v[20:23], a[20:23], v[220:223]
  ds_read_b64_tr_b16 v[18:19], v8 offset:41472
  v_add_f32 v59, 1.0, v59
  v_mfma_f32_16x16x32_bf16 v[244:247], v[20:23], a[24:27], v[244:247]
  v_rcp_f32 v56, v56
  v_mfma_f32_16x16x32_bf16 v[252:255], v[20:23], a[28:31], v[252:255]
  s_waitcnt lgkmcnt(4)
  v_rcp_f32 v57, v57
  v_mfma_f32_16x16x32_bf16 v[64:67], v[24:27], a[16:19], v[64:67]
  ds_read_b64_tr_b16 v[20:21], v9 offset:40960
  v_mfma_f32_16x16x32_bf16 v[72:75], v[24:27], a[20:23], v[72:75]
  ds_read_b64_tr_b16 v[22:23], v9 offset:41472
  v_mfma_f32_16x16x32_bf16 v[80:83], v[24:27], a[24:27], v[80:83]
  v_rcp_f32 v58, v58
  v_mfma_f32_16x16x32_bf16 v[88:91], v[24:27], a[28:31], v[88:91]
  s_waitcnt lgkmcnt(4)
  v_rcp_f32 v59, v59
  v_mfma_f32_16x16x32_bf16 v[96:99], v[28:31], a[16:19], v[96:99]
  ds_read_b64_tr_b16 v[24:25], v10 offset:40960
  v_mul_f32 v128, v128, v160
  v_mfma_f32_16x16x32_bf16 v[104:107], v[28:31], a[20:23], v[104:107]
  ds_read_b64_tr_b16 v[26:27], v10 offset:41472
  v_mul_f32 v129, v129, v161
  v_mfma_f32_16x16x32_bf16 v[112:115], v[28:31], a[24:27], v[112:115]
  v_mul_f32 v130, v130, v162
  v_mul_f32 v131, v131, v163
  v_mfma_f32_16x16x32_bf16 v[120:123], v[28:31], a[28:31], v[120:123]
  s_waitcnt lgkmcnt(4)
  v_mul_f32 v128, v128, v56
  v_mul_f32 v129, v129, v57
  v_mfma_f32_16x16x32_bf16 v[148:151], v[16:19], a[32:35], v[148:151]
  ds_read_b64_tr_b16 v[28:29], v11 offset:40960
  v_mul_f32 v130, v130, v58
  v_mfma_f32_16x16x32_bf16 v[156:159], v[16:19], a[36:39], v[156:159]
  ds_read_b64_tr_b16 v[30:31], v11 offset:41472
  v_mul_f32 v131, v131, v59
  v_mfma_f32_16x16x32_bf16 v[180:183], v[16:19], a[40:43], v[180:183]
  v_cvt_pk_bf16_f32 v32, v128, v129
  v_cvt_pk_bf16_f32 v33, v130, v131
  v_mfma_f32_16x16x32_bf16 v[188:191], v[16:19], a[44:47], v[188:191]
  s_waitcnt lgkmcnt(4)
  v_mul_f32 v56, 0xbfb8aa3b, v132
  v_mul_f32 v57, 0xbfb8aa3b, v133
  v_mfma_f32_16x16x32_bf16 v[212:215], v[20:23], a[32:35], v[212:215]
  ds_read_b64_tr_b16 v[16:17], v8 offset:45056
  v_mul_f32 v58, 0xbfb8aa3b, v134
  v_mfma_f32_16x16x32_bf16 v[220:223], v[20:23], a[36:39], v[220:223]
  ds_read_b64_tr_b16 v[18:19], v8 offset:45568
  v_mul_f32 v59, 0xbfb8aa3b, v135
  v_mfma_f32_16x16x32_bf16 v[244:247], v[20:23], a[40:43], v[244:247]
  v_exp_f32 v56, v56
  v_mfma_f32_16x16x32_bf16 v[252:255], v[20:23], a[44:47], v[252:255]
  s_waitcnt lgkmcnt(4)
  v_exp_f32 v57, v57
  v_mfma_f32_16x16x32_bf16 v[64:67], v[24:27], a[32:35], v[64:67]
  ds_read_b64_tr_b16 v[20:21], v9 offset:45056
  v_mfma_f32_16x16x32_bf16 v[72:75], v[24:27], a[36:39], v[72:75]
  ds_read_b64_tr_b16 v[22:23], v9 offset:45568
  v_mfma_f32_16x16x32_bf16 v[80:83], v[24:27], a[40:43], v[80:83]
  v_exp_f32 v58, v58
  v_mfma_f32_16x16x32_bf16 v[88:91], v[24:27], a[44:47], v[88:91]
  s_waitcnt lgkmcnt(4)
  v_exp_f32 v59, v59
  v_mfma_f32_16x16x32_bf16 v[96:99], v[28:31], a[32:35], v[96:99]
  ds_read_b64_tr_b16 v[24:25], v10 offset:45056
  v_add_f32 v56, 1.0, v56
  v_mfma_f32_16x16x32_bf16 v[104:107], v[28:31], a[36:39], v[104:107]
  ds_read_b64_tr_b16 v[26:27], v10 offset:45568
  v_add_f32 v57, 1.0, v57
  v_mfma_f32_16x16x32_bf16 v[112:115], v[28:31], a[40:43], v[112:115]
  v_add_f32 v58, 1.0, v58
  v_add_f32 v59, 1.0, v59
  v_mfma_f32_16x16x32_bf16 v[120:123], v[28:31], a[44:47], v[120:123]
  s_waitcnt lgkmcnt(4)
  v_rcp_f32 v56, v56
  v_mfma_f32_16x16x32_bf16 v[148:151], v[16:19], a[48:51], v[148:151]
  ds_read_b64_tr_b16 v[28:29], v11 offset:45056
  v_mfma_f32_16x16x32_bf16 v[156:159], v[16:19], a[52:55], v[156:159]
  ds_read_b64_tr_b16 v[30:31], v11 offset:45568
  v_mfma_f32_16x16x32_bf16 v[180:183], v[16:19], a[56:59], v[180:183]
  v_rcp_f32 v57, v57
  v_mfma_f32_16x16x32_bf16 v[188:191], v[16:19], a[60:63], v[188:191]
  s_waitcnt lgkmcnt(4)
  v_rcp_f32 v58, v58
  v_mfma_f32_16x16x32_bf16 v[212:215], v[20:23], a[48:51], v[212:215]
  ds_read_b64_tr_b16 v[16:17], v8 offset:49152
  v_mfma_f32_16x16x32_bf16 v[220:223], v[20:23], a[52:55], v[220:223]
  ds_read_b64_tr_b16 v[18:19], v8 offset:49664
  v_mfma_f32_16x16x32_bf16 v[244:247], v[20:23], a[56:59], v[244:247]
  v_rcp_f32 v59, v59
  v_mfma_f32_16x16x32_bf16 v[252:255], v[20:23], a[60:63], v[252:255]
  s_waitcnt lgkmcnt(4)
  v_mul_f32 v132, v132, v164
  v_mul_f32 v133, v133, v165
  v_mfma_f32_16x16x32_bf16 v[64:67], v[24:27], a[48:51], v[64:67]
  ds_read_b64_tr_b16 v[20:21], v9 offset:49152
  v_mul_f32 v134, v134, v166
  v_mfma_f32_16x16x32_bf16 v[72:75], v[24:27], a[52:55], v[72:75]
  ds_read_b64_tr_b16 v[22:23], v9 offset:49664
  v_mul_f32 v135, v135, v167
  v_mfma_f32_16x16x32_bf16 v[80:83], v[24:27], a[56:59], v[80:83]
  v_mul_f32 v132, v132, v56
  v_mul_f32 v133, v133, v57
  v_mfma_f32_16x16x32_bf16 v[88:91], v[24:27], a[60:63], v[88:91]
  s_waitcnt lgkmcnt(4)
  v_mul_f32 v134, v134, v58
  v_mul_f32 v135, v135, v59
  v_mfma_f32_16x16x32_bf16 v[96:99], v[28:31], a[48:51], v[96:99]
  ds_read_b64_tr_b16 v[24:25], v10 offset:49152
  v_cvt_pk_bf16_f32 v34, v132, v133
  v_mfma_f32_16x16x32_bf16 v[104:107], v[28:31], a[52:55], v[104:107]
  ds_read_b64_tr_b16 v[26:27], v10 offset:49664
  v_cvt_pk_bf16_f32 v35, v134, v135
  v_mfma_f32_16x16x32_bf16 v[112:115], v[28:31], a[56:59], v[112:115]
  global_store_dwordx4 v52, v[32:35], s[54:55] offset:0 sc1
  v_mul_f32 v56, 0xbfb8aa3b, v136
  v_mfma_f32_16x16x32_bf16 v[120:123], v[28:31], a[60:63], v[120:123]
  s_waitcnt lgkmcnt(4)
  v_mul_f32 v57, 0xbfb8aa3b, v137
  v_mul_f32 v58, 0xbfb8aa3b, v138
  v_mfma_f32_16x16x32_bf16 v[148:151], v[16:19], a[64:67], v[148:151]
  ds_read_b64_tr_b16 v[28:29], v11 offset:49152
  v_mul_f32 v59, 0xbfb8aa3b, v139
  v_mfma_f32_16x16x32_bf16 v[156:159], v[16:19], a[68:71], v[156:159]
  ds_read_b64_tr_b16 v[30:31], v11 offset:49664
  v_mfma_f32_16x16x32_bf16 v[180:183], v[16:19], a[72:75], v[180:183]
  v_exp_f32 v56, v56
  v_mfma_f32_16x16x32_bf16 v[188:191], v[16:19], a[76:79], v[188:191]
  s_waitcnt lgkmcnt(4)
  v_exp_f32 v57, v57
  v_mfma_f32_16x16x32_bf16 v[212:215], v[20:23], a[64:67], v[212:215]
  ds_read_b64_tr_b16 v[16:17], v8 offset:53248
  v_mfma_f32_16x16x32_bf16 v[220:223], v[20:23], a[68:71], v[220:223]
  ds_read_b64_tr_b16 v[18:19], v8 offset:53760
  v_mfma_f32_16x16x32_bf16 v[244:247], v[20:23], a[72:75], v[244:247]
  v_exp_f32 v58, v58
  v_mfma_f32_16x16x32_bf16 v[252:255], v[20:23], a[76:79], v[252:255]
  s_waitcnt lgkmcnt(4)
  v_exp_f32 v59, v59
  v_mfma_f32_16x16x32_bf16 v[64:67], v[24:27], a[64:67], v[64:67]
  ds_read_b64_tr_b16 v[20:21], v9 offset:53248
  v_add_f32 v56, 1.0, v56
  v_mfma_f32_16x16x32_bf16 v[72:75], v[24:27], a[68:71], v[72:75]
  ds_read_b64_tr_b16 v[22:23], v9 offset:53760
  v_add_f32 v57, 1.0, v57
  v_mfma_f32_16x16x32_bf16 v[80:83], v[24:27], a[72:75], v[80:83]
  v_add_f32 v58, 1.0, v58
  v_add_f32 v59, 1.0, v59
  v_mfma_f32_16x16x32_bf16 v[88:91], v[24:27], a[76:79], v[88:91]
  s_waitcnt lgkmcnt(4)
  v_rcp_f32 v56, v56
  v_mfma_f32_16x16x32_bf16 v[96:99], v[28:31], a[64:67], v[96:99]
  ds_read_b64_tr_b16 v[24:25], v10 offset:53248
  v_mfma_f32_16x16x32_bf16 v[104:107], v[28:31], a[68:71], v[104:107]
  ds_read_b64_tr_b16 v[26:27], v10 offset:53760
  v_mfma_f32_16x16x32_bf16 v[112:115], v[28:31], a[72:75], v[112:115]
  v_rcp_f32 v57, v57
  v_mfma_f32_16x16x32_bf16 v[120:123], v[28:31], a[76:79], v[120:123]
  s_waitcnt lgkmcnt(4)
  v_rcp_f32 v58, v58
  v_mfma_f32_16x16x32_bf16 v[148:151], v[16:19], a[80:83], v[148:151]
  ds_read_b64_tr_b16 v[28:29], v11 offset:53248
  v_mfma_f32_16x16x32_bf16 v[156:159], v[16:19], a[84:87], v[156:159]
  ds_read_b64_tr_b16 v[30:31], v11 offset:53760
  v_mfma_f32_16x16x32_bf16 v[180:183], v[16:19], a[88:91], v[180:183]
  v_rcp_f32 v59, v59
  v_mfma_f32_16x16x32_bf16 v[188:191], v[16:19], a[92:95], v[188:191]
  s_waitcnt lgkmcnt(4)
  v_mul_f32 v136, v136, v168
  v_mul_f32 v137, v137, v169
  v_mfma_f32_16x16x32_bf16 v[212:215], v[20:23], a[80:83], v[212:215]
  ds_read_b64_tr_b16 v[16:17], v8 offset:57344
  v_mul_f32 v138, v138, v170
  v_mfma_f32_16x16x32_bf16 v[220:223], v[20:23], a[84:87], v[220:223]
  ds_read_b64_tr_b16 v[18:19], v8 offset:57856
  v_mul_f32 v139, v139, v171
  v_mfma_f32_16x16x32_bf16 v[244:247], v[20:23], a[88:91], v[244:247]
  v_mul_f32 v136, v136, v56
  v_mul_f32 v137, v137, v57
  v_mfma_f32_16x16x32_bf16 v[252:255], v[20:23], a[92:95], v[252:255]
  s_waitcnt lgkmcnt(4)
  v_mul_f32 v138, v138, v58
  v_mul_f32 v139, v139, v59
  v_mfma_f32_16x16x32_bf16 v[64:67], v[24:27], a[80:83], v[64:67]
  ds_read_b64_tr_b16 v[20:21], v9 offset:57344
  v_cvt_pk_bf16_f32 v36, v136, v137
  v_mfma_f32_16x16x32_bf16 v[72:75], v[24:27], a[84:87], v[72:75]
  ds_read_b64_tr_b16 v[22:23], v9 offset:57856
  v_cvt_pk_bf16_f32 v37, v138, v139
  v_mfma_f32_16x16x32_bf16 v[80:83], v[24:27], a[88:91], v[80:83]
  v_mul_f32 v56, 0xbfb8aa3b, v140
  v_mul_f32 v57, 0xbfb8aa3b, v141
  v_mfma_f32_16x16x32_bf16 v[88:91], v[24:27], a[92:95], v[88:91]
  s_waitcnt lgkmcnt(4)
  v_mul_f32 v58, 0xbfb8aa3b, v142
  v_mul_f32 v59, 0xbfb8aa3b, v143
  v_mfma_f32_16x16x32_bf16 v[96:99], v[28:31], a[80:83], v[96:99]
  ds_read_b64_tr_b16 v[24:25], v10 offset:57344
  v_mfma_f32_16x16x32_bf16 v[104:107], v[28:31], a[84:87], v[104:107]
  ds_read_b64_tr_b16 v[26:27], v10 offset:57856
  v_mfma_f32_16x16x32_bf16 v[112:115], v[28:31], a[88:91], v[112:115]
  v_exp_f32 v56, v56
  v_mfma_f32_16x16x32_bf16 v[120:123], v[28:31], a[92:95], v[120:123]
  s_waitcnt lgkmcnt(4)
  v_exp_f32 v57, v57
  v_mfma_f32_16x16x32_bf16 v[148:151], v[16:19], a[96:99], v[148:151]
  ds_read_b64_tr_b16 v[28:29], v11 offset:57344
  v_mfma_f32_16x16x32_bf16 v[156:159], v[16:19], a[100:103], v[156:159]
  ds_read_b64_tr_b16 v[30:31], v11 offset:57856
  v_mfma_f32_16x16x32_bf16 v[180:183], v[16:19], a[104:107], v[180:183]
  v_exp_f32 v58, v58
  v_mfma_f32_16x16x32_bf16 v[188:191], v[16:19], a[108:111], v[188:191]
  s_waitcnt lgkmcnt(4)
  v_exp_f32 v59, v59
  v_mfma_f32_16x16x32_bf16 v[212:215], v[20:23], a[96:99], v[212:215]
  ds_read_b64_tr_b16 v[16:17], v8 offset:61440
  v_add_f32 v56, 1.0, v56
  v_mfma_f32_16x16x32_bf16 v[220:223], v[20:23], a[100:103], v[220:223]
  ds_read_b64_tr_b16 v[18:19], v8 offset:61952
  v_add_f32 v57, 1.0, v57
  v_mfma_f32_16x16x32_bf16 v[244:247], v[20:23], a[104:107], v[244:247]
  v_add_f32 v58, 1.0, v58
  v_add_f32 v59, 1.0, v59
  v_mfma_f32_16x16x32_bf16 v[252:255], v[20:23], a[108:111], v[252:255]
  s_waitcnt lgkmcnt(4)
  v_rcp_f32 v56, v56
  v_mfma_f32_16x16x32_bf16 v[64:67], v[24:27], a[96:99], v[64:67]
  ds_read_b64_tr_b16 v[20:21], v9 offset:61440
  v_mfma_f32_16x16x32_bf16 v[72:75], v[24:27], a[100:103], v[72:75]
  ds_read_b64_tr_b16 v[22:23], v9 offset:61952
  v_mfma_f32_16x16x32_bf16 v[80:83], v[24:27], a[104:107], v[80:83]
  v_rcp_f32 v57, v57
  v_mfma_f32_16x16x32_bf16 v[88:91], v[24:27], a[108:111], v[88:91]
  s_waitcnt lgkmcnt(4)
  v_rcp_f32 v58, v58
  v_mfma_f32_16x16x32_bf16 v[96:99], v[28:31], a[96:99], v[96:99]
  ds_read_b64_tr_b16 v[24:25], v10 offset:61440
  v_mfma_f32_16x16x32_bf16 v[104:107], v[28:31], a[100:103], v[104:107]
  ds_read_b64_tr_b16 v[26:27], v10 offset:61952
  v_mfma_f32_16x16x32_bf16 v[112:115], v[28:31], a[104:107], v[112:115]
  v_rcp_f32 v59, v59
  v_mfma_f32_16x16x32_bf16 v[120:123], v[28:31], a[108:111], v[120:123]
  s_waitcnt lgkmcnt(4)
  v_mul_f32 v140, v140, v172
  v_mul_f32 v141, v141, v173
  v_mfma_f32_16x16x32_bf16 v[148:151], v[16:19], a[112:115], v[148:151]
  ds_read_b64_tr_b16 v[28:29], v11 offset:61440
  v_mul_f32 v142, v142, v174
  v_mfma_f32_16x16x32_bf16 v[156:159], v[16:19], a[116:119], v[156:159]
  ds_read_b64_tr_b16 v[30:31], v11 offset:61952
  v_mul_f32 v143, v143, v175
  v_mfma_f32_16x16x32_bf16 v[180:183], v[16:19], a[120:123], v[180:183]
  v_mul_f32 v140, v140, v56
  v_mul_f32 v141, v141, v57
  v_mfma_f32_16x16x32_bf16 v[188:191], v[16:19], a[124:127], v[188:191]
  s_waitcnt lgkmcnt(4)
  v_mul_f32 v142, v142, v58
  v_mul_f32 v143, v143, v59
  v_mfma_f32_16x16x32_bf16 v[212:215], v[20:23], a[112:115], v[212:215]
  s_waitcnt vmcnt(1)
  s_waitcnt vmcnt(3)
  s_barrier
  v_mfma_f32_16x16x32_bf16 v[220:223], v[20:23], a[116:119], v[220:223]
  s_add_u32 s42, s72, 0
  s_and_b32 s42, s42, 15
  ds_read_b64_tr_b16 v[16:17], v12 offset:0
  s_cmp_eq_u32 s22, 0
  s_cbranch_scc0 L_sf38
  s_lshl_b32 s40, s20, 7
  s_lshl_b32 s41, s21, 2
  s_add_u32 s40, s40, s41
  s_add_u32 s40, s40, 0
  v_mov_b32 v60, s40
  v_mov_b32 v61, s71
  s_mov_b64 exec, 1
  global_store_dword v60, v61, s[68:69] sc1
  s_mov_b64 exec, -1
L_sf38:
  v_mfma_f32_16x16x32_bf16 v[244:247], v[20:23], a[120:123], v[244:247]
  s_mul_i32 s42, s42, 262144
  s_or_b32 s42, s42, 128
  ds_read_b64_tr_b16 v[18:19], v12 offset:512
  v_mfma_f32_16x16x32_bf16 v[252:255], v[20:23], a[124:127], v[252:255]
  s_waitcnt lgkmcnt(4)
  s_add_u32 s24, s18, s42
  s_addc_u32 s25, s19, 0
  v_mfma_f32_16x16x32_bf16 v[64:67], v[24:27], a[112:115], v[64:67]
  s_add_u32 m0, s23, 0
  ds_read_b64_tr_b16 v[20:21], v13 offset:0
  v_cvt_pk_bf16_f32 v38, v140, v141
  v_mfma_f32_16x16x32_bf16 v[72:75], v[24:27], a[116:119], v[72:75]
  ds_read_b64_tr_b16 v[22:23], v13 offset:512
  v_cvt_pk_bf16_f32 v39, v142, v143
  v_mfma_f32_16x16x32_bf16 v[80:83], v[24:27], a[120:123], v[80:83]
  global_load_lds_dwordx4 v2, s[24:25]
  global_store_dwordx4 v54, v[36:39], s[54:55] offset:0 sc1
  v_mfma_f32_16x16x32_bf16 v[88:91], v[24:27], a[124:127], v[88:91]
  s_waitcnt lgkmcnt(4)
  s_add_u32 s43, s72, 1
  s_and_b32 s43, s43, 15
  v_mfma_f32_16x16x32_bf16 v[96:99], v[28:31], a[112:115], v[96:99]
  s_mul_i32 s43, s43, 262144
  s_or_b32 s43, s43, 128
  ds_read_b64_tr_b16 v[24:25], v14 offset:0
  v_mfma_f32_16x16x32_bf16 v[104:107], v[28:31], a[116:119], v[104:107]
  s_add_u32 s26, s18, s43
  s_addc_u32 s27, s19, 0
  s_add_u32 m0, s23, 4096
  ds_read_b64_tr_b16 v[26:27], v14 offset:512
  v_mfma_f32_16x16x32_bf16 v[112:115], v[28:31], a[120:123], v[112:115]
  global_load_lds_dwordx4 v2, s[26:27]
  v_mul_f32 v56, 0xbfb8aa3b, v192
  v_mfma_f32_16x16x32_bf16 v[120:123], v[28:31], a[124:127], v[120:123]
  s_waitcnt lgkmcnt(4)
  s_add_u32 s42, s72, 2
  s_and_b32 s42, s42, 15
  v_mfma_f32_16x16x32_bf16 v[148:151], v[16:19], a[128:131], v[148:151]
  s_mul_i32 s42, s42, 262144
  s_or_b32 s42, s42, 128
  ds_read_b64_tr_b16 v[28:29], v15 offset:0
  v_mfma_f32_16x16x32_bf16 v[156:159], v[16:19], a[132:135], v[156:159]
  s_add_u32 s24, s18, s42
  s_addc_u32 s25, s19, 0
  s_add_u32 m0, s23, 8192
  ds_read_b64_tr_b16 v[30:31], v15 offset:512
  v_mfma_f32_16x16x32_bf16 v[180:183], v[16:19], a[136:139], v[180:183]
  global_load_lds_dwordx4 v2, s[24:25]
  v_mul_f32 v57, 0xbfb8aa3b, v193
  v_mfma_f32_16x16x32_bf16 v[188:191], v[16:19], a[140:143], v[188:191]
  s_waitcnt lgkmcnt(4)
  s_add_u32 s43, s72, 3
  s_and_b32 s43, s43, 15
  v_mfma_f32_16x16x32_bf16 v[212:215], v[20:23], a[128:131], v[212:215]
  s_mul_i32 s43, s43, 262144
  s_or_b32 s43, s43, 128
  ds_read_b64_tr_b16 v[16:17], v12 offset:4096
  v_mfma_f32_16x16x32_bf16 v[220:223], v[20:23], a[132:135], v[220:223]
  s_add_u32 s26, s18, s43
  s_addc_u32 s27, s19, 0
  s_add_u32 m0, s23, 12288
  ds_read_b64_tr_b16 v[18:19], v12 offset:4608
  v_mfma_f32_16x16x32_bf16 v[244:247], v[20:23], a[136:139], v[244:247]
  global_load_lds_dwordx4 v2, s[26:27]
  v_mul_f32 v58, 0xbfb8aa3b, v194
  v_mfma_f32_16x16x32_bf16 v[252:255], v[20:23], a[140:143], v[252:255]
  s_waitcnt lgkmcnt(4)
  s_add_u32 s42, s72, 4
  s_and_b32 s42, s42, 15
  v_mfma_f32_16x16x32_bf16 v[64:67], v[24:27], a[128:131], v[64:67]
  s_mul_i32 s42, s42, 262144
  s_or_b32 s42, s42, 128
  ds_read_b64_tr_b16 v[20:21], v13 offset:4096
  v_mfma_f32_16x16x32_bf16 v[72:75], v[24:27], a[132:135], v[72:75]
  s_add_u32 s24, s18, s42
  s_addc_u32 s25, s19, 0
  s_add_u32 m0, s23, 16384
  ds_read_b64_tr_b16 v[22:23], v13 offset:4608
  v_mfma_f32_16x16x32_bf16 v[80:83], v[24:27], a[136:139], v[80:83]
  global_load_lds_dwordx4 v2, s[24:25]
  v_mul_f32 v59, 0xbfb8aa3b, v195
  v_mfma_f32_16x16x32_bf16 v[88:91], v[24:27], a[140:143], v[88:91]
  s_waitcnt lgkmcnt(4)
  s_add_u32 s43, s72, 5
  s_and_b32 s43, s43, 15
  v_mfma_f32_16x16x32_bf16 v[96:99], v[28:31], a[128:131], v[96:99]
  s_mul_i32 s43, s43, 262144
  s_or_b32 s43, s43, 128
  ds_read_b64_tr_b16 v[24:25], v14 offset:4096
  v_mfma_f32_16x16x32_bf16 v[104:107], v[28:31], a[132:135], v[104:107]
  s_add_u32 s26, s18, s43
  s_addc_u32 s27, s19, 0
  s_add_u32 m0, s23, 20480
  ds_read_b64_tr_b16 v[26:27], v14 offset:4608
  v_mfma_f32_16x16x32_bf16 v[112:115], v[28:31], a[136:139], v[112:115]
  global_load_lds_dwordx4 v2, s[26:27]
  v_mfma_f32_16x16x32_bf16 v[120:123], v[28:31], a[140:143], v[120:123]
  s_waitcnt lgkmcnt(4)
  s_add_u32 s42, s72, 6
  s_and_b32 s42, s42, 15
  v_mfma_f32_16x16x32_bf16 v[148:151], v[16:19], a[144:147], v[148:151]
  s_mul_i32 s42, s42, 262144
  s_or_b32 s42, s42, 128
  ds_read_b64_tr_b16 v[28:29], v15 offset:4096
  v_mfma_f32_16x16x32_bf16 v[156:159], v[16:19], a[148:151], v[156:159]
  s_add_u32 s24, s18, s42
  s_addc_u32 s25, s19, 0
  s_add_u32 m0, s23, 24576
  ds_read_b64_tr_b16 v[30:31], v15 offset:4608
  v_mfma_f32_16x16x32_bf16 v[180:183], v[16:19], a[152:155], v[180:183]
  global_load_lds_dwordx4 v2, s[24:25]
  v_mfma_f32_16x16x32_bf16 v[188:191], v[16:19], a[156:159], v[188:191]
  s_waitcnt lgkmcnt(4)
  s_add_u32 s43, s72, 7
  s_and_b32 s43, s43, 15
  v_mfma_f32_16x16x32_bf16 v[212:215], v[20:23], a[144:147], v[212:215]
  s_mul_i32 s43, s43, 262144
  s_or_b32 s43, s43, 128
  ds_read_b64_tr_b16 v[16:17], v12 offset:8192
  v_mfma_f32_16x16x32_bf16 v[220:223], v[20:23], a[148:151], v[220:223]
  s_add_u32 s26, s18, s43
  s_addc_u32 s27, s19, 0
  s_add_u32 m0, s23, 28672
  ds_read_b64_tr_b16 v[18:19], v12 offset:8704
  v_mfma_f32_16x16x32_bf16 v[244:247], v[20:23], a[152:155], v[244:247]
  global_load_lds_dwordx4 v2, s[26:27]
  v_mfma_f32_16x16x32_bf16 v[252:255], v[20:23], a[156:159], v[252:255]
  s_waitcnt lgkmcnt(4)
  v_exp_f32 v56, v56
  v_mfma_f32_16x16x32_bf16 v[64:67], v[24:27], a[144:147], v[64:67]
  ds_read_b64_tr_b16 v[20:21], v13 offset:8192
  v_mfma_f32_16x16x32_bf16 v[72:75], v[24:27], a[148:151], v[72:75]
  ds_read_b64_tr_b16 v[22:23], v13 offset:8704
  v_mfma_f32_16x16x32_bf16 v[80:83], v[24:27], a[152:155], v[80:83]
  v_exp_f32 v57, v57
  v_mfma_f32_16x16x32_bf16 v[88:91], v[24:27], a[156:159], v[88:91]
  s_waitcnt lgkmcnt(4)
  v_exp_f32 v58, v58
  v_mfma_f32_16x16x32_bf16 v[96:99], v[28:31], a[144:147], v[96:99]
  ds_read_b64_tr_b16 v[24:25], v14 offset:8192
  v_mfma_f32_16x16x32_bf16 v[104:107], v[28:31], a[148:151], v[104:107]
  ds_read_b64_tr_b16 v[26:27], v14 offset:8704
  v_mfma_f32_16x16x32_bf16 v[112:115], v[28:31], a[152:155], v[112:115]
  v_exp_f32 v59, v59
  v_mfma_f32_16x16x32_bf16 v[120:123], v[28:31], a[156:159], v[120:123]
  s_waitcnt lgkmcnt(4)
  v_add_f32 v56, 1.0, v56
  v_add_f32 v57, 1.0, v57
  v_mfma_f32_16x16x32_bf16 v[148:151], v[16:19], a[160:163], v[148:151]
  ds_read_b64_tr_b16 v[28:29], v15 offset:8192
  v_add_f32 v58, 1.0, v58
  v_mfma_f32_16x16x32_bf16 v[156:159], v[16:19], a[164:167], v[156:159]
  ds_read_b64_tr_b16 v[30:31], v15 offset:8704
  v_add_f32 v59, 1.0, v59
  v_mfma_f32_16x16x32_bf16 v[180:183], v[16:19], a[168:171], v[180:183]
  v_rcp_f32 v56, v56
  v_mfma_f32_16x16x32_bf16 v[188:191], v[16:19], a[172:175], v[188:191]
  s_waitcnt lgkmcnt(4)
  v_rcp_f32 v57, v57
  v_mfma_f32_16x16x32_bf16 v[212:215], v[20:23], a[160:163], v[212:215]
  ds_read_b64_tr_b16 v[16:17], v12 offset:12288
  v_mfma_f32_16x16x32_bf16 v[220:223], v[20:23], a[164:167], v[220:223]
  ds_read_b64_tr_b16 v[18:19], v12 offset:12800
  v_mfma_f32_16x16x32_bf16 v[244:247], v[20:23], a[168:171], v[244:247]
  v_rcp_f32 v58, v58
  v_mfma_f32_16x16x32_bf16 v[252:255], v[20:23], a[172:175], v[252:255]
  s_waitcnt lgkmcnt(4)
  v_rcp_f32 v59, v59
  v_mfma_f32_16x16x32_bf16 v[64:67], v[24:27], a[160:163], v[64:67]
  ds_read_b64_tr_b16 v[20:21], v13 offset:12288
  v_mul_f32 v192, v192, v224
  v_mfma_f32_16x16x32_bf16 v[72:75], v[24:27], a[164:167], v[72:75]
  ds_read_b64_tr_b16 v[22:23], v13 offset:12800
  v_mul_f32 v193, v193, v225
  v_mfma_f32_16x16x32_bf16 v[80:83], v[24:27], a[168:171], v[80:83]
  v_mul_f32 v194, v194, v226
  v_mul_f32 v195, v195, v227
  v_mfma_f32_16x16x32_bf16 v[88:91], v[24:27], a[172:175], v[88:91]
  s_waitcnt lgkmcnt(4)
  v_mul_f32 v192, v192, v56
  v_mul_f32 v193, v193, v57
  v_mfma_f32_16x16x32_bf16 v[96:99], v[28:31], a[160:163], v[96:99]
  ds_read_b64_tr_b16 v[24:25], v14 offset:12288
  v_mul_f32 v194, v194, v58
  v_mfma_f32_16x16x32_bf16 v[104:107], v[28:31], a[164:167], v[104:107]
  ds_read_b64_tr_b16 v[26:27], v14 offset:12800
  v_mul_f32 v195, v195, v59
  v_mfma_f32_16x16x32_bf16 v[112:115], v[28:31], a[168:171], v[112:115]
  v_cvt_pk_bf16_f32 v40, v192, v193
  v_cvt_pk_bf16_f32 v41, v194, v195
  v_mfma_f32_16x16x32_bf16 v[120:123], v[28:31], a[172:175], v[120:123]
  s_waitcnt lgkmcnt(4)
  v_mul_f32 v56, 0xbfb8aa3b, v196
  v_mul_f32 v57, 0xbfb8aa3b, v197
  v_mfma_f32_16x16x32_bf16 v[148:151], v[16:19], a[176:179], v[148:151]
  ds_read_b64_tr_b16 v[28:29], v15 offset:12288
  v_mul_f32 v58, 0xbfb8aa3b, v198
  v_mfma_f32_16x16x32_bf16 v[156:159], v[16:19], a[180:183], v[156:159]
  ds_read_b64_tr_b16 v[30:31], v15 offset:12800
  v_mul_f32 v59, 0xbfb8aa3b, v199
  v_mfma_f32_16x16x32_bf16 v[180:183], v[16:19], a[184:187], v[180:183]
  v_exp_f32 v56, v56
  v_mfma_f32_16x16x32_bf16 v[188:191], v[16:19], a[188:191], v[188:191]
  s_waitcnt lgkmcnt(4)
  v_exp_f32 v57, v57
  v_mfma_f32_16x16x32_bf16 v[212:215], v[20:23], a[176:179], v[212:215]
  ds_read_b64_tr_b16 v[16:17], v12 offset:16384
  v_mfma_f32_16x16x32_bf16 v[220:223], v[20:23], a[180:183], v[220:223]
  ds_read_b64_tr_b16 v[18:19], v12 offset:16896
  v_mfma_f32_16x16x32_bf16 v[244:247], v[20:23], a[184:187], v[244:247]
  v_exp_f32 v58, v58
  v_mfma_f32_16x16x32_bf16 v[252:255], v[20:23], a[188:191], v[252:255]
  s_waitcnt lgkmcnt(4)
  v_exp_f32 v59, v59
  v_mfma_f32_16x16x32_bf16 v[64:67], v[24:27], a[176:179], v[64:67]
  ds_read_b64_tr_b16 v[20:21], v13 offset:16384
  v_add_f32 v56, 1.0, v56
  v_mfma_f32_16x16x32_bf16 v[72:75], v[24:27], a[180:183], v[72:75]
  ds_read_b64_tr_b16 v[22:23], v13 offset:16896
  v_add_f32 v57, 1.0, v57
  v_mfma_f32_16x16x32_bf16 v[80:83], v[24:27], a[184:187], v[80:83]
  v_add_f32 v58, 1.0, v58
  v_add_f32 v59, 1.0, v59
  v_mfma_f32_16x16x32_bf16 v[88:91], v[24:27], a[188:191], v[88:91]
  s_waitcnt lgkmcnt(4)
  v_rcp_f32 v56, v56
  v_mfma_f32_16x16x32_bf16 v[96:99], v[28:31], a[176:179], v[96:99]
  ds_read_b64_tr_b16 v[24:25], v14 offset:16384
  v_mfma_f32_16x16x32_bf16 v[104:107], v[28:31], a[180:183], v[104:107]
  ds_read_b64_tr_b16 v[26:27], v14 offset:16896
  v_mfma_f32_16x16x32_bf16 v[112:115], v[28:31], a[184:187], v[112:115]
  v_rcp_f32 v57, v57
  v_mfma_f32_16x16x32_bf16 v[120:123], v[28:31], a[188:191], v[120:123]
  s_waitcnt lgkmcnt(4)
  v_rcp_f32 v58, v58
  v_mfma_f32_16x16x32_bf16 v[148:151], v[16:19], a[192:195], v[148:151]
  ds_read_b64_tr_b16 v[28:29], v15 offset:16384
  v_mfma_f32_16x16x32_bf16 v[156:159], v[16:19], a[196:199], v[156:159]
  ds_read_b64_tr_b16 v[30:31], v15 offset:16896
  v_mfma_f32_16x16x32_bf16 v[180:183], v[16:19], a[200:203], v[180:183]
  v_rcp_f32 v59, v59
  v_mfma_f32_16x16x32_bf16 v[188:191], v[16:19], a[204:207], v[188:191]
  s_waitcnt lgkmcnt(4)
  v_mul_f32 v196, v196, v228
  v_mul_f32 v197, v197, v229
  v_mfma_f32_16x16x32_bf16 v[212:215], v[20:23], a[192:195], v[212:215]
  ds_read_b64_tr_b16 v[16:17], v12 offset:20480
  v_mul_f32 v198, v198, v230
  v_mfma_f32_16x16x32_bf16 v[220:223], v[20:23], a[196:199], v[220:223]
  ds_read_b64_tr_b16 v[18:19], v12 offset:20992
  v_mul_f32 v199, v199, v231
  v_mfma_f32_16x16x32_bf16 v[244:247], v[20:23], a[200:203], v[244:247]
  v_mul_f32 v196, v196, v56
  v_mul_f32 v197, v197, v57
  v_mfma_f32_16x16x32_bf16 v[252:255], v[20:23], a[204:207], v[252:255]
  s_waitcnt lgkmcnt(4)
  v_mul_f32 v198, v198, v58
  v_mul_f32 v199, v199, v59
  v_mfma_f32_16x16x32_bf16 v[64:67], v[24:27], a[192:195], v[64:67]
  ds_read_b64_tr_b16 v[20:21], v13 offset:20480
  v_cvt_pk_bf16_f32 v42, v196, v197
  v_mfma_f32_16x16x32_bf16 v[72:75], v[24:27], a[196:199], v[72:75]
  ds_read_b64_tr_b16 v[22:23], v13 offset:20992
  v_cvt_pk_bf16_f32 v43, v198, v199
  v_mfma_f32_16x16x32_bf16 v[80:83], v[24:27], a[200:203], v[80:83]
  global_store_dwordx4 v52, v[40:43], s[54:55] offset:1024 sc1
  v_mul_f32 v56, 0xbfb8aa3b, v200
  v_mfma_f32_16x16x32_bf16 v[88:91], v[24:27], a[204:207], v[88:91]
  s_waitcnt lgkmcnt(4)
  v_mul_f32 v57, 0xbfb8aa3b, v201
  v_mul_f32 v58, 0xbfb8aa3b, v202
  v_mfma_f32_16x16x32_bf16 v[96:99], v[28:31], a[192:195], v[96:99]
  ds_read_b64_tr_b16 v[24:25], v14 offset:20480
  v_mul_f32 v59, 0xbfb8aa3b, v203
  v_mfma_f32_16x16x32_bf16 v[104:107], v[28:31], a[196:199], v[104:107]
  ds_read_b64_tr_b16 v[26:27], v14 offset:20992
  v_mfma_f32_16x16x32_bf16 v[112:115], v[28:31], a[200:203], v[112:115]
  v_exp_f32 v56, v56
  v_mfma_f32_16x16x32_bf16 v[120:123], v[28:31], a[204:207], v[120:123]
  s_waitcnt lgkmcnt(4)
  v_exp_f32 v57, v57
  v_mfma_f32_16x16x32_bf16 v[148:151], v[16:19], a[208:211], v[148:151]
  ds_read_b64_tr_b16 v[28:29], v15 offset:20480
  v_mfma_f32_16x16x32_bf16 v[156:159], v[16:19], a[212:215], v[156:159]
  ds_read_b64_tr_b16 v[30:31], v15 offset:20992
  v_mfma_f32_16x16x32_bf16 v[180:183], v[16:19], a[216:219], v[180:183]
  v_exp_f32 v58, v58
  v_mfma_f32_16x16x32_bf16 v[188:191], v[16:19], a[220:223], v[188:191]
  s_waitcnt lgkmcnt(4)
  v_exp_f32 v59, v59
  v_mfma_f32_16x16x32_bf16 v[212:215], v[20:23], a[208:211], v[212:215]
  ds_read_b64_tr_b16 v[16:17], v12 offset:24576
  v_add_f32 v56, 1.0, v56
  v_mfma_f32_16x16x32_bf16 v[220:223], v[20:23], a[212:215], v[220:223]
  ds_read_b64_tr_b16 v[18:19], v12 offset:25088
  v_add_f32 v57, 1.0, v57
  v_mfma_f32_16x16x32_bf16 v[244:247], v[20:23], a[216:219], v[244:247]
  v_add_f32 v58, 1.0, v58
  v_add_f32 v59, 1.0, v59
  v_mfma_f32_16x16x32_bf16 v[252:255], v[20:23], a[220:223], v[252:255]
  s_waitcnt lgkmcnt(4)
  v_rcp_f32 v56, v56
  v_mfma_f32_16x16x32_bf16 v[64:67], v[24:27], a[208:211], v[64:67]
  ds_read_b64_tr_b16 v[20:21], v13 offset:24576
  v_mfma_f32_16x16x32_bf16 v[72:75], v[24:27], a[212:215], v[72:75]
  ds_read_b64_tr_b16 v[22:23], v13 offset:25088
  v_mfma_f32_16x16x32_bf16 v[80:83], v[24:27], a[216:219], v[80:83]
  v_rcp_f32 v57, v57
  v_mfma_f32_16x16x32_bf16 v[88:91], v[24:27], a[220:223], v[88:91]
  s_waitcnt lgkmcnt(4)
  v_rcp_f32 v58, v58
  v_mfma_f32_16x16x32_bf16 v[96:99], v[28:31], a[208:211], v[96:99]
  ds_read_b64_tr_b16 v[24:25], v14 offset:24576
  v_mfma_f32_16x16x32_bf16 v[104:107], v[28:31], a[212:215], v[104:107]
  ds_read_b64_tr_b16 v[26:27], v14 offset:25088
  v_mfma_f32_16x16x32_bf16 v[112:115], v[28:31], a[216:219], v[112:115]
  v_rcp_f32 v59, v59
  v_mfma_f32_16x16x32_bf16 v[120:123], v[28:31], a[220:223], v[120:123]
  s_waitcnt lgkmcnt(4)
  v_mul_f32 v200, v200, v232
  v_mul_f32 v201, v201, v233
  v_mfma_f32_16x16x32_bf16 v[148:151], v[16:19], a[224:227], v[148:151]
  ds_read_b64_tr_b16 v[28:29], v15 offset:24576
  v_mul_f32 v202, v202, v234
  v_mfma_f32_16x16x32_bf16 v[156:159], v[16:19], a[228:231], v[156:159]
  ds_read_b64_tr_b16 v[30:31], v15 offset:25088
  v_mul_f32 v203, v203, v235
  v_mfma_f32_16x16x32_bf16 v[180:183], v[16:19], a[232:235], v[180:183]
  v_mul_f32 v200, v200, v56
  v_mul_f32 v201, v201, v57
  v_mfma_f32_16x16x32_bf16 v[188:191], v[16:19], a[236:239], v[188:191]
  s_waitcnt lgkmcnt(4)
  v_mul_f32 v202, v202, v58
  v_mul_f32 v203, v203, v59
  v_mfma_f32_16x16x32_bf16 v[212:215], v[20:23], a[224:227], v[212:215]
  ds_read_b64_tr_b16 v[16:17], v12 offset:28672
  v_cvt_pk_bf16_f32 v44, v200, v201
  v_mfma_f32_16x16x32_bf16 v[220:223], v[20:23], a[228:231], v[220:223]
  ds_read_b64_tr_b16 v[18:19], v12 offset:29184
  v_cvt_pk_bf16_f32 v45, v202, v203
  v_mfma_f32_16x16x32_bf16 v[244:247], v[20:23], a[232:235], v[244:247]
  v_mul_f32 v56, 0xbfb8aa3b, v204
  v_mul_f32 v57, 0xbfb8aa3b, v205
  v_mfma_f32_16x16x32_bf16 v[252:255], v[20:23], a[236:239], v[252:255]
  s_waitcnt lgkmcnt(4)
  v_mul_f32 v58, 0xbfb8aa3b, v206
  v_mul_f32 v59, 0xbfb8aa3b, v207
  v_mfma_f32_16x16x32_bf16 v[64:67], v[24:27], a[224:227], v[64:67]
  ds_read_b64_tr_b16 v[20:21], v13 offset:28672
  v_mfma_f32_16x16x32_bf16 v[72:75], v[24:27], a[228:231], v[72:75]
  ds_read_b64_tr_b16 v[22:23], v13 offset:29184
  v_mfma_f32_16x16x32_bf16 v[80:83], v[24:27], a[232:235], v[80:83]
  v_exp_f32 v56, v56
  v_mfma_f32_16x16x32_bf16 v[88:91], v[24:27], a[236:239], v[88:91]
  s_waitcnt lgkmcnt(4)
  v_exp_f32 v57, v57
  v_mfma_f32_16x16x32_bf16 v[96:99], v[28:31], a[224:227], v[96:99]
  ds_read_b64_tr_b16 v[24:25], v14 offset:28672
  v_mfma_f32_16x16x32_bf16 v[104:107], v[28:31], a[228:231], v[104:107]
  ds_read_b64_tr_b16 v[26:27], v14 offset:29184
  v_mfma_f32_16x16x32_bf16 v[112:115], v[28:31], a[232:235], v[112:115]
  v_exp_f32 v58, v58
  v_mfma_f32_16x16x32_bf16 v[120:123], v[28:31], a[236:239], v[120:123]
  s_waitcnt lgkmcnt(4)
  v_exp_f32 v59, v59
  v_mfma_f32_16x16x32_bf16 v[148:151], v[16:19], a[240:243], v[148:151]
  ds_read_b64_tr_b16 v[28:29], v15 offset:28672
  v_add_f32 v56, 1.0, v56
  v_mfma_f32_16x16x32_bf16 v[156:159], v[16:19], a[244:247], v[156:159]
  ds_read_b64_tr_b16 v[30:31], v15 offset:29184
  v_add_f32 v57, 1.0, v57
  v_mfma_f32_16x16x32_bf16 v[180:183], v[16:19], a[248:251], v[180:183]
  v_add_f32 v58, 1.0, v58
  v_add_f32 v59, 1.0, v59
  v_mfma_f32_16x16x32_bf16 v[188:191], v[16:19], a[252:255], v[188:191]
  s_waitcnt lgkmcnt(4)
  v_rcp_f32 v56, v56
  v_mfma_f32_16x16x32_bf16 v[212:215], v[20:23], a[240:243], v[212:215]
  s_waitcnt vmcnt(1)
  s_barrier
  v_mfma_f32_16x16x32_bf16 v[220:223], v[20:23], a[244:247], v[220:223]
  s_add_u32 s42, s72, 8
  s_and_b32 s42, s42, 15
  ds_read_b64_tr_b16 v[16:17], v8 offset:0
  v_mfma_f32_16x16x32_bf16 v[244:247], v[20:23], a[248:251], v[244:247]
  s_mul_i32 s42, s42, 262144
  s_or_b32 s42, s42, 128
  ds_read_b64_tr_b16 v[18:19], v8 offset:512
  v_mfma_f32_16x16x32_bf16 v[252:255], v[20:23], a[252:255], v[252:255]
  s_waitcnt lgkmcnt(4)
  s_add_u32 s24, s18, s42
  s_addc_u32 s25, s19, 0
  v_mfma_f32_16x16x32_bf16 v[64:67], v[24:27], a[240:243], v[64:67]
  s_add_u32 m0, s23, 32768
  ds_read_b64_tr_b16 v[20:21], v9 offset:0
  v_mfma_f32_16x16x32_bf16 v[72:75], v[24:27], a[244:247], v[72:75]
  ds_read_b64_tr_b16 v[22:23], v9 offset:512
  v_mfma_f32_16x16x32_bf16 v[80:83], v[24:27], a[248:251], v[80:83]
  global_load_lds_dwordx4 v2, s[24:25]
  v_mfma_f32_16x16x32_bf16 v[88:91], v[24:27], a[252:255], v[88:91]
  s_waitcnt lgkmcnt(4)
  s_add_u32 s43, s72, 9
  s_and_b32 s43, s43, 15
  v_mfma_f32_16x16x32_bf16 v[96:99], v[28:31], a[240:243], v[96:99]
  s_mul_i32 s43, s43, 262144
  s_or_b32 s43, s43, 128
  ds_read_b64_tr_b16 v[24:25], v10 offset:0
  v_mfma_f32_16x16x32_bf16 v[104:107], v[28:31], a[244:247], v[104:107]
  s_add_u32 s26, s18, s43
  s_addc_u32 s27, s19, 0
  s_add_u32 m0, s23, 36864
  ds_read_b64_tr_b16 v[26:27], v10 offset:512
  v_mfma_f32_16x16x32_bf16 v[112:115], v[28:31], a[248:251], v[112:115]
  global_load_lds_dwordx4 v2, s[26:27]
  v_mfma_f32_16x16x32_bf16 v[120:123], v[28:31], a[252:255], v[120:123]
  s_waitcnt lgkmcnt(4)
  s_add_u32 s42, s72, 10
  s_and_b32 s42, s42, 15
  v_mfma_f32_16x16x32_bf16 v[128:131], v[16:19], a[0:3], 0
  s_mul_i32 s42, s42, 262144
  s_or_b32 s42, s42, 128
  ds_read_b64_tr_b16 v[28:29], v11 offset:0
  v_mfma_f32_16x16x32_bf16 v[132:135], v[16:19], a[4:7], 0
  s_add_u32 s24, s18, s42
  s_addc_u32 s25, s19, 0
  s_add_u32 m0, s23, 40960
  ds_read_b64_tr_b16 v[30:31], v11 offset:512
  v_mfma_f32_16x16x32_bf16 v[136:139], v[16:19], a[8:11], 0
  global_load_lds_dwordx4 v2, s[24:25]
  v_mfma_f32_16x16x32_bf16 v[140:143], v[16:19], a[12:15], 0
  s_waitcnt lgkmcnt(4)
  s_add_u32 s43, s72, 11
  s_and_b32 s43, s43, 15
  v_mfma_f32_16x16x32_bf16 v[160:163], v[20:23], a[0:3], 0
  s_mul_i32 s43, s43, 262144
  s_or_b32 s43, s43, 128
  ds_read_b64_tr_b16 v[16:17], v8 offset:4096
  v_mfma_f32_16x16x32_bf16 v[164:167], v[20:23], a[4:7], 0
  s_add_u32 s26, s18, s43
  s_addc_u32 s27, s19, 0
  s_add_u32 m0, s23, 45056
  ds_read_b64_tr_b16 v[18:19], v8 offset:4608
  v_mfma_f32_16x16x32_bf16 v[168:171], v[20:23], a[8:11], 0
  global_load_lds_dwordx4 v2, s[26:27]
  v_mfma_f32_16x16x32_bf16 v[172:175], v[20:23], a[12:15], 0
  s_waitcnt lgkmcnt(4)
  s_add_u32 s42, s72, 12
  s_and_b32 s42, s42, 15
  v_mfma_f32_16x16x32_bf16 v[144:147], v[24:27], a[0:3], 0
  s_mul_i32 s42, s42, 262144
  s_or_b32 s42, s42, 128
  ds_read_b64_tr_b16 v[20:21], v9 offset:4096
  v_mfma_f32_16x16x32_bf16 v[152:155], v[24:27], a[4:7], 0
  s_add_u32 s24, s18, s42
  s_addc_u32 s25, s19, 0
  s_add_u32 m0, s23, 49152
  ds_read_b64_tr_b16 v[22:23], v9 offset:4608
  v_mfma_f32_16x16x32_bf16 v[176:179], v[24:27], a[8:11], 0
  global_load_lds_dwordx4 v2, s[24:25]
  v_mfma_f32_16x16x32_bf16 v[184:187], v[24:27], a[12:15], 0
  s_waitcnt lgkmcnt(4)
  s_add_u32 s43, s72, 13
  s_and_b32 s43, s43, 15
  v_mfma_f32_16x16x32_bf16 v[208:211], v[28:31], a[0:3], 0
  s_mul_i32 s43, s43, 262144
  s_or_b32 s43, s43, 128
  ds_read_b64_tr_b16 v[24:25], v10 offset:4096
  v_mfma_f32_16x16x32_bf16 v[216:219], v[28:31], a[4:7], 0
  s_add_u32 s26, s18, s43
  s_addc_u32 s27, s19, 0
  s_add_u32 m0, s23, 53248
  ds_read_b64_tr_b16 v[26:27], v10 offset:4608
  v_mfma_f32_16x16x32_bf16 v[240:243], v[28:31], a[8:11], 0
  global_load_lds_dwordx4 v2, s[26:27]
  v_mfma_f32_16x16x32_bf16 v[248:251], v[28:31], a[12:15], 0
  s_waitcnt lgkmcnt(4)
  s_add_u32 s42, s72, 14
  s_and_b32 s42, s42, 15
  v_mfma_f32_16x16x32_bf16 v[128:131], v[16:19], a[16:19], v[128:131]
  s_mul_i32 s42, s42, 262144
  s_or_b32 s42, s42, 128
  ds_read_b64_tr_b16 v[28:29], v11 offset:4096
  v_mfma_f32_16x16x32_bf16 v[132:135], v[16:19], a[20:23], v[132:135]
  s_add_u32 s24, s18, s42
  s_addc_u32 s25, s19, 0
  s_add_u32 m0, s23, 57344
  ds_read_b64_tr_b16 v[30:31], v11 offset:4608
  v_mfma_f32_16x16x32_bf16 v[136:139], v[16:19], a[24:27], v[136:139]
  global_load_lds_dwordx4 v2, s[24:25]
  v_mfma_f32_16x16x32_bf16 v[140:143], v[16:19], a[28:31], v[140:143]
  s_waitcnt lgkmcnt(4)
  s_add_u32 s43, s72, 15
  s_and_b32 s43, s43, 15
  v_mfma_f32_16x16x32_bf16 v[160:163], v[20:23], a[16:19], v[160:163]
  s_mul_i32 s43, s43, 262144
  s_or_b32 s43, s43, 128
  ds_read_b64_tr_b16 v[16:17], v8 offset:8192
  v_mfma_f32_16x16x32_bf16 v[164:167], v[20:23], a[20:23], v[164:167]
  s_add_u32 s26, s18, s43
  s_addc_u32 s27, s19, 0
  s_add_u32 m0, s23, 61440
  ds_read_b64_tr_b16 v[18:19], v8 offset:8704
  v_mfma_f32_16x16x32_bf16 v[168:171], v[20:23], a[24:27], v[168:171]
  global_load_lds_dwordx4 v2, s[26:27]
  v_mfma_f32_16x16x32_bf16 v[172:175], v[20:23], a[28:31], v[172:175]
  s_waitcnt lgkmcnt(4)
  v_rcp_f32 v57, v57
  v_mfma_f32_16x16x32_bf16 v[144:147], v[24:27], a[16:19], v[144:147]
  ds_read_b64_tr_b16 v[20:21], v9 offset:8192
  v_mfma_f32_16x16x32_bf16 v[152:155], v[24:27], a[20:23], v[152:155]
  ds_read_b64_tr_b16 v[22:23], v9 offset:8704
  v_mfma_f32_16x16x32_bf16 v[176:179], v[24:27], a[24:27], v[176:179]
  v_rcp_f32 v58, v58
  v_mfma_f32_16x16x32_bf16 v[184:187], v[24:27], a[28:31], v[184:187]
  s_waitcnt lgkmcnt(4)
  v_rcp_f32 v59, v59
  v_mfma_f32_16x16x32_bf16 v[208:211], v[28:31], a[16:19], v[208:211]
  ds_read_b64_tr_b16 v[24:25], v10 offset:8192
  v_mul_f32 v204, v204, v236
  v_mfma_f32_16x16x32_bf16 v[216:219], v[28:31], a[20:23], v[216:219]
  ds_read_b64_tr_b16 v[26:27], v10 offset:8704
  v_mul_f32 v205, v205, v237
  v_mfma_f32_16x16x32_bf16 v[240:243], v[28:31], a[24:27], v[240:243]
  v_mul_f32 v206, v206, v238
  v_mul_f32 v207, v207, v239
  v_mfma_f32_16x16x32_bf16 v[248:251], v[28:31], a[28:31], v[248:251]
  s_waitcnt lgkmcnt(4)
  v_mul_f32 v204, v204, v56
  v_mul_f32 v205, v205, v57
  v_mfma_f32_16x16x32_bf16 v[128:131], v[16:19], a[32:35], v[128:131]
  ds_read_b64_tr_b16 v[28:29], v11 offset:8192
  v_mul_f32 v206, v206, v58
  v_mfma_f32_16x16x32_bf16 v[132:135], v[16:19], a[36:39], v[132:135]
  ds_read_b64_tr_b16 v[30:31], v11 offset:8704
  v_mul_f32 v207, v207, v59
  v_mfma_f32_16x16x32_bf16 v[136:139], v[16:19], a[40:43], v[136:139]
  v_cvt_pk_bf16_f32 v46, v204, v205
  v_cvt_pk_bf16_f32 v47, v206, v207
  v_mfma_f32_16x16x32_bf16 v[140:143], v[16:19], a[44:47], v[140:143]
  s_waitcnt lgkmcnt(4)
  global_store_dwordx4 v54, v[44:47], s[54:55] offset:1024 sc1
  v_mul_f32 v56, 0xbfb8aa3b, v68
  v_mfma_f32_16x16x32_bf16 v[160:163], v[20:23], a[32:35], v[160:163]
  ds_read_b64_tr_b16 v[16:17], v8 offset:12288
  v_and_b32 v60, 7, v1
  v_lshlrev_b32 v60, 2, v60
  s_lshl_b32 s40, s20, 7
  v_add_u32 v60, s40, v60
  global_load_dword v61, v60, s[68:69] sc1
  v_mfma_f32_16x16x32_bf16 v[164:167], v[20:23], a[36:39], v[164:167]
  ds_read_b64_tr_b16 v[18:19], v8 offset:12800
  v_mul_f32 v57, 0xbfb8aa3b, v69
  v_mfma_f32_16x16x32_bf16 v[168:171], v[20:23], a[40:43], v[168:171]
  v_mul_f32 v58, 0xbfb8aa3b, v70
  v_mul_f32 v59, 0xbfb8aa3b, v71
  v_mfma_f32_16x16x32_bf16 v[172:175], v[20:23], a[44:47], v[172:175]
  s_waitcnt lgkmcnt(4)
  v_exp_f32 v56, v56
  v_mfma_f32_16x16x32_bf16 v[144:147], v[24:27], a[32:35], v[144:147]
  ds_read_b64_tr_b16 v[20:21], v9 offset:12288
  v_mfma_f32_16x16x32_bf16 v[152:155], v[24:27], a[36:39], v[152:155]
  ds_read_b64_tr_b16 v[22:23], v9 offset:12800
  v_mfma_f32_16x16x32_bf16 v[176:179], v[24:27], a[40:43], v[176:179]
  v_exp_f32 v57, v57
  v_mfma_f32_16x16x32_bf16 v[184:187], v[24:27], a[44:47], v[184:187]
  s_waitcnt lgkmcnt(4)
  v_exp_f32 v58, v58
  v_mfma_f32_16x16x32_bf16 v[208:211], v[28:31], a[32:35], v[208:211]
  ds_read_b64_tr_b16 v[24:25], v10 offset:12288
  v_mfma_f32_16x16x32_bf16 v[216:219], v[28:31], a[36:39], v[216:219]
  ds_read_b64_tr_b16 v[26:27], v10 offset:12800
  v_mfma_f32_16x16x32_bf16 v[240:243], v[28:31], a[40:43], v[240:243]
  v_exp_f32 v59, v59
  v_mfma_f32_16x16x32_bf16 v[248:251], v[28:31], a[44:47], v[248:251]
  s_waitcnt lgkmcnt(4)
  v_add_f32 v56, 1.0, v56
  v_add_f32 v57, 1.0, v57
  v_mfma_f32_16x16x32_bf16 v[128:131], v[16:19], a[48:51], v[128:131]
  ds_read_b64_tr_b16 v[28:29], v11 offset:12288
  v_add_f32 v58, 1.0, v58
  v_mfma_f32_16x16x32_bf16 v[132:135], v[16:19], a[52:55], v[132:135]
  ds_read_b64_tr_b16 v[30:31], v11 offset:12800
  v_add_f32 v59, 1.0, v59
  v_mfma_f32_16x16x32_bf16 v[136:139], v[16:19], a[56:59], v[136:139]
  v_rcp_f32 v56, v56
  v_mfma_f32_16x16x32_bf16 v[140:143], v[16:19], a[60:63], v[140:143]
  s_waitcnt lgkmcnt(4)
  v_rcp_f32 v57, v57
  v_mfma_f32_16x16x32_bf16 v[160:163], v[20:23], a[48:51], v[160:163]
  ds_read_b64_tr_b16 v[16:17], v8 offset:16384
  v_mfma_f32_16x16x32_bf16 v[164:167], v[20:23], a[52:55], v[164:167]
  ds_read_b64_tr_b16 v[18:19], v8 offset:16896
  v_mfma_f32_16x16x32_bf16 v[168:171], v[20:23], a[56:59], v[168:171]
  v_rcp_f32 v58, v58
  v_mfma_f32_16x16x32_bf16 v[172:175], v[20:23], a[60:63], v[172:175]
  s_waitcnt lgkmcnt(4)
  v_rcp_f32 v59, v59
  v_mfma_f32_16x16x32_bf16 v[144:147], v[24:27], a[48:51], v[144:147]
  ds_read_b64_tr_b16 v[20:21], v9 offset:16384
  v_mul_f32 v68, v68, v100
  v_mfma_f32_16x16x32_bf16 v[152:155], v[24:27], a[52:55], v[152:155]
  ds_read_b64_tr_b16 v[22:23], v9 offset:16896
  v_mul_f32 v69, v69, v101
  v_mfma_f32_16x16x32_bf16 v[176:179], v[24:27], a[56:59], v[176:179]
  v_mul_f32 v70, v70, v102
  v_mul_f32 v71, v71, v103
  v_mfma_f32_16x16x32_bf16 v[184:187], v[24:27], a[60:63], v[184:187]
  s_waitcnt lgkmcnt(4)
  v_mul_f32 v68, v68, v56
  v_mul_f32 v69, v69, v57
  v_mfma_f32_16x16x32_bf16 v[208:211], v[28:31], a[48:51], v[208:211]
  ds_read_b64_tr_b16 v[24:25], v10 offset:16384
  v_mul_f32 v70, v70, v58
  v_mfma_f32_16x16x32_bf16 v[216:219], v[28:31], a[52:55], v[216:219]
  ds_read_b64_tr_b16 v[26:27], v10 offset:16896
  v_mul_f32 v71, v71, v59
  v_mfma_f32_16x16x32_bf16 v[240:243], v[28:31], a[56:59], v[240:243]
  v_cvt_pk_bf16_f32 v32, v68, v69
  v_cvt_pk_bf16_f32 v33, v70, v71
  v_mfma_f32_16x16x32_bf16 v[248:251], v[28:31], a[60:63], v[248:251]
  s_waitcnt lgkmcnt(4)
  v_mul_f32 v56, 0xbfb8aa3b, v76
  v_mul_f32 v57, 0xbfb8aa3b, v77
  v_mfma_f32_16x16x32_bf16 v[128:131], v[16:19], a[64:67], v[128:131]
  ds_read_b64_tr_b16 v[28:29], v11 offset:16384
  v_mul_f32 v58, 0xbfb8aa3b, v78
  v_mfma_f32_16x16x32_bf16 v[132:135], v[16:19], a[68:71], v[132:135]
  ds_read_b64_tr_b16 v[30:31], v11 offset:16896
  v_mul_f32 v59, 0xbfb8aa3b, v79
  v_mfma_f32_16x16x32_bf16 v[136:139], v[16:19], a[72:75], v[136:139]
  v_exp_f32 v56, v56
  v_mfma_f32_16x16x32_bf16 v[140:143], v[16:19], a[76:79], v[140:143]
  s_waitcnt lgkmcnt(4)
  v_exp_f32 v57, v57
  v_mfma_f32_16x16x32_bf16 v[160:163], v[20:23], a[64:67], v[160:163]
  ds_read_b64_tr_b16 v[16:17], v8 offset:20480
  v_mfma_f32_16x16x32_bf16 v[164:167], v[20:23], a[68:71], v[164:167]
  ds_read_b64_tr_b16 v[18:19], v8 offset:20992
  v_mfma_f32_16x16x32_bf16 v[168:171], v[20:23], a[72:75], v[168:171]
  v_exp_f32 v58, v58
  v_mfma_f32_16x16x32_bf16 v[172:175], v[20:23], a[76:79], v[172:175]
  s_waitcnt lgkmcnt(4)
  v_exp_f32 v59, v59
  v_mfma_f32_16x16x32_bf16 v[144:147], v[24:27], a[64:67], v[144:147]
  ds_read_b64_tr_b16 v[20:21], v9 offset:20480
  v_add_f32 v56, 1.0, v56
  v_mfma_f32_16x16x32_bf16 v[152:155], v[24:27], a[68:71], v[152:155]
  ds_read_b64_tr_b16 v[22:23], v9 offset:20992
  v_add_f32 v57, 1.0, v57
  v_mfma_f32_16x16x32_bf16 v[176:179], v[24:27], a[72:75], v[176:179]
  v_add_f32 v58, 1.0, v58
  v_add_f32 v59, 1.0, v59
  v_mfma_f32_16x16x32_bf16 v[184:187], v[24:27], a[76:79], v[184:187]
  s_waitcnt lgkmcnt(4)
  v_rcp_f32 v56, v56
  v_mfma_f32_16x16x32_bf16 v[208:211], v[28:31], a[64:67], v[208:211]
  ds_read_b64_tr_b16 v[24:25], v10 offset:20480
  v_mfma_f32_16x16x32_bf16 v[216:219], v[28:31], a[68:71], v[216:219]
  ds_read_b64_tr_b16 v[26:27], v10 offset:20992
  v_mfma_f32_16x16x32_bf16 v[240:243], v[28:31], a[72:75], v[240:243]
  v_rcp_f32 v57, v57
  v_mfma_f32_16x16x32_bf16 v[248:251], v[28:31], a[76:79], v[248:251]
  s_waitcnt lgkmcnt(4)
  v_rcp_f32 v58, v58
  v_mfma_f32_16x16x32_bf16 v[128:131], v[16:19], a[80:83], v[128:131]
  ds_read_b64_tr_b16 v[28:29], v11 offset:20480
  v_mfma_f32_16x16x32_bf16 v[132:135], v[16:19], a[84:87], v[132:135]
  ds_read_b64_tr_b16 v[30:31], v11 offset:20992
  v_mfma_f32_16x16x32_bf16 v[136:139], v[16:19], a[88:91], v[136:139]
  v_rcp_f32 v59, v59
  v_mfma_f32_16x16x32_bf16 v[140:143], v[16:19], a[92:95], v[140:143]
  s_waitcnt lgkmcnt(4)
  v_mul_f32 v76, v76, v108
  v_mul_f32 v77, v77, v109
  v_mfma_f32_16x16x32_bf16 v[160:163], v[20:23], a[80:83], v[160:163]
  ds_read_b64_tr_b16 v[16:17], v8 offset:24576
  v_mul_f32 v78, v78, v110
  v_mfma_f32_16x16x32_bf16 v[164:167], v[20:23], a[84:87], v[164:167]
  ds_read_b64_tr_b16 v[18:19], v8 offset:25088
  v_mul_f32 v79, v79, v111
  v_mfma_f32_16x16x32_bf16 v[168:171], v[20:23], a[88:91], v[168:171]
  v_mul_f32 v76, v76, v56
  v_mul_f32 v77, v77, v57
  v_mfma_f32_16x16x32_bf16 v[172:175], v[20:23], a[92:95], v[172:175]
  s_waitcnt lgkmcnt(4)
  v_mul_f32 v78, v78, v58
  v_mul_f32 v79, v79, v59
  v_mfma_f32_16x16x32_bf16 v[144:147], v[24:27], a[80:83], v[144:147]
  ds_read_b64_tr_b16 v[20:21], v9 offset:24576
  v_cvt_pk_bf16_f32 v34, v76, v77
  v_mfma_f32_16x16x32_bf16 v[152:155], v[24:27], a[84:87], v[152:155]
  ds_read_b64_tr_b16 v[22:23], v9 offset:25088
  v_cvt_pk_bf16_f32 v35, v78, v79
  v_mfma_f32_16x16x32_bf16 v[176:179], v[24:27], a[88:91], v[176:179]
  s_cmp_eq_u32 s37, 1
  s_cbranch_scc0 L_h2s36
  global_store_dwordx4 v52, v[32:35], s[54:55] offset:2048 sc1
L_h2s36:
  v_mfma_f32_16x16x32_bf16 v[184:187], v[24:27], a[92:95], v[184:187]
  s_waitcnt lgkmcnt(4)
  v_mul_f32 v56, 0xbfb8aa3b, v84
  v_mul_f32 v57, 0xbfb8aa3b, v85
  v_mfma_f32_16x16x32_bf16 v[208:211], v[28:31], a[80:83], v[208:211]
  ds_read_b64_tr_b16 v[24:25], v10 offset:24576
  v_mul_f32 v58, 0xbfb8aa3b, v86
  v_mfma_f32_16x16x32_bf16 v[216:219], v[28:31], a[84:87], v[216:219]
  ds_read_b64_tr_b16 v[26:27], v10 offset:25088
  v_mul_f32 v59, 0xbfb8aa3b, v87
  v_mfma_f32_16x16x32_bf16 v[240:243], v[28:31], a[88:91], v[240:243]
  v_exp_f32 v56, v56
  v_mfma_f32_16x16x32_bf16 v[248:251], v[28:31], a[92:95], v[248:251]
  s_waitcnt lgkmcnt(4)
  v_exp_f32 v57, v57
  v_mfma_f32_16x16x32_bf16 v[128:131], v[16:19], a[96:99], v[128:131]
  ds_read_b64_tr_b16 v[28:29], v11 offset:24576
  s_waitcnt vmcnt(0)
  v_cmp_ne_u32 vcc, s71, v61
  s_nop 3
  s_cmp_eq_u64 vcc, 0
  s_cbranch_scc0 L_spin39
L_back39:
  v_mfma_f32_16x16x32_bf16 v[132:135], v[16:19], a[100:103], v[132:135]
  ds_read_b64_tr_b16 v[30:31], v11 offset:25088
  v_mfma_f32_16x16x32_bf16 v[136:139], v[16:19], a[104:107], v[136:139]
  v_exp_f32 v58, v58
  v_mfma_f32_16x16x32_bf16 v[140:143], v[16:19], a[108:111], v[140:143]
  s_waitcnt lgkmcnt(4)
  v_exp_f32 v59, v59
  v_mfma_f32_16x16x32_bf16 v[160:163], v[20:23], a[96:99], v[160:163]
  s_add_u32 s38, s34, 0
  s_addc_u32 s39, s35, 0
  ds_read_b64_tr_b16 v[16:17], v8 offset:28672
  v_mfma_f32_16x16x32_bf16 v[164:167], v[20:23], a[100:103], v[164:167]
  s_add_u32 m0, s36, 0
  ds_read_b64_tr_b16 v[18:19], v8 offset:29184
  v_add_f32 v56, 1.0, v56
  v_mfma_f32_16x16x32_bf16 v[168:171], v[20:23], a[104:107], v[168:171]
  v_add_f32 v57, 1.0, v57
  v_add_f32 v58, 1.0, v58
  v_mfma_f32_16x16x32_bf16 v[172:175], v[20:23], a[108:111], v[172:175]
  s_waitcnt lgkmcnt(4)
  global_load_lds_dwordx4 v4, s[38:39] offset:0
  v_add_f32 v59, 1.0, v59
  v_mfma_f32_16x16x32_bf16 v[144:147], v[24:27], a[96:99], v[144:147]
  ds_read_b64_tr_b16 v[20:21], v9 offset:28672
  v_mfma_f32_16x16x32_bf16 v[152:155], v[24:27], a[100:103], v[152:155]
  ds_read_b64_tr_b16 v[22:23], v9 offset:29184
  v_mfma_f32_16x16x32_bf16 v[176:179], v[24:27], a[104:107], v[176:179]
  v_rcp_f32 v56, v56
  v_mfma_f32_16x16x32_bf16 v[184:187], v[24:27], a[108:111], v[184:187]
  s_waitcnt lgkmcnt(4)
  v_rcp_f32 v57, v57
  v_mfma_f32_16x16x32_bf16 v[208:211], v[28:31], a[96:99], v[208:211]
  s_add_u32 m0, s36, 0
  ds_read_b64_tr_b16 v[24:25], v10 offset:28672
  v_mfma_f32_16x16x32_bf16 v[216:219], v[28:31], a[100:103], v[216:219]
  ds_read_b64_tr_b16 v[26:27], v10 offset:29184
  v_mfma_f32_16x16x32_bf16 v[240:243], v[28:31], a[104:107], v[240:243]
  global_load_lds_dwordx4 v4, s[38:39] offset:1024
  v_mfma_f32_16x16x32_bf16 v[248:251], v[28:31], a[108:111], v[248:251]
  s_waitcnt lgkmcnt(4)
  v_rcp_f32 v58, v58
  v_mfma_f32_16x16x32_bf16 v[128:131], v[16:19], a[112:115], v[128:131]
  ds_read_b64_tr_b16 v[28:29], v11 offset:28672
  v_mfma_f32_16x16x32_bf16 v[132:135], v[16:19], a[116:119], v[132:135]
  s_add_u32 m0, s36, 0
  ds_read_b64_tr_b16 v[30:31], v11 offset:29184
  v_mfma_f32_16x16x32_bf16 v[136:139], v[16:19], a[120:123], v[136:139]
  v_rcp_f32 v59, v59
  v_mfma_f32_16x16x32_bf16 v[140:143], v[16:19], a[124:127], v[140:143]
  s_waitcnt lgkmcnt(4)
  global_load_lds_dwordx4 v4, s[38:39] offset:2048
  v_mul_f32 v84, v84, v116
  v_mfma_f32_16x16x32_bf16 v[160:163], v[20:23], a[112:115], v[160:163]
  s_waitcnt vmcnt(5)
  s_barrier
  v_mul_f32 v85, v85, v117
  v_mfma_f32_16x16x32_bf16 v[164:167], v[20:23], a[116:119], v[164:167]
  ds_read_b64_tr_b16 v[16:17], v8 offset:32768
  v_mul_f32 v86, v86, v118
  v_mfma_f32_16x16x32_bf16 v[168:171], v[20:23], a[120:123], v[168:171]
  ds_read_b64_tr_b16 v[18:19], v8 offset:33280
  v_mul_f32 v87, v87, v119
  v_mfma_f32_16x16x32_bf16 v[172:175], v[20:23], a[124:127], v[172:175]
  s_waitcnt lgkmcnt(4)
  v_mul_f32 v84, v84, v56
  v_mul_f32 v85, v85, v57
  v_mfma_f32_16x16x32_bf16 v[144:147], v[24:27], a[112:115], v[144:147]
  s_add_u32 m0, s36, 0
  ds_read_b64_tr_b16 v[20:21], v9 offset:32768
  v_mul_f32 v86, v86, v58
  v_mfma_f32_16x16x32_bf16 v[152:155], v[24:27], a[116:119], v[152:155]
  ds_read_b64_tr_b16 v[22:23], v9 offset:33280
  v_mul_f32 v87, v87, v59
  v_mfma_f32_16x16x32_bf16 v[176:179], v[24:27], a[120:123], v[176:179]
  global_load_lds_dwordx4 v4, s[38:39] offset:3072
  v_cvt_pk_bf16_f32 v36, v84, v85
  v_mfma_f32_16x16x32_bf16 v[184:187], v[24:27], a[124:127], v[184:187]
  s_waitcnt lgkmcnt(4)
  v_cvt_pk_bf16_f32 v37, v86, v87
  v_mul_f32 v56, 0xbfb8aa3b, v92
  v_mfma_f32_16x16x32_bf16 v[208:211], v[28:31], a[112:115], v[208:211]
  s_add_u32 s38, s34, 16384
  s_addc_u32 s39, s35, 0
  ds_read_b64_tr_b16 v[24:25], v10 offset:32768
  v_mfma_f32_16x16x32_bf16 v[216:219], v[28:31], a[116:119], v[216:219]
  s_add_u32 m0, s36, 16384
  ds_read_b64_tr_b16 v[26:27], v10 offset:33280
  v_mul_f32 v57, 0xbfb8aa3b, v93
  v_mfma_f32_16x16x32_bf16 v[240:243], v[28:31], a[120:123], v[240:243]
  v_mul_f32 v58, 0xbfb8aa3b, v94
  v_mul_f32 v59, 0xbfb8aa3b, v95
  v_mfma_f32_16x16x32_bf16 v[248:251], v[28:31], a[124:127], v[248:251]
  s_waitcnt lgkmcnt(4)
  global_load_lds_dwordx4 v4, s[38:39] offset:0
  v_mfma_f32_16x16x32_bf16 v[128:131], v[16:19], a[128:131], v[128:131]
  ds_read_b64_tr_b16 v[28:29], v11 offset:32768
  v_mfma_f32_16x16x32_bf16 v[132:135], v[16:19], a[132:135], v[132:135]
  ds_read_b64_tr_b16 v[30:31], v11 offset:33280
  v_mfma_f32_16x16x32_bf16 v[136:139], v[16:19], a[136:139], v[136:139]
  v_exp_f32 v56, v56
  v_mfma_f32_16x16x32_bf16 v[140:143], v[16:19], a[140:143], v[140:143]
  s_waitcnt lgkmcnt(4)
  v_exp_f32 v57, v57
  v_mfma_f32_16x16x32_bf16 v[160:163], v[20:23], a[128:131], v[160:163]
  s_add_u32 m0, s36, 16384
  ds_read_b64_tr_b16 v[16:17], v8 offset:36864
  v_mfma_f32_16x16x32_bf16 v[164:167], v[20:23], a[132:135], v[164:167]
  ds_read_b64_tr_b16 v[18:19], v8 offset:37376
  v_mfma_f32_16x16x32_bf16 v[168:171], v[20:23], a[136:139], v[168:171]
  global_load_lds_dwordx4 v4, s[38:39] offset:1024
  v_mfma_f32_16x16x32_bf16 v[172:175], v[20:23], a[140:143], v[172:175]
  s_waitcnt lgkmcnt(4)
  v_exp_f32 v58, v58
  v_mfma_f32_16x16x32_bf16 v[144:147], v[24:27], a[128:131], v[144:147]
  ds_read_b64_tr_b16 v[20:21], v9 offset:36864
  v_mfma_f32_16x16x32_bf16 v[152:155], v[24:27], a[132:135], v[152:155]
  s_add_u32 m0, s36, 16384
  ds_read_b64_tr_b16 v[22:23], v9 offset:37376
  v_mfma_f32_16x16x32_bf16 v[176:179], v[24:27], a[136:139], v[176:179]
  v_exp_f32 v59, v59
  v_mfma_f32_16x16x32_bf16 v[184:187], v[24:27], a[140:143], v[184:187]
  s_waitcnt lgkmcnt(4)
  global_load_lds_dwordx4 v4, s[38:39] offset:2048
  v_add_f32 v56, 1.0, v56
  v_mfma_f32_16x16x32_bf16 v[208:211], v[28:31], a[128:131], v[208:211]
  ds_read_b64_tr_b16 v[24:25], v10 offset:36864
  v_add_f32 v57, 1.0, v57
  v_mfma_f32_16x16x32_bf16 v[216:219], v[28:31], a[132:135], v[216:219]
  ds_read_b64_tr_b16 v[26:27], v10 offset:37376
  v_add_f32 v58, 1.0, v58
  v_mfma_f32_16x16x32_bf16 v[240:243], v[28:31], a[136:139], v[240:243]
  v_add_f32 v59, 1.0, v59
  v_mfma_f32_16x16x32_bf16 v[248:251], v[28:31], a[140:143], v[248:251]
  s_waitcnt lgkmcnt(4)
  v_rcp_f32 v56, v56
  v_mfma_f32_16x16x32_bf16 v[128:131], v[16:19], a[144:147], v[128:131]
  s_add_u32 m0, s36, 16384
  ds_read_b64_tr_b16 v[28:29], v11 offset:36864
  v_mfma_f32_16x16x32_bf16 v[132:135], v[16:19], a[148:151], v[132:135]
  ds_read_b64_tr_b16 v[30:31], v11 offset:37376
  v_mfma_f32_16x16x32_bf16 v[136:139], v[16:19], a[152:155], v[136:139]
  global_load_lds_dwordx4 v4, s[38:39] offset:3072
  v_mfma_f32_16x16x32_bf16 v[140:143], v[16:19], a[156:159], v[140:143]
  s_waitcnt lgkmcnt(4)
  v_rcp_f32 v57, v57
  v_mfma_f32_16x16x32_bf16 v[160:163], v[20:23], a[144:147], v[160:163]
  s_add_u32 s38, s34, 32768
  s_addc_u32 s39, s35, 0
  ds_read_b64_tr_b16 v[16:17], v8 offset:40960
  v_mfma_f32_16x16x32_bf16 v[164:167], v[20:23], a[148:151], v[164:167]
  s_add_u32 m0, s36, 32768
  ds_read_b64_tr_b16 v[18:19], v8 offset:41472
  v_mfma_f32_16x16x32_bf16 v[168:171], v[20:23], a[152:155], v[168:171]
  v_rcp_f32 v58, v58
  v_mfma_f32_16x16x32_bf16 v[172:175], v[20:23], a[156:159], v[172:175]
  s_waitcnt lgkmcnt(4)
  global_load_lds_dwordx4 v4, s[38:39] offset:0
  v_mfma_f32_16x16x32_bf16 v[144:147], v[24:27], a[144:147], v[144:147]
  ds_read_b64_tr_b16 v[20:21], v9 offset:40960
  v_mfma_f32_16x16x32_bf16 v[152:155], v[24:27], a[148:151], v[152:155]
  ds_read_b64_tr_b16 v[22:23], v9 offset:41472
  v_mfma_f32_16x16x32_bf16 v[176:179], v[24:27], a[152:155], v[176:179]
  v_rcp_f32 v59, v59
  v_mfma_f32_16x16x32_bf16 v[184:187], v[24:27], a[156:159], v[184:187]
  s_waitcnt lgkmcnt(4)
  v_mul_f32 v92, v92, v124
  v_mul_f32 v93, v93, v125
  v_mfma_f32_16x16x32_bf16 v[208:211], v[28:31], a[144:147], v[208:211]
  s_add_u32 m0, s36, 32768
  ds_read_b64_tr_b16 v[24:25], v10 offset:40960
  v_mul_f32 v94, v94, v126
  v_mfma_f32_16x16x32_bf16 v[216:219], v[28:31], a[148:151], v[216:219]
  ds_read_b64_tr_b16 v[26:27], v10 offset:41472
  v_mul_f32 v95, v95, v127
  v_mfma_f32_16x16x32_bf16 v[240:243], v[28:31], a[152:155], v[240:243]
  global_load_lds_dwordx4 v4, s[38:39] offset:1024
  v_mul_f32 v92, v92, v56
  v_mfma_f32_16x16x32_bf16 v[248:251], v[28:31], a[156:159], v[248:251]
  s_waitcnt lgkmcnt(4)
  v_mul_f32 v93, v93, v57
  v_mul_f32 v94, v94, v58
  v_mfma_f32_16x16x32_bf16 v[128:131], v[16:19], a[160:163], v[128:131]
  ds_read_b64_tr_b16 v[28:29], v11 offset:40960
  v_mul_f32 v95, v95, v59
  v_mfma_f32_16x16x32_bf16 v[132:135], v[16:19], a[164:167], v[132:135]
  s_add_u32 m0, s36, 32768
  ds_read_b64_tr_b16 v[30:31], v11 offset:41472
  v_cvt_pk_bf16_f32 v38, v92, v93
  v_mfma_f32_16x16x32_bf16 v[136:139], v[16:19], a[168:171], v[136:139]
  v_cvt_pk_bf16_f32 v39, v94, v95
  v_mfma_f32_16x16x32_bf16 v[140:143], v[16:19], a[172:175], v[140:143]
  s_waitcnt lgkmcnt(4)
  global_load_lds_dwordx4 v4, s[38:39] offset:2048
  v_mfma_f32_16x16x32_bf16 v[160:163], v[20:23], a[160:163], v[160:163]
  ds_read_b64_tr_b16 v[16:17], v8 offset:45056
  v_mfma_f32_16x16x32_bf16 v[164:167], v[20:23], a[164:167], v[164:167]
  ds_read_b64_tr_b16 v[18:19], v8 offset:45568
  v_mfma_f32_16x16x32_bf16 v[168:171], v[20:23], a[168:171], v[168:171]
  s_cmp_eq_u32 s37, 1
  s_cbranch_scc0 L_h2s37
  global_store_dwordx4 v54, v[36:39], s[54:55] offset:2048 sc1
L_h2s37:
  v_mfma_f32_16x16x32_bf16 v[172:175], v[20:23], a[172:175], v[172:175]
  s_waitcnt lgkmcnt(4)
  v_cvt_pk_bf16_f32 v32, v148, v149
  v_cvt_pk_bf16_f32 v33, v150, v151
  v_mfma_f32_16x16x32_bf16 v[144:147], v[24:27], a[160:163], v[144:147]
  s_add_u32 m0, s36, 32768
  ds_read_b64_tr_b16 v[20:21], v9 offset:45056
  v_cvt_pk_bf16_f32 v34, v212, v213
  v_mfma_f32_16x16x32_bf16 v[152:155], v[24:27], a[164:167], v[152:155]
  ds_read_b64_tr_b16 v[22:23], v9 offset:45568
  v_cvt_pk_bf16_f32 v35, v214, v215
  v_mfma_f32_16x16x32_bf16 v[176:179], v[24:27], a[168:171], v[176:179]
  global_load_lds_dwordx4 v4, s[38:39] offset:3072
  v_accvgpr_write_b32 a0, v32
  v_mfma_f32_16x16x32_bf16 v[184:187], v[24:27], a[172:175], v[184:187]
  s_waitcnt lgkmcnt(4)
  v_accvgpr_write_b32 a1, v33
  v_accvgpr_write_b32 a2, v34
  v_mfma_f32_16x16x32_bf16 v[208:211], v[28:31], a[160:163], v[208:211]
  s_add_u32 s38, s34, 49152
  s_addc_u32 s39, s35, 0
  ds_read_b64_tr_b16 v[24:25], v10 offset:45056
  v_mfma_f32_16x16x32_bf16 v[216:219], v[28:31], a[164:167], v[216:219]
  s_add_u32 m0, s36, 49152
  ds_read_b64_tr_b16 v[26:27], v10 offset:45568
  v_accvgpr_write_b32 a3, v35
  v_mfma_f32_16x16x32_bf16 v[240:243], v[28:31], a[168:171], v[240:243]
  v_cvt_pk_bf16_f32 v36, v64, v65
  v_cvt_pk_bf16_f32 v37, v66, v67
  v_mfma_f32_16x16x32_bf16 v[248:251], v[28:31], a[172:175], v[248:251]
  s_waitcnt lgkmcnt(4)
  global_load_lds_dwordx4 v4, s[38:39] offset:0
  v_cvt_pk_bf16_f32 v38, v96, v97
  v_mfma_f32_16x16x32_bf16 v[128:131], v[16:19], a[176:179], v[128:131]
  ds_read_b64_tr_b16 v[28:29], v11 offset:45056
  v_cvt_pk_bf16_f32 v39, v98, v99
  v_mfma_f32_16x16x32_bf16 v[132:135], v[16:19], a[180:183], v[132:135]
  ds_read_b64_tr_b16 v[30:31], v11 offset:45568
  v_accvgpr_write_b32 a4, v36
  v_mfma_f32_16x16x32_bf16 v[136:139], v[16:19], a[184:187], v[136:139]
  v_accvgpr_write_b32 a5, v37
  v_accvgpr_write_b32 a6, v38
  v_mfma_f32_16x16x32_bf16 v[140:143], v[16:19], a[188:191], v[140:143]
  s_waitcnt lgkmcnt(4)
  v_accvgpr_write_b32 a7, v39
  v_cvt_pk_bf16_f32 v40, v156, v157
  v_mfma_f32_16x16x32_bf16 v[160:163], v[20:23], a[176:179], v[160:163]
  s_add_u32 m0, s36, 49152
  ds_read_b64_tr_b16 v[16:17], v8 offset:49152
  v_cvt_pk_bf16_f32 v41, v158, v159
  v_mfma_f32_16x16x32_bf16 v[164:167], v[20:23], a[180:183], v[164:167]
  ds_read_b64_tr_b16 v[18:19], v8 offset:49664
  v_cvt_pk_bf16_f32 v42, v220, v221
  v_mfma_f32_16x16x32_bf16 v[168:171], v[20:23], a[184:187], v[168:171]
  global_load_lds_dwordx4 v4, s[38:39] offset:1024
  v_cvt_pk_bf16_f32 v43, v222, v223
  v_mfma_f32_16x16x32_bf16 v[172:175], v[20:23], a[188:191], v[172:175]
  s_waitcnt lgkmcnt(4)
  v_accvgpr_write_b32 a16, v40
  v_accvgpr_write_b32 a17, v41
  v_mfma_f32_16x16x32_bf16 v[144:147], v[24:27], a[176:179], v[144:147]
  ds_read_b64_tr_b16 v[20:21], v9 offset:49152
  v_accvgpr_write_b32 a18, v42
  v_mfma_f32_16x16x32_bf16 v[152:155], v[24:27], a[180:183], v[152:155]
  s_add_u32 m0, s36, 49152
  ds_read_b64_tr_b16 v[22:23], v9 offset:49664
  v_accvgpr_write_b32 a19, v43
  v_mfma_f32_16x16x32_bf16 v[176:179], v[24:27], a[184:187], v[176:179]
  v_cvt_pk_bf16_f32 v44, v72, v73
  v_cvt_pk_bf16_f32 v45, v74, v75
  v_mfma_f32_16x16x32_bf16 v[184:187], v[24:27], a[188:191], v[184:187]
  s_waitcnt lgkmcnt(4)
  global_load_lds_dwordx4 v4, s[38:39] offset:2048
  v_cvt_pk_bf16_f32 v46, v104, v105
  v_mfma_f32_16x16x32_bf16 v[208:211], v[28:31], a[176:179], v[208:211]
  ds_read_b64_tr_b16 v[24:25], v10 offset:49152
  v_cvt_pk_bf16_f32 v47, v106, v107
  v_mfma_f32_16x16x32_bf16 v[216:219], v[28:31], a[180:183], v[216:219]
  ds_read_b64_tr_b16 v[26:27], v10 offset:49664
  v_accvgpr_write_b32 a20, v44
  v_mfma_f32_16x16x32_bf16 v[240:243], v[28:31], a[184:187], v[240:243]
  v_accvgpr_write_b32 a21, v45
  v_accvgpr_write_b32 a22, v46
  v_mfma_f32_16x16x32_bf16 v[248:251], v[28:31], a[188:191], v[248:251]
  s_waitcnt lgkmcnt(4)
  v_accvgpr_write_b32 a23, v47
  v_cvt_pk_bf16_f32 v32, v180, v181
  v_mfma_f32_16x16x32_bf16 v[128:131], v[16:19], a[192:195], v[128:131]
  s_add_u32 m0, s36, 49152
  ds_read_b64_tr_b16 v[28:29], v11 offset:49152
  v_cvt_pk_bf16_f32 v33, v182, v183
  v_mfma_f32_16x16x32_bf16 v[132:135], v[16:19], a[196:199], v[132:135]
  ds_read_b64_tr_b16 v[30:31], v11 offset:49664
  v_cvt_pk_bf16_f32 v34, v244, v245
  v_mfma_f32_16x16x32_bf16 v[136:139], v[16:19], a[200:203], v[136:139]
  global_load_lds_dwordx4 v4, s[38:39] offset:3072
  v_cvt_pk_bf16_f32 v35, v246, v247
  v_mfma_f32_16x16x32_bf16 v[140:143], v[16:19], a[204:207], v[140:143]
  s_waitcnt lgkmcnt(4)
  v_accvgpr_write_b32 a32, v32
  v_accvgpr_write_b32 a33, v33
  v_mfma_f32_16x16x32_bf16 v[160:163], v[20:23], a[192:195], v[160:163]
  ds_read_b64_tr_b16 v[16:17], v8 offset:53248
  v_accvgpr_write_b32 a34, v34
  v_mfma_f32_16x16x32_bf16 v[164:167], v[20:23], a[196:199], v[164:167]
  ds_read_b64_tr_b16 v[18:19], v8 offset:53760
  v_accvgpr_write_b32 a35, v35
  v_mfma_f32_16x16x32_bf16 v[168:171], v[20:23], a[200:203], v[168:171]
  v_cvt_pk_bf16_f32 v36, v80, v81
  v_cvt_pk_bf16_f32 v37, v82, v83
  v_mfma_f32_16x16x32_bf16 v[172:175], v[20:23], a[204:207], v[172:175]
  s_waitcnt lgkmcnt(4)
  v_cvt_pk_bf16_f32 v38, v112, v113
  v_cvt_pk_bf16_f32 v39, v114, v115
  v_mfma_f32_16x16x32_bf16 v[144:147], v[24:27], a[192:195], v[144:147]
  ds_read_b64_tr_b16 v[20:21], v9 offset:53248
  v_accvgpr_write_b32 a36, v36
  v_mfma_f32_16x16x32_bf16 v[152:155], v[24:27], a[196:199], v[152:155]
  ds_read_b64_tr_b16 v[22:23], v9 offset:53760
  v_accvgpr_write_b32 a37, v37
  v_mfma_f32_16x16x32_bf16 v[176:179], v[24:27], a[200:203], v[176:179]
  v_accvgpr_write_b32 a38, v38
  v_accvgpr_write_b32 a39, v39
  v_mfma_f32_16x16x32_bf16 v[184:187], v[24:27], a[204:207], v[184:187]
  s_waitcnt lgkmcnt(4)
  v_cvt_pk_bf16_f32 v40, v188, v189
  v_cvt_pk_bf16_f32 v41, v190, v191
  v_mfma_f32_16x16x32_bf16 v[208:211], v[28:31], a[192:195], v[208:211]
  ds_read_b64_tr_b16 v[24:25], v10 offset:53248
  v_cvt_pk_bf16_f32 v42, v252, v253
  v_mfma_f32_16x16x32_bf16 v[216:219], v[28:31], a[196:199], v[216:219]
  ds_read_b64_tr_b16 v[26:27], v10 offset:53760
  v_cvt_pk_bf16_f32 v43, v254, v255
  v_mfma_f32_16x16x32_bf16 v[240:243], v[28:31], a[200:203], v[240:243]
  v_accvgpr_write_b32 a48, v40
  v_accvgpr_write_b32 a49, v41
  v_mfma_f32_16x16x32_bf16 v[248:251], v[28:31], a[204:207], v[248:251]
  s_waitcnt lgkmcnt(4)
  v_accvgpr_write_b32 a50, v42
  v_accvgpr_write_b32 a51, v43
  v_mfma_f32_16x16x32_bf16 v[128:131], v[16:19], a[208:211], v[128:131]
  ds_read_b64_tr_b16 v[28:29], v11 offset:53248
  v_cvt_pk_bf16_f32 v44, v88, v89
  v_mfma_f32_16x16x32_bf16 v[132:135], v[16:19], a[212:215], v[132:135]
  ds_read_b64_tr_b16 v[30:31], v11 offset:53760
  v_cvt_pk_bf16_f32 v45, v90, v91
  v_mfma_f32_16x16x32_bf16 v[136:139], v[16:19], a[216:219], v[136:139]
  v_cvt_pk_bf16_f32 v46, v120, v121
  v_cvt_pk_bf16_f32 v47, v122, v123
  v_mfma_f32_16x16x32_bf16 v[140:143], v[16:19], a[220:223], v[140:143]
  s_waitcnt lgkmcnt(4)
  v_accvgpr_write_b32 a52, v44
  v_accvgpr_write_b32 a53, v45
  v_mfma_f32_16x16x32_bf16 v[160:163], v[20:23], a[208:211], v[160:163]
  ds_read_b64_tr_b16 v[16:17], v8 offset:57344
  v_accvgpr_write_b32 a54, v46
  v_mfma_f32_16x16x32_bf16 v[164:167], v[20:23], a[212:215], v[164:167]
  ds_read_b64_tr_b16 v[18:19], v8 offset:57856
  v_accvgpr_write_b32 a55, v47
  v_mfma_f32_16x16x32_bf16 v[168:171], v[20:23], a[216:219], v[168:171]
  v_mfma_f32_16x16x32_bf16 v[172:175], v[20:23], a[220:223], v[172:175]
  s_waitcnt lgkmcnt(4)
  v_mfma_f32_16x16x32_bf16 v[144:147], v[24:27], a[208:211], v[144:147]
  ds_read_b64_tr_b16 v[20:21], v9 offset:57344
  v_mfma_f32_16x16x32_bf16 v[152:155], v[24:27], a[212:215], v[152:155]
  ds_read_b64_tr_b16 v[22:23], v9 offset:57856
  v_mfma_f32_16x16x32_bf16 v[176:179], v[24:27], a[216:219], v[176:179]
  v_mfma_f32_16x16x32_bf16 v[184:187], v[24:27], a[220:223], v[184:187]
  s_waitcnt lgkmcnt(4)
  v_mfma_f32_16x16x32_bf16 v[208:211], v[28:31], a[208:211], v[208:211]
  ds_read_b64_tr_b16 v[24:25], v10 offset:57344
  v_mfma_f32_16x16x32_bf16 v[216:219], v[28:31], a[212:215], v[216:219]
  ds_read_b64_tr_b16 v[26:27], v10 offset:57856
  v_mfma_f32_16x16x32_bf16 v[240:243], v[28:31], a[216:219], v[240:243]
  v_mfma_f32_16x16x32_bf16 v[248:251], v[28:31], a[220:223], v[248:251]
  s_waitcnt lgkmcnt(4)
  v_mfma_f32_16x16x32_bf16 v[128:131], v[16:19], a[224:227], v[128:131]
  ds_read_b64_tr_b16 v[28:29], v11 offset:57344
  v_mfma_f32_16x16x32_bf16 v[132:135], v[16:19], a[228:231], v[132:135]
  ds_read_b64_tr_b16 v[30:31], v11 offset:57856
  v_mfma_f32_16x16x32_bf16 v[136:139], v[16:19], a[232:235], v[136:139]
  v_mfma_f32_16x16x32_bf16 v[140:143], v[16:19], a[236:239], v[140:143]
  s_waitcnt lgkmcnt(4)
  v_mfma_f32_16x16x32_bf16 v[160:163], v[20:23], a[224:227], v[160:163]
  ds_read_b64_tr_b16 v[16:17], v8 offset:61440
  v_mfma_f32_16x16x32_bf16 v[164:167], v[20:23], a[228:231], v[164:167]
  ds_read_b64_tr_b16 v[18:19], v8 offset:61952
  v_mfma_f32_16x16x32_bf16 v[168:171], v[20:23], a[232:235], v[168:171]
  v_mfma_f32_16x16x32_bf16 v[172:175], v[20:23], a[236:239], v[172:175]
  s_waitcnt lgkmcnt(4)
  v_mfma_f32_16x16x32_bf16 v[144:147], v[24:27], a[224:227], v[144:147]
  ds_read_b64_tr_b16 v[20:21], v9 offset:61440
  v_mfma_f32_16x16x32_bf16 v[152:155], v[24:27], a[228:231], v[152:155]
  ds_read_b64_tr_b16 v[22:23], v9 offset:61952
  v_mfma_f32_16x16x32_bf16 v[176:179], v[24:27], a[232:235], v[176:179]
  v_mfma_f32_16x16x32_bf16 v[184:187], v[24:27], a[236:239], v[184:187]
  s_waitcnt lgkmcnt(4)
  v_mfma_f32_16x16x32_bf16 v[208:211], v[28:31], a[224:227], v[208:211]
  ds_read_b64_tr_b16 v[24:25], v10 offset:61440
  v_mfma_f32_16x16x32_bf16 v[216:219], v[28:31], a[228:231], v[216:219]
  ds_read_b64_tr_b16 v[26:27], v10 offset:61952
  v_mfma_f32_16x16x32_bf16 v[240:243], v[28:31], a[232:235], v[240:243]
  v_mfma_f32_16x16x32_bf16 v[248:251], v[28:31], a[236:239], v[248:251]
  s_waitcnt lgkmcnt(4)
  v_mfma_f32_16x16x32_bf16 v[128:131], v[16:19], a[240:243], v[128:131]
  ds_read_b64_tr_b16 v[28:29], v11 offset:61440
  v_mfma_f32_16x16x32_bf16 v[132:135], v[16:19], a[244:247], v[132:135]
  ds_read_b64_tr_b16 v[30:31], v11 offset:61952
  v_mfma_f32_16x16x32_bf16 v[136:139], v[16:19], a[248:251], v[136:139]
  v_mfma_f32_16x16x32_bf16 v[140:143], v[16:19], a[252:255], v[140:143]
  s_waitcnt lgkmcnt(4)
  v_mfma_f32_16x16x32_bf16 v[160:163], v[20:23], a[240:243], v[160:163]
  v_mfma_f32_16x16x32_bf16 v[164:167], v[20:23], a[244:247], v[164:167]
  v_mfma_f32_16x16x32_bf16 v[168:171], v[20:23], a[248:251], v[168:171]
  v_mfma_f32_16x16x32_bf16 v[172:175], v[20:23], a[252:255], v[172:175]
  s_waitcnt lgkmcnt(2)
  v_mfma_f32_16x16x32_bf16 v[144:147], v[24:27], a[240:243], v[144:147]
  v_mfma_f32_16x16x32_bf16 v[152:155], v[24:27], a[244:247], v[152:155]
  v_mfma_f32_16x16x32_bf16 v[176:179], v[24:27], a[248:251], v[176:179]
  v_mfma_f32_16x16x32_bf16 v[184:187], v[24:27], a[252:255], v[184:187]
  s_waitcnt lgkmcnt(0)
  v_mfma_f32_16x16x32_bf16 v[208:211], v[28:31], a[240:243], v[208:211]
  v_mfma_f32_16x16x32_bf16 v[216:219], v[28:31], a[244:247], v[216:219]
  v_mfma_f32_16x16x32_bf16 v[240:243], v[28:31], a[248:251], v[240:243]
  v_mfma_f32_16x16x32_bf16 v[248:251], v[28:31], a[252:255], v[248:251]
  s_nop 7
  v_cvt_pk_bf16_f32 v32, v128, v129
  v_cvt_pk_bf16_f32 v33, v130, v131
  v_cvt_pk_bf16_f32 v34, v160, v161
  v_cvt_pk_bf16_f32 v35, v162, v163
  v_accvgpr_write_b32 a8, v32
  v_accvgpr_write_b32 a9, v33
  v_accvgpr_write_b32 a10, v34
  v_accvgpr_write_b32 a11, v35
  v_cvt_pk_bf16_f32 v36, v144, v145
  v_cvt_pk_bf16_f32 v37, v146, v147
  v_cvt_pk_bf16_f32 v38, v208, v209
  v_cvt_pk_bf16_f32 v39, v210, v211
  v_accvgpr_write_b32 a12, v36
  v_accvgpr_write_b32 a13, v37
  v_accvgpr_write_b32 a14, v38
  v_accvgpr_write_b32 a15, v39
  v_cvt_pk_bf16_f32 v40, v132, v133
  v_cvt_pk_bf16_f32 v41, v134, v135
  v_cvt_pk_bf16_f32 v42, v164, v165
  v_cvt_pk_bf16_f32 v43, v166, v167
  v_accvgpr_write_b32 a24, v40
  v_accvgpr_write_b32 a25, v41
  v_accvgpr_write_b32 a26, v42
  v_accvgpr_write_b32 a27, v43
  v_cvt_pk_bf16_f32 v44, v152, v153
  v_cvt_pk_bf16_f32 v45, v154, v155
  v_cvt_pk_bf16_f32 v46, v216, v217
  v_cvt_pk_bf16_f32 v47, v218, v219
  v_accvgpr_write_b32 a28, v44
  v_accvgpr_write_b32 a29, v45
  v_accvgpr_write_b32 a30, v46
  v_accvgpr_write_b32 a31, v47
  v_cvt_pk_bf16_f32 v32, v136, v137
  v_cvt_pk_bf16_f32 v33, v138, v139
  v_cvt_pk_bf16_f32 v34, v168, v169
  v_cvt_pk_bf16_f32 v35, v170, v171
  v_accvgpr_write_b32 a40, v32
  v_accvgpr_write_b32 a41, v33
  v_accvgpr_write_b32 a42, v34
  v_accvgpr_write_b32 a43, v35
  v_cvt_pk_bf16_f32 v36, v176, v177
  v_cvt_pk_bf16_f32 v37, v178, v179
  v_cvt_pk_bf16_f32 v38, v240, v241
  v_cvt_pk_bf16_f32 v39, v242, v243
  v_accvgpr_write_b32 a44, v36
  v_accvgpr_write_b32 a45, v37
  v_accvgpr_write_b32 a46, v38
  v_accvgpr_write_b32 a47, v39
  v_cvt_pk_bf16_f32 v40, v140, v141
  v_cvt_pk_bf16_f32 v41, v142, v143
  v_cvt_pk_bf16_f32 v42, v172, v173
  v_cvt_pk_bf16_f32 v43, v174, v175
  v_accvgpr_write_b32 a56, v40
  v_accvgpr_write_b32 a57, v41
  v_accvgpr_write_b32 a58, v42
  v_accvgpr_write_b32 a59, v43
  v_cvt_pk_bf16_f32 v44, v184, v185
  v_cvt_pk_bf16_f32 v45, v186, v187
  v_cvt_pk_bf16_f32 v46, v248, v249
  v_cvt_pk_bf16_f32 v47, v250, v251
  v_accvgpr_write_b32 a60, v44
  v_accvgpr_write_b32 a61, v45
  v_accvgpr_write_b32 a62, v46
  v_accvgpr_write_b32 a63, v47
  s_waitcnt vmcnt(0) lgkmcnt(0)
  s_barrier
  s_add_u32 s38, s34, 65536
  s_addc_u32 s39, s35, 0
  s_sub_u32 m0, s36, 65536
  s_nop 0
  global_load_lds_dwordx4 v4, s[38:39] offset:0
  s_sub_u32 m0, s36, 65536
  s_nop 0
  global_load_lds_dwordx4 v4, s[38:39] offset:1024
  s_sub_u32 m0, s36, 65536
  s_nop 0
  global_load_lds_dwordx4 v4, s[38:39] offset:2048
  s_sub_u32 m0, s36, 65536
  s_nop 0
  global_load_lds_dwordx4 v4, s[38:39] offset:3072
  s_add_u32 s38, s34, 81920
  s_addc_u32 s39, s35, 0
  s_sub_u32 m0, s36, 49152
  s_nop 0
  global_load_lds_dwordx4 v4, s[38:39] offset:0
  s_sub_u32 m0, s36, 49152
  s_nop 0
  global_load_lds_dwordx4 v4, s[38:39] offset:1024
  s_cmp_eq_u32 s22, 0
  s_cbranch_scc0 L_sf40
  s_lshl_b32 s40, s21, 7
  s_lshl_b32 s41, s20, 2
  s_add_u32 s40, s40, s41
  s_add_u32 s40, s40, 4096
  v_mov_b32 v60, s40
  v_mov_b32 v61, s71
  s_mov_b64 exec, 1
  global_store_dword v60, v61, s[68:69] sc1
  s_mov_b64 exec, -1
L_sf40:
  s_add_u32 s54, s34, 65536
  s_addc_u32 s55, s35, 0
  s_xor_b32 s37, s36, 65536
  s_add_u32 s34, s34, 131072
  s_addc_u32 s35, s35, 0
  v_add_u32 v2, 98304, v4
  s_sub_u32 s52, 14, s21
  ds_read_b128 a[64:67], v2 offset:0
  ds_read_b128 a[68:71], v2 offset:1024
  ds_read_b128 a[72:75], v2 offset:2048
  ds_read_b128 a[76:79], v2 offset:3072
  ds_read_b128 a[80:83], v2 offset:4096
  ds_read_b128 a[84:87], v2 offset:5120
  ds_read_b128 a[88:91], v2 offset:6144
  ds_read_b128 a[92:95], v2 offset:7168
  ds_read_b128 a[128:131], v2 offset:8192
  ds_read_b128 a[132:135], v2 offset:9216
  ds_read_b128 a[136:139], v2 offset:10240
  ds_read_b128 a[140:143], v2 offset:11264
  ds_read_b128 a[144:147], v2 offset:12288
  ds_read_b128 a[148:151], v2 offset:13312
  ds_read_b128 a[152:155], v2 offset:14336
  ds_read_b128 a[156:159], v2 offset:15360
  v_mov_b32 v80, 0
  v_mov_b32 v81, 0
  v_mov_b32 v82, 0
  v_mov_b32 v83, 0
  s_nop 1
  v_mfma_f32_32x32x16_bf16 v[128:143], v[80:83], v[80:83], 0
  v_mfma_f32_32x32x16_bf16 v[144:159], v[80:83], v[80:83], 0
  v_mfma_f32_32x32x16_bf16 v[160:175], v[80:83], v[80:83], 0
  v_mfma_f32_32x32x16_bf16 v[176:191], v[80:83], v[80:83], 0
  v_mfma_f32_32x32x16_bf16 v[192:207], v[80:83], v[80:83], 0
  v_mfma_f32_32x32x16_bf16 v[208:223], v[80:83], v[80:83], 0
  v_mfma_f32_32x32x16_bf16 v[224:239], v[80:83], v[80:83], 0
  v_mfma_f32_32x32x16_bf16 v[240:255], v[80:83], v[80:83], 0
  v_mov_b32 v60, 0
  v_mov_b32 v61, 0
  v_mov_b32 v62, 0
  v_mov_b32 v63, 0
  v_mov_b32 v88, 0xf149f2ca
  v_and_b32 v89, 15, v1
  v_lshrrev_b32 v90, 4, v1
  v_lshlrev_b32 v90, 2, v90
  v_add_u32 v91, 0, v90
  v_cmp_le_u32 s[44:45], v91, v89
  v_add_u32 v91, 1, v90
  v_cmp_le_u32 s[46:47], v91, v89
  v_add_u32 v91, 2, v90
  v_cmp_le_u32 s[48:49], v91, v89
  v_add_u32 v91, 3, v90
  v_cmp_le_u32 s[50:51], v91, v89
  s_waitcnt lgkmcnt(8)
  v_mfma_f32_16x16x32_bf16 v[64:67], a[64:67], a[0:3], 0
  v_mfma_f32_16x16x32_bf16 v[64:67], a[68:71], a[4:7], v[64:67]
  v_mfma_f32_16x16x32_bf16 v[64:67], a[72:75], a[8:11], v[64:67]
  v_mfma_f32_16x16x32_bf16 v[64:67], a[76:79], a[12:15], v[64:67]
  v_mfma_f32_16x16x32_bf16 v[68:71], a[64:67], a[16:19], 0
  v_mfma_f32_16x16x32_bf16 v[68:71], a[68:71], a[20:23], v[68:71]
  v_mfma_f32_16x16x32_bf16 v[68:71], a[72:75], a[24:27], v[68:71]
  v_mfma_f32_16x16x32_bf16 v[68:71], a[76:79], a[28:31], v[68:71]
  v_mfma_f32_16x16x32_bf16 v[72:75], a[64:67], a[32:35], 0
  v_mfma_f32_16x16x32_bf16 v[72:75], a[68:71], a[36:39], v[72:75]
  v_mfma_f32_16x16x32_bf16 v[72:75], a[72:75], a[40:43], v[72:75]
  v_mfma_f32_16x16x32_bf16 v[72:75], a[76:79], a[44:47], v[72:75]
  v_mfma_f32_16x16x32_bf16 v[76:79], a[64:67], a[48:51], 0
  v_mfma_f32_16x16x32_bf16 v[76:79], a[68:71], a[52:55], v[76:79]
  v_mfma_f32_16x16x32_bf16 v[76:79], a[72:75], a[56:59], v[76:79]
  v_mfma_f32_16x16x32_bf16 v[76:79], a[76:79], a[60:63], v[76:79]
  s_nop 7
  v_max3_f32 v56, v64, v65, v66
  v_max_f32 v56, v56, v67
  v_max3_f32 v57, v68, v69, v70
  v_max_f32 v57, v57, v71
  v_max3_f32 v58, v72, v73, v74
  v_max_f32 v58, v58, v75
  v_max3_f32 v59, v76, v77, v78
  v_max_f32 v59, v59, v79
  v_mov_b32 v89, v56
  s_nop 1
  v_permlane16_swap_b32 v56, v89
  s_nop 1
  v_max_f32 v56, v56, v89
  v_mov_b32 v89, v56
  s_nop 1
  v_permlane32_swap_b32 v56, v89
  s_nop 1
  v_max_f32 v56, v56, v89
  v_mov_b32 v89, v57
  s_nop 1
  v_permlane16_swap_b32 v57, v89
  s_nop 1
  v_max_f32 v57, v57, v89
  v_mov_b32 v89, v57
  s_nop 1
  v_permlane32_swap_b32 v57, v89
  s_nop 1
  v_max_f32 v57, v57, v89
  v_mov_b32 v89, v58
  s_nop 1
  v_permlane16_swap_b32 v58, v89
  s_nop 1
  v_max_f32 v58, v58, v89
  v_mov_b32 v89, v58
  s_nop 1
  v_permlane32_swap_b32 v58, v89
  s_nop 1
  v_max_f32 v58, v58, v89
  v_mov_b32 v89, v59
  s_nop 1
  v_permlane16_swap_b32 v59, v89
  s_nop 1
  v_max_f32 v59, v59, v89
  v_mov_b32 v89, v59
  s_nop 1
  v_permlane32_swap_b32 v59, v89
  s_nop 1
  v_max_f32 v59, v59, v89
  v_sub_f32 v56, 0, v56
  v_mov_b32 v96, v56
  v_mov_b32 v97, v56
  v_mov_b32 v98, v56
  v_mov_b32 v99, v56
  v_mov_b32 v100, v56
  v_mov_b32 v101, v56
  v_mov_b32 v102, v56
  v_mov_b32 v103, v56
  v_sub_f32 v57, 0, v57
  v_mov_b32 v104, v57
  v_mov_b32 v105, v57
  v_mov_b32 v106, v57
  v_mov_b32 v107, v57
  v_mov_b32 v108, v57
  v_mov_b32 v109, v57
  v_mov_b32 v110, v57
  v_mov_b32 v111, v57
  v_sub_f32 v58, 0, v58
  v_mov_b32 v112, v58
  v_mov_b32 v113, v58
  v_mov_b32 v114, v58
  v_mov_b32 v115, v58
  v_mov_b32 v116, v58
  v_mov_b32 v117, v58
  v_mov_b32 v118, v58
  v_mov_b32 v119, v58
  v_sub_f32 v59, 0, v59
  v_mov_b32 v120, v59
  v_mov_b32 v121, v59
  v_mov_b32 v122, v59
  v_mov_b32 v123, v59
  v_mov_b32 v124, v59
  v_mov_b32 v125, v59
  v_mov_b32 v126, v59
  v_mov_b32 v127, v59
  v_mov_b32 v76, 0
  v_mov_b32 v77, v88
  v_mov_b32 v78, v88
  v_mov_b32 v79, v88
  v_mov_b32 v84, 0
  v_mov_b32 v85, 0
  s_nop 1
  s_mov_b32 s53, s21
  s_cmp_eq_u32 s53, 0
  s_cbranch_scc1 L_dual_diag
.p2align 5
L_dual_loop:
  v_mfma_f32_16x16x32_bf16 v[64:67], a[64:67], a[0:3], v[96:99]
  s_add_u32 s38, s54, 16384
  s_addc_u32 s39, s55, 0
  ds_read_b128 a[96:99], v2 offset:16384
  v_add_f32 v63, v63, v76
  v_mfma_f32_16x16x32_bf16 v[64:67], a[68:71], a[4:7], v[64:67]
  s_add_u32 m0, s37, 16384
  v_exp_f32 v77, v77
  v_mfma_f32_16x16x32_bf16 v[64:67], a[72:75], a[8:11], v[64:67]
  global_load_lds_dwordx4 v4, s[38:39] offset:2048
  v_cvt_pk_bf16_f32 v86, v76, v77
  v_add_f32 v63, v63, v77
  v_mfma_f32_16x16x32_bf16 v[64:67], a[76:79], a[12:15], v[64:67]
  v_exp_f32 v78, v78
  v_mfma_f32_16x16x32_bf16 v[68:71], a[80:83], a[0:3], v[100:103]
  ds_read_b128 a[100:103], v2 offset:17408
  v_add_f32 v63, v63, v78
  v_mfma_f32_16x16x32_bf16 v[68:71], a[84:87], a[4:7], v[68:71]
  v_exp_f32 v79, v79
  v_mfma_f32_16x16x32_bf16 v[68:71], a[88:91], a[8:11], v[68:71]
  v_cvt_pk_bf16_f32 v87, v78, v79
  v_add_f32 v63, v63, v79
  v_mfma_f32_16x16x32_bf16 v[68:71], a[92:95], a[12:15], v[68:71]
  v_exp_f32 v64, v64
  v_mfma_f32_16x16x32_bf16 v[140:143], a[160:163], v[84:87], v[140:143]
  ds_read_b128 a[104:107], v2 offset:18432
  v_add_f32 v60, v60, v64
  v_mfma_f32_16x16x32_bf16 v[156:159], a[164:167], v[84:87], v[156:159]
  v_exp_f32 v65, v65
  v_mfma_f32_16x16x32_bf16 v[172:175], a[168:171], v[84:87], v[172:175]
  v_cvt_pk_bf16_f32 v80, v64, v65
  v_add_f32 v60, v60, v65
  v_mfma_f32_16x16x32_bf16 v[188:191], a[172:175], v[84:87], v[188:191]
  v_exp_f32 v66, v66
  v_mfma_f32_16x16x32_bf16 v[204:207], a[176:179], v[84:87], v[204:207]
  ds_read_b128 a[108:111], v2 offset:19456
  v_add_f32 v60, v60, v66
  v_mfma_f32_16x16x32_bf16 v[220:223], a[180:183], v[84:87], v[220:223]
  v_exp_f32 v67, v67
  v_mfma_f32_16x16x32_bf16 v[236:239], a[184:187], v[84:87], v[236:239]
  global_load_lds_dwordx4 v4, s[38:39] offset:3072
  v_cvt_pk_bf16_f32 v81, v66, v67
  v_add_f32 v60, v60, v67
  v_mfma_f32_16x16x32_bf16 v[252:255], a[188:191], v[84:87], v[252:255]
  v_exp_f32 v68, v68
  v_mfma_f32_16x16x32_bf16 v[72:75], a[64:67], a[16:19], v[104:107]
  ds_read_b128 a[112:115], v2 offset:20480
  v_add_f32 v60, v60, v68
  v_mfma_f32_16x16x32_bf16 v[72:75], a[68:71], a[20:23], v[72:75]
  v_exp_f32 v69, v69
  v_mfma_f32_16x16x32_bf16 v[72:75], a[72:75], a[24:27], v[72:75]
  v_cvt_pk_bf16_f32 v82, v68, v69
  v_add_f32 v60, v60, v69
  v_mfma_f32_16x16x32_bf16 v[72:75], a[76:79], a[28:31], v[72:75]
  v_exp_f32 v70, v70
  v_mfma_f32_16x16x32_bf16 v[76:79], a[80:83], a[16:19], v[108:111]
  ds_read_b128 a[116:119], v2 offset:21504
  v_add_f32 v60, v60, v70
  v_mfma_f32_16x16x32_bf16 v[76:79], a[84:87], a[20:23], v[76:79]
  v_exp_f32 v71, v71
  v_mfma_f32_16x16x32_bf16 v[76:79], a[88:91], a[24:27], v[76:79]
  v_cvt_pk_bf16_f32 v83, v70, v71
  v_add_f32 v60, v60, v71
  v_mfma_f32_16x16x32_bf16 v[76:79], a[92:95], a[28:31], v[76:79]
  s_waitcnt lgkmcnt(6)
  v_exp_f32 v72, v72
  v_mfma_f32_16x16x32_bf16 v[128:131], a[128:131], v[80:83], v[128:131]
  s_add_u32 s38, s54, 32768
  s_addc_u32 s39, s55, 0
  ds_read_b128 a[120:123], v2 offset:22528
  v_add_f32 v61, v61, v72
  v_mfma_f32_16x16x32_bf16 v[144:147], a[132:135], v[80:83], v[144:147]
  s_add_u32 m0, s37, 32768
  v_exp_f32 v73, v73
  v_mfma_f32_16x16x32_bf16 v[160:163], a[136:139], v[80:83], v[160:163]
  global_load_lds_dwordx4 v4, s[38:39] offset:0
  v_cvt_pk_bf16_f32 v84, v72, v73
  v_add_f32 v61, v61, v73
  v_mfma_f32_16x16x32_bf16 v[176:179], a[140:143], v[80:83], v[176:179]
  v_exp_f32 v74, v74
  v_mfma_f32_16x16x32_bf16 v[192:195], a[144:147], v[80:83], v[192:195]
  ds_read_b128 a[124:127], v2 offset:23552
  v_add_f32 v61, v61, v74
  v_mfma_f32_16x16x32_bf16 v[208:211], a[148:151], v[80:83], v[208:211]
  v_exp_f32 v75, v75
  v_mfma_f32_16x16x32_bf16 v[224:227], a[152:155], v[80:83], v[224:227]
  v_cvt_pk_bf16_f32 v85, v74, v75
  v_add_f32 v61, v61, v75
  v_mfma_f32_16x16x32_bf16 v[240:243], a[156:159], v[80:83], v[240:243]
  v_exp_f32 v76, v76
  v_mfma_f32_16x16x32_bf16 v[64:67], a[64:67], a[32:35], v[112:115]
  ds_read_b128 a[160:163], v2 offset:24576
  v_add_f32 v61, v61, v76
  v_mfma_f32_16x16x32_bf16 v[64:67], a[68:71], a[36:39], v[64:67]
  v_exp_f32 v77, v77
  v_mfma_f32_16x16x32_bf16 v[64:67], a[72:75], a[40:43], v[64:67]
  v_cvt_pk_bf16_f32 v86, v76, v77
  v_add_f32 v61, v61, v77
  v_mfma_f32_16x16x32_bf16 v[64:67], a[76:79], a[44:47], v[64:67]
  v_exp_f32 v78, v78
  v_mfma_f32_16x16x32_bf16 v[68:71], a[80:83], a[32:35], v[116:119]
  ds_read_b128 a[164:167], v2 offset:25600
  v_add_f32 v61, v61, v78
  v_mfma_f32_16x16x32_bf16 v[68:71], a[84:87], a[36:39], v[68:71]
  v_exp_f32 v79, v79
  v_mfma_f32_16x16x32_bf16 v[68:71], a[88:91], a[40:43], v[68:71]
  global_load_lds_dwordx4 v4, s[38:39] offset:1024
  v_cvt_pk_bf16_f32 v87, v78, v79
  v_add_f32 v61, v61, v79
  v_mfma_f32_16x16x32_bf16 v[68:71], a[92:95], a[44:47], v[68:71]
  v_exp_f32 v64, v64
  v_mfma_f32_16x16x32_bf16 v[132:135], a[128:131], v[84:87], v[132:135]
  ds_read_b128 a[168:171], v2 offset:26624
  v_add_f32 v62, v62, v64
  v_mfma_f32_16x16x32_bf16 v[148:151], a[132:135], v[84:87], v[148:151]
  v_exp_f32 v65, v65
  v_mfma_f32_16x16x32_bf16 v[164:167], a[136:139], v[84:87], v[164:167]
  v_cvt_pk_bf16_f32 v80, v64, v65
  v_add_f32 v62, v62, v65
  v_mfma_f32_16x16x32_bf16 v[180:183], a[140:143], v[84:87], v[180:183]
  v_exp_f32 v66, v66
  v_mfma_f32_16x16x32_bf16 v[196:199], a[144:147], v[84:87], v[196:199]
  ds_read_b128 a[172:175], v2 offset:27648
  v_add_f32 v62, v62, v66
  v_mfma_f32_16x16x32_bf16 v[212:215], a[148:151], v[84:87], v[212:215]
  v_exp_f32 v67, v67
  v_mfma_f32_16x16x32_bf16 v[228:231], a[152:155], v[84:87], v[228:231]
  v_cvt_pk_bf16_f32 v81, v66, v67
  v_add_f32 v62, v62, v67
  v_mfma_f32_16x16x32_bf16 v[244:247], a[156:159], v[84:87], v[244:247]
  v_exp_f32 v68, v68
  v_mfma_f32_16x16x32_bf16 v[72:75], a[64:67], a[48:51], v[120:123]
  ds_read_b128 a[176:179], v2 offset:28672
  v_add_f32 v62, v62, v68
  v_mfma_f32_16x16x32_bf16 v[72:75], a[68:71], a[52:55], v[72:75]
  v_exp_f32 v69, v69
  v_mfma_f32_16x16x32_bf16 v[72:75], a[72:75], a[56:59], v[72:75]
  global_load_lds_dwordx4 v4, s[38:39] offset:2048
  v_cvt_pk_bf16_f32 v82, v68, v69
  v_add_f32 v62, v62, v69
  v_mfma_f32_16x16x32_bf16 v[72:75], a[76:79], a[60:63], v[72:75]
  v_exp_f32 v70, v70
  v_mfma_f32_16x16x32_bf16 v[76:79], a[80:83], a[48:51], v[124:127]
  ds_read_b128 a[180:183], v2 offset:29696
  v_add_f32 v62, v62, v70
  v_mfma_f32_16x16x32_bf16 v[76:79], a[84:87], a[52:55], v[76:79]
  v_exp_f32 v71, v71
  v_mfma_f32_16x16x32_bf16 v[76:79], a[88:91], a[56:59], v[76:79]
  v_cvt_pk_bf16_f32 v83, v70, v71
  v_add_f32 v62, v62, v71
  v_mfma_f32_16x16x32_bf16 v[76:79], a[92:95], a[60:63], v[76:79]
  v_exp_f32 v72, v72
  v_mfma_f32_16x16x32_bf16 v[136:139], a[128:131], v[80:83], v[136:139]
  ds_read_b128 a[184:187], v2 offset:30720
  v_add_f32 v63, v63, v72
  v_mfma_f32_16x16x32_bf16 v[152:155], a[132:135], v[80:83], v[152:155]
  v_exp_f32 v73, v73
  v_mfma_f32_16x16x32_bf16 v[168:171], a[136:139], v[80:83], v[168:171]
  v_cvt_pk_bf16_f32 v84, v72, v73
  v_add_f32 v63, v63, v73
  v_mfma_f32_16x16x32_bf16 v[184:187], a[140:143], v[80:83], v[184:187]
  v_exp_f32 v74, v74
  v_mfma_f32_16x16x32_bf16 v[200:203], a[144:147], v[80:83], v[200:203]
  ds_read_b128 a[188:191], v2 offset:31744
  v_add_f32 v63, v63, v74
  v_mfma_f32_16x16x32_bf16 v[216:219], a[148:151], v[80:83], v[216:219]
  v_exp_f32 v75, v75
  v_mfma_f32_16x16x32_bf16 v[232:235], a[152:155], v[80:83], v[232:235]
  v_cvt_pk_bf16_f32 v85, v74, v75
  v_add_f32 v63, v63, v75
  v_mfma_f32_16x16x32_bf16 v[248:251], a[156:159], v[80:83], v[248:251]
  s_waitcnt lgkmcnt(8)
  global_load_lds_dwordx4 v4, s[38:39] offset:3072
  v_exp_f32 v76, v76
  v_mfma_f32_16x16x32_bf16 v[64:67], a[96:99], a[0:3], v[96:99]
  ds_read_b128 a[64:67], v2 offset:32768
  v_add_f32 v63, v63, v76
  v_mfma_f32_16x16x32_bf16 v[64:67], a[100:103], a[4:7], v[64:67]
  v_exp_f32 v77, v77
  v_mfma_f32_16x16x32_bf16 v[64:67], a[104:107], a[8:11], v[64:67]
  v_cvt_pk_bf16_f32 v86, v76, v77
  v_add_f32 v63, v63, v77
  v_mfma_f32_16x16x32_bf16 v[64:67], a[108:111], a[12:15], v[64:67]
  v_exp_f32 v78, v78
  v_mfma_f32_16x16x32_bf16 v[68:71], a[112:115], a[0:3], v[100:103]
  ds_read_b128 a[68:71], v2 offset:33792
  v_add_f32 v63, v63, v78
  v_mfma_f32_16x16x32_bf16 v[68:71], a[116:119], a[4:7], v[68:71]
  v_exp_f32 v79, v79
  v_mfma_f32_16x16x32_bf16 v[68:71], a[120:123], a[8:11], v[68:71]
  v_cvt_pk_bf16_f32 v87, v78, v79
  v_add_f32 v63, v63, v79
  v_mfma_f32_16x16x32_bf16 v[68:71], a[124:127], a[12:15], v[68:71]
  v_exp_f32 v64, v64
  v_mfma_f32_16x16x32_bf16 v[140:143], a[128:131], v[84:87], v[140:143]
  ds_read_b128 a[72:75], v2 offset:34816
  v_add_f32 v60, v60, v64
  v_mfma_f32_16x16x32_bf16 v[156:159], a[132:135], v[84:87], v[156:159]
  s_add_u32 s38, s54, 49152
  s_addc_u32 s39, s55, 0
  v_exp_f32 v65, v65
  v_mfma_f32_16x16x32_bf16 v[172:175], a[136:139], v[84:87], v[172:175]
  s_add_u32 m0, s37, 49152
  v_cvt_pk_bf16_f32 v80, v64, v65
  v_add_f32 v60, v60, v65
  v_mfma_f32_16x16x32_bf16 v[188:191], a[140:143], v[84:87], v[188:191]
  global_load_lds_dwordx4 v4, s[38:39] offset:0
  v_exp_f32 v66, v66
  v_mfma_f32_16x16x32_bf16 v[204:207], a[144:147], v[84:87], v[204:207]
  ds_read_b128 a[76:79], v2 offset:35840
  v_add_f32 v60, v60, v66
  v_mfma_f32_16x16x32_bf16 v[220:223], a[148:151], v[84:87], v[220:223]
  v_exp_f32 v67, v67
  v_mfma_f32_16x16x32_bf16 v[236:239], a[152:155], v[84:87], v[236:239]
  v_cvt_pk_bf16_f32 v81, v66, v67
  v_add_f32 v60, v60, v67
  v_mfma_f32_16x16x32_bf16 v[252:255], a[156:159], v[84:87], v[252:255]
  v_exp_f32 v68, v68
  v_mfma_f32_16x16x32_bf16 v[72:75], a[96:99], a[16:19], v[104:107]
  ds_read_b128 a[80:83], v2 offset:36864
  v_add_f32 v60, v60, v68
  v_mfma_f32_16x16x32_bf16 v[72:75], a[100:103], a[20:23], v[72:75]
  v_exp_f32 v69, v69
  v_mfma_f32_16x16x32_bf16 v[72:75], a[104:107], a[24:27], v[72:75]
  v_cvt_pk_bf16_f32 v82, v68, v69
  v_add_f32 v60, v60, v69
  v_mfma_f32_16x16x32_bf16 v[72:75], a[108:111], a[28:31], v[72:75]
  v_exp_f32 v70, v70
  v_mfma_f32_16x16x32_bf16 v[76:79], a[112:115], a[16:19], v[108:111]
  ds_read_b128 a[84:87], v2 offset:37888
  v_add_f32 v60, v60, v70
  v_mfma_f32_16x16x32_bf16 v[76:79], a[116:119], a[20:23], v[76:79]
  v_exp_f32 v71, v71
  v_mfma_f32_16x16x32_bf16 v[76:79], a[120:123], a[24:27], v[76:79]
  v_cvt_pk_bf16_f32 v83, v70, v71
  v_add_f32 v60, v60, v71
  v_mfma_f32_16x16x32_bf16 v[76:79], a[124:127], a[28:31], v[76:79]
  s_waitcnt lgkmcnt(6)
  global_load_lds_dwordx4 v4, s[38:39] offset:1024
  v_exp_f32 v72, v72
  v_mfma_f32_16x16x32_bf16 v[128:131], a[160:163], v[80:83], v[128:131]
  ds_read_b128 a[88:91], v2 offset:38912
  v_add_f32 v61, v61, v72
  v_mfma_f32_16x16x32_bf16 v[144:147], a[164:167], v[80:83], v[144:147]
  v_exp_f32 v73, v73
  v_mfma_f32_16x16x32_bf16 v[160:163], a[168:171], v[80:83], v[160:163]
  v_cvt_pk_bf16_f32 v84, v72, v73
  v_add_f32 v61, v61, v73
  v_mfma_f32_16x16x32_bf16 v[176:179], a[172:175], v[80:83], v[176:179]
  v_exp_f32 v74, v74
  v_mfma_f32_16x16x32_bf16 v[192:195], a[176:179], v[80:83], v[192:195]
  ds_read_b128 a[92:95], v2 offset:39936
  v_add_f32 v61, v61, v74
  v_mfma_f32_16x16x32_bf16 v[208:211], a[180:183], v[80:83], v[208:211]
  v_exp_f32 v75, v75
  v_mfma_f32_16x16x32_bf16 v[224:227], a[184:187], v[80:83], v[224:227]
  v_cvt_pk_bf16_f32 v85, v74, v75
  v_add_f32 v61, v61, v75
  v_mfma_f32_16x16x32_bf16 v[240:243], a[188:191], v[80:83], v[240:243]
  v_exp_f32 v76, v76
  v_mfma_f32_16x16x32_bf16 v[64:67], a[96:99], a[32:35], v[112:115]
  ds_read_b128 a[128:131], v2 offset:40960
  v_add_f32 v61, v61, v76
  v_mfma_f32_16x16x32_bf16 v[64:67], a[100:103], a[36:39], v[64:67]
  v_exp_f32 v77, v77
  v_mfma_f32_16x16x32_bf16 v[64:67], a[104:107], a[40:43], v[64:67]
  v_cvt_pk_bf16_f32 v86, v76, v77
  v_add_f32 v61, v61, v77
  v_mfma_f32_16x16x32_bf16 v[64:67], a[108:111], a[44:47], v[64:67]
  global_load_lds_dwordx4 v4, s[38:39] offset:2048
  v_exp_f32 v78, v78
  v_mfma_f32_16x16x32_bf16 v[68:71], a[112:115], a[32:35], v[116:119]
  ds_read_b128 a[132:135], v2 offset:41984
  v_add_f32 v61, v61, v78
  v_mfma_f32_16x16x32_bf16 v[68:71], a[116:119], a[36:39], v[68:71]
  v_exp_f32 v79, v79
  v_mfma_f32_16x16x32_bf16 v[68:71], a[120:123], a[40:43], v[68:71]
  v_cvt_pk_bf16_f32 v87, v78, v79
  v_add_f32 v61, v61, v79
  v_mfma_f32_16x16x32_bf16 v[68:71], a[124:127], a[44:47], v[68:71]
  v_exp_f32 v64, v64
  v_mfma_f32_16x16x32_bf16 v[132:135], a[160:163], v[84:87], v[132:135]
  ds_read_b128 a[136:139], v2 offset:43008
  v_add_f32 v62, v62, v64
  v_mfma_f32_16x16x32_bf16 v[148:151], a[164:167], v[84:87], v[148:151]
  v_exp_f32 v65, v65
  v_mfma_f32_16x16x32_bf16 v[164:167], a[168:171], v[84:87], v[164:167]
  v_cvt_pk_bf16_f32 v80, v64, v65
  v_add_f32 v62, v62, v65
  v_mfma_f32_16x16x32_bf16 v[180:183], a[172:175], v[84:87], v[180:183]
  v_exp_f32 v66, v66
  v_mfma_f32_16x16x32_bf16 v[196:199], a[176:179], v[84:87], v[196:199]
  ds_read_b128 a[140:143], v2 offset:44032
  v_add_f32 v62, v62, v66
  v_mfma_f32_16x16x32_bf16 v[212:215], a[180:183], v[84:87], v[212:215]
  v_exp_f32 v67, v67
  v_mfma_f32_16x16x32_bf16 v[228:231], a[184:187], v[84:87], v[228:231]
  v_cvt_pk_bf16_f32 v81, v66, v67
  v_add_f32 v62, v62, v67
  v_mfma_f32_16x16x32_bf16 v[244:247], a[188:191], v[84:87], v[244:247]
  global_load_lds_dwordx4 v4, s[38:39] offset:3072
  v_exp_f32 v68, v68
  v_mfma_f32_16x16x32_bf16 v[72:75], a[96:99], a[48:51], v[120:123]
  ds_read_b128 a[144:147], v2 offset:45056
  v_add_f32 v62, v62, v68
  v_mfma_f32_16x16x32_bf16 v[72:75], a[100:103], a[52:55], v[72:75]
  v_exp_f32 v69, v69
  v_mfma_f32_16x16x32_bf16 v[72:75], a[104:107], a[56:59], v[72:75]
  v_cvt_pk_bf16_f32 v82, v68, v69
  v_add_f32 v62, v62, v69
  v_mfma_f32_16x16x32_bf16 v[72:75], a[108:111], a[60:63], v[72:75]
  v_exp_f32 v70, v70
  v_mfma_f32_16x16x32_bf16 v[76:79], a[112:115], a[48:51], v[124:127]
  ds_read_b128 a[148:151], v2 offset:46080
  v_add_f32 v62, v62, v70
  v_mfma_f32_16x16x32_bf16 v[76:79], a[116:119], a[52:55], v[76:79]
  v_exp_f32 v71, v71
  v_mfma_f32_16x16x32_bf16 v[76:79], a[120:123], a[56:59], v[76:79]
  v_cvt_pk_bf16_f32 v83, v70, v71
  v_add_f32 v62, v62, v71
  v_mfma_f32_16x16x32_bf16 v[76:79], a[124:127], a[60:63], v[76:79]
  v_exp_f32 v72, v72
  v_mfma_f32_16x16x32_bf16 v[136:139], a[160:163], v[80:83], v[136:139]
  ds_read_b128 a[152:155], v2 offset:47104
  v_add_f32 v63, v63, v72
  v_mfma_f32_16x16x32_bf16 v[152:155], a[164:167], v[80:83], v[152:155]
  v_exp_f32 v73, v73
  v_mfma_f32_16x16x32_bf16 v[168:171], a[168:171], v[80:83], v[168:171]
  v_cvt_pk_bf16_f32 v84, v72, v73
  v_add_f32 v63, v63, v73
  v_mfma_f32_16x16x32_bf16 v[184:187], a[172:175], v[80:83], v[184:187]
  v_exp_f32 v74, v74
  v_mfma_f32_16x16x32_bf16 v[200:203], a[176:179], v[80:83], v[200:203]
  ds_read_b128 a[156:159], v2 offset:48128
  v_add_f32 v63, v63, v74
  v_mfma_f32_16x16x32_bf16 v[216:219], a[180:183], v[80:83], v[216:219]
  v_exp_f32 v75, v75
  v_mfma_f32_16x16x32_bf16 v[232:235], a[184:187], v[80:83], v[232:235]
  v_cvt_pk_bf16_f32 v85, v74, v75
  v_add_f32 v63, v63, v75
  v_mfma_f32_16x16x32_bf16 v[248:251], a[188:191], v[80:83], v[248:251]
  s_waitcnt lgkmcnt(8)
  v_exp_f32 v76, v76
  v_mfma_f32_16x16x32_bf16 v[64:67], a[64:67], a[0:3], v[96:99]
  ds_read_b128 a[96:99], v2 offset:49152
  v_add_f32 v63, v63, v76
  v_mfma_f32_16x16x32_bf16 v[64:67], a[68:71], a[4:7], v[64:67]
  v_exp_f32 v77, v77
  v_mfma_f32_16x16x32_bf16 v[64:67], a[72:75], a[8:11], v[64:67]
  v_cvt_pk_bf16_f32 v86, v76, v77
  v_add_f32 v63, v63, v77
  v_mfma_f32_16x16x32_bf16 v[64:67], a[76:79], a[12:15], v[64:67]
  ds_read_b128 a[100:103], v2 offset:50176
  v_exp_f32 v78, v78
  v_mfma_f32_16x16x32_bf16 v[68:71], a[80:83], a[0:3], v[100:103]
  v_add_f32 v63, v63, v78
  v_mfma_f32_16x16x32_bf16 v[68:71], a[84:87], a[4:7], v[68:71]
  v_exp_f32 v79, v79
  v_mfma_f32_16x16x32_bf16 v[68:71], a[88:91], a[8:11], v[68:71]
  v_cvt_pk_bf16_f32 v87, v78, v79
  v_add_f32 v63, v63, v79
  v_mfma_f32_16x16x32_bf16 v[68:71], a[92:95], a[12:15], v[68:71]
  ds_read_b128 a[104:107], v2 offset:51200
  v_exp_f32 v64, v64
  v_mfma_f32_16x16x32_bf16 v[140:143], a[160:163], v[84:87], v[140:143]
  v_add_f32 v60, v60, v64
  v_mfma_f32_16x16x32_bf16 v[156:159], a[164:167], v[84:87], v[156:159]
  v_exp_f32 v65, v65
  v_mfma_f32_16x16x32_bf16 v[172:175], a[168:171], v[84:87], v[172:175]
  ds_read_b128 a[108:111], v2 offset:52224
  v_cvt_pk_bf16_f32 v80, v64, v65
  v_add_f32 v60, v60, v65
  v_mfma_f32_16x16x32_bf16 v[188:191], a[172:175], v[84:87], v[188:191]
  v_exp_f32 v66, v66
  v_mfma_f32_16x16x32_bf16 v[204:207], a[176:179], v[84:87], v[204:207]
  v_add_f32 v60, v60, v66
  v_mfma_f32_16x16x32_bf16 v[220:223], a[180:183], v[84:87], v[220:223]
  v_exp_f32 v67, v67
  v_mfma_f32_16x16x32_bf16 v[236:239], a[184:187], v[84:87], v[236:239]
  ds_read_b128 a[112:115], v2 offset:53248
  v_cvt_pk_bf16_f32 v81, v66, v67
  v_add_f32 v60, v60, v67
  v_mfma_f32_16x16x32_bf16 v[252:255], a[188:191], v[84:87], v[252:255]
  v_exp_f32 v68, v68
  v_mfma_f32_16x16x32_bf16 v[72:75], a[64:67], a[16:19], v[104:107]
  v_add_f32 v60, v60, v68
  v_mfma_f32_16x16x32_bf16 v[72:75], a[68:71], a[20:23], v[72:75]
  ds_read_b128 a[116:119], v2 offset:54272
  v_exp_f32 v69, v69
  v_mfma_f32_16x16x32_bf16 v[72:75], a[72:75], a[24:27], v[72:75]
  v_cvt_pk_bf16_f32 v82, v68, v69
  v_add_f32 v60, v60, v69
  v_mfma_f32_16x16x32_bf16 v[72:75], a[76:79], a[28:31], v[72:75]
  v_exp_f32 v70, v70
  v_mfma_f32_16x16x32_bf16 v[76:79], a[80:83], a[16:19], v[108:111]
  v_add_f32 v60, v60, v70
  v_mfma_f32_16x16x32_bf16 v[76:79], a[84:87], a[20:23], v[76:79]
  ds_read_b128 a[120:123], v2 offset:55296
  v_exp_f32 v71, v71
  v_mfma_f32_16x16x32_bf16 v[76:79], a[88:91], a[24:27], v[76:79]
  v_cvt_pk_bf16_f32 v83, v70, v71
  v_add_f32 v60, v60, v71
  v_mfma_f32_16x16x32_bf16 v[76:79], a[92:95], a[28:31], v[76:79]
  s_waitcnt lgkmcnt(7)
  v_exp_f32 v72, v72
  v_mfma_f32_16x16x32_bf16 v[128:131], a[128:131], v[80:83], v[128:131]
  ds_read_b128 a[124:127], v2 offset:56320
  v_add_f32 v61, v61, v72
  v_mfma_f32_16x16x32_bf16 v[144:147], a[132:135], v[80:83], v[144:147]
  v_exp_f32 v73, v73
  v_mfma_f32_16x16x32_bf16 v[160:163], a[136:139], v[80:83], v[160:163]
  v_cvt_pk_bf16_f32 v84, v72, v73
  v_add_f32 v61, v61, v73
  v_mfma_f32_16x16x32_bf16 v[176:179], a[140:143], v[80:83], v[176:179]
  v_exp_f32 v74, v74
  v_mfma_f32_16x16x32_bf16 v[192:195], a[144:147], v[80:83], v[192:195]
  ds_read_b128 a[160:163], v2 offset:57344
  v_add_f32 v61, v61, v74
  v_mfma_f32_16x16x32_bf16 v[208:211], a[148:151], v[80:83], v[208:211]
  v_exp_f32 v75, v75
  v_mfma_f32_16x16x32_bf16 v[224:227], a[152:155], v[80:83], v[224:227]
  v_cvt_pk_bf16_f32 v85, v74, v75
  v_add_f32 v61, v61, v75
  v_mfma_f32_16x16x32_bf16 v[240:243], a[156:159], v[80:83], v[240:243]
  ds_read_b128 a[164:167], v2 offset:58368
  v_exp_f32 v76, v76
  v_mfma_f32_16x16x32_bf16 v[64:67], a[64:67], a[32:35], v[112:115]
  v_add_f32 v61, v61, v76
  v_mfma_f32_16x16x32_bf16 v[64:67], a[68:71], a[36:39], v[64:67]
  v_exp_f32 v77, v77
  v_mfma_f32_16x16x32_bf16 v[64:67], a[72:75], a[40:43], v[64:67]
  v_cvt_pk_bf16_f32 v86, v76, v77
  v_add_f32 v61, v61, v77
  v_mfma_f32_16x16x32_bf16 v[64:67], a[76:79], a[44:47], v[64:67]
  ds_read_b128 a[168:171], v2 offset:59392
  v_exp_f32 v78, v78
  v_mfma_f32_16x16x32_bf16 v[68:71], a[80:83], a[32:35], v[116:119]
  v_add_f32 v61, v61, v78
  v_mfma_f32_16x16x32_bf16 v[68:71], a[84:87], a[36:39], v[68:71]
  v_exp_f32 v79, v79
  v_mfma_f32_16x16x32_bf16 v[68:71], a[88:91], a[40:43], v[68:71]
  ds_read_b128 a[172:175], v2 offset:60416
  v_cvt_pk_bf16_f32 v87, v78, v79
  v_add_f32 v61, v61, v79
  v_mfma_f32_16x16x32_bf16 v[68:71], a[92:95], a[44:47], v[68:71]
  v_exp_f32 v64, v64
  v_mfma_f32_16x16x32_bf16 v[132:135], a[128:131], v[84:87], v[132:135]
  v_add_f32 v62, v62, v64
  v_mfma_f32_16x16x32_bf16 v[148:151], a[132:135], v[84:87], v[148:151]
  v_exp_f32 v65, v65
  v_mfma_f32_16x16x32_bf16 v[164:167], a[136:139], v[84:87], v[164:167]
  ds_read_b128 a[176:179], v2 offset:61440
  v_cvt_pk_bf16_f32 v80, v64, v65
  v_add_f32 v62, v62, v65
  v_mfma_f32_16x16x32_bf16 v[180:183], a[140:143], v[84:87], v[180:183]
  v_exp_f32 v66, v66
  v_mfma_f32_16x16x32_bf16 v[196:199], a[144:147], v[84:87], v[196:199]
  v_add_f32 v62, v62, v66
  v_mfma_f32_16x16x32_bf16 v[212:215], a[148:151], v[84:87], v[212:215]
  ds_read_b128 a[180:183], v2 offset:62464
  v_exp_f32 v67, v67
  v_mfma_f32_16x16x32_bf16 v[228:231], a[152:155], v[84:87], v[228:231]
  v_cvt_pk_bf16_f32 v81, v66, v67
  v_add_f32 v62, v62, v67
  v_mfma_f32_16x16x32_bf16 v[244:247], a[156:159], v[84:87], v[244:247]
  v_exp_f32 v68, v68
  v_mfma_f32_16x16x32_bf16 v[72:75], a[64:67], a[48:51], v[120:123]
  v_add_f32 v62, v62, v68
  v_mfma_f32_16x16x32_bf16 v[72:75], a[68:71], a[52:55], v[72:75]
  ds_read_b128 a[184:187], v2 offset:63488
  v_exp_f32 v69, v69
  v_mfma_f32_16x16x32_bf16 v[72:75], a[72:75], a[56:59], v[72:75]
  v_cvt_pk_bf16_f32 v82, v68, v69
  v_add_f32 v62, v62, v69
  v_mfma_f32_16x16x32_bf16 v[72:75], a[76:79], a[60:63], v[72:75]
  v_exp_f32 v70, v70
  v_mfma_f32_16x16x32_bf16 v[76:79], a[80:83], a[48:51], v[124:127]
  ds_read_b128 a[188:191], v2 offset:64512
  v_add_f32 v62, v62, v70
  v_mfma_f32_16x16x32_bf16 v[76:79], a[84:87], a[52:55], v[76:79]
  v_exp_f32 v71, v71
  v_mfma_f32_16x16x32_bf16 v[76:79], a[88:91], a[56:59], v[76:79]
  v_cvt_pk_bf16_f32 v83, v70, v71
  v_add_f32 v62, v62, v71
  v_mfma_f32_16x16x32_bf16 v[76:79], a[92:95], a[60:63], v[76:79]
  v_exp_f32 v72, v72
  v_mfma_f32_16x16x32_bf16 v[136:139], a[128:131], v[80:83], v[136:139]
  v_add_f32 v63, v63, v72
  v_mfma_f32_16x16x32_bf16 v[152:155], a[132:135], v[80:83], v[152:155]
  v_exp_f32 v73, v73
  v_mfma_f32_16x16x32_bf16 v[168:171], a[136:139], v[80:83], v[168:171]
  v_cvt_pk_bf16_f32 v84, v72, v73
  v_add_f32 v63, v63, v73
  v_mfma_f32_16x16x32_bf16 v[184:187], a[140:143], v[80:83], v[184:187]
  v_exp_f32 v74, v74
  v_mfma_f32_16x16x32_bf16 v[200:203], a[144:147], v[80:83], v[200:203]
  v_add_f32 v63, v63, v74
  v_mfma_f32_16x16x32_bf16 v[216:219], a[148:151], v[80:83], v[216:219]
  v_exp_f32 v75, v75
  v_mfma_f32_16x16x32_bf16 v[232:235], a[152:155], v[80:83], v[232:235]
  v_cvt_pk_bf16_f32 v85, v74, v75
  v_add_f32 v63, v63, v75
  v_mfma_f32_16x16x32_bf16 v[248:251], a[156:159], v[80:83], v[248:251]
  s_waitcnt lgkmcnt(8)
  v_exp_f32 v76, v76
  s_waitcnt vmcnt(0) lgkmcnt(0)
  s_barrier
  v_xor_b32 v2, 65536, v2
  v_mfma_f32_16x16x32_bf16 v[64:67], a[96:99], a[0:3], v[96:99]
  ds_read_b128 a[64:67], v2 offset:0
  v_add_f32 v63, v63, v76
  v_mfma_f32_16x16x32_bf16 v[64:67], a[100:103], a[4:7], v[64:67]
  s_add_u32 s38, s34, 0
  s_addc_u32 s39, s35, 0
  v_exp_f32 v77, v77
  v_mfma_f32_16x16x32_bf16 v[64:67], a[104:107], a[8:11], v[64:67]
  s_add_u32 m0, s36, 0
  v_cvt_pk_bf16_f32 v86, v76, v77
  v_add_f32 v63, v63, v77
  v_mfma_f32_16x16x32_bf16 v[64:67], a[108:111], a[12:15], v[64:67]
  global_load_lds_dwordx4 v4, s[38:39] offset:0
  v_exp_f32 v78, v78
  v_mfma_f32_16x16x32_bf16 v[68:71], a[112:115], a[0:3], v[100:103]
  ds_read_b128 a[68:71], v2 offset:1024
  v_add_f32 v63, v63, v78
  v_mfma_f32_16x16x32_bf16 v[68:71], a[116:119], a[4:7], v[68:71]
  v_exp_f32 v79, v79
  v_mfma_f32_16x16x32_bf16 v[68:71], a[120:123], a[8:11], v[68:71]
  v_cvt_pk_bf16_f32 v87, v78, v79
  v_add_f32 v63, v63, v79
  v_mfma_f32_16x16x32_bf16 v[68:71], a[124:127], a[12:15], v[68:71]
  v_exp_f32 v64, v64
  v_mfma_f32_16x16x32_bf16 v[140:143], a[128:131], v[84:87], v[140:143]
  ds_read_b128 a[72:75], v2 offset:2048
  v_add_f32 v60, v60, v64
  v_mfma_f32_16x16x32_bf16 v[156:159], a[132:135], v[84:87], v[156:159]
  v_exp_f32 v65, v65
  v_mfma_f32_16x16x32_bf16 v[172:175], a[136:139], v[84:87], v[172:175]
  v_cvt_pk_bf16_f32 v80, v64, v65
  v_add_f32 v60, v60, v65
  v_mfma_f32_16x16x32_bf16 v[188:191], a[140:143], v[84:87], v[188:191]
  v_exp_f32 v66, v66
  v_mfma_f32_16x16x32_bf16 v[204:207], a[144:147], v[84:87], v[204:207]
  global_load_lds_dwordx4 v4, s[38:39] offset:1024
  ds_read_b128 a[76:79], v2 offset:3072
  v_add_f32 v60, v60, v66
  v_mfma_f32_16x16x32_bf16 v[220:223], a[148:151], v[84:87], v[220:223]
  v_exp_f32 v67, v67
  v_mfma_f32_16x16x32_bf16 v[236:239], a[152:155], v[84:87], v[236:239]
  v_cvt_pk_bf16_f32 v81, v66, v67
  v_add_f32 v60, v60, v67
  v_mfma_f32_16x16x32_bf16 v[252:255], a[156:159], v[84:87], v[252:255]
  v_exp_f32 v68, v68
  v_mfma_f32_16x16x32_bf16 v[72:75], a[96:99], a[16:19], v[104:107]
  ds_read_b128 a[80:83], v2 offset:4096
  v_add_f32 v60, v60, v68
  v_mfma_f32_16x16x32_bf16 v[72:75], a[100:103], a[20:23], v[72:75]
  v_exp_f32 v69, v69
  v_mfma_f32_16x16x32_bf16 v[72:75], a[104:107], a[24:27], v[72:75]
  v_cvt_pk_bf16_f32 v82, v68, v69
  v_add_f32 v60, v60, v69
  v_mfma_f32_16x16x32_bf16 v[72:75], a[108:111], a[28:31], v[72:75]
  v_exp_f32 v70, v70
  v_mfma_f32_16x16x32_bf16 v[76:79], a[112:115], a[16:19], v[108:111]
  ds_read_b128 a[84:87], v2 offset:5120
  v_add_f32 v60, v60, v70
  v_mfma_f32_16x16x32_bf16 v[76:79], a[116:119], a[20:23], v[76:79]
  v_exp_f32 v71, v71
  v_mfma_f32_16x16x32_bf16 v[76:79], a[120:123], a[24:27], v[76:79]
  global_load_lds_dwordx4 v4, s[38:39] offset:2048
  v_cvt_pk_bf16_f32 v83, v70, v71
  v_add_f32 v60, v60, v71
  v_mfma_f32_16x16x32_bf16 v[76:79], a[124:127], a[28:31], v[76:79]
  s_waitcnt lgkmcnt(6)
  v_exp_f32 v72, v72
  v_mfma_f32_16x16x32_bf16 v[128:131], a[160:163], v[80:83], v[128:131]
  ds_read_b128 a[88:91], v2 offset:6144
  v_add_f32 v61, v61, v72
  v_mfma_f32_16x16x32_bf16 v[144:147], a[164:167], v[80:83], v[144:147]
  v_exp_f32 v73, v73
  v_mfma_f32_16x16x32_bf16 v[160:163], a[168:171], v[80:83], v[160:163]
  v_cvt_pk_bf16_f32 v84, v72, v73
  v_add_f32 v61, v61, v73
  v_mfma_f32_16x16x32_bf16 v[176:179], a[172:175], v[80:83], v[176:179]
  v_exp_f32 v74, v74
  v_mfma_f32_16x16x32_bf16 v[192:195], a[176:179], v[80:83], v[192:195]
  ds_read_b128 a[92:95], v2 offset:7168
  v_add_f32 v61, v61, v74
  v_mfma_f32_16x16x32_bf16 v[208:211], a[180:183], v[80:83], v[208:211]
  v_exp_f32 v75, v75
  v_mfma_f32_16x16x32_bf16 v[224:227], a[184:187], v[80:83], v[224:227]
  v_cvt_pk_bf16_f32 v85, v74, v75
  v_add_f32 v61, v61, v75
  v_mfma_f32_16x16x32_bf16 v[240:243], a[188:191], v[80:83], v[240:243]
  v_exp_f32 v76, v76
  v_mfma_f32_16x16x32_bf16 v[64:67], a[96:99], a[32:35], v[112:115]
  global_load_lds_dwordx4 v4, s[38:39] offset:3072
  ds_read_b128 a[128:131], v2 offset:8192
  v_add_f32 v61, v61, v76
  v_mfma_f32_16x16x32_bf16 v[64:67], a[100:103], a[36:39], v[64:67]
  v_exp_f32 v77, v77
  v_mfma_f32_16x16x32_bf16 v[64:67], a[104:107], a[40:43], v[64:67]
  v_cvt_pk_bf16_f32 v86, v76, v77
  v_add_f32 v61, v61, v77
  v_mfma_f32_16x16x32_bf16 v[64:67], a[108:111], a[44:47], v[64:67]
  v_exp_f32 v78, v78
  v_mfma_f32_16x16x32_bf16 v[68:71], a[112:115], a[32:35], v[116:119]
  ds_read_b128 a[132:135], v2 offset:9216
  v_add_f32 v61, v61, v78
  v_mfma_f32_16x16x32_bf16 v[68:71], a[116:119], a[36:39], v[68:71]
  v_exp_f32 v79, v79
  v_mfma_f32_16x16x32_bf16 v[68:71], a[120:123], a[40:43], v[68:71]
  v_cvt_pk_bf16_f32 v87, v78, v79
  v_add_f32 v61, v61, v79
  v_mfma_f32_16x16x32_bf16 v[68:71], a[124:127], a[44:47], v[68:71]
  v_exp_f32 v64, v64
  v_mfma_f32_16x16x32_bf16 v[132:135], a[160:163], v[84:87], v[132:135]
  s_add_u32 s38, s34, 16384
  s_addc_u32 s39, s35, 0
  ds_read_b128 a[136:139], v2 offset:10240
  v_add_f32 v62, v62, v64
  v_mfma_f32_16x16x32_bf16 v[148:151], a[164:167], v[84:87], v[148:151]
  s_add_u32 m0, s36, 16384
  v_exp_f32 v65, v65
  v_mfma_f32_16x16x32_bf16 v[164:167], a[168:171], v[84:87], v[164:167]
  global_load_lds_dwordx4 v4, s[38:39] offset:0
  v_cvt_pk_bf16_f32 v80, v64, v65
  v_add_f32 v62, v62, v65
  v_mfma_f32_16x16x32_bf16 v[180:183], a[172:175], v[84:87], v[180:183]
  v_exp_f32 v66, v66
  v_mfma_f32_16x16x32_bf16 v[196:199], a[176:179], v[84:87], v[196:199]
  ds_read_b128 a[140:143], v2 offset:11264
  v_add_f32 v62, v62, v66
  v_mfma_f32_16x16x32_bf16 v[212:215], a[180:183], v[84:87], v[212:215]
  v_exp_f32 v67, v67
  v_mfma_f32_16x16x32_bf16 v[228:231], a[184:187], v[84:87], v[228:231]
  v_cvt_pk_bf16_f32 v81, v66, v67
  v_add_f32 v62, v62, v67
  v_mfma_f32_16x16x32_bf16 v[244:247], a[188:191], v[84:87], v[244:247]
  v_exp_f32 v68, v68
  v_mfma_f32_16x16x32_bf16 v[72:75], a[96:99], a[48:51], v[120:123]
  ds_read_b128 a[144:147], v2 offset:12288
  v_add_f32 v62, v62, v68
  v_mfma_f32_16x16x32_bf16 v[72:75], a[100:103], a[52:55], v[72:75]
  v_exp_f32 v69, v69
  v_mfma_f32_16x16x32_bf16 v[72:75], a[104:107], a[56:59], v[72:75]
  v_cvt_pk_bf16_f32 v82, v68, v69
  v_add_f32 v62, v62, v69
  v_mfma_f32_16x16x32_bf16 v[72:75], a[108:111], a[60:63], v[72:75]
  v_exp_f32 v70, v70
  v_mfma_f32_16x16x32_bf16 v[76:79], a[112:115], a[48:51], v[124:127]
  global_load_lds_dwordx4 v4, s[38:39] offset:1024
  ds_read_b128 a[148:151], v2 offset:13312
  v_add_f32 v62, v62, v70
  v_mfma_f32_16x16x32_bf16 v[76:79], a[116:119], a[52:55], v[76:79]
  v_exp_f32 v71, v71
  v_mfma_f32_16x16x32_bf16 v[76:79], a[120:123], a[56:59], v[76:79]
  v_cvt_pk_bf16_f32 v83, v70, v71
  v_add_f32 v62, v62, v71
  v_mfma_f32_16x16x32_bf16 v[76:79], a[124:127], a[60:63], v[76:79]
  v_exp_f32 v72, v72
  v_mfma_f32_16x16x32_bf16 v[136:139], a[160:163], v[80:83], v[136:139]
  ds_read_b128 a[152:155], v2 offset:14336
  v_add_f32 v63, v63, v72
  v_mfma_f32_16x16x32_bf16 v[152:155], a[164:167], v[80:83], v[152:155]
  v_exp_f32 v73, v73
  v_mfma_f32_16x16x32_bf16 v[168:171], a[168:171], v[80:83], v[168:171]
  v_cvt_pk_bf16_f32 v84, v72, v73
  v_add_f32 v63, v63, v73
  v_mfma_f32_16x16x32_bf16 v[184:187], a[172:175], v[80:83], v[184:187]
  v_exp_f32 v74, v74
  v_mfma_f32_16x16x32_bf16 v[200:203], a[176:179], v[80:83], v[200:203]
  ds_read_b128 a[156:159], v2 offset:15360
  v_add_f32 v63, v63, v74
  v_mfma_f32_16x16x32_bf16 v[216:219], a[180:183], v[80:83], v[216:219]
  v_exp_f32 v75, v75
  v_mfma_f32_16x16x32_bf16 v[232:235], a[184:187], v[80:83], v[232:235]
  v_cvt_pk_bf16_f32 v85, v74, v75
  v_add_f32 v63, v63, v75
  v_mfma_f32_16x16x32_bf16 v[248:251], a[188:191], v[80:83], v[248:251]
  s_waitcnt lgkmcnt(8)
  v_exp_f32 v76, v76
  s_mov_b64 s[54:55], s[34:35]
  s_mov_b32 s37, s36
  s_cmp_gt_u32 s52, 1
  s_cselect_b32 s38, 0x10000, 0
  s_add_u32 s34, s34, s38
  s_addc_u32 s35, s35, 0
  s_xor_b32 s36, s36, 65536
  s_max_u32 s52, s52, 1
  s_sub_u32 s52, s52, 1
  s_sub_u32 s53, s53, 1
  s_cmp_lg_u32 s53, 0
  s_cbranch_scc1 L_dual_loop
L_dual_diag:
  v_mfma_f32_16x16x32_bf16 v[64:67], a[64:67], a[0:3], v[96:99]
  s_add_u32 s38, s54, 16384
  s_addc_u32 s39, s55, 0
  ds_read_b128 a[96:99], v2 offset:16384
  v_add_f32 v63, v63, v76
  s_cmp_eq_u32 s22, 0
  s_cbranch_scc0 Ldd_m0_a
  v_cndmask_b32 v112, v88, v58, s[44:45]
  v_cndmask_b32 v113, v88, v58, s[46:47]
  v_cndmask_b32 v114, v88, v58, s[48:49]
  v_cndmask_b32 v115, v88, v58, s[50:51]
  v_mov_b32 v116, v88
  v_mov_b32 v117, v88
  v_mov_b32 v118, v88
  v_mov_b32 v119, v88
  v_cndmask_b32 v124, v88, v59, s[44:45]
  v_cndmask_b32 v125, v88, v59, s[46:47]
  v_cndmask_b32 v126, v88, v59, s[48:49]
  v_cndmask_b32 v127, v88, v59, s[50:51]
Ldd_m0_a:
  s_nop 1
  v_mfma_f32_16x16x32_bf16 v[64:67], a[68:71], a[4:7], v[64:67]
  s_add_u32 m0, s37, 16384
  v_exp_f32 v77, v77
  v_mfma_f32_16x16x32_bf16 v[64:67], a[72:75], a[8:11], v[64:67]
  global_load_lds_dwordx4 v4, s[38:39] offset:2048
  v_cvt_pk_bf16_f32 v86, v76, v77
  v_add_f32 v63, v63, v77
  v_mfma_f32_16x16x32_bf16 v[64:67], a[76:79], a[12:15], v[64:67]
  v_exp_f32 v78, v78
  v_mfma_f32_16x16x32_bf16 v[68:71], a[80:83], a[0:3], v[100:103]
  ds_read_b128 a[100:103], v2 offset:17408
  v_add_f32 v63, v63, v78
  v_mfma_f32_16x16x32_bf16 v[68:71], a[84:87], a[4:7], v[68:71]
  v_exp_f32 v79, v79
  v_mfma_f32_16x16x32_bf16 v[68:71], a[88:91], a[8:11], v[68:71]
  v_cvt_pk_bf16_f32 v87, v78, v79
  v_add_f32 v63, v63, v79
  v_mfma_f32_16x16x32_bf16 v[68:71], a[92:95], a[12:15], v[68:71]
  v_exp_f32 v64, v64
  v_mfma_f32_16x16x32_bf16 v[140:143], a[160:163], v[84:87], v[140:143]
  ds_read_b128 a[104:107], v2 offset:18432
  v_add_f32 v60, v60, v64
  v_mfma_f32_16x16x32_bf16 v[156:159], a[164:167], v[84:87], v[156:159]
  v_exp_f32 v65, v65
  v_mfma_f32_16x16x32_bf16 v[172:175], a[168:171], v[84:87], v[172:175]
  v_cvt_pk_bf16_f32 v80, v64, v65
  v_add_f32 v60, v60, v65
  v_mfma_f32_16x16x32_bf16 v[188:191], a[172:175], v[84:87], v[188:191]
  v_exp_f32 v66, v66
  v_mfma_f32_16x16x32_bf16 v[204:207], a[176:179], v[84:87], v[204:207]
  ds_read_b128 a[108:111], v2 offset:19456
  v_add_f32 v60, v60, v66
  v_mfma_f32_16x16x32_bf16 v[220:223], a[180:183], v[84:87], v[220:223]
  v_exp_f32 v67, v67
  v_mfma_f32_16x16x32_bf16 v[236:239], a[184:187], v[84:87], v[236:239]
  global_load_lds_dwordx4 v4, s[38:39] offset:3072
  v_cvt_pk_bf16_f32 v81, v66, v67
  v_add_f32 v60, v60, v67
  v_mfma_f32_16x16x32_bf16 v[252:255], a[188:191], v[84:87], v[252:255]
  v_exp_f32 v68, v68
  v_mfma_f32_16x16x32_bf16 v[72:75], a[64:67], a[16:19], v[104:107]
  ds_read_b128 a[112:115], v2 offset:20480
  v_add_f32 v60, v60, v68
  v_mfma_f32_16x16x32_bf16 v[72:75], a[68:71], a[20:23], v[72:75]
  v_exp_f32 v69, v69
  v_mfma_f32_16x16x32_bf16 v[72:75], a[72:75], a[24:27], v[72:75]
  v_cvt_pk_bf16_f32 v82, v68, v69
  v_add_f32 v60, v60, v69
  v_mfma_f32_16x16x32_bf16 v[72:75], a[76:79], a[28:31], v[72:75]
  v_exp_f32 v70, v70
  v_mfma_f32_16x16x32_bf16 v[76:79], a[80:83], a[16:19], v[108:111]
  ds_read_b128 a[116:119], v2 offset:21504
  v_add_f32 v60, v60, v70
  v_mfma_f32_16x16x32_bf16 v[76:79], a[84:87], a[20:23], v[76:79]
  v_exp_f32 v71, v71
  v_mfma_f32_16x16x32_bf16 v[76:79], a[88:91], a[24:27], v[76:79]
  v_cvt_pk_bf16_f32 v83, v70, v71
  v_add_f32 v60, v60, v71
  v_mfma_f32_16x16x32_bf16 v[76:79], a[92:95], a[28:31], v[76:79]
  s_waitcnt lgkmcnt(6)
  v_exp_f32 v72, v72
  v_mfma_f32_16x16x32_bf16 v[128:131], a[128:131], v[80:83], v[128:131]
  s_add_u32 s38, s54, 32768
  s_addc_u32 s39, s55, 0
  ds_read_b128 a[120:123], v2 offset:22528
  v_add_f32 v61, v61, v72
  v_mfma_f32_16x16x32_bf16 v[144:147], a[132:135], v[80:83], v[144:147]
  s_add_u32 m0, s37, 32768
  v_exp_f32 v73, v73
  v_mfma_f32_16x16x32_bf16 v[160:163], a[136:139], v[80:83], v[160:163]
  global_load_lds_dwordx4 v4, s[38:39] offset:0
  v_cvt_pk_bf16_f32 v84, v72, v73
  v_add_f32 v61, v61, v73
  v_mfma_f32_16x16x32_bf16 v[176:179], a[140:143], v[80:83], v[176:179]
  v_exp_f32 v74, v74
  v_mfma_f32_16x16x32_bf16 v[192:195], a[144:147], v[80:83], v[192:195]
  ds_read_b128 a[124:127], v2 offset:23552
  v_add_f32 v61, v61, v74
  v_mfma_f32_16x16x32_bf16 v[208:211], a[148:151], v[80:83], v[208:211]
  v_exp_f32 v75, v75
  v_mfma_f32_16x16x32_bf16 v[224:227], a[152:155], v[80:83], v[224:227]
  v_cvt_pk_bf16_f32 v85, v74, v75
  v_add_f32 v61, v61, v75
  v_mfma_f32_16x16x32_bf16 v[240:243], a[156:159], v[80:83], v[240:243]
  v_exp_f32 v76, v76
  v_mfma_f32_16x16x32_bf16 v[64:67], a[64:67], a[32:35], v[112:115]
  ds_read_b128 a[160:163], v2 offset:24576
  v_add_f32 v61, v61, v76
  v_mfma_f32_16x16x32_bf16 v[64:67], a[68:71], a[36:39], v[64:67]
  v_exp_f32 v77, v77
  v_mfma_f32_16x16x32_bf16 v[64:67], a[72:75], a[40:43], v[64:67]
  v_cvt_pk_bf16_f32 v86, v76, v77
  v_add_f32 v61, v61, v77
  v_mfma_f32_16x16x32_bf16 v[64:67], a[76:79], a[44:47], v[64:67]
  v_exp_f32 v78, v78
  v_mfma_f32_16x16x32_bf16 v[68:71], a[80:83], a[32:35], v[116:119]
  ds_read_b128 a[164:167], v2 offset:25600
  v_add_f32 v61, v61, v78
  v_mfma_f32_16x16x32_bf16 v[68:71], a[84:87], a[36:39], v[68:71]
  v_exp_f32 v79, v79
  v_mfma_f32_16x16x32_bf16 v[68:71], a[88:91], a[40:43], v[68:71]
  global_load_lds_dwordx4 v4, s[38:39] offset:1024
  v_cvt_pk_bf16_f32 v87, v78, v79
  v_add_f32 v61, v61, v79
  v_mfma_f32_16x16x32_bf16 v[68:71], a[92:95], a[44:47], v[68:71]
  v_exp_f32 v64, v64
  v_mfma_f32_16x16x32_bf16 v[132:135], a[128:131], v[84:87], v[132:135]
  ds_read_b128 a[168:171], v2 offset:26624
  v_add_f32 v62, v62, v64
  v_mfma_f32_16x16x32_bf16 v[148:151], a[132:135], v[84:87], v[148:151]
  v_exp_f32 v65, v65
  v_mfma_f32_16x16x32_bf16 v[164:167], a[136:139], v[84:87], v[164:167]
  v_cvt_pk_bf16_f32 v80, v64, v65
  v_add_f32 v62, v62, v65
  v_mfma_f32_16x16x32_bf16 v[180:183], a[140:143], v[84:87], v[180:183]
  v_exp_f32 v66, v66
  v_mfma_f32_16x16x32_bf16 v[196:199], a[144:147], v[84:87], v[196:199]
  ds_read_b128 a[172:175], v2 offset:27648
  v_add_f32 v62, v62, v66
  v_mfma_f32_16x16x32_bf16 v[212:215], a[148:151], v[84:87], v[212:215]
  v_exp_f32 v67, v67
  v_mfma_f32_16x16x32_bf16 v[228:231], a[152:155], v[84:87], v[228:231]
  v_cvt_pk_bf16_f32 v81, v66, v67
  v_add_f32 v62, v62, v67
  v_mfma_f32_16x16x32_bf16 v[244:247], a[156:159], v[84:87], v[244:247]
  v_exp_f32 v68, v68
  v_mfma_f32_16x16x32_bf16 v[72:75], a[64:67], a[48:51], v[120:123]
  ds_read_b128 a[176:179], v2 offset:28672
  v_add_f32 v62, v62, v68
  v_mfma_f32_16x16x32_bf16 v[72:75], a[68:71], a[52:55], v[72:75]
  v_exp_f32 v69, v69
  v_mfma_f32_16x16x32_bf16 v[72:75], a[72:75], a[56:59], v[72:75]
  global_load_lds_dwordx4 v4, s[38:39] offset:2048
  v_cvt_pk_bf16_f32 v82, v68, v69
  v_add_f32 v62, v62, v69
  v_mfma_f32_16x16x32_bf16 v[72:75], a[76:79], a[60:63], v[72:75]
  v_exp_f32 v70, v70
  v_mfma_f32_16x16x32_bf16 v[76:79], a[80:83], a[48:51], v[124:127]
  ds_read_b128 a[180:183], v2 offset:29696
  v_add_f32 v62, v62, v70
  v_mfma_f32_16x16x32_bf16 v[76:79], a[84:87], a[52:55], v[76:79]
  v_exp_f32 v71, v71
  v_mfma_f32_16x16x32_bf16 v[76:79], a[88:91], a[56:59], v[76:79]
  v_cvt_pk_bf16_f32 v83, v70, v71
  v_add_f32 v62, v62, v71
  v_mfma_f32_16x16x32_bf16 v[76:79], a[92:95], a[60:63], v[76:79]
  v_exp_f32 v72, v72
  v_mfma_f32_16x16x32_bf16 v[136:139], a[128:131], v[80:83], v[136:139]
  ds_read_b128 a[184:187], v2 offset:30720
  v_add_f32 v63, v63, v72
  v_mfma_f32_16x16x32_bf16 v[152:155], a[132:135], v[80:83], v[152:155]
  v_exp_f32 v73, v73
  v_mfma_f32_16x16x32_bf16 v[168:171], a[136:139], v[80:83], v[168:171]
  v_cvt_pk_bf16_f32 v84, v72, v73
  v_add_f32 v63, v63, v73
  v_mfma_f32_16x16x32_bf16 v[184:187], a[140:143], v[80:83], v[184:187]
  v_exp_f32 v74, v74
  v_mfma_f32_16x16x32_bf16 v[200:203], a[144:147], v[80:83], v[200:203]
  ds_read_b128 a[188:191], v2 offset:31744
  v_add_f32 v63, v63, v74
  v_mfma_f32_16x16x32_bf16 v[216:219], a[148:151], v[80:83], v[216:219]
  v_exp_f32 v75, v75
  v_mfma_f32_16x16x32_bf16 v[232:235], a[152:155], v[80:83], v[232:235]
  v_cvt_pk_bf16_f32 v85, v74, v75
  v_add_f32 v63, v63, v75
  v_mfma_f32_16x16x32_bf16 v[248:251], a[156:159], v[80:83], v[248:251]
  s_waitcnt lgkmcnt(8)
  global_load_lds_dwordx4 v4, s[38:39] offset:3072
  v_exp_f32 v76, v76
  v_mfma_f32_16x16x32_bf16 v[64:67], a[96:99], a[0:3], v[96:99]
  ds_read_b128 a[64:67], v2 offset:32768
  v_add_f32 v63, v63, v76
  s_cmp_eq_u32 s22, 1
  s_cbranch_scc0 Ldd_m1_a
  v_cndmask_b32 v112, v88, v58, s[44:45]
  v_cndmask_b32 v113, v88, v58, s[46:47]
  v_cndmask_b32 v114, v88, v58, s[48:49]
  v_cndmask_b32 v115, v88, v58, s[50:51]
  v_mov_b32 v116, v88
  v_mov_b32 v117, v88
  v_mov_b32 v118, v88
  v_mov_b32 v119, v88
  v_cndmask_b32 v124, v88, v59, s[44:45]
  v_cndmask_b32 v125, v88, v59, s[46:47]
  v_cndmask_b32 v126, v88, v59, s[48:49]
  v_cndmask_b32 v127, v88, v59, s[50:51]
Ldd_m1_a:
  s_cmp_eq_u32 s22, 0
  s_cbranch_scc0 Ldd_m1_b
  v_mov_b32 v112, v88
  v_mov_b32 v113, v88
  v_mov_b32 v114, v88
  v_mov_b32 v115, v88
  v_mov_b32 v120, v88
  v_mov_b32 v121, v88
  v_mov_b32 v122, v88
  v_mov_b32 v123, v88
  v_mov_b32 v124, v88
  v_mov_b32 v125, v88
  v_mov_b32 v126, v88
  v_mov_b32 v127, v88
Ldd_m1_b:
  s_nop 1
  v_mfma_f32_16x16x32_bf16 v[64:67], a[100:103], a[4:7], v[64:67]
  v_exp_f32 v77, v77
  v_mfma_f32_16x16x32_bf16 v[64:67], a[104:107], a[8:11], v[64:67]
  v_cvt_pk_bf16_f32 v86, v76, v77
  v_add_f32 v63, v63, v77
  v_mfma_f32_16x16x32_bf16 v[64:67], a[108:111], a[12:15], v[64:67]
  v_exp_f32 v78, v78
  v_mfma_f32_16x16x32_bf16 v[68:71], a[112:115], a[0:3], v[100:103]
  ds_read_b128 a[68:71], v2 offset:33792
  v_add_f32 v63, v63, v78
  v_mfma_f32_16x16x32_bf16 v[68:71], a[116:119], a[4:7], v[68:71]
  v_exp_f32 v79, v79
  v_mfma_f32_16x16x32_bf16 v[68:71], a[120:123], a[8:11], v[68:71]
  v_cvt_pk_bf16_f32 v87, v78, v79
  v_add_f32 v63, v63, v79
  v_mfma_f32_16x16x32_bf16 v[68:71], a[124:127], a[12:15], v[68:71]
  v_exp_f32 v64, v64
  v_mfma_f32_16x16x32_bf16 v[140:143], a[128:131], v[84:87], v[140:143]
  ds_read_b128 a[72:75], v2 offset:34816
  v_add_f32 v60, v60, v64
  v_mfma_f32_16x16x32_bf16 v[156:159], a[132:135], v[84:87], v[156:159]
  s_add_u32 s38, s54, 49152
  s_addc_u32 s39, s55, 0
  v_exp_f32 v65, v65
  v_mfma_f32_16x16x32_bf16 v[172:175], a[136:139], v[84:87], v[172:175]
  s_add_u32 m0, s37, 49152
  v_cvt_pk_bf16_f32 v80, v64, v65
  v_add_f32 v60, v60, v65
  v_mfma_f32_16x16x32_bf16 v[188:191], a[140:143], v[84:87], v[188:191]
  global_load_lds_dwordx4 v4, s[38:39] offset:0
  v_exp_f32 v66, v66
  v_mfma_f32_16x16x32_bf16 v[204:207], a[144:147], v[84:87], v[204:207]
  ds_read_b128 a[76:79], v2 offset:35840
  v_add_f32 v60, v60, v66
  v_mfma_f32_16x16x32_bf16 v[220:223], a[148:151], v[84:87], v[220:223]
  v_exp_f32 v67, v67
  v_mfma_f32_16x16x32_bf16 v[236:239], a[152:155], v[84:87], v[236:239]
  v_cvt_pk_bf16_f32 v81, v66, v67
  v_add_f32 v60, v60, v67
  v_mfma_f32_16x16x32_bf16 v[252:255], a[156:159], v[84:87], v[252:255]
  v_exp_f32 v68, v68
  v_mfma_f32_16x16x32_bf16 v[72:75], a[96:99], a[16:19], v[104:107]
  ds_read_b128 a[80:83], v2 offset:36864
  v_add_f32 v60, v60, v68
  v_mfma_f32_16x16x32_bf16 v[72:75], a[100:103], a[20:23], v[72:75]
  v_exp_f32 v69, v69
  v_mfma_f32_16x16x32_bf16 v[72:75], a[104:107], a[24:27], v[72:75]
  v_cvt_pk_bf16_f32 v82, v68, v69
  v_add_f32 v60, v60, v69
  v_mfma_f32_16x16x32_bf16 v[72:75], a[108:111], a[28:31], v[72:75]
  v_exp_f32 v70, v70
  v_mfma_f32_16x16x32_bf16 v[76:79], a[112:115], a[16:19], v[108:111]
  ds_read_b128 a[84:87], v2 offset:37888
  v_add_f32 v60, v60, v70
  v_mfma_f32_16x16x32_bf16 v[76:79], a[116:119], a[20:23], v[76:79]
  v_exp_f32 v71, v71
  v_mfma_f32_16x16x32_bf16 v[76:79], a[120:123], a[24:27], v[76:79]
  v_cvt_pk_bf16_f32 v83, v70, v71
  v_add_f32 v60, v60, v71
  v_mfma_f32_16x16x32_bf16 v[76:79], a[124:127], a[28:31], v[76:79]
  s_waitcnt lgkmcnt(6)
  global_load_lds_dwordx4 v4, s[38:39] offset:1024
  v_exp_f32 v72, v72
  v_mfma_f32_16x16x32_bf16 v[128:131], a[160:163], v[80:83], v[128:131]
  ds_read_b128 a[88:91], v2 offset:38912
  v_add_f32 v61, v61, v72
  v_mfma_f32_16x16x32_bf16 v[144:147], a[164:167], v[80:83], v[144:147]
  v_exp_f32 v73, v73
  v_mfma_f32_16x16x32_bf16 v[160:163], a[168:171], v[80:83], v[160:163]
  v_cvt_pk_bf16_f32 v84, v72, v73
  v_add_f32 v61, v61, v73
  v_mfma_f32_16x16x32_bf16 v[176:179], a[172:175], v[80:83], v[176:179]
  v_exp_f32 v74, v74
  v_mfma_f32_16x16x32_bf16 v[192:195], a[176:179], v[80:83], v[192:195]
  ds_read_b128 a[92:95], v2 offset:39936
  v_add_f32 v61, v61, v74
  v_mfma_f32_16x16x32_bf16 v[208:211], a[180:183], v[80:83], v[208:211]
  v_exp_f32 v75, v75
  v_mfma_f32_16x16x32_bf16 v[224:227], a[184:187], v[80:83], v[224:227]
  v_cvt_pk_bf16_f32 v85, v74, v75
  v_add_f32 v61, v61, v75
  v_mfma_f32_16x16x32_bf16 v[240:243], a[188:191], v[80:83], v[240:243]
  v_exp_f32 v76, v76
  v_mfma_f32_16x16x32_bf16 v[64:67], a[96:99], a[32:35], v[112:115]
  ds_read_b128 a[128:131], v2 offset:40960
  v_add_f32 v61, v61, v76
  v_mfma_f32_16x16x32_bf16 v[64:67], a[100:103], a[36:39], v[64:67]
  v_exp_f32 v77, v77
  v_mfma_f32_16x16x32_bf16 v[64:67], a[104:107], a[40:43], v[64:67]
  v_cvt_pk_bf16_f32 v86, v76, v77
  v_add_f32 v61, v61, v77
  v_mfma_f32_16x16x32_bf16 v[64:67], a[108:111], a[44:47], v[64:67]
  global_load_lds_dwordx4 v4, s[38:39] offset:2048
  v_exp_f32 v78, v78
  v_mfma_f32_16x16x32_bf16 v[68:71], a[112:115], a[32:35], v[116:119]
  ds_read_b128 a[132:135], v2 offset:41984
  v_add_f32 v61, v61, v78
  v_mfma_f32_16x16x32_bf16 v[68:71], a[116:119], a[36:39], v[68:71]
  v_exp_f32 v79, v79
  v_mfma_f32_16x16x32_bf16 v[68:71], a[120:123], a[40:43], v[68:71]
  v_cvt_pk_bf16_f32 v87, v78, v79
  v_add_f32 v61, v61, v79
  v_mfma_f32_16x16x32_bf16 v[68:71], a[124:127], a[44:47], v[68:71]
  v_exp_f32 v64, v64
  v_mfma_f32_16x16x32_bf16 v[132:135], a[160:163], v[84:87], v[132:135]
  ds_read_b128 a[136:139], v2 offset:43008
  v_add_f32 v62, v62, v64
  v_mfma_f32_16x16x32_bf16 v[148:151], a[164:167], v[84:87], v[148:151]
  v_exp_f32 v65, v65
  v_mfma_f32_16x16x32_bf16 v[164:167], a[168:171], v[84:87], v[164:167]
  v_cvt_pk_bf16_f32 v80, v64, v65
  v_add_f32 v62, v62, v65
  v_mfma_f32_16x16x32_bf16 v[180:183], a[172:175], v[84:87], v[180:183]
  v_exp_f32 v66, v66
  v_mfma_f32_16x16x32_bf16 v[196:199], a[176:179], v[84:87], v[196:199]
  ds_read_b128 a[140:143], v2 offset:44032
  v_add_f32 v62, v62, v66
  v_mfma_f32_16x16x32_bf16 v[212:215], a[180:183], v[84:87], v[212:215]
  v_exp_f32 v67, v67
  v_mfma_f32_16x16x32_bf16 v[228:231], a[184:187], v[84:87], v[228:231]
  v_cvt_pk_bf16_f32 v81, v66, v67
  v_add_f32 v62, v62, v67
  v_mfma_f32_16x16x32_bf16 v[244:247], a[188:191], v[84:87], v[244:247]
  global_load_lds_dwordx4 v4, s[38:39] offset:3072
  v_exp_f32 v68, v68
  v_mfma_f32_16x16x32_bf16 v[72:75], a[96:99], a[48:51], v[120:123]
  ds_read_b128 a[144:147], v2 offset:45056
  v_add_f32 v62, v62, v68
  v_mfma_f32_16x16x32_bf16 v[72:75], a[100:103], a[52:55], v[72:75]
  v_exp_f32 v69, v69
  v_mfma_f32_16x16x32_bf16 v[72:75], a[104:107], a[56:59], v[72:75]
  v_cvt_pk_bf16_f32 v82, v68, v69
  v_add_f32 v62, v62, v69
  v_mfma_f32_16x16x32_bf16 v[72:75], a[108:111], a[60:63], v[72:75]
  v_exp_f32 v70, v70
  v_mfma_f32_16x16x32_bf16 v[76:79], a[112:115], a[48:51], v[124:127]
  ds_read_b128 a[148:151], v2 offset:46080
  v_add_f32 v62, v62, v70
  v_mfma_f32_16x16x32_bf16 v[76:79], a[116:119], a[52:55], v[76:79]
  v_exp_f32 v71, v71
  v_mfma_f32_16x16x32_bf16 v[76:79], a[120:123], a[56:59], v[76:79]
  v_cvt_pk_bf16_f32 v83, v70, v71
  v_add_f32 v62, v62, v71
  v_mfma_f32_16x16x32_bf16 v[76:79], a[124:127], a[60:63], v[76:79]
  v_exp_f32 v72, v72
  v_mfma_f32_16x16x32_bf16 v[136:139], a[160:163], v[80:83], v[136:139]
  ds_read_b128 a[152:155], v2 offset:47104
  v_add_f32 v63, v63, v72
  v_mfma_f32_16x16x32_bf16 v[152:155], a[164:167], v[80:83], v[152:155]
  v_exp_f32 v73, v73
  v_mfma_f32_16x16x32_bf16 v[168:171], a[168:171], v[80:83], v[168:171]
  v_cvt_pk_bf16_f32 v84, v72, v73
  v_add_f32 v63, v63, v73
  v_mfma_f32_16x16x32_bf16 v[184:187], a[172:175], v[80:83], v[184:187]
  v_exp_f32 v74, v74
  v_mfma_f32_16x16x32_bf16 v[200:203], a[176:179], v[80:83], v[200:203]
  ds_read_b128 a[156:159], v2 offset:48128
  v_add_f32 v63, v63, v74
  v_mfma_f32_16x16x32_bf16 v[216:219], a[180:183], v[80:83], v[216:219]
  v_exp_f32 v75, v75
  v_mfma_f32_16x16x32_bf16 v[232:235], a[184:187], v[80:83], v[232:235]
  v_cvt_pk_bf16_f32 v85, v74, v75
  v_add_f32 v63, v63, v75
  v_mfma_f32_16x16x32_bf16 v[248:251], a[188:191], v[80:83], v[248:251]
  s_waitcnt lgkmcnt(8)
  v_exp_f32 v76, v76
  v_mfma_f32_16x16x32_bf16 v[64:67], a[64:67], a[0:3], v[96:99]
  ds_read_b128 a[96:99], v2 offset:49152
  v_add_f32 v63, v63, v76
  s_cmp_eq_u32 s22, 2
  s_cbranch_scc0 Ldd_m2_a
  v_cndmask_b32 v112, v88, v58, s[44:45]
  v_cndmask_b32 v113, v88, v58, s[46:47]
  v_cndmask_b32 v114, v88, v58, s[48:49]
  v_cndmask_b32 v115, v88, v58, s[50:51]
  v_mov_b32 v116, v88
  v_mov_b32 v117, v88
  v_mov_b32 v118, v88
  v_mov_b32 v119, v88
  v_cndmask_b32 v124, v88, v59, s[44:45]
  v_cndmask_b32 v125, v88, v59, s[46:47]
  v_cndmask_b32 v126, v88, v59, s[48:49]
  v_cndmask_b32 v127, v88, v59, s[50:51]
Ldd_m2_a:
  s_cmp_eq_u32 s22, 1
  s_cbranch_scc0 Ldd_m2_b
  v_mov_b32 v112, v88
  v_mov_b32 v113, v88
  v_mov_b32 v114, v88
  v_mov_b32 v115, v88
  v_mov_b32 v120, v88
  v_mov_b32 v121, v88
  v_mov_b32 v122, v88
  v_mov_b32 v123, v88
  v_mov_b32 v124, v88
  v_mov_b32 v125, v88
  v_mov_b32 v126, v88
  v_mov_b32 v127, v88
Ldd_m2_b:
  s_nop 1
  v_mfma_f32_16x16x32_bf16 v[64:67], a[68:71], a[4:7], v[64:67]
  v_exp_f32 v77, v77
  v_mfma_f32_16x16x32_bf16 v[64:67], a[72:75], a[8:11], v[64:67]
  v_cvt_pk_bf16_f32 v86, v76, v77
  v_add_f32 v63, v63, v77
  v_mfma_f32_16x16x32_bf16 v[64:67], a[76:79], a[12:15], v[64:67]
  ds_read_b128 a[100:103], v2 offset:50176
  v_exp_f32 v78, v78
  v_mfma_f32_16x16x32_bf16 v[68:71], a[80:83], a[0:3], v[100:103]
  v_add_f32 v63, v63, v78
  v_mfma_f32_16x16x32_bf16 v[68:71], a[84:87], a[4:7], v[68:71]
  v_exp_f32 v79, v79
  v_mfma_f32_16x16x32_bf16 v[68:71], a[88:91], a[8:11], v[68:71]
  v_cvt_pk_bf16_f32 v87, v78, v79
  v_add_f32 v63, v63, v79
  v_mfma_f32_16x16x32_bf16 v[68:71], a[92:95], a[12:15], v[68:71]
  ds_read_b128 a[104:107], v2 offset:51200
  v_exp_f32 v64, v64
  v_mfma_f32_16x16x32_bf16 v[140:143], a[160:163], v[84:87], v[140:143]
  v_add_f32 v60, v60, v64
  v_mfma_f32_16x16x32_bf16 v[156:159], a[164:167], v[84:87], v[156:159]
  v_exp_f32 v65, v65
  v_mfma_f32_16x16x32_bf16 v[172:175], a[168:171], v[84:87], v[172:175]
  ds_read_b128 a[108:111], v2 offset:52224
  v_cvt_pk_bf16_f32 v80, v64, v65
  v_add_f32 v60, v60, v65
  v_mfma_f32_16x16x32_bf16 v[188:191], a[172:175], v[84:87], v[188:191]
  v_exp_f32 v66, v66
  v_mfma_f32_16x16x32_bf16 v[204:207], a[176:179], v[84:87], v[204:207]
  v_add_f32 v60, v60, v66
  v_mfma_f32_16x16x32_bf16 v[220:223], a[180:183], v[84:87], v[220:223]
  v_exp_f32 v67, v67
  v_mfma_f32_16x16x32_bf16 v[236:239], a[184:187], v[84:87], v[236:239]
  ds_read_b128 a[112:115], v2 offset:53248
  v_cvt_pk_bf16_f32 v81, v66, v67
  v_add_f32 v60, v60, v67
  v_mfma_f32_16x16x32_bf16 v[252:255], a[188:191], v[84:87], v[252:255]
  v_exp_f32 v68, v68
  v_mfma_f32_16x16x32_bf16 v[72:75], a[64:67], a[16:19], v[104:107]
  v_add_f32 v60, v60, v68
  v_mfma_f32_16x16x32_bf16 v[72:75], a[68:71], a[20:23], v[72:75]
  ds_read_b128 a[116:119], v2 offset:54272
  v_exp_f32 v69, v69
  v_mfma_f32_16x16x32_bf16 v[72:75], a[72:75], a[24:27], v[72:75]
  v_cvt_pk_bf16_f32 v82, v68, v69
  v_add_f32 v60, v60, v69
  v_mfma_f32_16x16x32_bf16 v[72:75], a[76:79], a[28:31], v[72:75]
  v_exp_f32 v70, v70
  v_mfma_f32_16x16x32_bf16 v[76:79], a[80:83], a[16:19], v[108:111]
  v_add_f32 v60, v60, v70
  v_mfma_f32_16x16x32_bf16 v[76:79], a[84:87], a[20:23], v[76:79]
  ds_read_b128 a[120:123], v2 offset:55296
  v_exp_f32 v71, v71
  v_mfma_f32_16x16x32_bf16 v[76:79], a[88:91], a[24:27], v[76:79]
  v_cvt_pk_bf16_f32 v83, v70, v71
  v_add_f32 v60, v60, v71
  v_mfma_f32_16x16x32_bf16 v[76:79], a[92:95], a[28:31], v[76:79]
  s_waitcnt lgkmcnt(7)
  v_exp_f32 v72, v72
  v_mfma_f32_16x16x32_bf16 v[128:131], a[128:131], v[80:83], v[128:131]
  ds_read_b128 a[124:127], v2 offset:56320
  v_add_f32 v61, v61, v72
  v_mfma_f32_16x16x32_bf16 v[144:147], a[132:135], v[80:83], v[144:147]
  v_exp_f32 v73, v73
  v_mfma_f32_16x16x32_bf16 v[160:163], a[136:139], v[80:83], v[160:163]
  v_cvt_pk_bf16_f32 v84, v72, v73
  v_add_f32 v61, v61, v73
  v_mfma_f32_16x16x32_bf16 v[176:179], a[140:143], v[80:83], v[176:179]
  v_exp_f32 v74, v74
  v_mfma_f32_16x16x32_bf16 v[192:195], a[144:147], v[80:83], v[192:195]
  ds_read_b128 a[160:163], v2 offset:57344
  v_add_f32 v61, v61, v74
  v_mfma_f32_16x16x32_bf16 v[208:211], a[148:151], v[80:83], v[208:211]
  v_exp_f32 v75, v75
  v_mfma_f32_16x16x32_bf16 v[224:227], a[152:155], v[80:83], v[224:227]
  v_cvt_pk_bf16_f32 v85, v74, v75
  v_add_f32 v61, v61, v75
  v_mfma_f32_16x16x32_bf16 v[240:243], a[156:159], v[80:83], v[240:243]
  ds_read_b128 a[164:167], v2 offset:58368
  v_exp_f32 v76, v76
  v_mfma_f32_16x16x32_bf16 v[64:67], a[64:67], a[32:35], v[112:115]
  v_add_f32 v61, v61, v76
  v_mfma_f32_16x16x32_bf16 v[64:67], a[68:71], a[36:39], v[64:67]
  v_exp_f32 v77, v77
  v_mfma_f32_16x16x32_bf16 v[64:67], a[72:75], a[40:43], v[64:67]
  v_cvt_pk_bf16_f32 v86, v76, v77
  v_add_f32 v61, v61, v77
  v_mfma_f32_16x16x32_bf16 v[64:67], a[76:79], a[44:47], v[64:67]
  ds_read_b128 a[168:171], v2 offset:59392
  v_exp_f32 v78, v78
  v_mfma_f32_16x16x32_bf16 v[68:71], a[80:83], a[32:35], v[116:119]
  v_add_f32 v61, v61, v78
  v_mfma_f32_16x16x32_bf16 v[68:71], a[84:87], a[36:39], v[68:71]
  v_exp_f32 v79, v79
  v_mfma_f32_16x16x32_bf16 v[68:71], a[88:91], a[40:43], v[68:71]
  ds_read_b128 a[172:175], v2 offset:60416
  v_cvt_pk_bf16_f32 v87, v78, v79
  v_add_f32 v61, v61, v79
  v_mfma_f32_16x16x32_bf16 v[68:71], a[92:95], a[44:47], v[68:71]
  v_exp_f32 v64, v64
  v_mfma_f32_16x16x32_bf16 v[132:135], a[128:131], v[84:87], v[132:135]
  v_add_f32 v62, v62, v64
  v_mfma_f32_16x16x32_bf16 v[148:151], a[132:135], v[84:87], v[148:151]
  v_exp_f32 v65, v65
  v_mfma_f32_16x16x32_bf16 v[164:167], a[136:139], v[84:87], v[164:167]
  ds_read_b128 a[176:179], v2 offset:61440
  v_cvt_pk_bf16_f32 v80, v64, v65
  v_add_f32 v62, v62, v65
  v_mfma_f32_16x16x32_bf16 v[180:183], a[140:143], v[84:87], v[180:183]
  v_exp_f32 v66, v66
  v_mfma_f32_16x16x32_bf16 v[196:199], a[144:147], v[84:87], v[196:199]
  v_add_f32 v62, v62, v66
  v_mfma_f32_16x16x32_bf16 v[212:215], a[148:151], v[84:87], v[212:215]
  ds_read_b128 a[180:183], v2 offset:62464
  v_exp_f32 v67, v67
  v_mfma_f32_16x16x32_bf16 v[228:231], a[152:155], v[84:87], v[228:231]
  v_cvt_pk_bf16_f32 v81, v66, v67
  v_add_f32 v62, v62, v67
  v_mfma_f32_16x16x32_bf16 v[244:247], a[156:159], v[84:87], v[244:247]
  v_exp_f32 v68, v68
  v_mfma_f32_16x16x32_bf16 v[72:75], a[64:67], a[48:51], v[120:123]
  v_add_f32 v62, v62, v68
  v_mfma_f32_16x16x32_bf16 v[72:75], a[68:71], a[52:55], v[72:75]
  ds_read_b128 a[184:187], v2 offset:63488
  v_exp_f32 v69, v69
  v_mfma_f32_16x16x32_bf16 v[72:75], a[72:75], a[56:59], v[72:75]
  v_cvt_pk_bf16_f32 v82, v68, v69
  v_add_f32 v62, v62, v69
  v_mfma_f32_16x16x32_bf16 v[72:75], a[76:79], a[60:63], v[72:75]
  v_exp_f32 v70, v70
  v_mfma_f32_16x16x32_bf16 v[76:79], a[80:83], a[48:51], v[124:127]
  ds_read_b128 a[188:191], v2 offset:64512
  v_add_f32 v62, v62, v70
  v_mfma_f32_16x16x32_bf16 v[76:79], a[84:87], a[52:55], v[76:79]
  v_exp_f32 v71, v71
  v_mfma_f32_16x16x32_bf16 v[76:79], a[88:91], a[56:59], v[76:79]
  v_cvt_pk_bf16_f32 v83, v70, v71
  v_add_f32 v62, v62, v71
  v_mfma_f32_16x16x32_bf16 v[76:79], a[92:95], a[60:63], v[76:79]
  v_exp_f32 v72, v72
  v_mfma_f32_16x16x32_bf16 v[136:139], a[128:131], v[80:83], v[136:139]
  v_add_f32 v63, v63, v72
  v_mfma_f32_16x16x32_bf16 v[152:155], a[132:135], v[80:83], v[152:155]
  v_exp_f32 v73, v73
  v_mfma_f32_16x16x32_bf16 v[168:171], a[136:139], v[80:83], v[168:171]
  v_cvt_pk_bf16_f32 v84, v72, v73
  v_add_f32 v63, v63, v73
  v_mfma_f32_16x16x32_bf16 v[184:187], a[140:143], v[80:83], v[184:187]
  v_exp_f32 v74, v74
  v_mfma_f32_16x16x32_bf16 v[200:203], a[144:147], v[80:83], v[200:203]
  v_add_f32 v63, v63, v74
  v_mfma_f32_16x16x32_bf16 v[216:219], a[148:151], v[80:83], v[216:219]
  v_exp_f32 v75, v75
  v_mfma_f32_16x16x32_bf16 v[232:235], a[152:155], v[80:83], v[232:235]
  v_cvt_pk_bf16_f32 v85, v74, v75
  v_add_f32 v63, v63, v75
  v_mfma_f32_16x16x32_bf16 v[248:251], a[156:159], v[80:83], v[248:251]
  s_waitcnt lgkmcnt(8)
  v_exp_f32 v76, v76
  s_waitcnt vmcnt(0) lgkmcnt(0)
  s_barrier
  v_xor_b32 v2, 65536, v2
  v_mfma_f32_16x16x32_bf16 v[64:67], a[96:99], a[0:3], v[96:99]
  ds_read_b128 a[64:67], v2 offset:0
  v_add_f32 v63, v63, v76
  s_cmp_eq_u32 s22, 3
  s_cbranch_scc0 Ldd_m3_a
  v_cndmask_b32 v112, v88, v58, s[44:45]
  v_cndmask_b32 v113, v88, v58, s[46:47]
  v_cndmask_b32 v114, v88, v58, s[48:49]
  v_cndmask_b32 v115, v88, v58, s[50:51]
  v_mov_b32 v116, v88
  v_mov_b32 v117, v88
  v_mov_b32 v118, v88
  v_mov_b32 v119, v88
  v_cndmask_b32 v124, v88, v59, s[44:45]
  v_cndmask_b32 v125, v88, v59, s[46:47]
  v_cndmask_b32 v126, v88, v59, s[48:49]
  v_cndmask_b32 v127, v88, v59, s[50:51]
Ldd_m3_a:
  s_cmp_eq_u32 s22, 2
  s_cbranch_scc0 Ldd_m3_b
  v_mov_b32 v112, v88
  v_mov_b32 v113, v88
  v_mov_b32 v114, v88
  v_mov_b32 v115, v88
  v_mov_b32 v120, v88
  v_mov_b32 v121, v88
  v_mov_b32 v122, v88
  v_mov_b32 v123, v88
  v_mov_b32 v124, v88
  v_mov_b32 v125, v88
  v_mov_b32 v126, v88
  v_mov_b32 v127, v88
Ldd_m3_b:
  s_nop 1
  v_mfma_f32_16x16x32_bf16 v[64:67], a[100:103], a[4:7], v[64:67]
  s_add_u32 s38, s34, 0
  s_addc_u32 s39, s35, 0
  v_exp_f32 v77, v77
  v_mfma_f32_16x16x32_bf16 v[64:67], a[104:107], a[8:11], v[64:67]
  s_add_u32 m0, s36, 0
  v_cvt_pk_bf16_f32 v86, v76, v77
  v_add_f32 v63, v63, v77
  v_mfma_f32_16x16x32_bf16 v[64:67], a[108:111], a[12:15], v[64:67]
  global_load_lds_dwordx4 v4, s[38:39] offset:0
  v_exp_f32 v78, v78
  v_mfma_f32_16x16x32_bf16 v[68:71], a[112:115], a[0:3], v[100:103]
  ds_read_b128 a[68:71], v2 offset:1024
  v_add_f32 v63, v63, v78
  v_mfma_f32_16x16x32_bf16 v[68:71], a[116:119], a[4:7], v[68:71]
  v_exp_f32 v79, v79
  v_mfma_f32_16x16x32_bf16 v[68:71], a[120:123], a[8:11], v[68:71]
  v_cvt_pk_bf16_f32 v87, v78, v79
  v_add_f32 v63, v63, v79
  v_mfma_f32_16x16x32_bf16 v[68:71], a[124:127], a[12:15], v[68:71]
  v_exp_f32 v64, v64
  v_mfma_f32_16x16x32_bf16 v[140:143], a[128:131], v[84:87], v[140:143]
  ds_read_b128 a[72:75], v2 offset:2048
  v_add_f32 v60, v60, v64
  v_mfma_f32_16x16x32_bf16 v[156:159], a[132:135], v[84:87], v[156:159]
  v_exp_f32 v65, v65
  v_mfma_f32_16x16x32_bf16 v[172:175], a[136:139], v[84:87], v[172:175]
  v_cvt_pk_bf16_f32 v80, v64, v65
  v_add_f32 v60, v60, v65
  v_mfma_f32_16x16x32_bf16 v[188:191], a[140:143], v[84:87], v[188:191]
  v_exp_f32 v66, v66
  v_mfma_f32_16x16x32_bf16 v[204:207], a[144:147], v[84:87], v[204:207]
  global_load_lds_dwordx4 v4, s[38:39] offset:1024
  ds_read_b128 a[76:79], v2 offset:3072
  v_add_f32 v60, v60, v66
  v_mfma_f32_16x16x32_bf16 v[220:223], a[148:151], v[84:87], v[220:223]
  v_exp_f32 v67, v67
  v_mfma_f32_16x16x32_bf16 v[236:239], a[152:155], v[84:87], v[236:239]
  v_cvt_pk_bf16_f32 v81, v66, v67
  v_add_f32 v60, v60, v67
  v_mfma_f32_16x16x32_bf16 v[252:255], a[156:159], v[84:87], v[252:255]
  v_exp_f32 v68, v68
  v_mfma_f32_16x16x32_bf16 v[72:75], a[96:99], a[16:19], v[104:107]
  ds_read_b128 a[80:83], v2 offset:4096
  v_add_f32 v60, v60, v68
  v_mfma_f32_16x16x32_bf16 v[72:75], a[100:103], a[20:23], v[72:75]
  v_exp_f32 v69, v69
  v_mfma_f32_16x16x32_bf16 v[72:75], a[104:107], a[24:27], v[72:75]
  v_cvt_pk_bf16_f32 v82, v68, v69
  v_add_f32 v60, v60, v69
  v_mfma_f32_16x16x32_bf16 v[72:75], a[108:111], a[28:31], v[72:75]
  v_exp_f32 v70, v70
  v_mfma_f32_16x16x32_bf16 v[76:79], a[112:115], a[16:19], v[108:111]
  ds_read_b128 a[84:87], v2 offset:5120
  v_add_f32 v60, v60, v70
  v_mfma_f32_16x16x32_bf16 v[76:79], a[116:119], a[20:23], v[76:79]
  v_exp_f32 v71, v71
  v_mfma_f32_16x16x32_bf16 v[76:79], a[120:123], a[24:27], v[76:79]
  global_load_lds_dwordx4 v4, s[38:39] offset:2048
  v_cvt_pk_bf16_f32 v83, v70, v71
  v_add_f32 v60, v60, v71
  v_mfma_f32_16x16x32_bf16 v[76:79], a[124:127], a[28:31], v[76:79]
  s_waitcnt lgkmcnt(6)
  v_exp_f32 v72, v72
  v_mfma_f32_16x16x32_bf16 v[128:131], a[160:163], v[80:83], v[128:131]
  ds_read_b128 a[88:91], v2 offset:6144
  v_add_f32 v61, v61, v72
  v_mfma_f32_16x16x32_bf16 v[144:147], a[164:167], v[80:83], v[144:147]
  v_exp_f32 v73, v73
  v_mfma_f32_16x16x32_bf16 v[160:163], a[168:171], v[80:83], v[160:163]
  v_cvt_pk_bf16_f32 v84, v72, v73
  v_add_f32 v61, v61, v73
  v_mfma_f32_16x16x32_bf16 v[176:179], a[172:175], v[80:83], v[176:179]
  v_exp_f32 v74, v74
  v_mfma_f32_16x16x32_bf16 v[192:195], a[176:179], v[80:83], v[192:195]
  ds_read_b128 a[92:95], v2 offset:7168
  v_add_f32 v61, v61, v74
  v_mfma_f32_16x16x32_bf16 v[208:211], a[180:183], v[80:83], v[208:211]
  v_exp_f32 v75, v75
  v_mfma_f32_16x16x32_bf16 v[224:227], a[184:187], v[80:83], v[224:227]
  v_cvt_pk_bf16_f32 v85, v74, v75
  v_add_f32 v61, v61, v75
  v_mfma_f32_16x16x32_bf16 v[240:243], a[188:191], v[80:83], v[240:243]
  v_exp_f32 v76, v76
  v_mfma_f32_16x16x32_bf16 v[64:67], a[96:99], a[32:35], v[112:115]
  global_load_lds_dwordx4 v4, s[38:39] offset:3072
  ds_read_b128 a[128:131], v2 offset:8192
  v_add_f32 v61, v61, v76
  v_mfma_f32_16x16x32_bf16 v[64:67], a[100:103], a[36:39], v[64:67]
  v_exp_f32 v77, v77
  v_mfma_f32_16x16x32_bf16 v[64:67], a[104:107], a[40:43], v[64:67]
  v_cvt_pk_bf16_f32 v86, v76, v77
  v_add_f32 v61, v61, v77
  v_mfma_f32_16x16x32_bf16 v[64:67], a[108:111], a[44:47], v[64:67]
  v_exp_f32 v78, v78
  v_mfma_f32_16x16x32_bf16 v[68:71], a[112:115], a[32:35], v[116:119]
  ds_read_b128 a[132:135], v2 offset:9216
  v_add_f32 v61, v61, v78
  v_mfma_f32_16x16x32_bf16 v[68:71], a[116:119], a[36:39], v[68:71]
  v_exp_f32 v79, v79
  v_mfma_f32_16x16x32_bf16 v[68:71], a[120:123], a[40:43], v[68:71]
  v_cvt_pk_bf16_f32 v87, v78, v79
  v_add_f32 v61, v61, v79
  v_mfma_f32_16x16x32_bf16 v[68:71], a[124:127], a[44:47], v[68:71]
  v_exp_f32 v64, v64
  v_mfma_f32_16x16x32_bf16 v[132:135], a[160:163], v[84:87], v[132:135]
  s_add_u32 s38, s34, 16384
  s_addc_u32 s39, s35, 0
  ds_read_b128 a[136:139], v2 offset:10240
  v_add_f32 v62, v62, v64
  v_mfma_f32_16x16x32_bf16 v[148:151], a[164:167], v[84:87], v[148:151]
  s_add_u32 m0, s36, 16384
  v_exp_f32 v65, v65
  v_mfma_f32_16x16x32_bf16 v[164:167], a[168:171], v[84:87], v[164:167]
  global_load_lds_dwordx4 v4, s[38:39] offset:0
  v_cvt_pk_bf16_f32 v80, v64, v65
  v_add_f32 v62, v62, v65
  v_mfma_f32_16x16x32_bf16 v[180:183], a[172:175], v[84:87], v[180:183]
  v_exp_f32 v66, v66
  v_mfma_f32_16x16x32_bf16 v[196:199], a[176:179], v[84:87], v[196:199]
  ds_read_b128 a[140:143], v2 offset:11264
  v_add_f32 v62, v62, v66
  v_mfma_f32_16x16x32_bf16 v[212:215], a[180:183], v[84:87], v[212:215]
  v_exp_f32 v67, v67
  v_mfma_f32_16x16x32_bf16 v[228:231], a[184:187], v[84:87], v[228:231]
  v_cvt_pk_bf16_f32 v81, v66, v67
  v_add_f32 v62, v62, v67
  v_mfma_f32_16x16x32_bf16 v[244:247], a[188:191], v[84:87], v[244:247]
  v_exp_f32 v68, v68
  v_mfma_f32_16x16x32_bf16 v[72:75], a[96:99], a[48:51], v[120:123]
  ds_read_b128 a[144:147], v2 offset:12288
  v_add_f32 v62, v62, v68
  v_mfma_f32_16x16x32_bf16 v[72:75], a[100:103], a[52:55], v[72:75]
  v_exp_f32 v69, v69
  v_mfma_f32_16x16x32_bf16 v[72:75], a[104:107], a[56:59], v[72:75]
  v_cvt_pk_bf16_f32 v82, v68, v69
  v_add_f32 v62, v62, v69
  v_mfma_f32_16x16x32_bf16 v[72:75], a[108:111], a[60:63], v[72:75]
  v_exp_f32 v70, v70
  v_mfma_f32_16x16x32_bf16 v[76:79], a[112:115], a[48:51], v[124:127]
  global_load_lds_dwordx4 v4, s[38:39] offset:1024
  ds_read_b128 a[148:151], v2 offset:13312
  v_add_f32 v62, v62, v70
  v_mfma_f32_16x16x32_bf16 v[76:79], a[116:119], a[52:55], v[76:79]
  v_exp_f32 v71, v71
  v_mfma_f32_16x16x32_bf16 v[76:79], a[120:123], a[56:59], v[76:79]
  v_cvt_pk_bf16_f32 v83, v70, v71
  v_add_f32 v62, v62, v71
  v_mfma_f32_16x16x32_bf16 v[76:79], a[124:127], a[60:63], v[76:79]
  v_exp_f32 v72, v72
  v_mfma_f32_16x16x32_bf16 v[136:139], a[160:163], v[80:83], v[136:139]
  ds_read_b128 a[152:155], v2 offset:14336
  v_add_f32 v63, v63, v72
  v_mfma_f32_16x16x32_bf16 v[152:155], a[164:167], v[80:83], v[152:155]
  v_exp_f32 v73, v73
  v_mfma_f32_16x16x32_bf16 v[168:171], a[168:171], v[80:83], v[168:171]
  v_cvt_pk_bf16_f32 v84, v72, v73
  v_add_f32 v63, v63, v73
  v_mfma_f32_16x16x32_bf16 v[184:187], a[172:175], v[80:83], v[184:187]
  v_exp_f32 v74, v74
  v_mfma_f32_16x16x32_bf16 v[200:203], a[176:179], v[80:83], v[200:203]
  ds_read_b128 a[156:159], v2 offset:15360
  v_add_f32 v63, v63, v74
  v_mfma_f32_16x16x32_bf16 v[216:219], a[180:183], v[80:83], v[216:219]
  v_exp_f32 v75, v75
  v_mfma_f32_16x16x32_bf16 v[232:235], a[184:187], v[80:83], v[232:235]
  v_cvt_pk_bf16_f32 v85, v74, v75
  v_add_f32 v63, v63, v75
  v_mfma_f32_16x16x32_bf16 v[248:251], a[188:191], v[80:83], v[248:251]
  s_waitcnt lgkmcnt(8)
  v_exp_f32 v76, v76
  s_mov_b64 s[54:55], s[34:35]
  s_mov_b32 s37, s36
  s_cmp_gt_u32 s52, 1
  s_cselect_b32 s38, 0x10000, 0
  s_add_u32 s34, s34, s38
  s_addc_u32 s35, s35, 0
  s_xor_b32 s36, s36, 65536
  s_max_u32 s52, s52, 1
  s_sub_u32 s52, s52, 1
  s_nop 0
  v_add_f32 v63, v63, v76
  v_exp_f32 v77, v77
  s_nop 0
  v_cvt_pk_bf16_f32 v86, v76, v77
  v_add_f32 v63, v63, v77
  v_exp_f32 v78, v78
  s_nop 0
  v_add_f32 v63, v63, v78
  v_exp_f32 v79, v79
  s_nop 0
  v_cvt_pk_bf16_f32 v87, v78, v79
  v_add_f32 v63, v63, v79
  s_nop 1
  s_waitcnt lgkmcnt(0)
  v_mfma_f32_16x16x32_bf16 v[140:143], a[160:163], v[84:87], v[140:143]
  v_mfma_f32_16x16x32_bf16 v[156:159], a[164:167], v[84:87], v[156:159]
  v_mfma_f32_16x16x32_bf16 v[172:175], a[168:171], v[84:87], v[172:175]
  v_mfma_f32_16x16x32_bf16 v[188:191], a[172:175], v[84:87], v[188:191]
  v_mfma_f32_16x16x32_bf16 v[204:207], a[176:179], v[84:87], v[204:207]
  v_mfma_f32_16x16x32_bf16 v[220:223], a[180:183], v[84:87], v[220:223]
  v_mfma_f32_16x16x32_bf16 v[236:239], a[184:187], v[84:87], v[236:239]
  v_mfma_f32_16x16x32_bf16 v[252:255], a[188:191], v[84:87], v[252:255]
L_ddg_done:
  s_nop 7
  v_mov_b32 v89, v62
  s_nop 1
  v_permlane16_swap_b32 v62, v89
  s_nop 1
  v_add_f32 v62, v62, v89
  v_mov_b32 v89, v62
  s_nop 1
  v_permlane32_swap_b32 v62, v89
  s_nop 1
  v_add_f32 v62, v62, v89
  v_mov_b32 v89, v63
  s_nop 1
  v_permlane16_swap_b32 v63, v89
  s_nop 1
  v_add_f32 v63, v63, v89
  v_mov_b32 v89, v63
  s_nop 1
  v_permlane32_swap_b32 v63, v89
  s_nop 1
  v_add_f32 v63, v63, v89
  s_mov_b32 s73, 0
  v_mov_b32 v90, 0x1f800000
  v_mov_b32 v91, 0x5f800000
  v_cmp_lt_f32 vcc, v90, v62
  v_cmp_gt_f32 s[40:41], v91, v62
  s_nop 3
  s_and_b64 s[40:41], s[40:41], vcc
  s_cmp_eq_u64 s[40:41], -1
  s_cselect_b32 s42, 0, 1
  s_or_b32 s73, s73, s42
  v_mov_b32 v90, 0x1f800000
  v_mov_b32 v91, 0x5f800000
  v_cmp_lt_f32 vcc, v90, v63
  v_cmp_gt_f32 s[40:41], v91, v63
  s_nop 3
  s_and_b64 s[40:41], s[40:41], vcc
  s_cmp_eq_u64 s[40:41], -1
  s_cselect_b32 s42, 0, 1
  s_or_b32 s73, s73, s42
  v_rcp_f32 v62, v62
  v_rcp_f32 v63, v63
  s_nop 0
  s_lshl_b32 s40, s58, 17
  v_add_u32 v54, s40, v4
  s_lshl_b32 s40, s59, 17
  v_add_u32 v55, s40, v4
  v_mul_f32 v136, v136, v62
  v_mul_f32 v152, v152, v62
  v_mul_f32 v137, v137, v62
  v_mul_f32 v153, v153, v62
  v_mul_f32 v138, v138, v62
  v_mul_f32 v154, v154, v62
  v_mul_f32 v139, v139, v62
  v_mul_f32 v155, v155, v62
  v_cvt_pk_bf16_f32 v32, v136, v137
  v_cvt_pk_bf16_f32 v33, v138, v139
  v_cvt_pk_bf16_f32 v34, v152, v153
  v_cvt_pk_bf16_f32 v35, v154, v155
  global_store_dwordx4 v54, v[32:35], s[62:63] offset:0 sc1
  v_mul_f32 v168, v168, v62
  v_mul_f32 v184, v184, v62
  v_mul_f32 v169, v169, v62
  v_mul_f32 v185, v185, v62
  v_mul_f32 v170, v170, v62
  v_mul_f32 v186, v186, v62
  v_mul_f32 v171, v171, v62
  v_mul_f32 v187, v187, v62
  v_cvt_pk_bf16_f32 v36, v168, v169
  v_cvt_pk_bf16_f32 v37, v170, v171
  v_cvt_pk_bf16_f32 v38, v184, v185
  v_cvt_pk_bf16_f32 v39, v186, v187
  global_store_dwordx4 v54, v[36:39], s[62:63] offset:1024 sc1
  v_mul_f32 v200, v200, v62
  v_mul_f32 v216, v216, v62
  v_mul_f32 v201, v201, v62
  v_mul_f32 v217, v217, v62
  v_mul_f32 v202, v202, v62
  v_mul_f32 v218, v218, v62
  v_mul_f32 v203, v203, v62
  v_mul_f32 v219, v219, v62
  v_cvt_pk_bf16_f32 v40, v200, v201
  v_cvt_pk_bf16_f32 v41, v202, v203
  v_cvt_pk_bf16_f32 v42, v216, v217
  v_cvt_pk_bf16_f32 v43, v218, v219
  global_store_dwordx4 v54, v[40:43], s[62:63] offset:2048 sc1
  v_mul_f32 v232, v232, v62
  v_mul_f32 v248, v248, v62
  v_mul_f32 v233, v233, v62
  v_mul_f32 v249, v249, v62
  v_mul_f32 v234, v234, v62
  v_mul_f32 v250, v250, v62
  v_mul_f32 v235, v235, v62
  v_mul_f32 v251, v251, v62
  v_cvt_pk_bf16_f32 v44, v232, v233
  v_cvt_pk_bf16_f32 v45, v234, v235
  v_cvt_pk_bf16_f32 v46, v248, v249
  v_cvt_pk_bf16_f32 v47, v250, v251
  global_store_dwordx4 v54, v[44:47], s[62:63] offset:3072 sc1
  v_mul_f32 v140, v140, v63
  v_mul_f32 v156, v156, v63
  v_mul_f32 v141, v141, v63
  v_mul_f32 v157, v157, v63
  v_mul_f32 v142, v142, v63
  v_mul_f32 v158, v158, v63
  v_mul_f32 v143, v143, v63
  v_mul_f32 v159, v159, v63
  v_cvt_pk_bf16_f32 v32, v140, v141
  v_cvt_pk_bf16_f32 v33, v142, v143
  v_cvt_pk_bf16_f32 v34, v156, v157
  v_cvt_pk_bf16_f32 v35, v158, v159
  global_store_dwordx4 v55, v[32:35], s[62:63] offset:0 sc1
  v_mul_f32 v172, v172, v63
  v_mul_f32 v188, v188, v63
  v_mul_f32 v173, v173, v63
  v_mul_f32 v189, v189, v63
  v_mul_f32 v174, v174, v63
  v_mul_f32 v190, v190, v63
  v_mul_f32 v175, v175, v63
  v_mul_f32 v191, v191, v63
  v_cvt_pk_bf16_f32 v36, v172, v173
  v_cvt_pk_bf16_f32 v37, v174, v175
  v_cvt_pk_bf16_f32 v38, v188, v189
  v_cvt_pk_bf16_f32 v39, v190, v191
  global_store_dwordx4 v55, v[36:39], s[62:63] offset:1024 sc1
  v_mul_f32 v204, v204, v63
  v_mul_f32 v220, v220, v63
  v_mul_f32 v205, v205, v63
  v_mul_f32 v221, v221, v63
  v_mul_f32 v206, v206, v63
  v_mul_f32 v222, v222, v63
  v_mul_f32 v207, v207, v63
  v_mul_f32 v223, v223, v63
  v_cvt_pk_bf16_f32 v40, v204, v205
  v_cvt_pk_bf16_f32 v41, v206, v207
  v_cvt_pk_bf16_f32 v42, v220, v221
  v_cvt_pk_bf16_f32 v43, v222, v223
  global_store_dwordx4 v55, v[40:43], s[62:63] offset:2048 sc1
  v_mul_f32 v236, v236, v63
  v_mul_f32 v252, v252, v63
  v_mul_f32 v237, v237, v63
  v_mul_f32 v253, v253, v63
  v_mul_f32 v238, v238, v63
  v_mul_f32 v254, v254, v63
  v_mul_f32 v239, v239, v63
  v_mul_f32 v255, v255, v63
  v_cvt_pk_bf16_f32 v44, v236, v237
  v_cvt_pk_bf16_f32 v45, v238, v239
  v_cvt_pk_bf16_f32 v46, v252, v253
  v_cvt_pk_bf16_f32 v47, v254, v255
  global_store_dwordx4 v55, v[44:47], s[62:63] offset:3072 sc1
  v_mov_b32 v28, 0x3f803f80
  v_mov_b32 v29, 0x3f803f80
  v_mov_b32 v30, 0x3f803f80
  v_mov_b32 v31, 0x3f803f80
  v_mov_b32 v20, 0
  v_mov_b32 v21, 0
  v_mov_b32 v22, 0
  v_mov_b32 v23, 0
  v_mov_b32 v24, 0
  v_mov_b32 v25, 0
  v_mov_b32 v26, 0
  v_mov_b32 v27, 0
  s_lshl_b32 s40, s22, 2
  s_add_u32 s40, s40, 16
  v_mov_b32 v90, s40
  v_mov_b32 v91, s73
  ds_write_b32 v90, v91
  s_mov_b32 s23, 0
  s_mov_b32 s33, 0
  v_and_b32 v14, 7, v1
  v_lshlrev_b32 v14, 2, v14
  s_lshl_b32 s40, s21, 3
  s_lshr_b32 s41, s20, 3
  s_add_u32 s40, s40, s41
  s_lshl_b32 s40, s40, 7
  s_add_u32 s40, s40, 8192
  v_add_u32 v14, s40, v14
  v_mov_b32 v15, 0
  v_and_b32 v92, 31, v1
  v_lshlrev_b32 v92, 2, v92
  s_lshl_b32 s40, s21, 7
  s_add_u32 s40, s40, 4096
  v_add_u32 v92, s40, v92
  global_load_dword v93, v92, s[68:69] sc1
  v_mov_b32 v76, 0
  v_mov_b32 v77, v88
  v_mov_b32 v78, v88
  v_mov_b32 v79, v88
  v_mov_b32 v84, 0
  v_mov_b32 v85, 0
  s_nop 1
  s_lshl_b32 s53, s21, 1
  s_sub_u32 s53, 14, s53
  s_cmp_eq_u32 s53, 0
  s_cbranch_scc1 L_single_diag
.p2align 5
L_single_loop:
  v_mfma_f32_16x16x32_bf16 v[64:67], a[64:67], a[0:3], v[96:99]
  ds_read_b128 a[96:99], v2 offset:16384
  v_mfma_f32_16x16x32_bf16 v[64:67], a[68:71], a[4:7], v[64:67]
  v_exp_f32 v77, v77
  v_mfma_f32_16x16x32_bf16 v[64:67], a[72:75], a[8:11], v[64:67]
  s_add_u32 s38, s54, 16384
  s_addc_u32 s39, s55, 0
  ds_read_b128 a[100:103], v2 offset:17408
  v_cvt_pk_bf16_f32 v86, v76, v77
  v_mfma_f32_16x16x32_bf16 v[64:67], a[76:79], a[12:15], v[64:67]
  s_add_u32 m0, s37, 16384
  v_exp_f32 v78, v78
  v_mfma_f32_16x16x32_bf16 v[68:71], a[80:83], a[0:3], v[100:103]
  global_load_lds_dwordx4 v4, s[38:39] offset:2048
  ds_read_b128 a[104:107], v2 offset:18432
  v_mfma_f32_16x16x32_bf16 v[68:71], a[84:87], a[4:7], v[68:71]
  v_exp_f32 v79, v79
  v_mfma_f32_16x16x32_bf16 v[68:71], a[88:91], a[8:11], v[68:71]
  ds_read_b128 a[108:111], v2 offset:19456
  v_cvt_pk_bf16_f32 v87, v78, v79
  v_mfma_f32_16x16x32_bf16 v[68:71], a[92:95], a[12:15], v[68:71]
  ds_read_b128 a[112:115], v2 offset:20480
  v_mfma_f32_16x16x32_bf16 v[132:135], a[160:163], v[84:87], v[132:135]
  v_exp_f32 v64, v64
  v_mfma_f32_16x16x32_bf16 v[148:151], a[164:167], v[84:87], v[148:151]
  global_load_lds_dwordx4 v4, s[38:39] offset:3072
  ds_read_b128 a[116:119], v2 offset:21504
  v_mfma_f32_16x16x32_bf16 v[164:167], a[168:171], v[84:87], v[164:167]
  v_exp_f32 v65, v65
  v_mfma_f32_16x16x32_bf16 v[180:183], a[172:175], v[84:87], v[180:183]
  s_add_u32 s38, s54, 32768
  s_addc_u32 s39, s55, 0
  ds_read_b128 a[120:123], v2 offset:22528
  v_cvt_pk_bf16_f32 v80, v64, v65
  v_mfma_f32_16x16x32_bf16 v[196:199], a[176:179], v[84:87], v[196:199]
  s_add_u32 m0, s37, 32768
  v_exp_f32 v66, v66
  v_mfma_f32_16x16x32_bf16 v[212:215], a[180:183], v[84:87], v[212:215]
  global_load_lds_dwordx4 v4, s[38:39] offset:0
  ds_read_b128 a[124:127], v2 offset:23552
  v_mfma_f32_16x16x32_bf16 v[228:231], a[184:187], v[84:87], v[228:231]
  v_exp_f32 v67, v67
  v_mfma_f32_16x16x32_bf16 v[244:247], a[188:191], v[84:87], v[244:247]
  v_cvt_pk_bf16_f32 v81, v66, v67
  v_mfma_f32_16x16x32_bf16 v[24:27], v[28:31], v[84:87], v[24:27]
  v_exp_f32 v68, v68
  v_mfma_f32_16x16x32_bf16 v[72:75], a[64:67], a[16:19], v[104:107]
  ds_read_b128 a[160:163], v2 offset:24576
  v_mfma_f32_16x16x32_bf16 v[72:75], a[68:71], a[20:23], v[72:75]
  v_exp_f32 v69, v69
  v_mfma_f32_16x16x32_bf16 v[72:75], a[72:75], a[24:27], v[72:75]
  ds_read_b128 a[164:167], v2 offset:25600
  v_cvt_pk_bf16_f32 v82, v68, v69
  v_mfma_f32_16x16x32_bf16 v[72:75], a[76:79], a[28:31], v[72:75]
  v_exp_f32 v70, v70
  v_mfma_f32_16x16x32_bf16 v[76:79], a[80:83], a[16:19], v[108:111]
  global_load_lds_dwordx4 v4, s[38:39] offset:1024
  ds_read_b128 a[168:171], v2 offset:26624
  v_mfma_f32_16x16x32_bf16 v[76:79], a[84:87], a[20:23], v[76:79]
  v_exp_f32 v71, v71
  v_mfma_f32_16x16x32_bf16 v[76:79], a[88:91], a[24:27], v[76:79]
  ds_read_b128 a[172:175], v2 offset:27648
  v_cvt_pk_bf16_f32 v83, v70, v71
  v_mfma_f32_16x16x32_bf16 v[76:79], a[92:95], a[28:31], v[76:79]
  s_waitcnt lgkmcnt(12)
  ds_read_b128 a[176:179], v2 offset:28672
  v_mfma_f32_16x16x32_bf16 v[128:131], a[128:131], v[80:83], v[128:131]
  v_exp_f32 v72, v72
  v_mfma_f32_16x16x32_bf16 v[144:147], a[132:135], v[80:83], v[144:147]
  global_load_lds_dwordx4 v4, s[38:39] offset:2048
  ds_read_b128 a[180:183], v2 offset:29696
  v_mfma_f32_16x16x32_bf16 v[160:163], a[136:139], v[80:83], v[160:163]
  v_exp_f32 v73, v73
  v_mfma_f32_16x16x32_bf16 v[176:179], a[140:143], v[80:83], v[176:179]
  ds_read_b128 a[184:187], v2 offset:30720
  v_cvt_pk_bf16_f32 v84, v72, v73
  v_mfma_f32_16x16x32_bf16 v[192:195], a[144:147], v[80:83], v[192:195]
  v_exp_f32 v74, v74
  v_mfma_f32_16x16x32_bf16 v[208:211], a[148:151], v[80:83], v[208:211]
  global_load_lds_dwordx4 v4, s[38:39] offset:3072
  ds_read_b128 a[188:191], v2 offset:31744
  v_mfma_f32_16x16x32_bf16 v[224:227], a[152:155], v[80:83], v[224:227]
  v_exp_f32 v75, v75
  v_mfma_f32_16x16x32_bf16 v[240:243], a[156:159], v[80:83], v[240:243]
  v_cvt_pk_bf16_f32 v85, v74, v75
  v_mfma_f32_16x16x32_bf16 v[20:23], v[28:31], v[80:83], v[20:23]
  s_waitcnt lgkmcnt(8)
  v_exp_f32 v76, v76
  v_mfma_f32_16x16x32_bf16 v[64:67], a[96:99], a[0:3], v[96:99]
  ds_read_b128 a[64:67], v2 offset:32768
  v_mfma_f32_16x16x32_bf16 v[64:67], a[100:103], a[4:7], v[64:67]
  v_exp_f32 v77, v77
  v_mfma_f32_16x16x32_bf16 v[64:67], a[104:107], a[8:11], v[64:67]
  s_add_u32 s38, s54, 49152
  s_addc_u32 s39, s55, 0
  ds_read_b128 a[68:71], v2 offset:33792
  v_cvt_pk_bf16_f32 v86, v76, v77
  v_mfma_f32_16x16x32_bf16 v[64:67], a[108:111], a[12:15], v[64:67]
  s_add_u32 m0, s37, 49152
  v_exp_f32 v78, v78
  v_mfma_f32_16x16x32_bf16 v[68:71], a[112:115], a[0:3], v[100:103]
  global_load_lds_dwordx4 v4, s[38:39] offset:0
  ds_read_b128 a[72:75], v2 offset:34816
  v_mfma_f32_16x16x32_bf16 v[68:71], a[116:119], a[4:7], v[68:71]
  v_exp_f32 v79, v79
  v_mfma_f32_16x16x32_bf16 v[68:71], a[120:123], a[8:11], v[68:71]
  ds_read_b128 a[76:79], v2 offset:35840
  v_cvt_pk_bf16_f32 v87, v78, v79
  v_mfma_f32_16x16x32_bf16 v[68:71], a[124:127], a[12:15], v[68:71]
  ds_read_b128 a[80:83], v2 offset:36864
  v_mfma_f32_16x16x32_bf16 v[132:135], a[128:131], v[84:87], v[132:135]
  v_exp_f32 v64, v64
  v_mfma_f32_16x16x32_bf16 v[148:151], a[132:135], v[84:87], v[148:151]
  ds_read_b128 a[84:87], v2 offset:37888
  v_mfma_f32_16x16x32_bf16 v[164:167], a[136:139], v[84:87], v[164:167]
  v_exp_f32 v65, v65
  v_mfma_f32_16x16x32_bf16 v[180:183], a[140:143], v[84:87], v[180:183]
  ds_read_b128 a[88:91], v2 offset:38912
  v_cvt_pk_bf16_f32 v80, v64, v65
  v_mfma_f32_16x16x32_bf16 v[196:199], a[144:147], v[84:87], v[196:199]
  v_exp_f32 v66, v66
  v_mfma_f32_16x16x32_bf16 v[212:215], a[148:151], v[84:87], v[212:215]
  global_load_lds_dwordx4 v4, s[38:39] offset:1024
  ds_read_b128 a[92:95], v2 offset:39936
  v_mfma_f32_16x16x32_bf16 v[228:231], a[152:155], v[84:87], v[228:231]
  v_exp_f32 v67, v67
  v_mfma_f32_16x16x32_bf16 v[244:247], a[156:159], v[84:87], v[244:247]
  v_cvt_pk_bf16_f32 v81, v66, v67
  v_mfma_f32_16x16x32_bf16 v[24:27], v[28:31], v[84:87], v[24:27]
  v_exp_f32 v68, v68
  v_mfma_f32_16x16x32_bf16 v[72:75], a[96:99], a[16:19], v[104:107]
  ds_read_b128 a[128:131], v2 offset:40960
  v_mfma_f32_16x16x32_bf16 v[72:75], a[100:103], a[20:23], v[72:75]
  v_exp_f32 v69, v69
  v_mfma_f32_16x16x32_bf16 v[72:75], a[104:107], a[24:27], v[72:75]
  ds_read_b128 a[132:135], v2 offset:41984
  v_cvt_pk_bf16_f32 v82, v68, v69
  v_mfma_f32_16x16x32_bf16 v[72:75], a[108:111], a[28:31], v[72:75]
  v_exp_f32 v70, v70
  v_mfma_f32_16x16x32_bf16 v[76:79], a[112:115], a[16:19], v[108:111]
  global_load_lds_dwordx4 v4, s[38:39] offset:2048
  ds_read_b128 a[136:139], v2 offset:43008
  v_mfma_f32_16x16x32_bf16 v[76:79], a[116:119], a[20:23], v[76:79]
  v_exp_f32 v71, v71
  v_mfma_f32_16x16x32_bf16 v[76:79], a[120:123], a[24:27], v[76:79]
  ds_read_b128 a[140:143], v2 offset:44032
  v_cvt_pk_bf16_f32 v83, v70, v71
  v_mfma_f32_16x16x32_bf16 v[76:79], a[124:127], a[28:31], v[76:79]
  s_waitcnt lgkmcnt(12)
  ds_read_b128 a[144:147], v2 offset:45056
  v_mfma_f32_16x16x32_bf16 v[128:131], a[160:163], v[80:83], v[128:131]
  v_exp_f32 v72, v72
  v_mfma_f32_16x16x32_bf16 v[144:147], a[164:167], v[80:83], v[144:147]
  ds_read_b128 a[148:151], v2 offset:46080
  v_mfma_f32_16x16x32_bf16 v[160:163], a[168:171], v[80:83], v[160:163]
  v_exp_f32 v73, v73
  v_mfma_f32_16x16x32_bf16 v[176:179], a[172:175], v[80:83], v[176:179]
  ds_read_b128 a[152:155], v2 offset:47104
  v_cvt_pk_bf16_f32 v84, v72, v73
  v_mfma_f32_16x16x32_bf16 v[192:195], a[176:179], v[80:83], v[192:195]
  v_exp_f32 v74, v74
  v_mfma_f32_16x16x32_bf16 v[208:211], a[180:183], v[80:83], v[208:211]
  global_load_lds_dwordx4 v4, s[38:39] offset:3072
  ds_read_b128 a[156:159], v2 offset:48128
  v_mfma_f32_16x16x32_bf16 v[224:227], a[184:187], v[80:83], v[224:227]
  v_exp_f32 v75, v75
  v_mfma_f32_16x16x32_bf16 v[240:243], a[188:191], v[80:83], v[240:243]
  v_cvt_pk_bf16_f32 v85, v74, v75
  v_mfma_f32_16x16x32_bf16 v[20:23], v[28:31], v[80:83], v[20:23]
  s_waitcnt lgkmcnt(8)
  v_exp_f32 v76, v76
  v_mfma_f32_16x16x32_bf16 v[64:67], a[64:67], a[0:3], v[96:99]
  ds_read_b128 a[96:99], v2 offset:49152
  v_mfma_f32_16x16x32_bf16 v[64:67], a[68:71], a[4:7], v[64:67]
  v_exp_f32 v77, v77
  v_mfma_f32_16x16x32_bf16 v[64:67], a[72:75], a[8:11], v[64:67]
  ds_read_b128 a[100:103], v2 offset:50176
  v_cvt_pk_bf16_f32 v86, v76, v77
  v_mfma_f32_16x16x32_bf16 v[64:67], a[76:79], a[12:15], v[64:67]
  v_exp_f32 v78, v78
  v_mfma_f32_16x16x32_bf16 v[68:71], a[80:83], a[0:3], v[100:103]
  ds_read_b128 a[104:107], v2 offset:51200
  v_mfma_f32_16x16x32_bf16 v[68:71], a[84:87], a[4:7], v[68:71]
  v_exp_f32 v79, v79
  v_mfma_f32_16x16x32_bf16 v[68:71], a[88:91], a[8:11], v[68:71]
  ds_read_b128 a[108:111], v2 offset:52224
  v_cvt_pk_bf16_f32 v87, v78, v79
  v_mfma_f32_16x16x32_bf16 v[68:71], a[92:95], a[12:15], v[68:71]
  ds_read_b128 a[112:115], v2 offset:53248
  v_mfma_f32_16x16x32_bf16 v[132:135], a[160:163], v[84:87], v[132:135]
  v_exp_f32 v64, v64
  v_mfma_f32_16x16x32_bf16 v[148:151], a[164:167], v[84:87], v[148:151]
  ds_read_b128 a[116:119], v2 offset:54272
  v_mfma_f32_16x16x32_bf16 v[164:167], a[168:171], v[84:87], v[164:167]
  v_exp_f32 v65, v65
  v_mfma_f32_16x16x32_bf16 v[180:183], a[172:175], v[84:87], v[180:183]
  ds_read_b128 a[120:123], v2 offset:55296
  v_cvt_pk_bf16_f32 v80, v64, v65
  v_mfma_f32_16x16x32_bf16 v[196:199], a[176:179], v[84:87], v[196:199]
  v_exp_f32 v66, v66
  v_mfma_f32_16x16x32_bf16 v[212:215], a[180:183], v[84:87], v[212:215]
  ds_read_b128 a[124:127], v2 offset:56320
  v_mfma_f32_16x16x32_bf16 v[228:231], a[184:187], v[84:87], v[228:231]
  v_exp_f32 v67, v67
  v_mfma_f32_16x16x32_bf16 v[244:247], a[188:191], v[84:87], v[244:247]
  v_cvt_pk_bf16_f32 v81, v66, v67
  v_mfma_f32_16x16x32_bf16 v[24:27], v[28:31], v[84:87], v[24:27]
  v_exp_f32 v68, v68
  v_mfma_f32_16x16x32_bf16 v[72:75], a[64:67], a[16:19], v[104:107]
  ds_read_b128 a[160:163], v2 offset:57344
  v_mfma_f32_16x16x32_bf16 v[72:75], a[68:71], a[20:23], v[72:75]
  v_exp_f32 v69, v69
  v_mfma_f32_16x16x32_bf16 v[72:75], a[72:75], a[24:27], v[72:75]
  ds_read_b128 a[164:167], v2 offset:58368
  v_cvt_pk_bf16_f32 v82, v68, v69
  v_mfma_f32_16x16x32_bf16 v[72:75], a[76:79], a[28:31], v[72:75]
  v_exp_f32 v70, v70
  v_mfma_f32_16x16x32_bf16 v[76:79], a[80:83], a[16:19], v[108:111]
  ds_read_b128 a[168:171], v2 offset:59392
  ds_read_b128 a[172:175], v2 offset:60416
  v_mfma_f32_16x16x32_bf16 v[76:79], a[84:87], a[20:23], v[76:79]
  v_exp_f32 v71, v71
  v_mfma_f32_16x16x32_bf16 v[76:79], a[88:91], a[24:27], v[76:79]
  ds_read_b128 a[176:179], v2 offset:61440
  v_cvt_pk_bf16_f32 v83, v70, v71
  v_mfma_f32_16x16x32_bf16 v[76:79], a[92:95], a[28:31], v[76:79]
  s_waitcnt lgkmcnt(13)
  ds_read_b128 a[180:183], v2 offset:62464
  ds_read_b128 a[184:187], v2 offset:63488
  v_mfma_f32_16x16x32_bf16 v[128:131], a[128:131], v[80:83], v[128:131]
  v_exp_f32 v72, v72
  v_mfma_f32_16x16x32_bf16 v[144:147], a[132:135], v[80:83], v[144:147]
  ds_read_b128 a[188:191], v2 offset:64512
  v_mfma_f32_16x16x32_bf16 v[160:163], a[136:139], v[80:83], v[160:163]
  v_exp_f32 v73, v73
  v_mfma_f32_16x16x32_bf16 v[176:179], a[140:143], v[80:83], v[176:179]
  v_cvt_pk_bf16_f32 v84, v72, v73
  v_mfma_f32_16x16x32_bf16 v[192:195], a[144:147], v[80:83], v[192:195]
  v_exp_f32 v74, v74
  v_mfma_f32_16x16x32_bf16 v[208:211], a[148:151], v[80:83], v[208:211]
  v_mfma_f32_16x16x32_bf16 v[224:227], a[152:155], v[80:83], v[224:227]
  v_exp_f32 v75, v75
  v_mfma_f32_16x16x32_bf16 v[240:243], a[156:159], v[80:83], v[240:243]
  v_cvt_pk_bf16_f32 v85, v74, v75
  v_mfma_f32_16x16x32_bf16 v[20:23], v[28:31], v[80:83], v[20:23]
  s_waitcnt lgkmcnt(8)
  v_exp_f32 v76, v76
  s_waitcnt vmcnt(0) lgkmcnt(0)
  s_barrier
  v_xor_b32 v2, 65536, v2
  v_mfma_f32_16x16x32_bf16 v[64:67], a[96:99], a[0:3], v[96:99]
  ds_read_b128 a[64:67], v2 offset:0
  v_mfma_f32_16x16x32_bf16 v[64:67], a[100:103], a[4:7], v[64:67]
  v_exp_f32 v77, v77
  v_mfma_f32_16x16x32_bf16 v[64:67], a[104:107], a[8:11], v[64:67]
  s_add_u32 s38, s34, 0
  s_addc_u32 s39, s35, 0
  ds_read_b128 a[68:71], v2 offset:1024
  v_cvt_pk_bf16_f32 v86, v76, v77
  v_mfma_f32_16x16x32_bf16 v[64:67], a[108:111], a[12:15], v[64:67]
  s_add_u32 m0, s36, 0
  v_exp_f32 v78, v78
  v_mfma_f32_16x16x32_bf16 v[68:71], a[112:115], a[0:3], v[100:103]
  global_load_lds_dwordx4 v4, s[38:39] offset:0
  ds_read_b128 a[72:75], v2 offset:2048
  v_mfma_f32_16x16x32_bf16 v[68:71], a[116:119], a[4:7], v[68:71]
  v_exp_f32 v79, v79
  v_mfma_f32_16x16x32_bf16 v[68:71], a[120:123], a[8:11], v[68:71]
  ds_read_b128 a[76:79], v2 offset:3072
  v_cvt_pk_bf16_f32 v87, v78, v79
  v_mfma_f32_16x16x32_bf16 v[68:71], a[124:127], a[12:15], v[68:71]
  ds_read_b128 a[80:83], v2 offset:4096
  v_mfma_f32_16x16x32_bf16 v[132:135], a[128:131], v[84:87], v[132:135]
  v_exp_f32 v64, v64
  v_mfma_f32_16x16x32_bf16 v[148:151], a[132:135], v[84:87], v[148:151]
  global_load_lds_dwordx4 v4, s[38:39] offset:1024
  ds_read_b128 a[84:87], v2 offset:5120
  v_mfma_f32_16x16x32_bf16 v[164:167], a[136:139], v[84:87], v[164:167]
  v_exp_f32 v65, v65
  v_mfma_f32_16x16x32_bf16 v[180:183], a[140:143], v[84:87], v[180:183]
  ds_read_b128 a[88:91], v2 offset:6144
  v_cvt_pk_bf16_f32 v80, v64, v65
  v_mfma_f32_16x16x32_bf16 v[196:199], a[144:147], v[84:87], v[196:199]
  v_exp_f32 v66, v66
  v_mfma_f32_16x16x32_bf16 v[212:215], a[148:151], v[84:87], v[212:215]
  global_load_lds_dwordx4 v4, s[38:39] offset:2048
  ds_read_b128 a[92:95], v2 offset:7168
  v_mfma_f32_16x16x32_bf16 v[228:231], a[152:155], v[84:87], v[228:231]
  v_exp_f32 v67, v67
  v_mfma_f32_16x16x32_bf16 v[244:247], a[156:159], v[84:87], v[244:247]
  v_cvt_pk_bf16_f32 v81, v66, v67
  v_mfma_f32_16x16x32_bf16 v[24:27], v[28:31], v[84:87], v[24:27]
  v_exp_f32 v68, v68
  v_mfma_f32_16x16x32_bf16 v[72:75], a[96:99], a[16:19], v[104:107]
  ds_read_b128 a[128:131], v2 offset:8192
  v_mfma_f32_16x16x32_bf16 v[72:75], a[100:103], a[20:23], v[72:75]
  v_exp_f32 v69, v69
  v_mfma_f32_16x16x32_bf16 v[72:75], a[104:107], a[24:27], v[72:75]
  ds_read_b128 a[132:135], v2 offset:9216
  v_cvt_pk_bf16_f32 v82, v68, v69
  v_mfma_f32_16x16x32_bf16 v[72:75], a[108:111], a[28:31], v[72:75]
  v_exp_f32 v70, v70
  v_mfma_f32_16x16x32_bf16 v[76:79], a[112:115], a[16:19], v[108:111]
  global_load_lds_dwordx4 v4, s[38:39] offset:3072
  ds_read_b128 a[136:139], v2 offset:10240
  v_mfma_f32_16x16x32_bf16 v[76:79], a[116:119], a[20:23], v[76:79]
  v_exp_f32 v71, v71
  v_mfma_f32_16x16x32_bf16 v[76:79], a[120:123], a[24:27], v[76:79]
  ds_read_b128 a[140:143], v2 offset:11264
  v_cvt_pk_bf16_f32 v83, v70, v71
  v_mfma_f32_16x16x32_bf16 v[76:79], a[124:127], a[28:31], v[76:79]
  s_waitcnt lgkmcnt(12)
  s_add_u32 s38, s34, 16384
  s_addc_u32 s39, s35, 0
  ds_read_b128 a[144:147], v2 offset:12288
  v_mfma_f32_16x16x32_bf16 v[128:131], a[160:163], v[80:83], v[128:131]
  s_add_u32 m0, s36, 16384
  v_exp_f32 v72, v72
  v_mfma_f32_16x16x32_bf16 v[144:147], a[164:167], v[80:83], v[144:147]
  global_load_lds_dwordx4 v4, s[38:39] offset:0
  ds_read_b128 a[148:151], v2 offset:13312
  v_mfma_f32_16x16x32_bf16 v[160:163], a[168:171], v[80:83], v[160:163]
  v_exp_f32 v73, v73
  v_mfma_f32_16x16x32_bf16 v[176:179], a[172:175], v[80:83], v[176:179]
  ds_read_b128 a[152:155], v2 offset:14336
  v_cvt_pk_bf16_f32 v84, v72, v73
  v_mfma_f32_16x16x32_bf16 v[192:195], a[176:179], v[80:83], v[192:195]
  v_exp_f32 v74, v74
  v_mfma_f32_16x16x32_bf16 v[208:211], a[180:183], v[80:83], v[208:211]
  global_load_lds_dwordx4 v4, s[38:39] offset:1024
  ds_read_b128 a[156:159], v2 offset:15360
  v_mfma_f32_16x16x32_bf16 v[224:227], a[184:187], v[80:83], v[224:227]
  v_exp_f32 v75, v75
  v_mfma_f32_16x16x32_bf16 v[240:243], a[188:191], v[80:83], v[240:243]
  v_cvt_pk_bf16_f32 v85, v74, v75
  v_mfma_f32_16x16x32_bf16 v[20:23], v[28:31], v[80:83], v[20:23]
  s_waitcnt lgkmcnt(8)
  v_exp_f32 v76, v76
  s_mov_b64 s[54:55], s[34:35]
  s_mov_b32 s37, s36
  s_cmp_gt_u32 s52, 1
  s_cselect_b32 s38, 0x10000, 0
  s_add_u32 s34, s34, s38
  s_addc_u32 s35, s35, 0
  s_xor_b32 s36, s36, 65536
  s_max_u32 s52, s52, 1
  s_sub_u32 s52, s52, 1
  s_sub_u32 s53, s53, 1
  s_cmp_lg_u32 s53, 0
  s_cbranch_scc1 L_single_loop
L_single_diag:
  s_waitcnt vmcnt(0)
  s_load_dwordx2 s[8:9], s[0:1], 40
  s_load_dwordx2 s[10:11], s[0:1], 72
  s_load_dwordx2 s[18:19], s[0:1], 80
  s_waitcnt lgkmcnt(0)
  s_nop 0
  v_cmp_ne_u32 vcc, s71, v93
  s_nop 3
  s_cmp_eq_u64 vcc, 0
  s_cbranch_scc0 L_spin41
L_back41:
  s_lshr_b32 s40, s20, 2
  s_xor_b32 s40, s40, s21
  s_and_b32 s40, s40, 1
  s_sub_u32 s41, 15, s21
  s_cmp_eq_u32 s40, 0
  s_cselect_b32 s40, s21, s41
  s_lshl_b32 s40, s40, 2
  s_and_b32 s41, s20, 3
  s_add_u32 s40, s40, s41
  s_mul_i32 s40, s40, 88064
  s_lshr_b32 s41, s20, 3
  s_mul_i32 s42, s41, 22528
  s_add_u32 s40, s40, s42
  s_add_u32 s40, s40, 35651584
  s_cmp_eq_u32 s41, 3
  s_cselect_b32 s43, 16, 0
  s_sub_u32 s43, 175, s43
  s_cmp_eq_u32 s22, 1
  s_cbranch_scc0 L_hintl_h0
  v_add_u32 v49, 0, v1
  v_min_u32 v49, s43, v49
  v_lshlrev_b32 v49, 7, v49
  v_add_u32 v49, s40, v49
  global_load_dword v48, v49, s[12:13]
L_hintl_h0:
  s_cmp_eq_u32 s22, 2
  s_cbranch_scc0 L_hintl_h1
  v_add_u32 v49, 64, v1
  v_min_u32 v49, s43, v49
  v_lshlrev_b32 v49, 7, v49
  v_add_u32 v49, s40, v49
  global_load_dword v48, v49, s[12:13]
L_hintl_h1:
  s_cmp_eq_u32 s22, 3
  s_cbranch_scc0 L_hintl_h2
  v_add_u32 v49, 128, v1
  v_min_u32 v49, s43, v49
  v_lshlrev_b32 v49, 7, v49
  v_add_u32 v49, s40, v49
  global_load_dword v48, v49, s[12:13]
L_hintl_h2:
  s_cmp_ge_u32 s21, 4
  s_cbranch_scc0 L_hintl_nw
  s_lshr_b32 s40, s2, 3
  s_sub_u32 s40, s40, 16
  s_lshr_b32 s41, s20, 3
  s_lshl_b32 s42, s41, 20
  s_lshl_b32 s43, s40, 16
  s_add_u32 s42, s42, s43
  v_lshlrev_b32 v3, 7, v1
  v_add_u32 v3, s42, v3
  s_mul_i32 s42, s41, 360448
  s_mul_i32 s43, s40, 22528
  s_add_u32 s42, s42, s43
  v_lshlrev_b32 v7, 7, v1
  v_add_u32 v7, s42, v7
  v_min_u32 v7, 1384448, v7
  s_cmp_eq_u32 s22, 0
  s_cbranch_scc0 L_hintl_t0
  s_add_u32 s28, s10, 0
  s_addc_u32 s29, s11, 0
  global_load_dword v48, v7, s[28:29]
L_hintl_t0:
  s_cmp_eq_u32 s22, 1
  s_cbranch_scc0 L_hintl_t1
  s_add_u32 s28, s10, 8192
  s_addc_u32 s29, s11, 0
  global_load_dword v48, v7, s[28:29]
L_hintl_t1:
  s_cmp_eq_u32 s22, 2
  s_cbranch_scc0 L_hintl_t2
  s_add_u32 s28, s10, 16384
  s_addc_u32 s29, s11, 0
  global_load_dword v48, v7, s[28:29]
L_hintl_t2:
  s_cmp_eq_u32 s22, 3
  s_cbranch_scc0 L_hintl_t3
  s_add_u32 s28, s8, 0
  s_addc_u32 s29, s9, 0
  global_load_dword v48, v3, s[28:29]
L_hintl_t3:
  s_cmp_eq_u32 s22, 0
  s_cbranch_scc0 L_hintl_t4
  s_add_u32 s28, s8, 8192
  s_addc_u32 s29, s9, 0
  global_load_dword v48, v3, s[28:29]
L_hintl_t4:
  s_cmp_eq_u32 s22, 1
  s_cbranch_scc0 L_hintl_t5
  s_add_u32 s28, s8, 16384
  s_addc_u32 s29, s9, 0
  global_load_dword v48, v3, s[28:29]
L_hintl_t5:
  s_cmp_eq_u32 s22, 2
  s_cbranch_scc0 L_hintl_t6
  s_add_u32 s28, s8, 24576
  s_addc_u32 s29, s9, 0
  global_load_dword v48, v3, s[28:29]
L_hintl_t6:
  s_cmp_eq_u32 s22, 3
  s_cbranch_scc0 L_hintl_t7
  s_add_u32 s28, s8, 32768
  s_addc_u32 s29, s9, 0
  global_load_dword v48, v3, s[28:29]
L_hintl_t7:
  s_cmp_eq_u32 s22, 0
  s_cbranch_scc0 L_hintl_t8
  s_add_u32 s28, s8, 40960
  s_addc_u32 s29, s9, 0
  global_load_dword v48, v3, s[28:29]
L_hintl_t8:
  s_cmp_eq_u32 s22, 1
  s_cbranch_scc0 L_hintl_t9
  s_add_u32 s28, s8, 49152
  s_addc_u32 s29, s9, 0
  global_load_dword v48, v3, s[28:29]
L_hintl_t9:
  s_cmp_eq_u32 s22, 2
  s_cbranch_scc0 L_hintl_t10
  s_add_u32 s28, s8, 57344
  s_addc_u32 s29, s9, 0
  global_load_dword v48, v3, s[28:29]
L_hintl_t10:
L_hintl_nw:
  s_mov_b32 s33, 1
  s_cmp_eq_u32 s22, 0
  s_cbranch_scc0 Lsd_m0_a
  v_cndmask_b32 v96, v88, v56, s[44:45]
  v_cndmask_b32 v97, v88, v56, s[46:47]
  v_cndmask_b32 v98, v88, v56, s[48:49]
  v_cndmask_b32 v99, v88, v56, s[50:51]
  v_mov_b32 v100, v88
  v_mov_b32 v101, v88
  v_mov_b32 v102, v88
  v_mov_b32 v103, v88
  v_cndmask_b32 v108, v88, v57, s[44:45]
  v_cndmask_b32 v109, v88, v57, s[46:47]
  v_cndmask_b32 v110, v88, v57, s[48:49]
  v_cndmask_b32 v111, v88, v57, s[50:51]
Lsd_m0_a:
  s_nop 1
  v_mfma_f32_16x16x32_bf16 v[64:67], a[64:67], a[0:3], v[96:99]
  ds_read_b128 a[96:99], v2 offset:16384
  v_mfma_f32_16x16x32_bf16 v[64:67], a[68:71], a[4:7], v[64:67]
  v_exp_f32 v77, v77
  v_mfma_f32_16x16x32_bf16 v[64:67], a[72:75], a[8:11], v[64:67]
  ds_read_b128 a[100:103], v2 offset:17408
  v_cvt_pk_bf16_f32 v86, v76, v77
  v_mfma_f32_16x16x32_bf16 v[64:67], a[76:79], a[12:15], v[64:67]
  v_exp_f32 v78, v78
  v_mfma_f32_16x16x32_bf16 v[68:71], a[80:83], a[0:3], v[100:103]
  ds_read_b128 a[104:107], v2 offset:18432
  v_mfma_f32_16x16x32_bf16 v[68:71], a[84:87], a[4:7], v[68:71]
  v_exp_f32 v79, v79
  v_mfma_f32_16x16x32_bf16 v[68:71], a[88:91], a[8:11], v[68:71]
  ds_read_b128 a[108:111], v2 offset:19456
  v_cvt_pk_bf16_f32 v87, v78, v79
  v_mfma_f32_16x16x32_bf16 v[68:71], a[92:95], a[12:15], v[68:71]
  ds_read_b128 a[112:115], v2 offset:20480
  v_mfma_f32_16x16x32_bf16 v[132:135], a[160:163], v[84:87], v[132:135]
  v_exp_f32 v64, v64
  v_mfma_f32_16x16x32_bf16 v[148:151], a[164:167], v[84:87], v[148:151]
  ds_read_b128 a[116:119], v2 offset:21504
  v_mfma_f32_16x16x32_bf16 v[164:167], a[168:171], v[84:87], v[164:167]
  v_exp_f32 v65, v65
  v_mfma_f32_16x16x32_bf16 v[180:183], a[172:175], v[84:87], v[180:183]
  ds_read_b128 a[120:123], v2 offset:22528
  v_cvt_pk_bf16_f32 v80, v64, v65
  v_mfma_f32_16x16x32_bf16 v[196:199], a[176:179], v[84:87], v[196:199]
  v_exp_f32 v66, v66
  v_mfma_f32_16x16x32_bf16 v[212:215], a[180:183], v[84:87], v[212:215]
  ds_read_b128 a[124:127], v2 offset:23552
  v_mfma_f32_16x16x32_bf16 v[228:231], a[184:187], v[84:87], v[228:231]
  v_exp_f32 v67, v67
  v_mfma_f32_16x16x32_bf16 v[244:247], a[188:191], v[84:87], v[244:247]
  v_cvt_pk_bf16_f32 v81, v66, v67
  v_mfma_f32_16x16x32_bf16 v[24:27], v[28:31], v[84:87], v[24:27]
  v_exp_f32 v68, v68
  v_mfma_f32_16x16x32_bf16 v[72:75], a[64:67], a[16:19], v[104:107]
  ds_read_b128 a[160:163], v2 offset:24576
  v_mfma_f32_16x16x32_bf16 v[72:75], a[68:71], a[20:23], v[72:75]
  v_exp_f32 v69, v69
  v_mfma_f32_16x16x32_bf16 v[72:75], a[72:75], a[24:27], v[72:75]
  ds_read_b128 a[164:167], v2 offset:25600
  v_cvt_pk_bf16_f32 v82, v68, v69
  v_mfma_f32_16x16x32_bf16 v[72:75], a[76:79], a[28:31], v[72:75]
  v_exp_f32 v70, v70
  v_mfma_f32_16x16x32_bf16 v[76:79], a[80:83], a[16:19], v[108:111]
  ds_read_b128 a[168:171], v2 offset:26624
  v_mfma_f32_16x16x32_bf16 v[76:79], a[84:87], a[20:23], v[76:79]
  v_exp_f32 v71, v71
  v_mfma_f32_16x16x32_bf16 v[76:79], a[88:91], a[24:27], v[76:79]
  ds_read_b128 a[172:175], v2 offset:27648
  v_cvt_pk_bf16_f32 v83, v70, v71
  v_mfma_f32_16x16x32_bf16 v[76:79], a[92:95], a[28:31], v[76:79]
  s_waitcnt lgkmcnt(12)
  ds_read_b128 a[176:179], v2 offset:28672
  v_mfma_f32_16x16x32_bf16 v[128:131], a[128:131], v[80:83], v[128:131]
  v_exp_f32 v72, v72
  v_mfma_f32_16x16x32_bf16 v[144:147], a[132:135], v[80:83], v[144:147]
  ds_read_b128 a[180:183], v2 offset:29696
  v_mfma_f32_16x16x32_bf16 v[160:163], a[136:139], v[80:83], v[160:163]
  v_exp_f32 v73, v73
  v_mfma_f32_16x16x32_bf16 v[176:179], a[140:143], v[80:83], v[176:179]
  ds_read_b128 a[184:187], v2 offset:30720
  v_cvt_pk_bf16_f32 v84, v72, v73
  v_mfma_f32_16x16x32_bf16 v[192:195], a[144:147], v[80:83], v[192:195]
  v_exp_f32 v74, v74
  v_mfma_f32_16x16x32_bf16 v[208:211], a[148:151], v[80:83], v[208:211]
  ds_read_b128 a[188:191], v2 offset:31744
  v_mfma_f32_16x16x32_bf16 v[224:227], a[152:155], v[80:83], v[224:227]
  v_exp_f32 v75, v75
  v_mfma_f32_16x16x32_bf16 v[240:243], a[156:159], v[80:83], v[240:243]
  v_cvt_pk_bf16_f32 v85, v74, v75
  v_mfma_f32_16x16x32_bf16 v[20:23], v[28:31], v[80:83], v[20:23]
  s_waitcnt lgkmcnt(8)
  v_exp_f32 v76, v76
  s_cmp_eq_u32 s22, 0
  s_cbranch_scc1 Lsd_exit0
  s_cmp_eq_u32 s22, 1
  s_cbranch_scc0 Lsd_m1_a
  v_cndmask_b32 v96, v88, v56, s[44:45]
  v_cndmask_b32 v97, v88, v56, s[46:47]
  v_cndmask_b32 v98, v88, v56, s[48:49]
  v_cndmask_b32 v99, v88, v56, s[50:51]
  v_mov_b32 v100, v88
  v_mov_b32 v101, v88
  v_mov_b32 v102, v88
  v_mov_b32 v103, v88
  v_cndmask_b32 v108, v88, v57, s[44:45]
  v_cndmask_b32 v109, v88, v57, s[46:47]
  v_cndmask_b32 v110, v88, v57, s[48:49]
  v_cndmask_b32 v111, v88, v57, s[50:51]
Lsd_m1_a:
  s_cmp_eq_u32 s22, 0
  s_cbranch_scc0 Lsd_m1_b
  v_mov_b32 v96, v88
  v_mov_b32 v97, v88
  v_mov_b32 v98, v88
  v_mov_b32 v99, v88
  v_mov_b32 v104, v88
  v_mov_b32 v105, v88
  v_mov_b32 v106, v88
  v_mov_b32 v107, v88
  v_mov_b32 v108, v88
  v_mov_b32 v109, v88
  v_mov_b32 v110, v88
  v_mov_b32 v111, v88
Lsd_m1_b:
  s_nop 1
  v_mfma_f32_16x16x32_bf16 v[64:67], a[96:99], a[0:3], v[96:99]
  ds_read_b128 a[64:67], v2 offset:32768
  v_mfma_f32_16x16x32_bf16 v[64:67], a[100:103], a[4:7], v[64:67]
  v_exp_f32 v77, v77
  v_mfma_f32_16x16x32_bf16 v[64:67], a[104:107], a[8:11], v[64:67]
  ds_read_b128 a[68:71], v2 offset:33792
  v_cvt_pk_bf16_f32 v86, v76, v77
  v_mfma_f32_16x16x32_bf16 v[64:67], a[108:111], a[12:15], v[64:67]
  v_exp_f32 v78, v78
  v_mfma_f32_16x16x32_bf16 v[68:71], a[112:115], a[0:3], v[100:103]
  ds_read_b128 a[72:75], v2 offset:34816
  v_mfma_f32_16x16x32_bf16 v[68:71], a[116:119], a[4:7], v[68:71]
  v_exp_f32 v79, v79
  v_mfma_f32_16x16x32_bf16 v[68:71], a[120:123], a[8:11], v[68:71]
  ds_read_b128 a[76:79], v2 offset:35840
  v_cvt_pk_bf16_f32 v87, v78, v79
  v_mfma_f32_16x16x32_bf16 v[68:71], a[124:127], a[12:15], v[68:71]
  ds_read_b128 a[80:83], v2 offset:36864
  v_mfma_f32_16x16x32_bf16 v[132:135], a[128:131], v[84:87], v[132:135]
  v_exp_f32 v64, v64
  v_mfma_f32_16x16x32_bf16 v[148:151], a[132:135], v[84:87], v[148:151]
  ds_read_b128 a[84:87], v2 offset:37888
  v_mfma_f32_16x16x32_bf16 v[164:167], a[136:139], v[84:87], v[164:167]
  v_exp_f32 v65, v65
  v_mfma_f32_16x16x32_bf16 v[180:183], a[140:143], v[84:87], v[180:183]
  ds_read_b128 a[88:91], v2 offset:38912
  v_cvt_pk_bf16_f32 v80, v64, v65
  v_mfma_f32_16x16x32_bf16 v[196:199], a[144:147], v[84:87], v[196:199]
  v_exp_f32 v66, v66
  v_mfma_f32_16x16x32_bf16 v[212:215], a[148:151], v[84:87], v[212:215]
  ds_read_b128 a[92:95], v2 offset:39936
  v_mfma_f32_16x16x32_bf16 v[228:231], a[152:155], v[84:87], v[228:231]
  v_exp_f32 v67, v67
  v_mfma_f32_16x16x32_bf16 v[244:247], a[156:159], v[84:87], v[244:247]
  v_cvt_pk_bf16_f32 v81, v66, v67
  v_mfma_f32_16x16x32_bf16 v[24:27], v[28:31], v[84:87], v[24:27]
  v_exp_f32 v68, v68
  v_mfma_f32_16x16x32_bf16 v[72:75], a[96:99], a[16:19], v[104:107]
  ds_read_b128 a[128:131], v2 offset:40960
  v_mfma_f32_16x16x32_bf16 v[72:75], a[100:103], a[20:23], v[72:75]
  v_exp_f32 v69, v69
  v_mfma_f32_16x16x32_bf16 v[72:75], a[104:107], a[24:27], v[72:75]
  ds_read_b128 a[132:135], v2 offset:41984
  v_cvt_pk_bf16_f32 v82, v68, v69
  v_mfma_f32_16x16x32_bf16 v[72:75], a[108:111], a[28:31], v[72:75]
  v_exp_f32 v70, v70
  v_mfma_f32_16x16x32_bf16 v[76:79], a[112:115], a[16:19], v[108:111]
  ds_read_b128 a[136:139], v2 offset:43008
  v_mfma_f32_16x16x32_bf16 v[76:79], a[116:119], a[20:23], v[76:79]
  v_exp_f32 v71, v71
  v_mfma_f32_16x16x32_bf16 v[76:79], a[120:123], a[24:27], v[76:79]
  ds_read_b128 a[140:143], v2 offset:44032
  v_cvt_pk_bf16_f32 v83, v70, v71
  v_mfma_f32_16x16x32_bf16 v[76:79], a[124:127], a[28:31], v[76:79]
  s_waitcnt lgkmcnt(12)
  ds_read_b128 a[144:147], v2 offset:45056
  v_mfma_f32_16x16x32_bf16 v[128:131], a[160:163], v[80:83], v[128:131]
  v_exp_f32 v72, v72
  v_mfma_f32_16x16x32_bf16 v[144:147], a[164:167], v[80:83], v[144:147]
  ds_read_b128 a[148:151], v2 offset:46080
  v_mfma_f32_16x16x32_bf16 v[160:163], a[168:171], v[80:83], v[160:163]
  v_exp_f32 v73, v73
  v_mfma_f32_16x16x32_bf16 v[176:179], a[172:175], v[80:83], v[176:179]
  ds_read_b128 a[152:155], v2 offset:47104
  v_cvt_pk_bf16_f32 v84, v72, v73
  v_mfma_f32_16x16x32_bf16 v[192:195], a[176:179], v[80:83], v[192:195]
  v_exp_f32 v74, v74
  v_mfma_f32_16x16x32_bf16 v[208:211], a[180:183], v[80:83], v[208:211]
  ds_read_b128 a[156:159], v2 offset:48128
  v_mfma_f32_16x16x32_bf16 v[224:227], a[184:187], v[80:83], v[224:227]
  v_exp_f32 v75, v75
  v_mfma_f32_16x16x32_bf16 v[240:243], a[188:191], v[80:83], v[240:243]
  v_cvt_pk_bf16_f32 v85, v74, v75
  v_mfma_f32_16x16x32_bf16 v[20:23], v[28:31], v[80:83], v[20:23]
  s_waitcnt lgkmcnt(8)
  v_exp_f32 v76, v76
  s_cmp_eq_u32 s22, 1
  s_cbranch_scc1 Lsd_exit1
  s_cmp_eq_u32 s22, 2
  s_cbranch_scc0 Lsd_m2_a
  v_cndmask_b32 v96, v88, v56, s[44:45]
  v_cndmask_b32 v97, v88, v56, s[46:47]
  v_cndmask_b32 v98, v88, v56, s[48:49]
  v_cndmask_b32 v99, v88, v56, s[50:51]
  v_mov_b32 v100, v88
  v_mov_b32 v101, v88
  v_mov_b32 v102, v88
  v_mov_b32 v103, v88
  v_cndmask_b32 v108, v88, v57, s[44:45]
  v_cndmask_b32 v109, v88, v57, s[46:47]
  v_cndmask_b32 v110, v88, v57, s[48:49]
  v_cndmask_b32 v111, v88, v57, s[50:51]
Lsd_m2_a:
  s_cmp_eq_u32 s22, 1
  s_cbranch_scc0 Lsd_m2_b
  v_mov_b32 v96, v88
  v_mov_b32 v97, v88
  v_mov_b32 v98, v88
  v_mov_b32 v99, v88
  v_mov_b32 v104, v88
  v_mov_b32 v105, v88
  v_mov_b32 v106, v88
  v_mov_b32 v107, v88
  v_mov_b32 v108, v88
  v_mov_b32 v109, v88
  v_mov_b32 v110, v88
  v_mov_b32 v111, v88
Lsd_m2_b:
  s_nop 1
  v_mfma_f32_16x16x32_bf16 v[64:67], a[64:67], a[0:3], v[96:99]
  ds_read_b128 a[96:99], v2 offset:49152
  v_mfma_f32_16x16x32_bf16 v[64:67], a[68:71], a[4:7], v[64:67]
  v_exp_f32 v77, v77
  v_mfma_f32_16x16x32_bf16 v[64:67], a[72:75], a[8:11], v[64:67]
  ds_read_b128 a[100:103], v2 offset:50176
  v_cvt_pk_bf16_f32 v86, v76, v77
  v_mfma_f32_16x16x32_bf16 v[64:67], a[76:79], a[12:15], v[64:67]
  v_exp_f32 v78, v78
  v_mfma_f32_16x16x32_bf16 v[68:71], a[80:83], a[0:3], v[100:103]
  ds_read_b128 a[104:107], v2 offset:51200
  v_mfma_f32_16x16x32_bf16 v[68:71], a[84:87], a[4:7], v[68:71]
  v_exp_f32 v79, v79
  v_mfma_f32_16x16x32_bf16 v[68:71], a[88:91], a[8:11], v[68:71]
  ds_read_b128 a[108:111], v2 offset:52224
  v_cvt_pk_bf16_f32 v87, v78, v79
  v_mfma_f32_16x16x32_bf16 v[68:71], a[92:95], a[12:15], v[68:71]
  ds_read_b128 a[112:115], v2 offset:53248
  v_mfma_f32_16x16x32_bf16 v[132:135], a[160:163], v[84:87], v[132:135]
  v_exp_f32 v64, v64
  v_mfma_f32_16x16x32_bf16 v[148:151], a[164:167], v[84:87], v[148:151]
  ds_read_b128 a[116:119], v2 offset:54272
  v_mfma_f32_16x16x32_bf16 v[164:167], a[168:171], v[84:87], v[164:167]
  v_exp_f32 v65, v65
  v_mfma_f32_16x16x32_bf16 v[180:183], a[172:175], v[84:87], v[180:183]
  ds_read_b128 a[120:123], v2 offset:55296
  v_cvt_pk_bf16_f32 v80, v64, v65
  v_mfma_f32_16x16x32_bf16 v[196:199], a[176:179], v[84:87], v[196:199]
  v_exp_f32 v66, v66
  v_mfma_f32_16x16x32_bf16 v[212:215], a[180:183], v[84:87], v[212:215]
  ds_read_b128 a[124:127], v2 offset:56320
  v_mfma_f32_16x16x32_bf16 v[228:231], a[184:187], v[84:87], v[228:231]
  v_exp_f32 v67, v67
  v_mfma_f32_16x16x32_bf16 v[244:247], a[188:191], v[84:87], v[244:247]
  v_cvt_pk_bf16_f32 v81, v66, v67
  v_mfma_f32_16x16x32_bf16 v[24:27], v[28:31], v[84:87], v[24:27]
  v_exp_f32 v68, v68
  v_mfma_f32_16x16x32_bf16 v[72:75], a[64:67], a[16:19], v[104:107]
  ds_read_b128 a[160:163], v2 offset:57344
  v_mfma_f32_16x16x32_bf16 v[72:75], a[68:71], a[20:23], v[72:75]
  v_exp_f32 v69, v69
  v_mfma_f32_16x16x32_bf16 v[72:75], a[72:75], a[24:27], v[72:75]
  ds_read_b128 a[164:167], v2 offset:58368
  v_cvt_pk_bf16_f32 v82, v68, v69
  v_mfma_f32_16x16x32_bf16 v[72:75], a[76:79], a[28:31], v[72:75]
  v_exp_f32 v70, v70
  v_mfma_f32_16x16x32_bf16 v[76:79], a[80:83], a[16:19], v[108:111]
  ds_read_b128 a[168:171], v2 offset:59392
  ds_read_b128 a[172:175], v2 offset:60416
  v_mfma_f32_16x16x32_bf16 v[76:79], a[84:87], a[20:23], v[76:79]
  v_exp_f32 v71, v71
  v_mfma_f32_16x16x32_bf16 v[76:79], a[88:91], a[24:27], v[76:79]
  ds_read_b128 a[176:179], v2 offset:61440
  v_cvt_pk_bf16_f32 v83, v70, v71
  v_mfma_f32_16x16x32_bf16 v[76:79], a[92:95], a[28:31], v[76:79]
  s_waitcnt lgkmcnt(13)
  ds_read_b128 a[180:183], v2 offset:62464
  ds_read_b128 a[184:187], v2 offset:63488
  v_mfma_f32_16x16x32_bf16 v[128:131], a[128:131], v[80:83], v[128:131]
  v_exp_f32 v72, v72
  v_mfma_f32_16x16x32_bf16 v[144:147], a[132:135], v[80:83], v[144:147]
  ds_read_b128 a[188:191], v2 offset:64512
  v_mfma_f32_16x16x32_bf16 v[160:163], a[136:139], v[80:83], v[160:163]
  v_exp_f32 v73, v73
  v_mfma_f32_16x16x32_bf16 v[176:179], a[140:143], v[80:83], v[176:179]
  v_cvt_pk_bf16_f32 v84, v72, v73
  v_mfma_f32_16x16x32_bf16 v[192:195], a[144:147], v[80:83], v[192:195]
  v_exp_f32 v74, v74
  v_mfma_f32_16x16x32_bf16 v[208:211], a[148:151], v[80:83], v[208:211]
  v_mfma_f32_16x16x32_bf16 v[224:227], a[152:155], v[80:83], v[224:227]
  v_exp_f32 v75, v75
  v_mfma_f32_16x16x32_bf16 v[240:243], a[156:159], v[80:83], v[240:243]
  v_cvt_pk_bf16_f32 v85, v74, v75
  v_mfma_f32_16x16x32_bf16 v[20:23], v[28:31], v[80:83], v[20:23]
  s_waitcnt lgkmcnt(8)
  v_exp_f32 v76, v76
  s_cmp_eq_u32 s22, 2
  s_cbranch_scc1 Lsd_exit0
  s_cmp_eq_u32 s22, 3
  s_cbranch_scc0 Lsd_m3_a
  v_cndmask_b32 v96, v88, v56, s[44:45]
  v_cndmask_b32 v97, v88, v56, s[46:47]
  v_cndmask_b32 v98, v88, v56, s[48:49]
  v_cndmask_b32 v99, v88, v56, s[50:51]
  v_mov_b32 v100, v88
  v_mov_b32 v101, v88
  v_mov_b32 v102, v88
  v_mov_b32 v103, v88
  v_cndmask_b32 v108, v88, v57, s[44:45]
  v_cndmask_b32 v109, v88, v57, s[46:47]
  v_cndmask_b32 v110, v88, v57, s[48:49]
  v_cndmask_b32 v111, v88, v57, s[50:51]
Lsd_m3_a:
  s_cmp_eq_u32 s22, 2
  s_cbranch_scc0 Lsd_m3_b
  v_mov_b32 v96, v88
  v_mov_b32 v97, v88
  v_mov_b32 v98, v88
  v_mov_b32 v99, v88
  v_mov_b32 v104, v88
  v_mov_b32 v105, v88
  v_mov_b32 v106, v88
  v_mov_b32 v107, v88
  v_mov_b32 v108, v88
  v_mov_b32 v109, v88
  v_mov_b32 v110, v88
  v_mov_b32 v111, v88
Lsd_m3_b:
  s_nop 1
  v_mfma_f32_16x16x32_bf16 v[64:67], a[96:99], a[0:3], v[96:99]
  s_nop 0
  v_mfma_f32_16x16x32_bf16 v[64:67], a[100:103], a[4:7], v[64:67]
  v_exp_f32 v77, v77
  v_mfma_f32_16x16x32_bf16 v[64:67], a[104:107], a[8:11], v[64:67]
  v_cvt_pk_bf16_f32 v86, v76, v77
  s_nop 0
  v_mfma_f32_16x16x32_bf16 v[64:67], a[108:111], a[12:15], v[64:67]
  v_exp_f32 v78, v78
  v_mfma_f32_16x16x32_bf16 v[68:71], a[112:115], a[0:3], v[100:103]
  s_nop 0
  v_mfma_f32_16x16x32_bf16 v[68:71], a[116:119], a[4:7], v[68:71]
  v_exp_f32 v79, v79
  v_mfma_f32_16x16x32_bf16 v[68:71], a[120:123], a[8:11], v[68:71]
  v_cvt_pk_bf16_f32 v87, v78, v79
  s_nop 0
  v_mfma_f32_16x16x32_bf16 v[68:71], a[124:127], a[12:15], v[68:71]
  s_nop 0
  v_mfma_f32_16x16x32_bf16 v[132:135], a[128:131], v[84:87], v[132:135]
  v_exp_f32 v64, v64
  v_mfma_f32_16x16x32_bf16 v[148:151], a[132:135], v[84:87], v[148:151]
  v_mfma_f32_16x16x32_bf16 v[164:167], a[136:139], v[84:87], v[164:167]
  v_exp_f32 v65, v65
  v_mfma_f32_16x16x32_bf16 v[180:183], a[140:143], v[84:87], v[180:183]
  v_cvt_pk_bf16_f32 v80, v64, v65
  v_mfma_f32_16x16x32_bf16 v[196:199], a[144:147], v[84:87], v[196:199]
  v_exp_f32 v66, v66
  v_mfma_f32_16x16x32_bf16 v[212:215], a[148:151], v[84:87], v[212:215]
  v_mfma_f32_16x16x32_bf16 v[228:231], a[152:155], v[84:87], v[228:231]
  v_exp_f32 v67, v67
  v_mfma_f32_16x16x32_bf16 v[244:247], a[156:159], v[84:87], v[244:247]
  v_cvt_pk_bf16_f32 v81, v66, v67
  v_mfma_f32_16x16x32_bf16 v[24:27], v[28:31], v[84:87], v[24:27]
  v_exp_f32 v68, v68
  v_mfma_f32_16x16x32_bf16 v[72:75], a[96:99], a[16:19], v[104:107]
  v_mfma_f32_16x16x32_bf16 v[72:75], a[100:103], a[20:23], v[72:75]
  v_exp_f32 v69, v69
  v_mfma_f32_16x16x32_bf16 v[72:75], a[104:107], a[24:27], v[72:75]
  v_cvt_pk_bf16_f32 v82, v68, v69
  v_mfma_f32_16x16x32_bf16 v[72:75], a[108:111], a[28:31], v[72:75]
  v_exp_f32 v70, v70
  v_mfma_f32_16x16x32_bf16 v[76:79], a[112:115], a[16:19], v[108:111]
  v_mfma_f32_16x16x32_bf16 v[76:79], a[116:119], a[20:23], v[76:79]
  v_exp_f32 v71, v71
  v_mfma_f32_16x16x32_bf16 v[76:79], a[120:123], a[24:27], v[76:79]
  v_cvt_pk_bf16_f32 v83, v70, v71
  v_mfma_f32_16x16x32_bf16 v[76:79], a[124:127], a[28:31], v[76:79]
  s_waitcnt lgkmcnt(0)
  v_mfma_f32_16x16x32_bf16 v[128:131], a[160:163], v[80:83], v[128:131]
  v_exp_f32 v72, v72
  v_mfma_f32_16x16x32_bf16 v[144:147], a[164:167], v[80:83], v[144:147]
  v_mfma_f32_16x16x32_bf16 v[160:163], a[168:171], v[80:83], v[160:163]
  v_exp_f32 v73, v73
  v_mfma_f32_16x16x32_bf16 v[176:179], a[172:175], v[80:83], v[176:179]
  v_cvt_pk_bf16_f32 v84, v72, v73
  v_mfma_f32_16x16x32_bf16 v[192:195], a[176:179], v[80:83], v[192:195]
  v_exp_f32 v74, v74
  v_mfma_f32_16x16x32_bf16 v[208:211], a[180:183], v[80:83], v[208:211]
  v_mfma_f32_16x16x32_bf16 v[224:227], a[184:187], v[80:83], v[224:227]
  v_exp_f32 v75, v75
  v_mfma_f32_16x16x32_bf16 v[240:243], a[188:191], v[80:83], v[240:243]
  v_cvt_pk_bf16_f32 v85, v74, v75
  v_mfma_f32_16x16x32_bf16 v[20:23], v[28:31], v[80:83], v[20:23]
  v_exp_f32 v76, v76
Lsd_exit1:
  s_nop 0
  v_exp_f32 v77, v77
  s_nop 0
  v_cvt_pk_bf16_f32 v86, v76, v77
  v_exp_f32 v78, v78
  v_exp_f32 v79, v79
  s_nop 0
  v_cvt_pk_bf16_f32 v87, v78, v79
  s_nop 1
  s_waitcnt lgkmcnt(0)
  v_mfma_f32_16x16x32_bf16 v[132:135], a[160:163], v[84:87], v[132:135]
  v_mfma_f32_16x16x32_bf16 v[148:151], a[164:167], v[84:87], v[148:151]
  v_mfma_f32_16x16x32_bf16 v[164:167], a[168:171], v[84:87], v[164:167]
  v_mfma_f32_16x16x32_bf16 v[180:183], a[172:175], v[84:87], v[180:183]
  v_mfma_f32_16x16x32_bf16 v[196:199], a[176:179], v[84:87], v[196:199]
  v_mfma_f32_16x16x32_bf16 v[212:215], a[180:183], v[84:87], v[212:215]
  v_mfma_f32_16x16x32_bf16 v[228:231], a[184:187], v[84:87], v[228:231]
  v_mfma_f32_16x16x32_bf16 v[244:247], a[188:191], v[84:87], v[244:247]
  v_mfma_f32_16x16x32_bf16 v[24:27], v[28:31], v[84:87], v[24:27]
  s_branch L_sd_done
Lsd_exit0:
  s_nop 0
  v_exp_f32 v77, v77
  s_nop 0
  v_cvt_pk_bf16_f32 v86, v76, v77
  v_exp_f32 v78, v78
  v_exp_f32 v79, v79
  s_nop 0
  v_cvt_pk_bf16_f32 v87, v78, v79
  s_nop 1
  s_waitcnt lgkmcnt(0)
  v_mfma_f32_16x16x32_bf16 v[132:135], a[128:131], v[84:87], v[132:135]
  v_mfma_f32_16x16x32_bf16 v[148:151], a[132:135], v[84:87], v[148:151]
  v_mfma_f32_16x16x32_bf16 v[164:167], a[136:139], v[84:87], v[164:167]
  v_mfma_f32_16x16x32_bf16 v[180:183], a[140:143], v[84:87], v[180:183]
  v_mfma_f32_16x16x32_bf16 v[196:199], a[144:147], v[84:87], v[196:199]
  v_mfma_f32_16x16x32_bf16 v[212:215], a[148:151], v[84:87], v[212:215]
  v_mfma_f32_16x16x32_bf16 v[228:231], a[152:155], v[84:87], v[228:231]
  v_mfma_f32_16x16x32_bf16 v[244:247], a[156:159], v[84:87], v[244:247]
  v_mfma_f32_16x16x32_bf16 v[24:27], v[28:31], v[84:87], v[24:27]
L_sd_done:
  s_nop 7
  v_mov_b32 v89, v60
  s_nop 1
  v_permlane16_swap_b32 v60, v89
  s_nop 1
  v_add_f32 v60, v60, v89
  v_mov_b32 v89, v60
  s_nop 1
  v_permlane32_swap_b32 v60, v89
  s_nop 1
  v_add_f32 v60, v60, v89
  v_mov_b32 v89, v61
  s_nop 1
  v_permlane16_swap_b32 v61, v89
  s_nop 1
  v_add_f32 v61, v61, v89
  v_mov_b32 v89, v61
  s_nop 1
  v_permlane32_swap_b32 v61, v89
  s_nop 1
  v_add_f32 v61, v61, v89
  v_add_f32 v60, v60, v20
  v_add_f32 v61, v61, v24
  v_mov_b32 v90, 0x1f800000
  v_mov_b32 v91, 0x5f800000
  v_cmp_lt_f32 vcc, v90, v60
  v_cmp_gt_f32 s[40:41], v91, v60
  s_nop 3
  s_and_b64 s[40:41], s[40:41], vcc
  s_cmp_eq_u64 s[40:41], -1
  s_cselect_b32 s42, 0, 1
  s_or_b32 s73, s73, s42
  v_mov_b32 v90, 0x1f800000
  v_mov_b32 v91, 0x5f800000
  v_cmp_lt_f32 vcc, v90, v61
  v_cmp_gt_f32 s[40:41], v91, v61
  s_nop 3
  s_and_b64 s[40:41], s[40:41], vcc
  s_cmp_eq_u64 s[40:41], -1
  s_cselect_b32 s42, 0, 1
  s_or_b32 s73, s73, s42
  v_rcp_f32 v60, v60
  v_rcp_f32 v61, v61
  s_nop 0
  s_lshl_b32 s40, s22, 2
  v_mov_b32 v90, s40
  v_mov_b32 v91, s73
  ds_write_b32 v90, v91
  s_waitcnt vmcnt(0) lgkmcnt(0)
  s_barrier
  v_mov_b32 v90, 0
  ds_read_b128 v[92:95], v90
  s_waitcnt lgkmcnt(0)
  v_or_b32 v92, v92, v93
  v_or_b32 v94, v94, v95
  v_or_b32 v92, v92, v94
  s_nop 0
  v_readfirstlane_b32 s40, v92
  s_nop 0
  s_cmp_lg_u32 s40, 0
  s_cbranch_scc1 L_fallback
  s_cmp_eq_u32 s22, 0
  s_cbranch_scc0 L_sf42
  s_lshl_b32 s40, s21, 3
  s_lshr_b32 s41, s20, 3
  s_add_u32 s40, s40, s41
  s_add_u32 s40, s40, 0
  s_lshl_b32 s40, s40, 7
  s_and_b32 s41, s20, 7
  s_lshl_b32 s41, s41, 2
  s_add_u32 s40, s40, s41
  s_add_u32 s40, s40, 8192
  v_mov_b32 v12, s40
  v_mov_b32 v13, s71
  s_mov_b64 exec, 1
  global_store_dword v12, v13, s[68:69] sc1
  s_mov_b64 exec, -1
L_sf42:
  s_lshl_b32 s40, s56, 17
  v_add_u32 v52, s40, v4
  s_lshl_b32 s40, s57, 17
  v_add_u32 v53, s40, v4
  v_mul_f32 v128, v128, v60
  v_mul_f32 v144, v144, v60
  v_mul_f32 v129, v129, v60
  v_mul_f32 v145, v145, v60
  v_mul_f32 v130, v130, v60
  v_mul_f32 v146, v146, v60
  v_mul_f32 v131, v131, v60
  v_mul_f32 v147, v147, v60
  v_cvt_pk_bf16_f32 v32, v128, v129
  v_cvt_pk_bf16_f32 v33, v130, v131
  v_cvt_pk_bf16_f32 v34, v144, v145
  v_cvt_pk_bf16_f32 v35, v146, v147
  global_store_dwordx4 v52, v[32:35], s[62:63] offset:0 sc1
  v_mul_f32 v160, v160, v60
  v_mul_f32 v176, v176, v60
  v_mul_f32 v161, v161, v60
  v_mul_f32 v177, v177, v60
  v_mul_f32 v162, v162, v60
  v_mul_f32 v178, v178, v60
  v_mul_f32 v163, v163, v60
  v_mul_f32 v179, v179, v60
  v_cvt_pk_bf16_f32 v36, v160, v161
  v_cvt_pk_bf16_f32 v37, v162, v163
  v_cvt_pk_bf16_f32 v38, v176, v177
  v_cvt_pk_bf16_f32 v39, v178, v179
  global_store_dwordx4 v52, v[36:39], s[62:63] offset:1024 sc1
  v_mul_f32 v192, v192, v60
  v_mul_f32 v208, v208, v60
  v_mul_f32 v193, v193, v60
  v_mul_f32 v209, v209, v60
  v_mul_f32 v194, v194, v60
  v_mul_f32 v210, v210, v60
  v_mul_f32 v195, v195, v60
  v_mul_f32 v211, v211, v60
  v_cvt_pk_bf16_f32 v40, v192, v193
  v_cvt_pk_bf16_f32 v41, v194, v195
  v_cvt_pk_bf16_f32 v42, v208, v209
  v_cvt_pk_bf16_f32 v43, v210, v211
  global_store_dwordx4 v52, v[40:43], s[62:63] offset:2048 sc1
  v_mul_f32 v224, v224, v60
  v_mul_f32 v240, v240, v60
  v_mul_f32 v225, v225, v60
  v_mul_f32 v241, v241, v60
  v_mul_f32 v226, v226, v60
  v_mul_f32 v242, v242, v60
  v_mul_f32 v227, v227, v60
  v_mul_f32 v243, v243, v60
  v_cvt_pk_bf16_f32 v44, v224, v225
  v_cvt_pk_bf16_f32 v45, v226, v227
  v_cvt_pk_bf16_f32 v46, v240, v241
  v_cvt_pk_bf16_f32 v47, v242, v243
  global_store_dwordx4 v52, v[44:47], s[62:63] offset:3072 sc1
  v_mul_f32 v132, v132, v61
  v_mul_f32 v148, v148, v61
  v_mul_f32 v133, v133, v61
  v_mul_f32 v149, v149, v61
  v_mul_f32 v134, v134, v61
  v_mul_f32 v150, v150, v61
  v_mul_f32 v135, v135, v61
  v_mul_f32 v151, v151, v61
  v_cvt_pk_bf16_f32 v32, v132, v133
  v_cvt_pk_bf16_f32 v33, v134, v135
  v_cvt_pk_bf16_f32 v34, v148, v149
  v_cvt_pk_bf16_f32 v35, v150, v151
  global_store_dwordx4 v53, v[32:35], s[62:63] offset:0 sc1
  v_mul_f32 v164, v164, v61
  v_mul_f32 v180, v180, v61
  v_mul_f32 v165, v165, v61
  v_mul_f32 v181, v181, v61
  v_mul_f32 v166, v166, v61
  v_mul_f32 v182, v182, v61
  v_mul_f32 v167, v167, v61
  v_mul_f32 v183, v183, v61
  v_cvt_pk_bf16_f32 v36, v164, v165
  v_cvt_pk_bf16_f32 v37, v166, v167
  v_cvt_pk_bf16_f32 v38, v180, v181
  v_cvt_pk_bf16_f32 v39, v182, v183
  global_store_dwordx4 v53, v[36:39], s[62:63] offset:1024 sc1
  v_mul_f32 v196, v196, v61
  v_mul_f32 v212, v212, v61
  v_mul_f32 v197, v197, v61
  v_mul_f32 v213, v213, v61
  v_mul_f32 v198, v198, v61
  v_mul_f32 v214, v214, v61
  v_mul_f32 v199, v199, v61
  v_mul_f32 v215, v215, v61
  v_cvt_pk_bf16_f32 v40, v196, v197
  v_cvt_pk_bf16_f32 v41, v198, v199
  v_cvt_pk_bf16_f32 v42, v212, v213
  v_cvt_pk_bf16_f32 v43, v214, v215
  global_store_dwordx4 v53, v[40:43], s[62:63] offset:2048 sc1
  v_mul_f32 v228, v228, v61
  v_mul_f32 v244, v244, v61
  v_mul_f32 v229, v229, v61
  v_mul_f32 v245, v245, v61
  v_mul_f32 v230, v230, v61
  v_mul_f32 v246, v246, v61
  v_mul_f32 v231, v231, v61
  v_mul_f32 v247, v247, v61
  v_cvt_pk_bf16_f32 v44, v228, v229
  v_cvt_pk_bf16_f32 v45, v230, v231
  v_cvt_pk_bf16_f32 v46, v244, v245
  v_cvt_pk_bf16_f32 v47, v246, v247
  global_store_dwordx4 v53, v[44:47], s[62:63] offset:3072 sc1
L_after_ctx:
  s_mov_b64 s[24:25], s[66:67]
  s_lshr_b32 s6, s20, 3
  s_lshr_b32 s7, s20, 2
  s_xor_b32 s7, s7, s21
  s_and_b32 s7, s7, 1
  s_and_b32 s5, s20, 3
  s_sub_u32 s40, 15, s21
  s_cmp_eq_u32 s7, 0
  s_cselect_b32 s4, s21, s40
  s_lshr_b32 s40, s22, 1
  s_lshl_b32 s40, s40, 13
  v_lshlrev_b32 v5, 4, v1
  v_add_u32 v5, s40, v5
  v_lshlrev_b32 v6, 3, v1
  v_add_u32 v6, s40, v6
  v_lshrrev_b32 v60, 4, v1
  v_bfe_u32 v61, v1, 2, 2
  v_lshlrev_b32 v62, 2, v60
  v_add_u32 v62, v62, v61
  v_bfe_u32 v60, v62, 1, 2
  v_lshlrev_b32 v62, 7, v62
  v_lshlrev_b32 v60, 5, v60
  v_add_u32 v62, v62, v60
  v_and_b32 v61, 3, v1
  v_lshlrev_b32 v61, 3, v61
  v_add_u32 v8, v62, v61
  v_xor_b32 v9, 32, v8
  v_xor_b32 v10, 64, v8
  v_xor_b32 v11, 96, v8
  v_add_u32 v12, 0x10000, v8
  v_add_u32 v13, 0x10000, v9
  v_add_u32 v14, 0x10000, v10
  v_add_u32 v15, 0x10000, v11
  s_and_b32 s40, s22, 1
  s_lshl_b32 s40, s40, 12
  s_add_u32 s40, s40, 16384
  v_add_u32 v8, s40, v8
  v_add_u32 v9, s40, v9
  v_add_u32 v10, s40, v10
  v_add_u32 v11, s40, v11
  v_add_u32 v12, s40, v12
  v_add_u32 v13, s40, v13
  v_add_u32 v14, s40, v14
  v_add_u32 v15, s40, v15
  v_lshrrev_b32 v60, 3, v1
  v_bfe_u32 v61, v60, 1, 2
  v_lshlrev_b32 v61, 1, v61
  v_and_b32 v2, 7, v1
  v_xor_b32 v2, v2, v61
  v_lshlrev_b32 v2, 4, v2
  s_lshl_b32 s40, s22, 3
  v_add_u32 v60, s40, v60
  s_mov_b32 s40, 1024
  v_mul_lo_u32 v60, v60, s40
  v_add_u32 v2, v2, v60
  s_lshl_b32 s37, s22, 10
  s_add_u32 s37, s37, 16384
  s_lshl_b32 s36, s22, 12
  s_lshl_b32 s40, s5, 8
  s_mul_i32 s41, s6, 360448
  s_add_u32 s41, s41, s40
  s_add_u32 s10, s10, s41
  s_addc_u32 s11, s11, 0
  s_lshl_b32 s41, s6, 20
  s_add_u32 s41, s41, s40
  s_add_u32 s8, s8, s41
  s_addc_u32 s9, s9, 0
  s_lshl_b32 s42, s4, 3
  s_lshl_b32 s43, s22, 1
  s_add_u32 s42, s42, s43
  s_lshr_b32 s40, s42, 1
  s_mul_i32 s40, s40, 88064
  s_mul_i32 s41, s6, 22528
  s_add_u32 s40, s40, s41
  s_add_u32 s40, s40, 35651584
  s_add_u32 s14, s12, s40
  s_addc_u32 s15, s13, 0
  s_lshl_b32 s40, s42, 17
  s_lshl_b32 s41, s6, 15
  s_add_u32 s40, s40, s41
  s_add_u32 s40, s40, 41943040
  s_add_u32 s16, s12, s40
  s_addc_u32 s17, s13, 0
  s_lshr_b32 s40, s22, 1
  s_lshl_b32 s40, s40, 2
  s_add_u32 s40, s40, s6
  s_lshl_b32 s41, s4, 3
  s_add_u32 s40, s40, s41
  s_lshl_b32 s40, s40, 4
  v_and_b32 v60, 15, v1
  v_add_u32 v60, s40, v60
  v_lshlrev_b32 v60, 10, v60
  v_lshrrev_b32 v61, 4, v1
  v_lshlrev_b32 v61, 3, v61
  s_lshl_b32 s41, s5, 8
  s_and_b32 s42, s22, 1
  s_lshl_b32 s42, s42, 7
  s_add_u32 s41, s41, s42
  v_add_u32 v61, s41, v61
  v_add_u32 v40, v60, v61
  global_load_dwordx2 v[32:33], v40, s[24:25] offset:0
  global_load_dwordx2 v[34:35], v40, s[24:25] offset:32
  global_load_dwordx2 v[36:37], v40, s[24:25] offset:64
  global_load_dwordx2 v[38:39], v40, s[24:25] offset:96
  s_lshl_b32 s40, s21, 3
  s_and_b32 s41, s20, 7
  s_add_u32 s40, s40, s41
  s_lshl_b32 s40, s40, 18
  s_lshl_b32 s41, s22, 12
  s_add_u32 s40, s40, s41
  s_add_u32 s40, s40, 58720256
  s_lshl_b32 s41, s6, 14
  s_add_u32 s41, s41, s40
  s_lshl_b32 s42, s6, 16
  s_add_u32 s42, s42, s40
  s_add_u32 s26, s12, s41
  s_addc_u32 s27, s13, 0
  s_add_u32 s28, s12, s42
  s_addc_u32 s29, s13, 0
  v_add_u32 v56, 0x10000, v6
  v_add_u32 v57, 0x10000, v5
  v_add_u32 v49, 0x20000, v6
  v_add_u32 v50, 0x20000, v5
  v_add_u32 v44, 0x20000, v8
  v_add_u32 v45, 0x20000, v9
  v_add_u32 v46, 0x20000, v10
  v_add_u32 v47, 0x20000, v11
  s_add_u32 s30, s10, 0
  s_addc_u32 s31, s11, 0
  s_add_u32 m0, s37, 0
  s_nop 0
  global_load_lds_dwordx4 v2, s[30:31] offset:0
  s_add_u32 m0, s37, 3968
  s_nop 0
  global_load_lds_dwordx4 v2, s[30:31] offset:128
  s_add_u32 s32, s10, 32768
  s_addc_u32 s33, s11, 0
  s_add_u32 m0, s37, 8192
  s_nop 0
  global_load_lds_dwordx4 v2, s[32:33] offset:0
  s_add_u32 m0, s37, 12160
  s_nop 0
  global_load_lds_dwordx4 v2, s[32:33] offset:128
  s_add_u32 s34, s14, 0
  s_addc_u32 s35, s15, 0
  s_add_u32 m0, s36, 0
  s_nop 0
  global_load_lds_dwordx4 v4, s[34:35] offset:0
  s_nop 0
  global_load_lds_dwordx4 v4, s[34:35] offset:1024
  s_nop 0
  global_load_lds_dwordx4 v4, s[34:35] offset:2048
  s_nop 0
  global_load_lds_dwordx4 v4, s[34:35] offset:3072
  s_add_u32 s30, s10, 65536
  s_addc_u32 s31, s11, 0
  s_add_u32 m0, s37, 32768
  s_nop 0
  global_load_lds_dwordx4 v2, s[30:31] offset:0
  s_add_u32 m0, s37, 36736
  s_nop 0
  global_load_lds_dwordx4 v2, s[30:31] offset:128
  s_add_u32 s32, s10, 98304
  s_addc_u32 s33, s11, 0
  s_add_u32 m0, s37, 40960
  s_nop 0
  global_load_lds_dwordx4 v2, s[32:33] offset:0
  s_add_u32 m0, s37, 44928
  s_nop 0
  global_load_lds_dwordx4 v2, s[32:33] offset:128
  s_add_u32 s34, s14, 4096
  s_addc_u32 s35, s15, 0
  s_add_u32 m0, s36, 32768
  s_nop 0
  global_load_lds_dwordx4 v4, s[34:35] offset:0
  s_nop 0
  global_load_lds_dwordx4 v4, s[34:35] offset:1024
  s_nop 0
  global_load_lds_dwordx4 v4, s[34:35] offset:2048
  s_nop 0
  global_load_lds_dwordx4 v4, s[34:35] offset:3072
  s_add_u32 s30, s10, 131072
  s_addc_u32 s31, s11, 0
  s_add_u32 m0, s37, 65536
  s_nop 0
  global_load_lds_dwordx4 v2, s[30:31] offset:0
  s_add_u32 m0, s37, 69504
  s_nop 0
  global_load_lds_dwordx4 v2, s[30:31] offset:128
  s_add_u32 s32, s10, 163840
  s_addc_u32 s33, s11, 0
  s_add_u32 m0, s37, 73728
  s_nop 0
  global_load_lds_dwordx4 v2, s[32:33] offset:0
  s_add_u32 m0, s37, 77696
  s_nop 0
  global_load_lds_dwordx4 v2, s[32:33] offset:128
  s_add_u32 s34, s14, 8192
  s_addc_u32 s35, s15, 0
  s_add_u32 m0, s36, 65536
  s_nop 0
  global_load_lds_dwordx4 v4, s[34:35] offset:0
  s_nop 0
  global_load_lds_dwordx4 v4, s[34:35] offset:1024
  s_nop 0
  global_load_lds_dwordx4 v4, s[34:35] offset:2048
  s_nop 0
  global_load_lds_dwordx4 v4, s[34:35] offset:3072
  s_waitcnt vmcnt(28)
  s_barrier
  s_cmp_eq_u32 s22, 0
  s_cbranch_scc0 L_sf44
  s_lshl_b32 s40, s21, 3
  s_lshr_b32 s41, s20, 3
  s_add_u32 s40, s40, s41
  s_add_u32 s40, s40, 4
  s_lshl_b32 s40, s40, 7
  s_and_b32 s41, s20, 7
  s_lshl_b32 s41, s41, 2
  s_add_u32 s40, s40, s41
  s_add_u32 s40, s40, 8192
  v_mov_b32 v60, s40
  v_mov_b32 v61, s71
  s_mov_b64 exec, 1
  global_store_dword v60, v61, s[68:69] sc1
  s_mov_b64 exec, -1
L_sf44:
  s_waitcnt vmcnt(16)
  s_barrier
  ds_read_b64 v[64:65], v5 offset:0
  ds_read_b64 v[66:67], v5 offset:1024
  ds_read_b64 v[68:69], v5 offset:8
  ds_read_b64 v[70:71], v5 offset:1032
  ds_read_b64 v[72:73], v5 offset:4096
  ds_read_b64 v[74:75], v5 offset:5120
  ds_read_b64 v[76:77], v5 offset:4104
  ds_read_b64 v[78:79], v5 offset:5128
  ds_read_b64_tr_b16 v[16:17], v8 offset:0
  ds_read_b64_tr_b16 v[18:19], v8 offset:2048
  ds_read_b64_tr_b16 v[20:21], v9 offset:0
  ds_read_b64_tr_b16 v[22:23], v9 offset:2048
  ds_read_b64_tr_b16 v[24:25], v10 offset:0
  ds_read_b64_tr_b16 v[26:27], v10 offset:2048
  s_waitcnt lgkmcnt(4)
  v_mfma_f32_16x16x32_bf16 v[128:131], v[16:19], v[64:67], 0
  ds_read_b64_tr_b16 v[28:29], v11 offset:0
  v_mfma_f32_16x16x32_bf16 v[132:135], v[16:19], v[68:71], 0
  ds_read_b64_tr_b16 v[30:31], v11 offset:2048
  v_mfma_f32_16x16x32_bf16 v[136:139], v[16:19], v[72:75], 0
  ds_read_b64 v[80:81], v5 offset:2048
  v_mfma_f32_16x16x32_bf16 v[140:143], v[16:19], v[76:79], 0
  s_waitcnt lgkmcnt(5)
  ds_read_b64 v[82:83], v5 offset:3072
  ds_read_b64 v[84:85], v5 offset:2056
  v_mfma_f32_16x16x32_bf16 v[144:147], v[20:23], v[64:67], 0
  ds_read_b64_tr_b16 v[16:17], v8 offset:8192
  v_mfma_f32_16x16x32_bf16 v[148:151], v[20:23], v[68:71], 0
  ds_read_b64_tr_b16 v[18:19], v8 offset:10240
  v_mfma_f32_16x16x32_bf16 v[152:155], v[20:23], v[72:75], 0
  ds_read_b64 v[86:87], v5 offset:3080
  v_mfma_f32_16x16x32_bf16 v[156:159], v[20:23], v[76:79], 0
  s_waitcnt lgkmcnt(8)
  ds_read_b64 v[88:89], v5 offset:6144
  ds_read_b64 v[90:91], v5 offset:7168
  v_mfma_f32_16x16x32_bf16 v[160:163], v[24:27], v[64:67], 0
  ds_read_b64_tr_b16 v[20:21], v9 offset:8192
  v_mfma_f32_16x16x32_bf16 v[164:167], v[24:27], v[68:71], 0
  ds_read_b64_tr_b16 v[22:23], v9 offset:10240
  v_mfma_f32_16x16x32_bf16 v[168:171], v[24:27], v[72:75], 0
  ds_read_b64 v[92:93], v5 offset:6152
  v_mfma_f32_16x16x32_bf16 v[172:175], v[24:27], v[76:79], 0
  s_waitcnt lgkmcnt(11)
  ds_read_b64 v[94:95], v5 offset:7176
  v_mfma_f32_16x16x32_bf16 v[176:179], v[28:31], v[64:67], 0
  ds_read_b64_tr_b16 v[24:25], v10 offset:8192
  v_mfma_f32_16x16x32_bf16 v[180:183], v[28:31], v[68:71], 0
  ds_read_b64_tr_b16 v[26:27], v10 offset:10240
  v_mfma_f32_16x16x32_bf16 v[184:187], v[28:31], v[72:75], 0
  v_mfma_f32_16x16x32_bf16 v[188:191], v[28:31], v[76:79], 0
  s_waitcnt lgkmcnt(9)
  s_waitcnt lgkmcnt(2)
  v_mfma_f32_16x16x32_bf16 v[128:131], v[16:19], v[80:83], v[128:131]
  ds_read_b64_tr_b16 v[28:29], v11 offset:8192
  v_mfma_f32_16x16x32_bf16 v[132:135], v[16:19], v[84:87], v[132:135]
  ds_read_b64_tr_b16 v[30:31], v11 offset:10240
  v_mfma_f32_16x16x32_bf16 v[136:139], v[16:19], v[88:91], v[136:139]
  v_mfma_f32_16x16x32_bf16 v[140:143], v[16:19], v[92:95], v[140:143]
  s_waitcnt lgkmcnt(6)
  v_mfma_f32_16x16x32_bf16 v[144:147], v[20:23], v[80:83], v[144:147]
  s_waitcnt vmcnt(8)
  s_barrier
  v_mfma_f32_16x16x32_bf16 v[148:151], v[20:23], v[84:87], v[148:151]
  ds_read_b64_tr_b16 v[16:17], v8 offset:32768
  v_mfma_f32_16x16x32_bf16 v[152:155], v[20:23], v[88:91], v[152:155]
  ds_read_b64_tr_b16 v[18:19], v8 offset:34816
  ds_read_b64 v[64:65], v5 offset:32768
  v_mfma_f32_16x16x32_bf16 v[156:159], v[20:23], v[92:95], v[156:159]
  s_waitcnt lgkmcnt(5)
  ds_read_b64 v[66:67], v5 offset:33792
  ds_read_b64 v[68:69], v5 offset:32776
  v_mfma_f32_16x16x32_bf16 v[160:163], v[24:27], v[80:83], v[160:163]
  ds_read_b64_tr_b16 v[20:21], v9 offset:32768
  ds_read_b64 v[70:71], v5 offset:33800
  v_mfma_f32_16x16x32_bf16 v[164:167], v[24:27], v[84:87], v[164:167]
  ds_read_b64_tr_b16 v[22:23], v9 offset:34816
  ds_read_b64 v[72:73], v5 offset:36864
  v_mfma_f32_16x16x32_bf16 v[168:171], v[24:27], v[88:91], v[168:171]
  ds_read_b64 v[74:75], v5 offset:37888
  v_mfma_f32_16x16x32_bf16 v[172:175], v[24:27], v[92:95], v[172:175]
  s_waitcnt lgkmcnt(10)
  ds_read_b64 v[76:77], v5 offset:36872
  ds_read_b64 v[78:79], v5 offset:37896
  v_mfma_f32_16x16x32_bf16 v[176:179], v[28:31], v[80:83], v[176:179]
  s_add_u32 s30, s10, 196608
  s_addc_u32 s31, s11, 0
  ds_read_b64_tr_b16 v[24:25], v10 offset:32768
  v_mfma_f32_16x16x32_bf16 v[180:183], v[28:31], v[84:87], v[180:183]
  s_add_u32 m0, s37, 98304
  ds_read_b64_tr_b16 v[26:27], v10 offset:34816
  v_mfma_f32_16x16x32_bf16 v[184:187], v[28:31], v[88:91], v[184:187]
  global_load_lds_dwordx4 v2, s[30:31] offset:0
  s_add_u32 m0, s37, 102272
  v_mfma_f32_16x16x32_bf16 v[188:191], v[28:31], v[92:95], v[188:191]
  s_waitcnt lgkmcnt(12)
  s_waitcnt lgkmcnt(2)
  global_load_lds_dwordx4 v2, s[30:31] offset:128
  v_mfma_f32_16x16x32_bf16 v[128:131], v[16:19], v[64:67], v[128:131]
  ds_read_b64_tr_b16 v[28:29], v11 offset:32768
  v_mfma_f32_16x16x32_bf16 v[132:135], v[16:19], v[68:71], v[132:135]
  ds_read_b64_tr_b16 v[30:31], v11 offset:34816
  v_mfma_f32_16x16x32_bf16 v[136:139], v[16:19], v[72:75], v[136:139]
  ds_read_b64 v[80:81], v5 offset:34816
  v_mfma_f32_16x16x32_bf16 v[140:143], v[16:19], v[76:79], v[140:143]
  s_waitcnt lgkmcnt(9)
  ds_read_b64 v[82:83], v5 offset:35840
  ds_read_b64 v[84:85], v5 offset:34824
  v_mfma_f32_16x16x32_bf16 v[144:147], v[20:23], v[64:67], v[144:147]
  ds_read_b64_tr_b16 v[16:17], v8 offset:40960
  v_mfma_f32_16x16x32_bf16 v[148:151], v[20:23], v[68:71], v[148:151]
  ds_read_b64_tr_b16 v[18:19], v8 offset:43008
  v_mfma_f32_16x16x32_bf16 v[152:155], v[20:23], v[72:75], v[152:155]
  ds_read_b64 v[86:87], v5 offset:35848
  v_mfma_f32_16x16x32_bf16 v[156:159], v[20:23], v[76:79], v[156:159]
  s_waitcnt lgkmcnt(8)
  ds_read_b64 v[88:89], v5 offset:38912
  ds_read_b64 v[90:91], v5 offset:39936
  v_mfma_f32_16x16x32_bf16 v[160:163], v[24:27], v[64:67], v[160:163]
  s_add_u32 s32, s10, 229376
  s_addc_u32 s33, s11, 0
  ds_read_b64_tr_b16 v[20:21], v9 offset:40960
  v_mfma_f32_16x16x32_bf16 v[164:167], v[24:27], v[68:71], v[164:167]
  s_add_u32 m0, s37, 106496
  ds_read_b64_tr_b16 v[22:23], v9 offset:43008
  v_mfma_f32_16x16x32_bf16 v[168:171], v[24:27], v[72:75], v[168:171]
  global_load_lds_dwordx4 v2, s[32:33] offset:0
  ds_read_b64 v[92:93], v5 offset:38920
  s_add_u32 m0, s37, 110464
  v_mfma_f32_16x16x32_bf16 v[172:175], v[24:27], v[76:79], v[172:175]
  s_waitcnt lgkmcnt(11)
  global_load_lds_dwordx4 v2, s[32:33] offset:128
  ds_read_b64 v[94:95], v5 offset:39944
  v_mfma_f32_16x16x32_bf16 v[176:179], v[28:31], v[64:67], v[176:179]
  s_add_u32 s34, s14, 12288
  s_addc_u32 s35, s15, 0
  ds_read_b64_tr_b16 v[24:25], v10 offset:40960
  v_mfma_f32_16x16x32_bf16 v[180:183], v[28:31], v[68:71], v[180:183]
  s_add_u32 m0, s36, 98304
  ds_read_b64_tr_b16 v[26:27], v10 offset:43008
  v_mfma_f32_16x16x32_bf16 v[184:187], v[28:31], v[72:75], v[184:187]
  global_load_lds_dwordx4 v4, s[34:35] offset:0
  v_mfma_f32_16x16x32_bf16 v[188:191], v[28:31], v[76:79], v[188:191]
  s_waitcnt lgkmcnt(9)
  s_waitcnt lgkmcnt(2)
  global_load_lds_dwordx4 v4, s[34:35] offset:1024
  v_mfma_f32_16x16x32_bf16 v[128:131], v[16:19], v[80:83], v[128:131]
  ds_read_b64_tr_b16 v[28:29], v11 offset:40960
  v_mfma_f32_16x16x32_bf16 v[132:135], v[16:19], v[84:87], v[132:135]
  ds_read_b64_tr_b16 v[30:31], v11 offset:43008
  v_mfma_f32_16x16x32_bf16 v[136:139], v[16:19], v[88:91], v[136:139]
  global_load_lds_dwordx4 v4, s[34:35] offset:2048
  v_mfma_f32_16x16x32_bf16 v[140:143], v[16:19], v[92:95], v[140:143]
  s_waitcnt lgkmcnt(6)
  global_load_lds_dwordx4 v4, s[34:35] offset:3072
  v_mfma_f32_16x16x32_bf16 v[144:147], v[20:23], v[80:83], v[144:147]
  s_waitcnt vmcnt(8)
  s_barrier
  v_mfma_f32_16x16x32_bf16 v[148:151], v[20:23], v[84:87], v[148:151]
  ds_read_b64_tr_b16 v[16:17], v12 offset:0
  v_mfma_f32_16x16x32_bf16 v[152:155], v[20:23], v[88:91], v[152:155]
  ds_read_b64_tr_b16 v[18:19], v12 offset:2048
  ds_read_b64 v[64:65], v57 offset:0
  v_mfma_f32_16x16x32_bf16 v[156:159], v[20:23], v[92:95], v[156:159]
  s_waitcnt lgkmcnt(5)
  ds_read_b64 v[66:67], v57 offset:1024
  ds_read_b64 v[68:69], v57 offset:8
  v_mfma_f32_16x16x32_bf16 v[160:163], v[24:27], v[80:83], v[160:163]
  ds_read_b64_tr_b16 v[20:21], v13 offset:0
  ds_read_b64 v[70:71], v57 offset:1032
  v_mfma_f32_16x16x32_bf16 v[164:167], v[24:27], v[84:87], v[164:167]
  ds_read_b64_tr_b16 v[22:23], v13 offset:2048
  ds_read_b64 v[72:73], v57 offset:4096
  v_mfma_f32_16x16x32_bf16 v[168:171], v[24:27], v[88:91], v[168:171]
  ds_read_b64 v[74:75], v57 offset:5120
  v_mfma_f32_16x16x32_bf16 v[172:175], v[24:27], v[92:95], v[172:175]
  s_waitcnt lgkmcnt(10)
  ds_read_b64 v[76:77], v57 offset:4104
  ds_read_b64 v[78:79], v57 offset:5128
  v_mfma_f32_16x16x32_bf16 v[176:179], v[28:31], v[80:83], v[176:179]
  s_add_u32 s30, s10, 262144
  s_addc_u32 s31, s11, 0
  ds_read_b64_tr_b16 v[24:25], v14 offset:0
  v_mfma_f32_16x16x32_bf16 v[180:183], v[28:31], v[84:87], v[180:183]
  s_add_u32 m0, s37, 0
  ds_read_b64_tr_b16 v[26:27], v14 offset:2048
  v_mfma_f32_16x16x32_bf16 v[184:187], v[28:31], v[88:91], v[184:187]
  global_load_lds_dwordx4 v2, s[30:31] offset:0
  s_add_u32 m0, s37, 3968
  v_mfma_f32_16x16x32_bf16 v[188:191], v[28:31], v[92:95], v[188:191]
  s_waitcnt lgkmcnt(12)
  s_waitcnt lgkmcnt(2)
  global_load_lds_dwordx4 v2, s[30:31] offset:128
  v_mfma_f32_16x16x32_bf16 v[128:131], v[16:19], v[64:67], v[128:131]
  ds_read_b64_tr_b16 v[28:29], v15 offset:0
  v_mfma_f32_16x16x32_bf16 v[132:135], v[16:19], v[68:71], v[132:135]
  ds_read_b64_tr_b16 v[30:31], v15 offset:2048
  v_mfma_f32_16x16x32_bf16 v[136:139], v[16:19], v[72:75], v[136:139]
  ds_read_b64 v[80:81], v57 offset:2048
  v_mfma_f32_16x16x32_bf16 v[140:143], v[16:19], v[76:79], v[140:143]
  s_waitcnt lgkmcnt(9)
  ds_read_b64 v[82:83], v57 offset:3072
  ds_read_b64 v[84:85], v57 offset:2056
  v_mfma_f32_16x16x32_bf16 v[144:147], v[20:23], v[64:67], v[144:147]
  ds_read_b64_tr_b16 v[16:17], v12 offset:8192
  v_mfma_f32_16x16x32_bf16 v[148:151], v[20:23], v[68:71], v[148:151]
  ds_read_b64_tr_b16 v[18:19], v12 offset:10240
  v_mfma_f32_16x16x32_bf16 v[152:155], v[20:23], v[72:75], v[152:155]
  ds_read_b64 v[86:87], v57 offset:3080
  v_mfma_f32_16x16x32_bf16 v[156:159], v[20:23], v[76:79], v[156:159]
  s_waitcnt lgkmcnt(8)
  ds_read_b64 v[88:89], v57 offset:6144
  ds_read_b64 v[90:91], v57 offset:7168
  v_mfma_f32_16x16x32_bf16 v[160:163], v[24:27], v[64:67], v[160:163]
  s_add_u32 s32, s10, 294912
  s_addc_u32 s33, s11, 0
  ds_read_b64_tr_b16 v[20:21], v13 offset:8192
  v_mfma_f32_16x16x32_bf16 v[164:167], v[24:27], v[68:71], v[164:167]
  s_add_u32 m0, s37, 8192
  ds_read_b64_tr_b16 v[22:23], v13 offset:10240
  v_mfma_f32_16x16x32_bf16 v[168:171], v[24:27], v[72:75], v[168:171]
  global_load_lds_dwordx4 v2, s[32:33] offset:0
  ds_read_b64 v[92:93], v57 offset:6152
  s_add_u32 m0, s37, 12160
  v_mfma_f32_16x16x32_bf16 v[172:175], v[24:27], v[76:79], v[172:175]
  s_waitcnt lgkmcnt(11)
  global_load_lds_dwordx4 v2, s[32:33] offset:128
  ds_read_b64 v[94:95], v57 offset:7176
  v_mfma_f32_16x16x32_bf16 v[176:179], v[28:31], v[64:67], v[176:179]
  s_add_u32 s34, s14, 16384
  s_addc_u32 s35, s15, 0
  ds_read_b64_tr_b16 v[24:25], v14 offset:8192
  v_mfma_f32_16x16x32_bf16 v[180:183], v[28:31], v[68:71], v[180:183]
  s_add_u32 m0, s36, 0
  ds_read_b64_tr_b16 v[26:27], v14 offset:10240
  v_mfma_f32_16x16x32_bf16 v[184:187], v[28:31], v[72:75], v[184:187]
  global_load_lds_dwordx4 v4, s[34:35] offset:0
  v_mfma_f32_16x16x32_bf16 v[188:191], v[28:31], v[76:79], v[188:191]
  s_waitcnt lgkmcnt(9)
  s_waitcnt lgkmcnt(2)
  global_load_lds_dwordx4 v4, s[34:35] offset:1024
  v_mfma_f32_16x16x32_bf16 v[128:131], v[16:19], v[80:83], v[128:131]
  ds_read_b64_tr_b16 v[28:29], v15 offset:8192
  v_mfma_f32_16x16x32_bf16 v[132:135], v[16:19], v[84:87], v[132:135]
  ds_read_b64_tr_b16 v[30:31], v15 offset:10240
  v_mfma_f32_16x16x32_bf16 v[136:139], v[16:19], v[88:91], v[136:139]
  global_load_lds_dwordx4 v4, s[34:35] offset:2048
  v_mfma_f32_16x16x32_bf16 v[140:143], v[16:19], v[92:95], v[140:143]
  s_waitcnt lgkmcnt(6)
  global_load_lds_dwordx4 v4, s[34:35] offset:3072
  v_mfma_f32_16x16x32_bf16 v[144:147], v[20:23], v[80:83], v[144:147]
  s_waitcnt vmcnt(8)
  s_barrier
  v_mfma_f32_16x16x32_bf16 v[148:151], v[20:23], v[84:87], v[148:151]
  ds_read_b64_tr_b16 v[16:17], v12 offset:32768
  v_mfma_f32_16x16x32_bf16 v[152:155], v[20:23], v[88:91], v[152:155]
  ds_read_b64_tr_b16 v[18:19], v12 offset:34816
  ds_read_b64 v[64:65], v57 offset:32768
  v_mfma_f32_16x16x32_bf16 v[156:159], v[20:23], v[92:95], v[156:159]
  s_waitcnt lgkmcnt(5)
  ds_read_b64 v[66:67], v57 offset:33792
  ds_read_b64 v[68:69], v57 offset:32776
  v_mfma_f32_16x16x32_bf16 v[160:163], v[24:27], v[80:83], v[160:163]
  ds_read_b64_tr_b16 v[20:21], v13 offset:32768
  ds_read_b64 v[70:71], v57 offset:33800
  v_mfma_f32_16x16x32_bf16 v[164:167], v[24:27], v[84:87], v[164:167]
  ds_read_b64_tr_b16 v[22:23], v13 offset:34816
  ds_read_b64 v[72:73], v57 offset:36864
  v_mfma_f32_16x16x32_bf16 v[168:171], v[24:27], v[88:91], v[168:171]
  ds_read_b64 v[74:75], v57 offset:37888
  v_mfma_f32_16x16x32_bf16 v[172:175], v[24:27], v[92:95], v[172:175]
  s_waitcnt lgkmcnt(10)
  ds_read_b64 v[76:77], v57 offset:36872
  ds_read_b64 v[78:79], v57 offset:37896
  v_mfma_f32_16x16x32_bf16 v[176:179], v[28:31], v[80:83], v[176:179]
  ds_read_b64_tr_b16 v[24:25], v14 offset:32768
  v_mfma_f32_16x16x32_bf16 v[180:183], v[28:31], v[84:87], v[180:183]
  s_cmp_eq_u32 s6, 3
  s_cselect_b32 s42, 32768, 0
  s_sub_u32 s42, 327680, s42
  s_add_u32 s30, s10, s42
  s_addc_u32 s31, s11, 0
  s_add_u32 m0, s37, 32768
  ds_read_b64_tr_b16 v[26:27], v14 offset:34816
  v_mfma_f32_16x16x32_bf16 v[184:187], v[28:31], v[88:91], v[184:187]
  global_load_lds_dwordx4 v2, s[30:31] offset:0
  s_add_u32 m0, s37, 36736
  v_mfma_f32_16x16x32_bf16 v[188:191], v[28:31], v[92:95], v[188:191]
  s_waitcnt lgkmcnt(12)
  s_waitcnt lgkmcnt(2)
  global_load_lds_dwordx4 v2, s[30:31] offset:128
  v_mfma_f32_16x16x32_bf16 v[128:131], v[16:19], v[64:67], v[128:131]
  ds_read_b64_tr_b16 v[28:29], v15 offset:32768
  v_and_b32 v60, 7, v1
  v_lshlrev_b32 v60, 2, v60
  s_lshl_b32 s40, s21, 3
  s_lshl_b32 s41, s7, 2
  s_add_u32 s40, s40, s41
  s_add_u32 s40, s40, s6
  s_lshl_b32 s40, s40, 7
  s_add_u32 s40, s40, 8192
  v_add_u32 v60, s40, v60
  global_load_dword v61, v60, s[68:69] sc1
  v_mfma_f32_16x16x32_bf16 v[132:135], v[16:19], v[68:71], v[132:135]
  ds_read_b64_tr_b16 v[30:31], v15 offset:34816
  v_mfma_f32_16x16x32_bf16 v[136:139], v[16:19], v[72:75], v[136:139]
  ds_read_b64 v[80:81], v57 offset:34816
  v_mfma_f32_16x16x32_bf16 v[140:143], v[16:19], v[76:79], v[140:143]
  s_waitcnt lgkmcnt(9)
  ds_read_b64 v[82:83], v57 offset:35840
  ds_read_b64 v[84:85], v57 offset:34824
  v_mfma_f32_16x16x32_bf16 v[144:147], v[20:23], v[64:67], v[144:147]
  ds_read_b64_tr_b16 v[16:17], v12 offset:40960
  v_mfma_f32_16x16x32_bf16 v[148:151], v[20:23], v[68:71], v[148:151]
  ds_read_b64_tr_b16 v[18:19], v12 offset:43008
  v_mfma_f32_16x16x32_bf16 v[152:155], v[20:23], v[72:75], v[152:155]
  ds_read_b64 v[86:87], v57 offset:35848
  v_mfma_f32_16x16x32_bf16 v[156:159], v[20:23], v[76:79], v[156:159]
  s_waitcnt lgkmcnt(8)
  ds_read_b64 v[88:89], v57 offset:38912
  ds_read_b64 v[90:91], v57 offset:39936
  v_mfma_f32_16x16x32_bf16 v[160:163], v[24:27], v[64:67], v[160:163]
  ds_read_b64_tr_b16 v[20:21], v13 offset:40960
  v_mfma_f32_16x16x32_bf16 v[164:167], v[24:27], v[68:71], v[164:167]
  s_cmp_eq_u32 s6, 3
  s_cselect_b32 s42, 2048, 0
  s_sub_u32 s42, 20480, s42
  s_add_u32 s34, s14, s42
  s_addc_u32 s35, s15, 0
  s_add_u32 m0, s36, 32768
  ds_read_b64_tr_b16 v[22:23], v13 offset:43008
  v_mfma_f32_16x16x32_bf16 v[168:171], v[24:27], v[72:75], v[168:171]
  global_load_lds_dwordx4 v4, s[34:35] offset:0
  ds_read_b64 v[92:93], v57 offset:38920
  v_mfma_f32_16x16x32_bf16 v[172:175], v[24:27], v[76:79], v[172:175]
  s_waitcnt lgkmcnt(11)
  global_load_lds_dwordx4 v4, s[34:35] offset:1024
  ds_read_b64 v[94:95], v57 offset:39944
  v_mfma_f32_16x16x32_bf16 v[176:179], v[28:31], v[64:67], v[176:179]
  ds_read_b64_tr_b16 v[24:25], v14 offset:40960
  v_mfma_f32_16x16x32_bf16 v[180:183], v[28:31], v[68:71], v[180:183]
  ds_read_b64_tr_b16 v[26:27], v14 offset:43008
  v_mfma_f32_16x16x32_bf16 v[184:187], v[28:31], v[72:75], v[184:187]
  v_mfma_f32_16x16x32_bf16 v[188:191], v[28:31], v[76:79], v[188:191]
  s_waitcnt lgkmcnt(9)
  s_waitcnt lgkmcnt(2)
  v_mfma_f32_16x16x32_bf16 v[128:131], v[16:19], v[80:83], v[128:131]
  ds_read_b64_tr_b16 v[28:29], v15 offset:40960
  v_mfma_f32_16x16x32_bf16 v[132:135], v[16:19], v[84:87], v[132:135]
  ds_read_b64_tr_b16 v[30:31], v15 offset:43008
  v_mfma_f32_16x16x32_bf16 v[136:139], v[16:19], v[88:91], v[136:139]
  v_mfma_f32_16x16x32_bf16 v[140:143], v[16:19], v[92:95], v[140:143]
  s_waitcnt lgkmcnt(6)
  v_mfma_f32_16x16x32_bf16 v[144:147], v[20:23], v[80:83], v[144:147]
  s_waitcnt vmcnt(5)
  s_barrier
  v_mfma_f32_16x16x32_bf16 v[148:151], v[20:23], v[84:87], v[148:151]
  ds_read_b64_tr_b16 v[16:17], v8 offset:0
  v_mfma_f32_16x16x32_bf16 v[152:155], v[20:23], v[88:91], v[152:155]
  ds_read_b64_tr_b16 v[18:19], v8 offset:2048
  ds_read_b64 v[64:65], v5 offset:0
  v_mfma_f32_16x16x32_bf16 v[156:159], v[20:23], v[92:95], v[156:159]
  s_waitcnt lgkmcnt(5)
  ds_read_b64 v[66:67], v5 offset:1024
  ds_read_b64 v[68:69], v5 offset:8
  s_waitcnt vmcnt(2)
  v_cmp_ne_u32 vcc, s71, v61
  s_nop 3
  s_cmp_eq_u64 vcc, 0
  s_cbranch_scc0 L_spin46
L_back46:
  v_mfma_f32_16x16x32_bf16 v[160:163], v[24:27], v[80:83], v[160:163]
  ds_read_b64_tr_b16 v[20:21], v9 offset:0
  ds_read_b64 v[70:71], v5 offset:1032
  v_mfma_f32_16x16x32_bf16 v[164:167], v[24:27], v[84:87], v[164:167]
  ds_read_b64_tr_b16 v[22:23], v9 offset:2048
  ds_read_b64 v[72:73], v5 offset:4096
  v_mfma_f32_16x16x32_bf16 v[168:171], v[24:27], v[88:91], v[168:171]
  s_mov_b32 s38, 0
  s_mov_b32 s39, 0
  ds_read_b64 v[74:75], v5 offset:5120
  v_mfma_f32_16x16x32_bf16 v[172:175], v[24:27], v[92:95], v[172:175]
  s_waitcnt lgkmcnt(10)
  ds_read_b64 v[76:77], v5 offset:4104
  ds_read_b64 v[78:79], v5 offset:5128
  v_mfma_f32_16x16x32_bf16 v[176:179], v[28:31], v[80:83], v[176:179]
  s_add_u32 s30, s8, s39
  s_addc_u32 s31, s9, 0
  ds_read_b64_tr_b16 v[24:25], v10 offset:0
  v_mfma_f32_16x16x32_bf16 v[180:183], v[28:31], v[84:87], v[180:183]
  s_add_u32 m0, s37, 65536
  ds_read_b64_tr_b16 v[26:27], v10 offset:2048
  v_mfma_f32_16x16x32_bf16 v[184:187], v[28:31], v[88:91], v[184:187]
  global_load_lds_dwordx4 v2, s[30:31] offset:0
  s_add_u32 m0, s37, 69504
  v_mfma_f32_16x16x32_bf16 v[188:191], v[28:31], v[92:95], v[188:191]
  s_waitcnt lgkmcnt(12)
  s_waitcnt lgkmcnt(2)
  global_load_lds_dwordx4 v2, s[30:31] offset:128
  v_mfma_f32_16x16x32_bf16 v[128:131], v[16:19], v[64:67], v[128:131]
  ds_read_b64_tr_b16 v[28:29], v11 offset:0
  v_mfma_f32_16x16x32_bf16 v[132:135], v[16:19], v[68:71], v[132:135]
  ds_read_b64_tr_b16 v[30:31], v11 offset:2048
  v_mfma_f32_16x16x32_bf16 v[136:139], v[16:19], v[72:75], v[136:139]
  ds_read_b64 v[80:81], v5 offset:2048
  v_mfma_f32_16x16x32_bf16 v[140:143], v[16:19], v[76:79], v[140:143]
  s_waitcnt lgkmcnt(9)
  ds_read_b64 v[82:83], v5 offset:3072
  ds_read_b64 v[84:85], v5 offset:2056
  v_mfma_f32_16x16x32_bf16 v[144:147], v[20:23], v[64:67], v[144:147]
  ds_read_b64_tr_b16 v[16:17], v8 offset:8192
  v_mfma_f32_16x16x32_bf16 v[148:151], v[20:23], v[68:71], v[148:151]
  ds_read_b64_tr_b16 v[18:19], v8 offset:10240
  v_mfma_f32_16x16x32_bf16 v[152:155], v[20:23], v[72:75], v[152:155]
  ds_read_b64 v[86:87], v5 offset:3080
  v_mfma_f32_16x16x32_bf16 v[156:159], v[20:23], v[76:79], v[156:159]
  s_waitcnt lgkmcnt(8)
  ds_read_b64 v[88:89], v5 offset:6144
  ds_read_b64 v[90:91], v5 offset:7168
  v_mfma_f32_16x16x32_bf16 v[160:163], v[24:27], v[64:67], v[160:163]
  ds_read_b64_tr_b16 v[20:21], v9 offset:8192
  v_mfma_f32_16x16x32_bf16 v[164:167], v[24:27], v[68:71], v[164:167]
  s_add_u32 s42, s39, 32768
  s_add_u32 s32, s8, s42
  s_addc_u32 s33, s9, 0
  s_add_u32 m0, s37, 73728
  ds_read_b64_tr_b16 v[22:23], v9 offset:10240
  v_mfma_f32_16x16x32_bf16 v[168:171], v[24:27], v[72:75], v[168:171]
  global_load_lds_dwordx4 v2, s[32:33] offset:0
  ds_read_b64 v[92:93], v5 offset:6152
  s_add_u32 m0, s37, 77696
  v_mfma_f32_16x16x32_bf16 v[172:175], v[24:27], v[76:79], v[172:175]
  s_waitcnt lgkmcnt(11)
  global_load_lds_dwordx4 v2, s[32:33] offset:128
  ds_read_b64 v[94:95], v5 offset:7176
  v_mfma_f32_16x16x32_bf16 v[176:179], v[28:31], v[64:67], v[176:179]
  ds_read_b64_tr_b16 v[24:25], v10 offset:8192
  v_mfma_f32_16x16x32_bf16 v[180:183], v[28:31], v[68:71], v[180:183]
  s_add_u32 s42, s38, 0
  s_add_u32 s34, s16, s42
  s_addc_u32 s35, s17, 0
  s_add_u32 m0, s36, 65536
  ds_read_b64_tr_b16 v[26:27], v10 offset:10240
  v_mfma_f32_16x16x32_bf16 v[184:187], v[28:31], v[72:75], v[184:187]
  global_load_lds_dwordx4 v4, s[34:35] offset:0
  v_mfma_f32_16x16x32_bf16 v[188:191], v[28:31], v[76:79], v[188:191]
  s_waitcnt lgkmcnt(9)
  s_waitcnt lgkmcnt(2)
  global_load_lds_dwordx4 v4, s[34:35] offset:1024
  v_mfma_f32_16x16x32_bf16 v[128:131], v[16:19], v[80:83], v[128:131]
  ds_read_b64_tr_b16 v[28:29], v11 offset:8192
  v_mfma_f32_16x16x32_bf16 v[132:135], v[16:19], v[84:87], v[132:135]
  s_add_u32 s42, s38, 131072
  s_add_u32 s44, s16, s42
  s_addc_u32 s45, s17, 0
  s_add_u32 m0, s36, 67584
  ds_read_b64_tr_b16 v[30:31], v11 offset:10240
  v_mfma_f32_16x16x32_bf16 v[136:139], v[16:19], v[88:91], v[136:139]
  global_load_lds_dwordx4 v4, s[44:45] offset:0
  v_mfma_f32_16x16x32_bf16 v[140:143], v[16:19], v[92:95], v[140:143]
  s_waitcnt lgkmcnt(6)
  global_load_lds_dwordx4 v4, s[44:45] offset:1024
  v_mfma_f32_16x16x32_bf16 v[144:147], v[20:23], v[80:83], v[144:147]
  s_waitcnt vmcnt(8)
  s_barrier
  v_mfma_f32_16x16x32_bf16 v[148:151], v[20:23], v[84:87], v[148:151]
  ds_read_b64_tr_b16 v[16:17], v8 offset:32768
  v_mfma_f32_16x16x32_bf16 v[152:155], v[20:23], v[88:91], v[152:155]
  ds_read_b64_tr_b16 v[18:19], v8 offset:34816
  ds_read_b64 v[64:65], v5 offset:32768
  v_mfma_f32_16x16x32_bf16 v[156:159], v[20:23], v[92:95], v[156:159]
  s_waitcnt lgkmcnt(5)
  ds_read_b64 v[66:67], v5 offset:33792
  ds_read_b64 v[68:69], v5 offset:32776
  v_mfma_f32_16x16x32_bf16 v[160:163], v[24:27], v[80:83], v[160:163]
  ds_read_b64_tr_b16 v[20:21], v9 offset:32768
  ds_read_b64 v[70:71], v5 offset:33800
  v_mfma_f32_16x16x32_bf16 v[164:167], v[24:27], v[84:87], v[164:167]
  ds_read_b64_tr_b16 v[22:23], v9 offset:34816
  ds_read_b64 v[72:73], v5 offset:36864
  v_mfma_f32_16x16x32_bf16 v[168:171], v[24:27], v[88:91], v[168:171]
  s_mov_b32 s38, 2048
  s_mov_b32 s39, 65536
  ds_read_b64 v[74:75], v5 offset:37888
  v_mfma_f32_16x16x32_bf16 v[172:175], v[24:27], v[92:95], v[172:175]
  s_waitcnt lgkmcnt(10)
  ds_read_b64 v[76:77], v5 offset:36872
  ds_read_b64 v[78:79], v5 offset:37896
  v_mfma_f32_16x16x32_bf16 v[176:179], v[28:31], v[80:83], v[176:179]
  s_add_u32 s30, s8, s39
  s_addc_u32 s31, s9, 0
  ds_read_b64_tr_b16 v[24:25], v10 offset:32768
  v_mfma_f32_16x16x32_bf16 v[180:183], v[28:31], v[84:87], v[180:183]
  s_add_u32 m0, s37, 98304
  ds_read_b64_tr_b16 v[26:27], v10 offset:34816
  v_mfma_f32_16x16x32_bf16 v[184:187], v[28:31], v[88:91], v[184:187]
  global_load_lds_dwordx4 v2, s[30:31] offset:0
  s_add_u32 m0, s37, 102272
  v_mfma_f32_16x16x32_bf16 v[188:191], v[28:31], v[92:95], v[188:191]
  s_waitcnt lgkmcnt(12)
  s_waitcnt lgkmcnt(2)
  global_load_lds_dwordx4 v2, s[30:31] offset:128
  s_cmp_eq_u32 s6, 3
  s_cbranch_scc0 L_t4z45
  v_mov_b32 v64, 0
  v_mov_b32 v65, 0
  v_mov_b32 v66, 0
  v_mov_b32 v67, 0
  v_mov_b32 v68, 0
  v_mov_b32 v69, 0
  v_mov_b32 v70, 0
  v_mov_b32 v71, 0
  v_mov_b32 v72, 0
  v_mov_b32 v73, 0
  v_mov_b32 v74, 0
  v_mov_b32 v75, 0
  v_mov_b32 v76, 0
  v_mov_b32 v77, 0
  v_mov_b32 v78, 0
  v_mov_b32 v79, 0
L_t4z45:
  s_nop 1
  v_mfma_f32_16x16x32_bf16 v[128:131], v[16:19], v[64:67], v[128:131]
  ds_read_b64_tr_b16 v[28:29], v11 offset:32768
  v_mfma_f32_16x16x32_bf16 v[132:135], v[16:19], v[68:71], v[132:135]
  s_add_u32 s42, s39, 32768
  s_add_u32 s32, s8, s42
  s_addc_u32 s33, s9, 0
  s_add_u32 m0, s37, 106496
  ds_read_b64_tr_b16 v[30:31], v11 offset:34816
  v_mfma_f32_16x16x32_bf16 v[136:139], v[16:19], v[72:75], v[136:139]
  global_load_lds_dwordx4 v2, s[32:33] offset:0
  s_add_u32 m0, s37, 110464
  v_mfma_f32_16x16x32_bf16 v[140:143], v[16:19], v[76:79], v[140:143]
  s_waitcnt lgkmcnt(8)
  global_load_lds_dwordx4 v2, s[32:33] offset:128
  v_mfma_f32_16x16x32_bf16 v[144:147], v[20:23], v[64:67], v[144:147]
  s_waitcnt vmcnt(4)
  s_barrier
  v_mfma_f32_16x16x32_bf16 v[148:151], v[20:23], v[68:71], v[148:151]
  ds_read_b64_tr_b16 v[16:17], v12 offset:0
  v_mfma_f32_16x16x32_bf16 v[152:155], v[20:23], v[72:75], v[152:155]
  ds_read_b64_tr_b16 v[18:19], v12 offset:2048
  ds_read_b128 v[80:83], v57 offset:0
  v_mfma_f32_16x16x32_bf16 v[156:159], v[20:23], v[76:79], v[156:159]
  s_waitcnt lgkmcnt(5)
  ds_read_b128 v[84:87], v57 offset:2048
  v_mfma_f32_16x16x32_bf16 v[160:163], v[24:27], v[64:67], v[160:163]
  ds_read_b64_tr_b16 v[20:21], v13 offset:0
  v_mfma_f32_16x16x32_bf16 v[164:167], v[24:27], v[68:71], v[164:167]
  s_add_u32 s42, s38, 0
  s_add_u32 s34, s16, s42
  s_addc_u32 s35, s17, 0
  s_add_u32 m0, s36, 98304
  ds_read_b64_tr_b16 v[22:23], v13 offset:2048
  v_mfma_f32_16x16x32_bf16 v[168:171], v[24:27], v[72:75], v[168:171]
  global_load_lds_dwordx4 v4, s[34:35] offset:0
  ds_read_b128 v[88:91], v57 offset:4096
  v_mfma_f32_16x16x32_bf16 v[172:175], v[24:27], v[76:79], v[172:175]
  s_waitcnt lgkmcnt(7)
  global_load_lds_dwordx4 v4, s[34:35] offset:1024
  ds_read_b128 v[92:95], v57 offset:6144
  v_mfma_f32_16x16x32_bf16 v[176:179], v[28:31], v[64:67], v[176:179]
  ds_read_b64_tr_b16 v[24:25], v14 offset:0
  v_mfma_f32_16x16x32_bf16 v[180:183], v[28:31], v[68:71], v[180:183]
  s_add_u32 s42, s38, 131072
  s_add_u32 s44, s16, s42
  s_addc_u32 s45, s17, 0
  s_add_u32 m0, s36, 100352
  ds_read_b64_tr_b16 v[26:27], v14 offset:2048
  v_mfma_f32_16x16x32_bf16 v[184:187], v[28:31], v[72:75], v[184:187]
  global_load_lds_dwordx4 v4, s[44:45] offset:0
  v_mfma_f32_16x16x32_bf16 v[188:191], v[28:31], v[76:79], v[188:191]
  s_waitcnt lgkmcnt(8)
  s_waitcnt lgkmcnt(2)
  global_load_lds_dwordx4 v4, s[44:45] offset:1024
  s_mov_b32 s38, 4096
  s_mov_b32 s39, 131072
  s_add_u32 s30, s8, s39
  s_addc_u32 s31, s9, 0
  s_add_u32 m0, s37, 0
  v_mfma_f32_16x16x32_bf16 v[128:131], v[16:19], v[80:83], v[128:131]
  global_load_lds_dwordx4 v2, s[30:31] offset:0
  ds_read_b64_tr_b16 v[28:29], v15 offset:0
  s_add_u32 m0, s37, 3968
  v_mfma_f32_16x16x32_bf16 v[132:135], v[16:19], v[84:87], v[132:135]
  global_load_lds_dwordx4 v2, s[30:31] offset:128
  ds_read_b64_tr_b16 v[30:31], v15 offset:2048
  v_mfma_f32_16x16x32_bf16 v[136:139], v[16:19], v[88:91], v[136:139]
  ds_read_b128 v[64:67], v57 offset:1024
  v_mfma_f32_16x16x32_bf16 v[140:143], v[16:19], v[92:95], v[140:143]
  s_waitcnt lgkmcnt(7)
  ds_read_b128 v[68:71], v57 offset:3072
  v_mfma_f32_16x16x32_bf16 v[144:147], v[20:23], v[80:83], v[144:147]
  ds_read_b64_tr_b16 v[16:17], v12 offset:8192
  v_mfma_f32_16x16x32_bf16 v[148:151], v[20:23], v[84:87], v[148:151]
  ds_read_b64_tr_b16 v[18:19], v12 offset:10240
  v_mfma_f32_16x16x32_bf16 v[152:155], v[20:23], v[88:91], v[152:155]
  ds_read_b128 v[72:75], v57 offset:5120
  v_mfma_f32_16x16x32_bf16 v[156:159], v[20:23], v[92:95], v[156:159]
  s_waitcnt lgkmcnt(7)
  ds_read_b128 v[76:79], v57 offset:7168
  v_mfma_f32_16x16x32_bf16 v[160:163], v[24:27], v[80:83], v[160:163]
  ds_read_b64_tr_b16 v[20:21], v13 offset:8192
  v_mfma_f32_16x16x32_bf16 v[164:167], v[24:27], v[84:87], v[164:167]
  s_add_u32 s42, s39, 32768
  s_add_u32 s32, s8, s42
  s_addc_u32 s33, s9, 0
  s_add_u32 m0, s37, 8192
  ds_read_b64_tr_b16 v[22:23], v13 offset:10240
  v_mfma_f32_16x16x32_bf16 v[168:171], v[24:27], v[88:91], v[168:171]
  global_load_lds_dwordx4 v2, s[32:33] offset:0
  s_add_u32 m0, s37, 12160
  v_mfma_f32_16x16x32_bf16 v[172:175], v[24:27], v[92:95], v[172:175]
  s_waitcnt lgkmcnt(8)
  global_load_lds_dwordx4 v2, s[32:33] offset:128
  v_mfma_f32_16x16x32_bf16 v[176:179], v[28:31], v[80:83], v[176:179]
  ds_read_b64_tr_b16 v[24:25], v14 offset:8192
  v_mfma_f32_16x16x32_bf16 v[180:183], v[28:31], v[84:87], v[180:183]
  s_add_u32 s42, s38, 0
  s_add_u32 s34, s16, s42
  s_addc_u32 s35, s17, 0
  s_add_u32 m0, s36, 0
  ds_read_b64_tr_b16 v[26:27], v14 offset:10240
  v_mfma_f32_16x16x32_bf16 v[184:187], v[28:31], v[88:91], v[184:187]
  global_load_lds_dwordx4 v4, s[34:35] offset:0
  v_mfma_f32_16x16x32_bf16 v[188:191], v[28:31], v[92:95], v[188:191]
  s_waitcnt lgkmcnt(6)
  s_waitcnt lgkmcnt(4)
  global_load_lds_dwordx4 v4, s[34:35] offset:1024
  v_mfma_f32_16x16x32_bf16 v[128:131], v[16:19], v[64:67], v[128:131]
  ds_read_b64_tr_b16 v[28:29], v15 offset:8192
  v_mfma_f32_16x16x32_bf16 v[132:135], v[16:19], v[68:71], v[132:135]
  s_add_u32 s42, s38, 131072
  s_add_u32 s44, s16, s42
  s_addc_u32 s45, s17, 0
  s_add_u32 m0, s36, 2048
  ds_read_b64_tr_b16 v[30:31], v15 offset:10240
  v_mfma_f32_16x16x32_bf16 v[136:139], v[16:19], v[72:75], v[136:139]
  global_load_lds_dwordx4 v4, s[44:45] offset:0
  v_mfma_f32_16x16x32_bf16 v[140:143], v[16:19], v[76:79], v[140:143]
  s_waitcnt lgkmcnt(4)
  global_load_lds_dwordx4 v4, s[44:45] offset:1024
  v_mfma_f32_16x16x32_bf16 v[144:147], v[20:23], v[64:67], v[144:147]
  s_waitcnt vmcnt(8)
  s_barrier
  v_mfma_f32_16x16x32_bf16 v[148:151], v[20:23], v[68:71], v[148:151]
  ds_read_b64_tr_b16 v[16:17], v12 offset:32768
  v_mfma_f32_16x16x32_bf16 v[152:155], v[20:23], v[72:75], v[152:155]
  ds_read_b64_tr_b16 v[18:19], v12 offset:34816
  ds_read_b128 v[80:83], v57 offset:32768
  v_mfma_f32_16x16x32_bf16 v[156:159], v[20:23], v[76:79], v[156:159]
  s_waitcnt lgkmcnt(5)
  ds_read_b128 v[84:87], v57 offset:34816
  v_mfma_f32_16x16x32_bf16 v[160:163], v[24:27], v[64:67], v[160:163]
  ds_read_b64_tr_b16 v[20:21], v13 offset:32768
  v_mfma_f32_16x16x32_bf16 v[164:167], v[24:27], v[68:71], v[164:167]
  ds_read_b64_tr_b16 v[22:23], v13 offset:34816
  v_mfma_f32_16x16x32_bf16 v[168:171], v[24:27], v[72:75], v[168:171]
  s_mov_b32 s38, 6144
  s_mov_b32 s39, 196608
  ds_read_b128 v[88:91], v57 offset:36864
  v_mfma_f32_16x16x32_bf16 v[172:175], v[24:27], v[76:79], v[172:175]
  s_waitcnt lgkmcnt(7)
  ds_read_b128 v[92:95], v57 offset:38912
  v_mfma_f32_16x16x32_bf16 v[176:179], v[28:31], v[64:67], v[176:179]
  s_add_u32 s30, s8, s39
  s_addc_u32 s31, s9, 0
  ds_read_b64_tr_b16 v[24:25], v14 offset:32768
  v_mfma_f32_16x16x32_bf16 v[180:183], v[28:31], v[68:71], v[180:183]
  s_add_u32 m0, s37, 32768
  ds_read_b64_tr_b16 v[26:27], v14 offset:34816
  v_mfma_f32_16x16x32_bf16 v[184:187], v[28:31], v[72:75], v[184:187]
  global_load_lds_dwordx4 v2, s[30:31] offset:0
  s_add_u32 m0, s37, 36736
  v_mfma_f32_16x16x32_bf16 v[188:191], v[28:31], v[76:79], v[188:191]
  s_waitcnt lgkmcnt(8)
  s_waitcnt lgkmcnt(2)
  global_load_lds_dwordx4 v2, s[30:31] offset:128
  v_mfma_f32_16x16x32_bf16 v[128:131], v[16:19], v[80:83], v[128:131]
  ds_read_b64_tr_b16 v[28:29], v15 offset:32768
  v_mfma_f32_16x16x32_bf16 v[132:135], v[16:19], v[84:87], v[132:135]
  ds_read_b64_tr_b16 v[30:31], v15 offset:34816
  v_mfma_f32_16x16x32_bf16 v[136:139], v[16:19], v[88:91], v[136:139]
  ds_read_b128 v[64:67], v57 offset:33792
  v_mfma_f32_16x16x32_bf16 v[140:143], v[16:19], v[92:95], v[140:143]
  s_waitcnt lgkmcnt(7)
  ds_read_b128 v[68:71], v57 offset:35840
  v_mfma_f32_16x16x32_bf16 v[144:147], v[20:23], v[80:83], v[144:147]
  ds_read_b64_tr_b16 v[16:17], v12 offset:40960
  v_mfma_f32_16x16x32_bf16 v[148:151], v[20:23], v[84:87], v[148:151]
  ds_read_b64_tr_b16 v[18:19], v12 offset:43008
  v_mfma_f32_16x16x32_bf16 v[152:155], v[20:23], v[88:91], v[152:155]
  ds_read_b128 v[72:75], v57 offset:37888
  v_mfma_f32_16x16x32_bf16 v[156:159], v[20:23], v[92:95], v[156:159]
  s_waitcnt lgkmcnt(7)
  ds_read_b128 v[76:79], v57 offset:39936
  v_mfma_f32_16x16x32_bf16 v[160:163], v[24:27], v[80:83], v[160:163]
  ds_read_b64_tr_b16 v[20:21], v13 offset:40960
  v_mfma_f32_16x16x32_bf16 v[164:167], v[24:27], v[84:87], v[164:167]
  s_add_u32 s42, s39, 32768
  s_add_u32 s32, s8, s42
  s_addc_u32 s33, s9, 0
  s_add_u32 m0, s37, 40960
  ds_read_b64_tr_b16 v[22:23], v13 offset:43008
  v_mfma_f32_16x16x32_bf16 v[168:171], v[24:27], v[88:91], v[168:171]
  global_load_lds_dwordx4 v2, s[32:33] offset:0
  s_add_u32 m0, s37, 44928
  v_mfma_f32_16x16x32_bf16 v[172:175], v[24:27], v[92:95], v[172:175]
  s_waitcnt lgkmcnt(8)
  global_load_lds_dwordx4 v2, s[32:33] offset:128
  v_mfma_f32_16x16x32_bf16 v[176:179], v[28:31], v[80:83], v[176:179]
  ds_read_b64_tr_b16 v[24:25], v14 offset:40960
  v_mfma_f32_16x16x32_bf16 v[180:183], v[28:31], v[84:87], v[180:183]
  s_add_u32 s42, s38, 0
  s_add_u32 s34, s16, s42
  s_addc_u32 s35, s17, 0
  s_add_u32 m0, s36, 32768
  ds_read_b64_tr_b16 v[26:27], v14 offset:43008
  v_mfma_f32_16x16x32_bf16 v[184:187], v[28:31], v[88:91], v[184:187]
  global_load_lds_dwordx4 v4, s[34:35] offset:0
  v_mfma_f32_16x16x32_bf16 v[188:191], v[28:31], v[92:95], v[188:191]
  s_waitcnt lgkmcnt(6)
  s_waitcnt lgkmcnt(4)
  global_load_lds_dwordx4 v4, s[34:35] offset:1024
  v_mfma_f32_16x16x32_bf16 v[128:131], v[16:19], v[64:67], v[128:131]
  ds_read_b64_tr_b16 v[28:29], v15 offset:40960
  v_mfma_f32_16x16x32_bf16 v[132:135], v[16:19], v[68:71], v[132:135]
  s_add_u32 s42, s38, 131072
  s_add_u32 s44, s16, s42
  s_addc_u32 s45, s17, 0
  s_add_u32 m0, s36, 34816
  ds_read_b64_tr_b16 v[30:31], v15 offset:43008
  v_mfma_f32_16x16x32_bf16 v[136:139], v[16:19], v[72:75], v[136:139]
  global_load_lds_dwordx4 v4, s[44:45] offset:0
  v_mfma_f32_16x16x32_bf16 v[140:143], v[16:19], v[76:79], v[140:143]
  s_waitcnt lgkmcnt(4)
  global_load_lds_dwordx4 v4, s[44:45] offset:1024
  v_mfma_f32_16x16x32_bf16 v[144:147], v[20:23], v[64:67], v[144:147]
  s_waitcnt vmcnt(8)
  s_barrier
  v_mfma_f32_16x16x32_bf16 v[148:151], v[20:23], v[68:71], v[148:151]
  ds_read_b64_tr_b16 v[16:17], v8 offset:0
  v_mfma_f32_16x16x32_bf16 v[152:155], v[20:23], v[72:75], v[152:155]
  ds_read_b64_tr_b16 v[18:19], v8 offset:2048
  ds_read_b128 v[80:83], v5 offset:0
  v_mfma_f32_16x16x32_bf16 v[156:159], v[20:23], v[76:79], v[156:159]
  s_waitcnt lgkmcnt(5)
  ds_read_b128 v[84:87], v5 offset:2048
  v_mfma_f32_16x16x32_bf16 v[160:163], v[24:27], v[64:67], v[160:163]
  ds_read_b64_tr_b16 v[20:21], v9 offset:0
  v_mfma_f32_16x16x32_bf16 v[164:167], v[24:27], v[68:71], v[164:167]
  ds_read_b64_tr_b16 v[22:23], v9 offset:2048
  v_mfma_f32_16x16x32_bf16 v[168:171], v[24:27], v[72:75], v[168:171]
  s_mov_b32 s38, 8192
  s_mov_b32 s39, 262144
  ds_read_b128 v[88:91], v5 offset:4096
  v_mfma_f32_16x16x32_bf16 v[172:175], v[24:27], v[76:79], v[172:175]
  s_waitcnt lgkmcnt(7)
  ds_read_b128 v[92:95], v5 offset:6144
  v_mfma_f32_16x16x32_bf16 v[176:179], v[28:31], v[64:67], v[176:179]
  s_add_u32 s30, s8, s39
  s_addc_u32 s31, s9, 0
  ds_read_b64_tr_b16 v[24:25], v10 offset:0
  v_mfma_f32_16x16x32_bf16 v[180:183], v[28:31], v[68:71], v[180:183]
  s_add_u32 m0, s37, 65536
  ds_read_b64_tr_b16 v[26:27], v10 offset:2048
  v_mfma_f32_16x16x32_bf16 v[184:187], v[28:31], v[72:75], v[184:187]
  global_load_lds_dwordx4 v2, s[30:31] offset:0
  s_add_u32 m0, s37, 69504
  v_mfma_f32_16x16x32_bf16 v[188:191], v[28:31], v[76:79], v[188:191]
  s_waitcnt lgkmcnt(8)
  s_waitcnt lgkmcnt(2)
  global_load_lds_dwordx4 v2, s[30:31] offset:128
  v_mfma_f32_16x16x32_bf16 v[128:131], v[16:19], v[80:83], v[128:131]
  ds_read_b64_tr_b16 v[28:29], v11 offset:0
  v_mfma_f32_16x16x32_bf16 v[132:135], v[16:19], v[84:87], v[132:135]
  ds_read_b64_tr_b16 v[30:31], v11 offset:2048
  v_mfma_f32_16x16x32_bf16 v[136:139], v[16:19], v[88:91], v[136:139]
  ds_read_b128 v[64:67], v5 offset:1024
  v_mfma_f32_16x16x32_bf16 v[140:143], v[16:19], v[92:95], v[140:143]
  s_waitcnt lgkmcnt(7)
  ds_read_b128 v[68:71], v5 offset:3072
  v_mfma_f32_16x16x32_bf16 v[144:147], v[20:23], v[80:83], v[144:147]
  ds_read_b64_tr_b16 v[16:17], v8 offset:8192
  v_mfma_f32_16x16x32_bf16 v[148:151], v[20:23], v[84:87], v[148:151]
  ds_read_b64_tr_b16 v[18:19], v8 offset:10240
  v_mfma_f32_16x16x32_bf16 v[152:155], v[20:23], v[88:91], v[152:155]
  ds_read_b128 v[72:75], v5 offset:5120
  v_mfma_f32_16x16x32_bf16 v[156:159], v[20:23], v[92:95], v[156:159]
  s_waitcnt lgkmcnt(7)
  ds_read_b128 v[76:79], v5 offset:7168
  v_mfma_f32_16x16x32_bf16 v[160:163], v[24:27], v[80:83], v[160:163]
  ds_read_b64_tr_b16 v[20:21], v9 offset:8192
  v_mfma_f32_16x16x32_bf16 v[164:167], v[24:27], v[84:87], v[164:167]
  s_add_u32 s42, s39, 32768
  s_add_u32 s32, s8, s42
  s_addc_u32 s33, s9, 0
  s_add_u32 m0, s37, 73728
  ds_read_b64_tr_b16 v[22:23], v9 offset:10240
  v_mfma_f32_16x16x32_bf16 v[168:171], v[24:27], v[88:91], v[168:171]
  global_load_lds_dwordx4 v2, s[32:33] offset:0
  s_add_u32 m0, s37, 77696
  v_mfma_f32_16x16x32_bf16 v[172:175], v[24:27], v[92:95], v[172:175]
  s_waitcnt lgkmcnt(8)
  global_load_lds_dwordx4 v2, s[32:33] offset:128
  v_mfma_f32_16x16x32_bf16 v[176:179], v[28:31], v[80:83], v[176:179]
  ds_read_b64_tr_b16 v[24:25], v10 offset:8192
  v_mfma_f32_16x16x32_bf16 v[180:183], v[28:31], v[84:87], v[180:183]
  s_add_u32 s42, s38, 0
  s_add_u32 s34, s16, s42
  s_addc_u32 s35, s17, 0
  s_add_u32 m0, s36, 65536
  ds_read_b64_tr_b16 v[26:27], v10 offset:10240
  v_mfma_f32_16x16x32_bf16 v[184:187], v[28:31], v[88:91], v[184:187]
  global_load_lds_dwordx4 v4, s[34:35] offset:0
  v_mfma_f32_16x16x32_bf16 v[188:191], v[28:31], v[92:95], v[188:191]
  s_waitcnt lgkmcnt(6)
  s_waitcnt lgkmcnt(4)
  global_load_lds_dwordx4 v4, s[34:35] offset:1024
  v_mfma_f32_16x16x32_bf16 v[128:131], v[16:19], v[64:67], v[128:131]
  ds_read_b64_tr_b16 v[28:29], v11 offset:8192
  v_mfma_f32_16x16x32_bf16 v[132:135], v[16:19], v[68:71], v[132:135]
  s_add_u32 s42, s38, 131072
  s_add_u32 s44, s16, s42
  s_addc_u32 s45, s17, 0
  s_add_u32 m0, s36, 67584
  ds_read_b64_tr_b16 v[30:31], v11 offset:10240
  v_mfma_f32_16x16x32_bf16 v[136:139], v[16:19], v[72:75], v[136:139]
  global_load_lds_dwordx4 v4, s[44:45] offset:0
  v_mfma_f32_16x16x32_bf16 v[140:143], v[16:19], v[76:79], v[140:143]
  s_waitcnt lgkmcnt(4)
  global_load_lds_dwordx4 v4, s[44:45] offset:1024
  v_mfma_f32_16x16x32_bf16 v[144:147], v[20:23], v[64:67], v[144:147]
  s_waitcnt vmcnt(8)
  s_barrier
  v_mfma_f32_16x16x32_bf16 v[148:151], v[20:23], v[68:71], v[148:151]
  ds_read_b64_tr_b16 v[16:17], v8 offset:32768
  v_mfma_f32_16x16x32_bf16 v[152:155], v[20:23], v[72:75], v[152:155]
  ds_read_b64_tr_b16 v[18:19], v8 offset:34816
  ds_read_b128 v[80:83], v5 offset:32768
  v_mfma_f32_16x16x32_bf16 v[156:159], v[20:23], v[76:79], v[156:159]
  s_waitcnt lgkmcnt(5)
  ds_read_b128 v[84:87], v5 offset:34816
  v_mfma_f32_16x16x32_bf16 v[160:163], v[24:27], v[64:67], v[160:163]
  ds_read_b64_tr_b16 v[20:21], v9 offset:32768
  v_mfma_f32_16x16x32_bf16 v[164:167], v[24:27], v[68:71], v[164:167]
  ds_read_b64_tr_b16 v[22:23], v9 offset:34816
  v_mfma_f32_16x16x32_bf16 v[168:171], v[24:27], v[72:75], v[168:171]
  s_mov_b32 s38, 10240
  s_mov_b32 s39, 327680
  ds_read_b128 v[88:91], v5 offset:36864
  v_mfma_f32_16x16x32_bf16 v[172:175], v[24:27], v[76:79], v[172:175]
  s_waitcnt lgkmcnt(7)
  ds_read_b128 v[92:95], v5 offset:38912
  v_mfma_f32_16x16x32_bf16 v[176:179], v[28:31], v[64:67], v[176:179]
  s_add_u32 s30, s8, s39
  s_addc_u32 s31, s9, 0
  ds_read_b64_tr_b16 v[24:25], v10 offset:32768
  v_mfma_f32_16x16x32_bf16 v[180:183], v[28:31], v[68:71], v[180:183]
  s_add_u32 m0, s37, 98304
  ds_read_b64_tr_b16 v[26:27], v10 offset:34816
  v_mfma_f32_16x16x32_bf16 v[184:187], v[28:31], v[72:75], v[184:187]
  global_load_lds_dwordx4 v2, s[30:31] offset:0
  s_add_u32 m0, s37, 102272
  v_mfma_f32_16x16x32_bf16 v[188:191], v[28:31], v[76:79], v[188:191]
  s_waitcnt lgkmcnt(8)
  s_waitcnt lgkmcnt(2)
  global_load_lds_dwordx4 v2, s[30:31] offset:128
  v_mfma_f32_16x16x32_bf16 v[128:131], v[16:19], v[80:83], v[128:131]
  ds_read_b64_tr_b16 v[28:29], v11 offset:32768
  v_mfma_f32_16x16x32_bf16 v[132:135], v[16:19], v[84:87], v[132:135]
  ds_read_b64_tr_b16 v[30:31], v11 offset:34816
  v_mfma_f32_16x16x32_bf16 v[136:139], v[16:19], v[88:91], v[136:139]
  ds_read_b128 v[64:67], v5 offset:33792
  v_mfma_f32_16x16x32_bf16 v[140:143], v[16:19], v[92:95], v[140:143]
  s_waitcnt lgkmcnt(7)
  ds_read_b128 v[68:71], v5 offset:35840
  v_mfma_f32_16x16x32_bf16 v[144:147], v[20:23], v[80:83], v[144:147]
  ds_read_b64_tr_b16 v[16:17], v8 offset:40960
  v_mfma_f32_16x16x32_bf16 v[148:151], v[20:23], v[84:87], v[148:151]
  ds_read_b64_tr_b16 v[18:19], v8 offset:43008
  v_mfma_f32_16x16x32_bf16 v[152:155], v[20:23], v[88:91], v[152:155]
  ds_read_b128 v[72:75], v5 offset:37888
  v_mfma_f32_16x16x32_bf16 v[156:159], v[20:23], v[92:95], v[156:159]
  s_waitcnt lgkmcnt(7)
  ds_read_b128 v[76:79], v5 offset:39936
  v_mfma_f32_16x16x32_bf16 v[160:163], v[24:27], v[80:83], v[160:163]
  ds_read_b64_tr_b16 v[20:21], v9 offset:40960
  v_mfma_f32_16x16x32_bf16 v[164:167], v[24:27], v[84:87], v[164:167]
  s_add_u32 s42, s39, 32768
  s_add_u32 s32, s8, s42
  s_addc_u32 s33, s9, 0
  s_add_u32 m0, s37, 106496
  ds_read_b64_tr_b16 v[22:23], v9 offset:43008
  v_mfma_f32_16x16x32_bf16 v[168:171], v[24:27], v[88:91], v[168:171]
  global_load_lds_dwordx4 v2, s[32:33] offset:0
  s_add_u32 m0, s37, 110464
  v_mfma_f32_16x16x32_bf16 v[172:175], v[24:27], v[92:95], v[172:175]
  s_waitcnt lgkmcnt(8)
  global_load_lds_dwordx4 v2, s[32:33] offset:128
  v_mfma_f32_16x16x32_bf16 v[176:179], v[28:31], v[80:83], v[176:179]
  ds_read_b64_tr_b16 v[24:25], v10 offset:40960
  v_mfma_f32_16x16x32_bf16 v[180:183], v[28:31], v[84:87], v[180:183]
  s_add_u32 s42, s38, 0
  s_add_u32 s34, s16, s42
  s_addc_u32 s35, s17, 0
  s_add_u32 m0, s36, 98304
  ds_read_b64_tr_b16 v[26:27], v10 offset:43008
  v_mfma_f32_16x16x32_bf16 v[184:187], v[28:31], v[88:91], v[184:187]
  global_load_lds_dwordx4 v4, s[34:35] offset:0
  v_mfma_f32_16x16x32_bf16 v[188:191], v[28:31], v[92:95], v[188:191]
  s_waitcnt lgkmcnt(6)
  s_waitcnt lgkmcnt(4)
  global_load_lds_dwordx4 v4, s[34:35] offset:1024
  v_mfma_f32_16x16x32_bf16 v[128:131], v[16:19], v[64:67], v[128:131]
  ds_read_b64_tr_b16 v[28:29], v11 offset:40960
  v_mfma_f32_16x16x32_bf16 v[132:135], v[16:19], v[68:71], v[132:135]
  s_add_u32 s42, s38, 131072
  s_add_u32 s44, s16, s42
  s_addc_u32 s45, s17, 0
  s_add_u32 m0, s36, 100352
  ds_read_b64_tr_b16 v[30:31], v11 offset:43008
  v_mfma_f32_16x16x32_bf16 v[136:139], v[16:19], v[72:75], v[136:139]
  global_load_lds_dwordx4 v4, s[44:45] offset:0
  v_mfma_f32_16x16x32_bf16 v[140:143], v[16:19], v[76:79], v[140:143]
  s_waitcnt lgkmcnt(4)
  global_load_lds_dwordx4 v4, s[44:45] offset:1024
  v_mfma_f32_16x16x32_bf16 v[144:147], v[20:23], v[64:67], v[144:147]
  s_waitcnt vmcnt(8)
  s_barrier
  v_mfma_f32_16x16x32_bf16 v[148:151], v[20:23], v[68:71], v[148:151]
  ds_read_b64_tr_b16 v[16:17], v12 offset:0
  v_mfma_f32_16x16x32_bf16 v[152:155], v[20:23], v[72:75], v[152:155]
  ds_read_b64_tr_b16 v[18:19], v12 offset:2048
  ds_read_b128 v[80:83], v57 offset:0
  v_mfma_f32_16x16x32_bf16 v[156:159], v[20:23], v[76:79], v[156:159]
  s_waitcnt lgkmcnt(5)
  ds_read_b128 v[84:87], v57 offset:2048
  v_mfma_f32_16x16x32_bf16 v[160:163], v[24:27], v[64:67], v[160:163]
  ds_read_b64_tr_b16 v[20:21], v13 offset:0
  v_mfma_f32_16x16x32_bf16 v[164:167], v[24:27], v[68:71], v[164:167]
  ds_read_b64_tr_b16 v[22:23], v13 offset:2048
  v_mfma_f32_16x16x32_bf16 v[168:171], v[24:27], v[72:75], v[168:171]
  s_mov_b32 s38, 12288
  s_mov_b32 s39, 393216
  ds_read_b128 v[88:91], v57 offset:4096
  v_mfma_f32_16x16x32_bf16 v[172:175], v[24:27], v[76:79], v[172:175]
  s_waitcnt lgkmcnt(7)
  ds_read_b128 v[92:95], v57 offset:6144
  v_mfma_f32_16x16x32_bf16 v[176:179], v[28:31], v[64:67], v[176:179]
  s_add_u32 s30, s8, s39
  s_addc_u32 s31, s9, 0
  ds_read_b64_tr_b16 v[24:25], v14 offset:0
  v_mfma_f32_16x16x32_bf16 v[180:183], v[28:31], v[68:71], v[180:183]
  s_add_u32 m0, s37, 0
  ds_read_b64_tr_b16 v[26:27], v14 offset:2048
  v_mfma_f32_16x16x32_bf16 v[184:187], v[28:31], v[72:75], v[184:187]
  global_load_lds_dwordx4 v2, s[30:31] offset:0
  s_add_u32 m0, s37, 3968
  v_mfma_f32_16x16x32_bf16 v[188:191], v[28:31], v[76:79], v[188:191]
  s_waitcnt lgkmcnt(8)
  s_waitcnt lgkmcnt(2)
  global_load_lds_dwordx4 v2, s[30:31] offset:128
  v_mfma_f32_16x16x32_bf16 v[128:131], v[16:19], v[80:83], v[128:131]
  ds_read_b64_tr_b16 v[28:29], v15 offset:0
  v_mfma_f32_16x16x32_bf16 v[132:135], v[16:19], v[84:87], v[132:135]
  ds_read_b64_tr_b16 v[30:31], v15 offset:2048
  v_mfma_f32_16x16x32_bf16 v[136:139], v[16:19], v[88:91], v[136:139]
  ds_read_b128 v[64:67], v57 offset:1024
  v_mfma_f32_16x16x32_bf16 v[140:143], v[16:19], v[92:95], v[140:143]
  s_waitcnt lgkmcnt(7)
  ds_read_b128 v[68:71], v57 offset:3072
  v_mfma_f32_16x16x32_bf16 v[144:147], v[20:23], v[80:83], v[144:147]
  ds_read_b64_tr_b16 v[16:17], v12 offset:8192
  v_mfma_f32_16x16x32_bf16 v[148:151], v[20:23], v[84:87], v[148:151]
  ds_read_b64_tr_b16 v[18:19], v12 offset:10240
  v_mfma_f32_16x16x32_bf16 v[152:155], v[20:23], v[88:91], v[152:155]
  ds_read_b128 v[72:75], v57 offset:5120
  v_mfma_f32_16x16x32_bf16 v[156:159], v[20:23], v[92:95], v[156:159]
  s_waitcnt lgkmcnt(7)
  ds_read_b128 v[76:79], v57 offset:7168
  v_mfma_f32_16x16x32_bf16 v[160:163], v[24:27], v[80:83], v[160:163]
  ds_read_b64_tr_b16 v[20:21], v13 offset:8192
  v_mfma_f32_16x16x32_bf16 v[164:167], v[24:27], v[84:87], v[164:167]
  s_add_u32 s42, s39, 32768
  s_add_u32 s32, s8, s42
  s_addc_u32 s33, s9, 0
  s_add_u32 m0, s37, 8192
  ds_read_b64_tr_b16 v[22:23], v13 offset:10240
  v_mfma_f32_16x16x32_bf16 v[168:171], v[24:27], v[88:91], v[168:171]
  global_load_lds_dwordx4 v2, s[32:33] offset:0
  s_add_u32 m0, s37, 12160
  v_mfma_f32_16x16x32_bf16 v[172:175], v[24:27], v[92:95], v[172:175]
  s_waitcnt lgkmcnt(8)
  global_load_lds_dwordx4 v2, s[32:33] offset:128
  v_mfma_f32_16x16x32_bf16 v[176:179], v[28:31], v[80:83], v[176:179]
  ds_read_b64_tr_b16 v[24:25], v14 offset:8192
  v_mfma_f32_16x16x32_bf16 v[180:183], v[28:31], v[84:87], v[180:183]
  s_add_u32 s42, s38, 0
  s_add_u32 s34, s16, s42
  s_addc_u32 s35, s17, 0
  s_add_u32 m0, s36, 0
  ds_read_b64_tr_b16 v[26:27], v14 offset:10240
  v_mfma_f32_16x16x32_bf16 v[184:187], v[28:31], v[88:91], v[184:187]
  global_load_lds_dwordx4 v4, s[34:35] offset:0
  v_mfma_f32_16x16x32_bf16 v[188:191], v[28:31], v[92:95], v[188:191]
  s_waitcnt lgkmcnt(6)
  s_waitcnt lgkmcnt(4)
  global_load_lds_dwordx4 v4, s[34:35] offset:1024
  v_mfma_f32_16x16x32_bf16 v[128:131], v[16:19], v[64:67], v[128:131]
  ds_read_b64_tr_b16 v[28:29], v15 offset:8192
  v_mfma_f32_16x16x32_bf16 v[132:135], v[16:19], v[68:71], v[132:135]
  s_add_u32 s42, s38, 131072
  s_add_u32 s44, s16, s42
  s_addc_u32 s45, s17, 0
  s_add_u32 m0, s36, 2048
  ds_read_b64_tr_b16 v[30:31], v15 offset:10240
  v_mfma_f32_16x16x32_bf16 v[136:139], v[16:19], v[72:75], v[136:139]
  global_load_lds_dwordx4 v4, s[44:45] offset:0
  v_mfma_f32_16x16x32_bf16 v[140:143], v[16:19], v[76:79], v[140:143]
  s_waitcnt lgkmcnt(4)
  global_load_lds_dwordx4 v4, s[44:45] offset:1024
  v_mfma_f32_16x16x32_bf16 v[144:147], v[20:23], v[64:67], v[144:147]
  s_waitcnt vmcnt(8)
  s_barrier
  v_mfma_f32_16x16x32_bf16 v[148:151], v[20:23], v[68:71], v[148:151]
  ds_read_b64_tr_b16 v[16:17], v12 offset:32768
  v_mfma_f32_16x16x32_bf16 v[152:155], v[20:23], v[72:75], v[152:155]
  ds_read_b64_tr_b16 v[18:19], v12 offset:34816
  ds_read_b128 v[80:83], v57 offset:32768
  v_mfma_f32_16x16x32_bf16 v[156:159], v[20:23], v[76:79], v[156:159]
  s_waitcnt lgkmcnt(5)
  ds_read_b128 v[84:87], v57 offset:34816
  v_mfma_f32_16x16x32_bf16 v[160:163], v[24:27], v[64:67], v[160:163]
  ds_read_b64_tr_b16 v[20:21], v13 offset:32768
  v_mfma_f32_16x16x32_bf16 v[164:167], v[24:27], v[68:71], v[164:167]
  ds_read_b64_tr_b16 v[22:23], v13 offset:34816
  v_mfma_f32_16x16x32_bf16 v[168:171], v[24:27], v[72:75], v[168:171]
  s_mov_b32 s38, 14336
  s_mov_b32 s39, 458752
  ds_read_b128 v[88:91], v57 offset:36864
  v_mfma_f32_16x16x32_bf16 v[172:175], v[24:27], v[76:79], v[172:175]
  s_waitcnt lgkmcnt(7)
  ds_read_b128 v[92:95], v57 offset:38912
  v_mfma_f32_16x16x32_bf16 v[176:179], v[28:31], v[64:67], v[176:179]
  s_add_u32 s30, s8, s39
  s_addc_u32 s31, s9, 0
  ds_read_b64_tr_b16 v[24:25], v14 offset:32768
  v_mfma_f32_16x16x32_bf16 v[180:183], v[28:31], v[68:71], v[180:183]
  s_add_u32 m0, s37, 32768
  ds_read_b64_tr_b16 v[26:27], v14 offset:34816
  v_mfma_f32_16x16x32_bf16 v[184:187], v[28:31], v[72:75], v[184:187]
  global_load_lds_dwordx4 v2, s[30:31] offset:0
  s_add_u32 m0, s37, 36736
  v_mfma_f32_16x16x32_bf16 v[188:191], v[28:31], v[76:79], v[188:191]
  s_waitcnt lgkmcnt(8)
  s_waitcnt lgkmcnt(2)
  global_load_lds_dwordx4 v2, s[30:31] offset:128
  v_mfma_f32_16x16x32_bf16 v[128:131], v[16:19], v[80:83], v[128:131]
  ds_read_b64_tr_b16 v[28:29], v15 offset:32768
  v_mfma_f32_16x16x32_bf16 v[132:135], v[16:19], v[84:87], v[132:135]
  ds_read_b64_tr_b16 v[30:31], v15 offset:34816
  v_mfma_f32_16x16x32_bf16 v[136:139], v[16:19], v[88:91], v[136:139]
  ds_read_b128 v[64:67], v57 offset:33792
  v_mfma_f32_16x16x32_bf16 v[140:143], v[16:19], v[92:95], v[140:143]
  s_waitcnt lgkmcnt(7)
  ds_read_b128 v[68:71], v57 offset:35840
  v_mfma_f32_16x16x32_bf16 v[144:147], v[20:23], v[80:83], v[144:147]
  ds_read_b64_tr_b16 v[16:17], v12 offset:40960
  v_mfma_f32_16x16x32_bf16 v[148:151], v[20:23], v[84:87], v[148:151]
  ds_read_b64_tr_b16 v[18:19], v12 offset:43008
  v_mfma_f32_16x16x32_bf16 v[152:155], v[20:23], v[88:91], v[152:155]
  ds_read_b128 v[72:75], v57 offset:37888
  v_mfma_f32_16x16x32_bf16 v[156:159], v[20:23], v[92:95], v[156:159]
  s_waitcnt lgkmcnt(7)
  ds_read_b128 v[76:79], v57 offset:39936
  v_mfma_f32_16x16x32_bf16 v[160:163], v[24:27], v[80:83], v[160:163]
  ds_read_b64_tr_b16 v[20:21], v13 offset:40960
  v_mfma_f32_16x16x32_bf16 v[164:167], v[24:27], v[84:87], v[164:167]
  s_add_u32 s42, s39, 32768
  s_add_u32 s32, s8, s42
  s_addc_u32 s33, s9, 0
  s_add_u32 m0, s37, 40960
  ds_read_b64_tr_b16 v[22:23], v13 offset:43008
  v_mfma_f32_16x16x32_bf16 v[168:171], v[24:27], v[88:91], v[168:171]
  global_load_lds_dwordx4 v2, s[32:33] offset:0
  s_add_u32 m0, s37, 44928
  v_mfma_f32_16x16x32_bf16 v[172:175], v[24:27], v[92:95], v[172:175]
  s_waitcnt lgkmcnt(8)
  global_load_lds_dwordx4 v2, s[32:33] offset:128
  v_mfma_f32_16x16x32_bf16 v[176:179], v[28:31], v[80:83], v[176:179]
  ds_read_b64_tr_b16 v[24:25], v14 offset:40960
  v_mfma_f32_16x16x32_bf16 v[180:183], v[28:31], v[84:87], v[180:183]
  s_add_u32 s42, s38, 0
  s_add_u32 s34, s16, s42
  s_addc_u32 s35, s17, 0
  s_add_u32 m0, s36, 32768
  ds_read_b64_tr_b16 v[26:27], v14 offset:43008
  v_mfma_f32_16x16x32_bf16 v[184:187], v[28:31], v[88:91], v[184:187]
  global_load_lds_dwordx4 v4, s[34:35] offset:0
  v_mfma_f32_16x16x32_bf16 v[188:191], v[28:31], v[92:95], v[188:191]
  s_waitcnt lgkmcnt(6)
  s_waitcnt lgkmcnt(4)
  global_load_lds_dwordx4 v4, s[34:35] offset:1024
  v_mfma_f32_16x16x32_bf16 v[128:131], v[16:19], v[64:67], v[128:131]
  ds_read_b64_tr_b16 v[28:29], v15 offset:40960
  v_mfma_f32_16x16x32_bf16 v[132:135], v[16:19], v[68:71], v[132:135]
  s_add_u32 s42, s38, 131072
  s_add_u32 s44, s16, s42
  s_addc_u32 s45, s17, 0
  s_add_u32 m0, s36, 34816
  ds_read_b64_tr_b16 v[30:31], v15 offset:43008
  v_mfma_f32_16x16x32_bf16 v[136:139], v[16:19], v[72:75], v[136:139]
  global_load_lds_dwordx4 v4, s[44:45] offset:0
  v_mfma_f32_16x16x32_bf16 v[140:143], v[16:19], v[76:79], v[140:143]
  s_waitcnt lgkmcnt(4)
  global_load_lds_dwordx4 v4, s[44:45] offset:1024
  v_mfma_f32_16x16x32_bf16 v[144:147], v[20:23], v[64:67], v[144:147]
  s_waitcnt vmcnt(8)
  s_barrier
  v_mfma_f32_16x16x32_bf16 v[148:151], v[20:23], v[68:71], v[148:151]
  ds_read_b64_tr_b16 v[16:17], v8 offset:0
  v_mfma_f32_16x16x32_bf16 v[152:155], v[20:23], v[72:75], v[152:155]
  ds_read_b64_tr_b16 v[18:19], v8 offset:2048
  ds_read_b128 v[80:83], v5 offset:0
  v_mfma_f32_16x16x32_bf16 v[156:159], v[20:23], v[76:79], v[156:159]
  s_waitcnt lgkmcnt(5)
  ds_read_b128 v[84:87], v5 offset:2048
  v_mfma_f32_16x16x32_bf16 v[160:163], v[24:27], v[64:67], v[160:163]
  ds_read_b64_tr_b16 v[20:21], v9 offset:0
  v_mfma_f32_16x16x32_bf16 v[164:167], v[24:27], v[68:71], v[164:167]
  ds_read_b64_tr_b16 v[22:23], v9 offset:2048
  v_mfma_f32_16x16x32_bf16 v[168:171], v[24:27], v[72:75], v[168:171]
  s_mov_b32 s38, 16384
  s_mov_b32 s39, 524288
  ds_read_b128 v[88:91], v5 offset:4096
  v_mfma_f32_16x16x32_bf16 v[172:175], v[24:27], v[76:79], v[172:175]
  s_waitcnt lgkmcnt(7)
  ds_read_b128 v[92:95], v5 offset:6144
  v_mfma_f32_16x16x32_bf16 v[176:179], v[28:31], v[64:67], v[176:179]
  s_add_u32 s30, s8, s39
  s_addc_u32 s31, s9, 0
  ds_read_b64_tr_b16 v[24:25], v10 offset:0
  v_mfma_f32_16x16x32_bf16 v[180:183], v[28:31], v[68:71], v[180:183]
  s_add_u32 m0, s37, 65536
  ds_read_b64_tr_b16 v[26:27], v10 offset:2048
  v_mfma_f32_16x16x32_bf16 v[184:187], v[28:31], v[72:75], v[184:187]
  global_load_lds_dwordx4 v2, s[30:31] offset:0
  s_add_u32 m0, s37, 69504
  v_mfma_f32_16x16x32_bf16 v[188:191], v[28:31], v[76:79], v[188:191]
  s_waitcnt lgkmcnt(8)
  s_waitcnt lgkmcnt(2)
  global_load_lds_dwordx4 v2, s[30:31] offset:128
  v_mfma_f32_16x16x32_bf16 v[128:131], v[16:19], v[80:83], v[128:131]
  ds_read_b64_tr_b16 v[28:29], v11 offset:0
  v_mfma_f32_16x16x32_bf16 v[132:135], v[16:19], v[84:87], v[132:135]
  ds_read_b64_tr_b16 v[30:31], v11 offset:2048
  v_mfma_f32_16x16x32_bf16 v[136:139], v[16:19], v[88:91], v[136:139]
  ds_read_b128 v[64:67], v5 offset:1024
  v_mfma_f32_16x16x32_bf16 v[140:143], v[16:19], v[92:95], v[140:143]
  s_waitcnt lgkmcnt(7)
  ds_read_b128 v[68:71], v5 offset:3072
  v_mfma_f32_16x16x32_bf16 v[144:147], v[20:23], v[80:83], v[144:147]
  ds_read_b64_tr_b16 v[16:17], v8 offset:8192
  v_mfma_f32_16x16x32_bf16 v[148:151], v[20:23], v[84:87], v[148:151]
  ds_read_b64_tr_b16 v[18:19], v8 offset:10240
  v_mfma_f32_16x16x32_bf16 v[152:155], v[20:23], v[88:91], v[152:155]
  ds_read_b128 v[72:75], v5 offset:5120
  v_mfma_f32_16x16x32_bf16 v[156:159], v[20:23], v[92:95], v[156:159]
  s_waitcnt lgkmcnt(7)
  ds_read_b128 v[76:79], v5 offset:7168
  v_mfma_f32_16x16x32_bf16 v[160:163], v[24:27], v[80:83], v[160:163]
  ds_read_b64_tr_b16 v[20:21], v9 offset:8192
  v_mfma_f32_16x16x32_bf16 v[164:167], v[24:27], v[84:87], v[164:167]
  s_add_u32 s42, s39, 32768
  s_add_u32 s32, s8, s42
  s_addc_u32 s33, s9, 0
  s_add_u32 m0, s37, 73728
  ds_read_b64_tr_b16 v[22:23], v9 offset:10240
  v_mfma_f32_16x16x32_bf16 v[168:171], v[24:27], v[88:91], v[168:171]
  global_load_lds_dwordx4 v2, s[32:33] offset:0
  s_add_u32 m0, s37, 77696
  v_mfma_f32_16x16x32_bf16 v[172:175], v[24:27], v[92:95], v[172:175]
  s_waitcnt lgkmcnt(8)
  global_load_lds_dwordx4 v2, s[32:33] offset:128
  v_mfma_f32_16x16x32_bf16 v[176:179], v[28:31], v[80:83], v[176:179]
  ds_read_b64_tr_b16 v[24:25], v10 offset:8192
  v_mfma_f32_16x16x32_bf16 v[180:183], v[28:31], v[84:87], v[180:183]
  s_add_u32 s42, s38, 0
  s_add_u32 s34, s16, s42
  s_addc_u32 s35, s17, 0
  s_add_u32 m0, s36, 65536
  ds_read_b64_tr_b16 v[26:27], v10 offset:10240
  v_mfma_f32_16x16x32_bf16 v[184:187], v[28:31], v[88:91], v[184:187]
  global_load_lds_dwordx4 v4, s[34:35] offset:0
  v_mfma_f32_16x16x32_bf16 v[188:191], v[28:31], v[92:95], v[188:191]
  s_waitcnt lgkmcnt(6)
  s_waitcnt lgkmcnt(4)
  global_load_lds_dwordx4 v4, s[34:35] offset:1024
  v_mfma_f32_16x16x32_bf16 v[128:131], v[16:19], v[64:67], v[128:131]
  ds_read_b64_tr_b16 v[28:29], v11 offset:8192
  v_mfma_f32_16x16x32_bf16 v[132:135], v[16:19], v[68:71], v[132:135]
  s_add_u32 s42, s38, 131072
  s_add_u32 s44, s16, s42
  s_addc_u32 s45, s17, 0
  s_add_u32 m0, s36, 67584
  ds_read_b64_tr_b16 v[30:31], v11 offset:10240
  v_mfma_f32_16x16x32_bf16 v[136:139], v[16:19], v[72:75], v[136:139]
  global_load_lds_dwordx4 v4, s[44:45] offset:0
  v_mfma_f32_16x16x32_bf16 v[140:143], v[16:19], v[76:79], v[140:143]
  s_waitcnt lgkmcnt(4)
  global_load_lds_dwordx4 v4, s[44:45] offset:1024
  v_mfma_f32_16x16x32_bf16 v[144:147], v[20:23], v[64:67], v[144:147]
  s_waitcnt vmcnt(8)
  s_barrier
  v_mfma_f32_16x16x32_bf16 v[148:151], v[20:23], v[68:71], v[148:151]
  ds_read_b64_tr_b16 v[16:17], v8 offset:32768
  v_mfma_f32_16x16x32_bf16 v[152:155], v[20:23], v[72:75], v[152:155]
  ds_read_b64_tr_b16 v[18:19], v8 offset:34816
  ds_read_b128 v[80:83], v5 offset:32768
  v_mfma_f32_16x16x32_bf16 v[156:159], v[20:23], v[76:79], v[156:159]
  s_waitcnt lgkmcnt(5)
  ds_read_b128 v[84:87], v5 offset:34816
  v_mfma_f32_16x16x32_bf16 v[160:163], v[24:27], v[64:67], v[160:163]
  ds_read_b64_tr_b16 v[20:21], v9 offset:32768
  v_mfma_f32_16x16x32_bf16 v[164:167], v[24:27], v[68:71], v[164:167]
  ds_read_b64_tr_b16 v[22:23], v9 offset:34816
  v_mfma_f32_16x16x32_bf16 v[168:171], v[24:27], v[72:75], v[168:171]
  s_mov_b32 s38, 18432
  s_mov_b32 s39, 589824
  ds_read_b128 v[88:91], v5 offset:36864
  v_mfma_f32_16x16x32_bf16 v[172:175], v[24:27], v[76:79], v[172:175]
  s_waitcnt lgkmcnt(7)
  ds_read_b128 v[92:95], v5 offset:38912
  v_mfma_f32_16x16x32_bf16 v[176:179], v[28:31], v[64:67], v[176:179]
  s_add_u32 s30, s8, s39
  s_addc_u32 s31, s9, 0
  ds_read_b64_tr_b16 v[24:25], v10 offset:32768
  v_mfma_f32_16x16x32_bf16 v[180:183], v[28:31], v[68:71], v[180:183]
  s_add_u32 m0, s37, 98304
  ds_read_b64_tr_b16 v[26:27], v10 offset:34816
  v_mfma_f32_16x16x32_bf16 v[184:187], v[28:31], v[72:75], v[184:187]
  global_load_lds_dwordx4 v2, s[30:31] offset:0
  s_add_u32 m0, s37, 102272
  v_mfma_f32_16x16x32_bf16 v[188:191], v[28:31], v[76:79], v[188:191]
  s_waitcnt lgkmcnt(8)
  s_waitcnt lgkmcnt(2)
  global_load_lds_dwordx4 v2, s[30:31] offset:128
  v_mfma_f32_16x16x32_bf16 v[128:131], v[16:19], v[80:83], v[128:131]
  ds_read_b64_tr_b16 v[28:29], v11 offset:32768
  v_mfma_f32_16x16x32_bf16 v[132:135], v[16:19], v[84:87], v[132:135]
  ds_read_b64_tr_b16 v[30:31], v11 offset:34816
  v_mfma_f32_16x16x32_bf16 v[136:139], v[16:19], v[88:91], v[136:139]
  ds_read_b128 v[64:67], v5 offset:33792
  v_mfma_f32_16x16x32_bf16 v[140:143], v[16:19], v[92:95], v[140:143]
  s_waitcnt lgkmcnt(7)
  ds_read_b128 v[68:71], v5 offset:35840
  v_mfma_f32_16x16x32_bf16 v[144:147], v[20:23], v[80:83], v[144:147]
  ds_read_b64_tr_b16 v[16:17], v8 offset:40960
  v_mfma_f32_16x16x32_bf16 v[148:151], v[20:23], v[84:87], v[148:151]
  ds_read_b64_tr_b16 v[18:19], v8 offset:43008
  v_mfma_f32_16x16x32_bf16 v[152:155], v[20:23], v[88:91], v[152:155]
  ds_read_b128 v[72:75], v5 offset:37888
  v_mfma_f32_16x16x32_bf16 v[156:159], v[20:23], v[92:95], v[156:159]
  s_waitcnt lgkmcnt(7)
  ds_read_b128 v[76:79], v5 offset:39936
  v_mfma_f32_16x16x32_bf16 v[160:163], v[24:27], v[80:83], v[160:163]
  ds_read_b64_tr_b16 v[20:21], v9 offset:40960
  v_mfma_f32_16x16x32_bf16 v[164:167], v[24:27], v[84:87], v[164:167]
  s_add_u32 s42, s39, 32768
  s_add_u32 s32, s8, s42
  s_addc_u32 s33, s9, 0
  s_add_u32 m0, s37, 106496
  ds_read_b64_tr_b16 v[22:23], v9 offset:43008
  v_mfma_f32_16x16x32_bf16 v[168:171], v[24:27], v[88:91], v[168:171]
  global_load_lds_dwordx4 v2, s[32:33] offset:0
  s_add_u32 m0, s37, 110464
  v_mfma_f32_16x16x32_bf16 v[172:175], v[24:27], v[92:95], v[172:175]
  s_waitcnt lgkmcnt(8)
  global_load_lds_dwordx4 v2, s[32:33] offset:128
  v_mfma_f32_16x16x32_bf16 v[176:179], v[28:31], v[80:83], v[176:179]
  ds_read_b64_tr_b16 v[24:25], v10 offset:40960
  v_mfma_f32_16x16x32_bf16 v[180:183], v[28:31], v[84:87], v[180:183]
  s_add_u32 s42, s38, 0
  s_add_u32 s34, s16, s42
  s_addc_u32 s35, s17, 0
  s_add_u32 m0, s36, 98304
  ds_read_b64_tr_b16 v[26:27], v10 offset:43008
  v_mfma_f32_16x16x32_bf16 v[184:187], v[28:31], v[88:91], v[184:187]
  global_load_lds_dwordx4 v4, s[34:35] offset:0
  v_mfma_f32_16x16x32_bf16 v[188:191], v[28:31], v[92:95], v[188:191]
  s_waitcnt lgkmcnt(6)
  s_waitcnt lgkmcnt(4)
  global_load_lds_dwordx4 v4, s[34:35] offset:1024
  v_mfma_f32_16x16x32_bf16 v[128:131], v[16:19], v[64:67], v[128:131]
  ds_read_b64_tr_b16 v[28:29], v11 offset:40960
  v_mfma_f32_16x16x32_bf16 v[132:135], v[16:19], v[68:71], v[132:135]
  s_add_u32 s42, s38, 131072
  s_add_u32 s44, s16, s42
  s_addc_u32 s45, s17, 0
  s_add_u32 m0, s36, 100352
  ds_read_b64_tr_b16 v[30:31], v11 offset:43008
  v_mfma_f32_16x16x32_bf16 v[136:139], v[16:19], v[72:75], v[136:139]
  global_load_lds_dwordx4 v4, s[44:45] offset:0
  v_mfma_f32_16x16x32_bf16 v[140:143], v[16:19], v[76:79], v[140:143]
  s_waitcnt lgkmcnt(4)
  global_load_lds_dwordx4 v4, s[44:45] offset:1024
  v_mfma_f32_16x16x32_bf16 v[144:147], v[20:23], v[64:67], v[144:147]
  s_waitcnt vmcnt(8)
  s_barrier
  v_mfma_f32_16x16x32_bf16 v[148:151], v[20:23], v[68:71], v[148:151]
  ds_read_b64_tr_b16 v[16:17], v12 offset:0
  v_mfma_f32_16x16x32_bf16 v[152:155], v[20:23], v[72:75], v[152:155]
  ds_read_b64_tr_b16 v[18:19], v12 offset:2048
  ds_read_b128 v[80:83], v57 offset:0
  v_mfma_f32_16x16x32_bf16 v[156:159], v[20:23], v[76:79], v[156:159]
  s_waitcnt lgkmcnt(5)
  ds_read_b128 v[84:87], v57 offset:2048
  v_mfma_f32_16x16x32_bf16 v[160:163], v[24:27], v[64:67], v[160:163]
  ds_read_b64_tr_b16 v[20:21], v13 offset:0
  v_mfma_f32_16x16x32_bf16 v[164:167], v[24:27], v[68:71], v[164:167]
  ds_read_b64_tr_b16 v[22:23], v13 offset:2048
  v_mfma_f32_16x16x32_bf16 v[168:171], v[24:27], v[72:75], v[168:171]
  s_mov_b32 s38, 20480
  s_mov_b32 s39, 655360
  ds_read_b128 v[88:91], v57 offset:4096
  v_mfma_f32_16x16x32_bf16 v[172:175], v[24:27], v[76:79], v[172:175]
  s_waitcnt lgkmcnt(7)
  ds_read_b128 v[92:95], v57 offset:6144
  v_mfma_f32_16x16x32_bf16 v[176:179], v[28:31], v[64:67], v[176:179]
  s_add_u32 s30, s8, s39
  s_addc_u32 s31, s9, 0
  ds_read_b64_tr_b16 v[24:25], v14 offset:0
  v_mfma_f32_16x16x32_bf16 v[180:183], v[28:31], v[68:71], v[180:183]
  s_add_u32 m0, s37, 0
  ds_read_b64_tr_b16 v[26:27], v14 offset:2048
  v_mfma_f32_16x16x32_bf16 v[184:187], v[28:31], v[72:75], v[184:187]
  global_load_lds_dwordx4 v2, s[30:31] offset:0
  s_add_u32 m0, s37, 3968
  v_mfma_f32_16x16x32_bf16 v[188:191], v[28:31], v[76:79], v[188:191]
  s_waitcnt lgkmcnt(8)
  s_waitcnt lgkmcnt(2)
  global_load_lds_dwordx4 v2, s[30:31] offset:128
  v_mfma_f32_16x16x32_bf16 v[128:131], v[16:19], v[80:83], v[128:131]
  ds_read_b64_tr_b16 v[28:29], v15 offset:0
  v_mfma_f32_16x16x32_bf16 v[132:135], v[16:19], v[84:87], v[132:135]
  ds_read_b64_tr_b16 v[30:31], v15 offset:2048
  v_mfma_f32_16x16x32_bf16 v[136:139], v[16:19], v[88:91], v[136:139]
  ds_read_b128 v[64:67], v57 offset:1024
  v_mfma_f32_16x16x32_bf16 v[140:143], v[16:19], v[92:95], v[140:143]
  s_waitcnt lgkmcnt(7)
  ds_read_b128 v[68:71], v57 offset:3072
  v_mfma_f32_16x16x32_bf16 v[144:147], v[20:23], v[80:83], v[144:147]
  ds_read_b64_tr_b16 v[16:17], v12 offset:8192
  v_mfma_f32_16x16x32_bf16 v[148:151], v[20:23], v[84:87], v[148:151]
  ds_read_b64_tr_b16 v[18:19], v12 offset:10240
  v_mfma_f32_16x16x32_bf16 v[152:155], v[20:23], v[88:91], v[152:155]
  ds_read_b128 v[72:75], v57 offset:5120
  v_mfma_f32_16x16x32_bf16 v[156:159], v[20:23], v[92:95], v[156:159]
  s_waitcnt lgkmcnt(7)
  ds_read_b128 v[76:79], v57 offset:7168
  v_mfma_f32_16x16x32_bf16 v[160:163], v[24:27], v[80:83], v[160:163]
  ds_read_b64_tr_b16 v[20:21], v13 offset:8192
  v_mfma_f32_16x16x32_bf16 v[164:167], v[24:27], v[84:87], v[164:167]
  s_add_u32 s42, s39, 32768
  s_add_u32 s32, s8, s42
  s_addc_u32 s33, s9, 0
  s_add_u32 m0, s37, 8192
  ds_read_b64_tr_b16 v[22:23], v13 offset:10240
  v_mfma_f32_16x16x32_bf16 v[168:171], v[24:27], v[88:91], v[168:171]
  global_load_lds_dwordx4 v2, s[32:33] offset:0
  s_add_u32 m0, s37, 12160
  v_mfma_f32_16x16x32_bf16 v[172:175], v[24:27], v[92:95], v[172:175]
  s_waitcnt lgkmcnt(8)
  global_load_lds_dwordx4 v2, s[32:33] offset:128
  v_mfma_f32_16x16x32_bf16 v[176:179], v[28:31], v[80:83], v[176:179]
  ds_read_b64_tr_b16 v[24:25], v14 offset:8192
  v_mfma_f32_16x16x32_bf16 v[180:183], v[28:31], v[84:87], v[180:183]
  s_add_u32 s42, s38, 0
  s_add_u32 s34, s16, s42
  s_addc_u32 s35, s17, 0
  s_add_u32 m0, s36, 0
  ds_read_b64_tr_b16 v[26:27], v14 offset:10240
  v_mfma_f32_16x16x32_bf16 v[184:187], v[28:31], v[88:91], v[184:187]
  global_load_lds_dwordx4 v4, s[34:35] offset:0
  v_mfma_f32_16x16x32_bf16 v[188:191], v[28:31], v[92:95], v[188:191]
  s_waitcnt lgkmcnt(6)
  s_waitcnt lgkmcnt(4)
  global_load_lds_dwordx4 v4, s[34:35] offset:1024
  v_mfma_f32_16x16x32_bf16 v[128:131], v[16:19], v[64:67], v[128:131]
  ds_read_b64_tr_b16 v[28:29], v15 offset:8192
  v_mfma_f32_16x16x32_bf16 v[132:135], v[16:19], v[68:71], v[132:135]
  s_add_u32 s42, s38, 131072
  s_add_u32 s44, s16, s42
  s_addc_u32 s45, s17, 0
  s_add_u32 m0, s36, 2048
  ds_read_b64_tr_b16 v[30:31], v15 offset:10240
  v_mfma_f32_16x16x32_bf16 v[136:139], v[16:19], v[72:75], v[136:139]
  global_load_lds_dwordx4 v4, s[44:45] offset:0
  v_mfma_f32_16x16x32_bf16 v[140:143], v[16:19], v[76:79], v[140:143]
  s_waitcnt lgkmcnt(4)
  global_load_lds_dwordx4 v4, s[44:45] offset:1024
  v_mfma_f32_16x16x32_bf16 v[144:147], v[20:23], v[64:67], v[144:147]
  s_waitcnt vmcnt(8)
  s_barrier
  v_mfma_f32_16x16x32_bf16 v[148:151], v[20:23], v[68:71], v[148:151]
  ds_read_b64_tr_b16 v[16:17], v12 offset:32768
  v_mfma_f32_16x16x32_bf16 v[152:155], v[20:23], v[72:75], v[152:155]
  ds_read_b64_tr_b16 v[18:19], v12 offset:34816
  ds_read_b128 v[80:83], v57 offset:32768
  v_mfma_f32_16x16x32_bf16 v[156:159], v[20:23], v[76:79], v[156:159]
  s_waitcnt lgkmcnt(5)
  ds_read_b128 v[84:87], v57 offset:34816
  v_mfma_f32_16x16x32_bf16 v[160:163], v[24:27], v[64:67], v[160:163]
  ds_read_b64_tr_b16 v[20:21], v13 offset:32768
  v_mfma_f32_16x16x32_bf16 v[164:167], v[24:27], v[68:71], v[164:167]
  ds_read_b64_tr_b16 v[22:23], v13 offset:34816
  v_mfma_f32_16x16x32_bf16 v[168:171], v[24:27], v[72:75], v[168:171]
  s_mov_b32 s38, 22528
  s_mov_b32 s39, 720896
  ds_read_b128 v[88:91], v57 offset:36864
  v_mfma_f32_16x16x32_bf16 v[172:175], v[24:27], v[76:79], v[172:175]
  s_waitcnt lgkmcnt(7)
  ds_read_b128 v[92:95], v57 offset:38912
  v_mfma_f32_16x16x32_bf16 v[176:179], v[28:31], v[64:67], v[176:179]
  s_add_u32 s30, s8, s39
  s_addc_u32 s31, s9, 0
  ds_read_b64_tr_b16 v[24:25], v14 offset:32768
  v_mfma_f32_16x16x32_bf16 v[180:183], v[28:31], v[68:71], v[180:183]
  s_add_u32 m0, s37, 32768
  ds_read_b64_tr_b16 v[26:27], v14 offset:34816
  v_mfma_f32_16x16x32_bf16 v[184:187], v[28:31], v[72:75], v[184:187]
  global_load_lds_dwordx4 v2, s[30:31] offset:0
  s_add_u32 m0, s37, 36736
  v_mfma_f32_16x16x32_bf16 v[188:191], v[28:31], v[76:79], v[188:191]
  s_waitcnt lgkmcnt(8)
  s_waitcnt lgkmcnt(2)
  global_load_lds_dwordx4 v2, s[30:31] offset:128
  v_mfma_f32_16x16x32_bf16 v[128:131], v[16:19], v[80:83], v[128:131]
  ds_read_b64_tr_b16 v[28:29], v15 offset:32768
  v_mfma_f32_16x16x32_bf16 v[132:135], v[16:19], v[84:87], v[132:135]
  ds_read_b64_tr_b16 v[30:31], v15 offset:34816
  v_mfma_f32_16x16x32_bf16 v[136:139], v[16:19], v[88:91], v[136:139]
  ds_read_b128 v[64:67], v57 offset:33792
  v_mfma_f32_16x16x32_bf16 v[140:143], v[16:19], v[92:95], v[140:143]
  s_waitcnt lgkmcnt(7)
  ds_read_b128 v[68:71], v57 offset:35840
  v_mfma_f32_16x16x32_bf16 v[144:147], v[20:23], v[80:83], v[144:147]
  ds_read_b64_tr_b16 v[16:17], v12 offset:40960
  v_mfma_f32_16x16x32_bf16 v[148:151], v[20:23], v[84:87], v[148:151]
  ds_read_b64_tr_b16 v[18:19], v12 offset:43008
  v_mfma_f32_16x16x32_bf16 v[152:155], v[20:23], v[88:91], v[152:155]
  ds_read_b128 v[72:75], v57 offset:37888
  v_mfma_f32_16x16x32_bf16 v[156:159], v[20:23], v[92:95], v[156:159]
  s_waitcnt lgkmcnt(7)
  ds_read_b128 v[76:79], v57 offset:39936
  v_mfma_f32_16x16x32_bf16 v[160:163], v[24:27], v[80:83], v[160:163]
  ds_read_b64_tr_b16 v[20:21], v13 offset:40960
  v_mfma_f32_16x16x32_bf16 v[164:167], v[24:27], v[84:87], v[164:167]
  s_add_u32 s42, s39, 32768
  s_add_u32 s32, s8, s42
  s_addc_u32 s33, s9, 0
  s_add_u32 m0, s37, 40960
  ds_read_b64_tr_b16 v[22:23], v13 offset:43008
  v_mfma_f32_16x16x32_bf16 v[168:171], v[24:27], v[88:91], v[168:171]
  global_load_lds_dwordx4 v2, s[32:33] offset:0
  s_add_u32 m0, s37, 44928
  v_mfma_f32_16x16x32_bf16 v[172:175], v[24:27], v[92:95], v[172:175]
  s_waitcnt lgkmcnt(8)
  global_load_lds_dwordx4 v2, s[32:33] offset:128
  v_mfma_f32_16x16x32_bf16 v[176:179], v[28:31], v[80:83], v[176:179]
  ds_read_b64_tr_b16 v[24:25], v14 offset:40960
  v_mfma_f32_16x16x32_bf16 v[180:183], v[28:31], v[84:87], v[180:183]
  s_add_u32 s42, s38, 0
  s_add_u32 s34, s16, s42
  s_addc_u32 s35, s17, 0
  s_add_u32 m0, s36, 32768
  ds_read_b64_tr_b16 v[26:27], v14 offset:43008
  v_mfma_f32_16x16x32_bf16 v[184:187], v[28:31], v[88:91], v[184:187]
  global_load_lds_dwordx4 v4, s[34:35] offset:0
  v_mfma_f32_16x16x32_bf16 v[188:191], v[28:31], v[92:95], v[188:191]
  s_waitcnt lgkmcnt(6)
  s_waitcnt lgkmcnt(4)
  global_load_lds_dwordx4 v4, s[34:35] offset:1024
  v_mfma_f32_16x16x32_bf16 v[128:131], v[16:19], v[64:67], v[128:131]
  ds_read_b64_tr_b16 v[28:29], v15 offset:40960
  v_mfma_f32_16x16x32_bf16 v[132:135], v[16:19], v[68:71], v[132:135]
  s_add_u32 s42, s38, 131072
  s_add_u32 s44, s16, s42
  s_addc_u32 s45, s17, 0
  s_add_u32 m0, s36, 34816
  ds_read_b64_tr_b16 v[30:31], v15 offset:43008
  v_mfma_f32_16x16x32_bf16 v[136:139], v[16:19], v[72:75], v[136:139]
  global_load_lds_dwordx4 v4, s[44:45] offset:0
  v_mfma_f32_16x16x32_bf16 v[140:143], v[16:19], v[76:79], v[140:143]
  s_waitcnt lgkmcnt(4)
  global_load_lds_dwordx4 v4, s[44:45] offset:1024
  v_mfma_f32_16x16x32_bf16 v[144:147], v[20:23], v[64:67], v[144:147]
  s_waitcnt vmcnt(8)
  s_barrier
  v_mfma_f32_16x16x32_bf16 v[148:151], v[20:23], v[68:71], v[148:151]
  ds_read_b64_tr_b16 v[16:17], v8 offset:0
  v_mfma_f32_16x16x32_bf16 v[152:155], v[20:23], v[72:75], v[152:155]
  ds_read_b64_tr_b16 v[18:19], v8 offset:2048
  ds_read_b128 v[80:83], v5 offset:0
  v_mfma_f32_16x16x32_bf16 v[156:159], v[20:23], v[76:79], v[156:159]
  s_waitcnt lgkmcnt(5)
  ds_read_b128 v[84:87], v5 offset:2048
  v_mfma_f32_16x16x32_bf16 v[160:163], v[24:27], v[64:67], v[160:163]
  ds_read_b64_tr_b16 v[20:21], v9 offset:0
  v_mfma_f32_16x16x32_bf16 v[164:167], v[24:27], v[68:71], v[164:167]
  ds_read_b64_tr_b16 v[22:23], v9 offset:2048
  v_mfma_f32_16x16x32_bf16 v[168:171], v[24:27], v[72:75], v[168:171]
  s_mov_b32 s38, 24576
  s_mov_b32 s39, 786432
  ds_read_b128 v[88:91], v5 offset:4096
  v_mfma_f32_16x16x32_bf16 v[172:175], v[24:27], v[76:79], v[172:175]
  s_waitcnt lgkmcnt(7)
  ds_read_b128 v[92:95], v5 offset:6144
  v_mfma_f32_16x16x32_bf16 v[176:179], v[28:31], v[64:67], v[176:179]
  s_add_u32 s30, s8, s39
  s_addc_u32 s31, s9, 0
  ds_read_b64_tr_b16 v[24:25], v10 offset:0
  v_mfma_f32_16x16x32_bf16 v[180:183], v[28:31], v[68:71], v[180:183]
  s_add_u32 m0, s37, 65536
  ds_read_b64_tr_b16 v[26:27], v10 offset:2048
  v_mfma_f32_16x16x32_bf16 v[184:187], v[28:31], v[72:75], v[184:187]
  global_load_lds_dwordx4 v2, s[30:31] offset:0
  s_add_u32 m0, s37, 69504
  v_mfma_f32_16x16x32_bf16 v[188:191], v[28:31], v[76:79], v[188:191]
  s_waitcnt lgkmcnt(8)
  s_waitcnt lgkmcnt(2)
  global_load_lds_dwordx4 v2, s[30:31] offset:128
  v_mfma_f32_16x16x32_bf16 v[128:131], v[16:19], v[80:83], v[128:131]
  ds_read_b64_tr_b16 v[28:29], v11 offset:0
  v_mfma_f32_16x16x32_bf16 v[132:135], v[16:19], v[84:87], v[132:135]
  ds_read_b64_tr_b16 v[30:31], v11 offset:2048
  v_mfma_f32_16x16x32_bf16 v[136:139], v[16:19], v[88:91], v[136:139]
  ds_read_b128 v[64:67], v5 offset:1024
  v_mfma_f32_16x16x32_bf16 v[140:143], v[16:19], v[92:95], v[140:143]
  s_waitcnt lgkmcnt(7)
  ds_read_b128 v[68:71], v5 offset:3072
  v_mfma_f32_16x16x32_bf16 v[144:147], v[20:23], v[80:83], v[144:147]
  ds_read_b64_tr_b16 v[16:17], v8 offset:8192
  v_mfma_f32_16x16x32_bf16 v[148:151], v[20:23], v[84:87], v[148:151]
  ds_read_b64_tr_b16 v[18:19], v8 offset:10240
  v_mfma_f32_16x16x32_bf16 v[152:155], v[20:23], v[88:91], v[152:155]
  ds_read_b128 v[72:75], v5 offset:5120
  v_mfma_f32_16x16x32_bf16 v[156:159], v[20:23], v[92:95], v[156:159]
  s_waitcnt lgkmcnt(7)
  ds_read_b128 v[76:79], v5 offset:7168
  v_mfma_f32_16x16x32_bf16 v[160:163], v[24:27], v[80:83], v[160:163]
  ds_read_b64_tr_b16 v[20:21], v9 offset:8192
  v_mfma_f32_16x16x32_bf16 v[164:167], v[24:27], v[84:87], v[164:167]
  s_add_u32 s42, s39, 32768
  s_add_u32 s32, s8, s42
  s_addc_u32 s33, s9, 0
  s_add_u32 m0, s37, 73728
  ds_read_b64_tr_b16 v[22:23], v9 offset:10240
  v_mfma_f32_16x16x32_bf16 v[168:171], v[24:27], v[88:91], v[168:171]
  global_load_lds_dwordx4 v2, s[32:33] offset:0
  s_add_u32 m0, s37, 77696
  v_mfma_f32_16x16x32_bf16 v[172:175], v[24:27], v[92:95], v[172:175]
  s_waitcnt lgkmcnt(8)
  global_load_lds_dwordx4 v2, s[32:33] offset:128
  v_mfma_f32_16x16x32_bf16 v[176:179], v[28:31], v[80:83], v[176:179]
  ds_read_b64_tr_b16 v[24:25], v10 offset:8192
  v_mfma_f32_16x16x32_bf16 v[180:183], v[28:31], v[84:87], v[180:183]
  s_add_u32 s42, s38, 0
  s_add_u32 s34, s16, s42
  s_addc_u32 s35, s17, 0
  s_add_u32 m0, s36, 65536
  ds_read_b64_tr_b16 v[26:27], v10 offset:10240
  v_mfma_f32_16x16x32_bf16 v[184:187], v[28:31], v[88:91], v[184:187]
  global_load_lds_dwordx4 v4, s[34:35] offset:0
  v_mfma_f32_16x16x32_bf16 v[188:191], v[28:31], v[92:95], v[188:191]
  s_waitcnt lgkmcnt(6)
  s_waitcnt lgkmcnt(4)
  global_load_lds_dwordx4 v4, s[34:35] offset:1024
  v_mfma_f32_16x16x32_bf16 v[128:131], v[16:19], v[64:67], v[128:131]
  ds_read_b64_tr_b16 v[28:29], v11 offset:8192
  v_mfma_f32_16x16x32_bf16 v[132:135], v[16:19], v[68:71], v[132:135]
  s_add_u32 s42, s38, 131072
  s_add_u32 s44, s16, s42
  s_addc_u32 s45, s17, 0
  s_add_u32 m0, s36, 67584
  ds_read_b64_tr_b16 v[30:31], v11 offset:10240
  v_mfma_f32_16x16x32_bf16 v[136:139], v[16:19], v[72:75], v[136:139]
  global_load_lds_dwordx4 v4, s[44:45] offset:0
  v_mfma_f32_16x16x32_bf16 v[140:143], v[16:19], v[76:79], v[140:143]
  s_waitcnt lgkmcnt(4)
  global_load_lds_dwordx4 v4, s[44:45] offset:1024
  v_mfma_f32_16x16x32_bf16 v[144:147], v[20:23], v[64:67], v[144:147]
  s_waitcnt vmcnt(8)
  s_barrier
  v_mfma_f32_16x16x32_bf16 v[148:151], v[20:23], v[68:71], v[148:151]
  ds_read_b64_tr_b16 v[16:17], v8 offset:32768
  v_mfma_f32_16x16x32_bf16 v[152:155], v[20:23], v[72:75], v[152:155]
  ds_read_b64_tr_b16 v[18:19], v8 offset:34816
  ds_read_b128 v[80:83], v5 offset:32768
  v_mfma_f32_16x16x32_bf16 v[156:159], v[20:23], v[76:79], v[156:159]
  s_waitcnt lgkmcnt(5)
  ds_read_b128 v[84:87], v5 offset:34816
  v_mfma_f32_16x16x32_bf16 v[160:163], v[24:27], v[64:67], v[160:163]
  ds_read_b64_tr_b16 v[20:21], v9 offset:32768
  v_mfma_f32_16x16x32_bf16 v[164:167], v[24:27], v[68:71], v[164:167]
  ds_read_b64_tr_b16 v[22:23], v9 offset:34816
  v_mfma_f32_16x16x32_bf16 v[168:171], v[24:27], v[72:75], v[168:171]
  s_mov_b32 s38, 26624
  s_mov_b32 s39, 851968
  ds_read_b128 v[88:91], v5 offset:36864
  v_mfma_f32_16x16x32_bf16 v[172:175], v[24:27], v[76:79], v[172:175]
  s_waitcnt lgkmcnt(7)
  ds_read_b128 v[92:95], v5 offset:38912
  v_mfma_f32_16x16x32_bf16 v[176:179], v[28:31], v[64:67], v[176:179]
  s_add_u32 s30, s8, s39
  s_addc_u32 s31, s9, 0
  ds_read_b64_tr_b16 v[24:25], v10 offset:32768
  v_mfma_f32_16x16x32_bf16 v[180:183], v[28:31], v[68:71], v[180:183]
  s_add_u32 m0, s37, 98304
  ds_read_b64_tr_b16 v[26:27], v10 offset:34816
  v_mfma_f32_16x16x32_bf16 v[184:187], v[28:31], v[72:75], v[184:187]
  global_load_lds_dwordx4 v2, s[30:31] offset:0
  s_add_u32 m0, s37, 102272
  v_mfma_f32_16x16x32_bf16 v[188:191], v[28:31], v[76:79], v[188:191]
  s_waitcnt lgkmcnt(8)
  s_waitcnt lgkmcnt(2)
  global_load_lds_dwordx4 v2, s[30:31] offset:128
  v_mfma_f32_16x16x32_bf16 v[128:131], v[16:19], v[80:83], v[128:131]
  ds_read_b64_tr_b16 v[28:29], v11 offset:32768
  v_mfma_f32_16x16x32_bf16 v[132:135], v[16:19], v[84:87], v[132:135]
  ds_read_b64_tr_b16 v[30:31], v11 offset:34816
  v_mfma_f32_16x16x32_bf16 v[136:139], v[16:19], v[88:91], v[136:139]
  ds_read_b128 v[64:67], v5 offset:33792
  v_mfma_f32_16x16x32_bf16 v[140:143], v[16:19], v[92:95], v[140:143]
  s_waitcnt lgkmcnt(7)
  ds_read_b128 v[68:71], v5 offset:35840
  v_mfma_f32_16x16x32_bf16 v[144:147], v[20:23], v[80:83], v[144:147]
  ds_read_b64_tr_b16 v[16:17], v8 offset:40960
  v_mfma_f32_16x16x32_bf16 v[148:151], v[20:23], v[84:87], v[148:151]
  ds_read_b64_tr_b16 v[18:19], v8 offset:43008
  v_mfma_f32_16x16x32_bf16 v[152:155], v[20:23], v[88:91], v[152:155]
  ds_read_b128 v[72:75], v5 offset:37888
  v_mfma_f32_16x16x32_bf16 v[156:159], v[20:23], v[92:95], v[156:159]
  s_waitcnt lgkmcnt(7)
  ds_read_b128 v[76:79], v5 offset:39936
  v_mfma_f32_16x16x32_bf16 v[160:163], v[24:27], v[80:83], v[160:163]
  ds_read_b64_tr_b16 v[20:21], v9 offset:40960
  v_mfma_f32_16x16x32_bf16 v[164:167], v[24:27], v[84:87], v[164:167]
  s_add_u32 s42, s39, 32768
  s_add_u32 s32, s8, s42
  s_addc_u32 s33, s9, 0
  s_add_u32 m0, s37, 106496
  ds_read_b64_tr_b16 v[22:23], v9 offset:43008
  v_mfma_f32_16x16x32_bf16 v[168:171], v[24:27], v[88:91], v[168:171]
  global_load_lds_dwordx4 v2, s[32:33] offset:0
  s_add_u32 m0, s37, 110464
  v_mfma_f32_16x16x32_bf16 v[172:175], v[24:27], v[92:95], v[172:175]
  s_waitcnt lgkmcnt(8)
  global_load_lds_dwordx4 v2, s[32:33] offset:128
  v_mfma_f32_16x16x32_bf16 v[176:179], v[28:31], v[80:83], v[176:179]
  ds_read_b64_tr_b16 v[24:25], v10 offset:40960
  v_mfma_f32_16x16x32_bf16 v[180:183], v[28:31], v[84:87], v[180:183]
  s_add_u32 s42, s38, 0
  s_add_u32 s34, s16, s42
  s_addc_u32 s35, s17, 0
  s_add_u32 m0, s36, 98304
  ds_read_b64_tr_b16 v[26:27], v10 offset:43008
  v_mfma_f32_16x16x32_bf16 v[184:187], v[28:31], v[88:91], v[184:187]
  global_load_lds_dwordx4 v4, s[34:35] offset:0
  v_mfma_f32_16x16x32_bf16 v[188:191], v[28:31], v[92:95], v[188:191]
  s_waitcnt lgkmcnt(6)
  s_waitcnt lgkmcnt(4)
  global_load_lds_dwordx4 v4, s[34:35] offset:1024
  v_mfma_f32_16x16x32_bf16 v[128:131], v[16:19], v[64:67], v[128:131]
  ds_read_b64_tr_b16 v[28:29], v11 offset:40960
  v_mfma_f32_16x16x32_bf16 v[132:135], v[16:19], v[68:71], v[132:135]
  s_add_u32 s42, s38, 131072
  s_add_u32 s44, s16, s42
  s_addc_u32 s45, s17, 0
  s_add_u32 m0, s36, 100352
  ds_read_b64_tr_b16 v[30:31], v11 offset:43008
  v_mfma_f32_16x16x32_bf16 v[136:139], v[16:19], v[72:75], v[136:139]
  global_load_lds_dwordx4 v4, s[44:45] offset:0
  v_mfma_f32_16x16x32_bf16 v[140:143], v[16:19], v[76:79], v[140:143]
  s_waitcnt lgkmcnt(4)
  global_load_lds_dwordx4 v4, s[44:45] offset:1024
  v_mfma_f32_16x16x32_bf16 v[144:147], v[20:23], v[64:67], v[144:147]
  s_waitcnt vmcnt(8)
  s_barrier
  v_mfma_f32_16x16x32_bf16 v[148:151], v[20:23], v[68:71], v[148:151]
  ds_read_b64_tr_b16 v[16:17], v12 offset:0
  v_mfma_f32_16x16x32_bf16 v[152:155], v[20:23], v[72:75], v[152:155]
  ds_read_b64_tr_b16 v[18:19], v12 offset:2048
  ds_read_b128 v[80:83], v57 offset:0
  v_mfma_f32_16x16x32_bf16 v[156:159], v[20:23], v[76:79], v[156:159]
  s_waitcnt lgkmcnt(5)
  ds_read_b128 v[84:87], v57 offset:2048
  v_mfma_f32_16x16x32_bf16 v[160:163], v[24:27], v[64:67], v[160:163]
  ds_read_b64_tr_b16 v[20:21], v13 offset:0
  v_mfma_f32_16x16x32_bf16 v[164:167], v[24:27], v[68:71], v[164:167]
  ds_read_b64_tr_b16 v[22:23], v13 offset:2048
  v_mfma_f32_16x16x32_bf16 v[168:171], v[24:27], v[72:75], v[168:171]
  s_mov_b32 s38, 28672
  s_mov_b32 s39, 917504
  ds_read_b128 v[88:91], v57 offset:4096
  v_mfma_f32_16x16x32_bf16 v[172:175], v[24:27], v[76:79], v[172:175]
  s_waitcnt lgkmcnt(7)
  ds_read_b128 v[92:95], v57 offset:6144
  v_mfma_f32_16x16x32_bf16 v[176:179], v[28:31], v[64:67], v[176:179]
  s_add_u32 s30, s8, s39
  s_addc_u32 s31, s9, 0
  ds_read_b64_tr_b16 v[24:25], v14 offset:0
  v_mfma_f32_16x16x32_bf16 v[180:183], v[28:31], v[68:71], v[180:183]
  s_add_u32 m0, s37, 0
  ds_read_b64_tr_b16 v[26:27], v14 offset:2048
  v_mfma_f32_16x16x32_bf16 v[184:187], v[28:31], v[72:75], v[184:187]
  global_load_lds_dwordx4 v2, s[30:31] offset:0
  s_add_u32 m0, s37, 3968
  v_mfma_f32_16x16x32_bf16 v[188:191], v[28:31], v[76:79], v[188:191]
  s_waitcnt lgkmcnt(8)
  s_waitcnt lgkmcnt(2)
  global_load_lds_dwordx4 v2, s[30:31] offset:128
  v_mfma_f32_16x16x32_bf16 v[128:131], v[16:19], v[80:83], v[128:131]
  ds_read_b64_tr_b16 v[28:29], v15 offset:0
  v_mfma_f32_16x16x32_bf16 v[132:135], v[16:19], v[84:87], v[132:135]
  ds_read_b64_tr_b16 v[30:31], v15 offset:2048
  v_mfma_f32_16x16x32_bf16 v[136:139], v[16:19], v[88:91], v[136:139]
  ds_read_b128 v[64:67], v57 offset:1024
  v_mfma_f32_16x16x32_bf16 v[140:143], v[16:19], v[92:95], v[140:143]
  s_waitcnt lgkmcnt(7)
  ds_read_b128 v[68:71], v57 offset:3072
  v_mfma_f32_16x16x32_bf16 v[144:147], v[20:23], v[80:83], v[144:147]
  ds_read_b64_tr_b16 v[16:17], v12 offset:8192
  v_mfma_f32_16x16x32_bf16 v[148:151], v[20:23], v[84:87], v[148:151]
  ds_read_b64_tr_b16 v[18:19], v12 offset:10240
  v_mfma_f32_16x16x32_bf16 v[152:155], v[20:23], v[88:91], v[152:155]
  ds_read_b128 v[72:75], v57 offset:5120
  v_mfma_f32_16x16x32_bf16 v[156:159], v[20:23], v[92:95], v[156:159]
  s_waitcnt lgkmcnt(7)
  ds_read_b128 v[76:79], v57 offset:7168
  v_mfma_f32_16x16x32_bf16 v[160:163], v[24:27], v[80:83], v[160:163]
  ds_read_b64_tr_b16 v[20:21], v13 offset:8192
  v_mfma_f32_16x16x32_bf16 v[164:167], v[24:27], v[84:87], v[164:167]
  s_add_u32 s42, s39, 32768
  s_add_u32 s32, s8, s42
  s_addc_u32 s33, s9, 0
  s_add_u32 m0, s37, 8192
  ds_read_b64_tr_b16 v[22:23], v13 offset:10240
  v_mfma_f32_16x16x32_bf16 v[168:171], v[24:27], v[88:91], v[168:171]
  global_load_lds_dwordx4 v2, s[32:33] offset:0
  s_add_u32 m0, s37, 12160
  v_mfma_f32_16x16x32_bf16 v[172:175], v[24:27], v[92:95], v[172:175]
  s_waitcnt lgkmcnt(8)
  global_load_lds_dwordx4 v2, s[32:33] offset:128
  v_mfma_f32_16x16x32_bf16 v[176:179], v[28:31], v[80:83], v[176:179]
  ds_read_b64_tr_b16 v[24:25], v14 offset:8192
  v_mfma_f32_16x16x32_bf16 v[180:183], v[28:31], v[84:87], v[180:183]
  s_add_u32 s42, s38, 0
  s_add_u32 s34, s16, s42
  s_addc_u32 s35, s17, 0
  s_add_u32 m0, s36, 0
  ds_read_b64_tr_b16 v[26:27], v14 offset:10240
  v_mfma_f32_16x16x32_bf16 v[184:187], v[28:31], v[88:91], v[184:187]
  global_load_lds_dwordx4 v4, s[34:35] offset:0
  v_mfma_f32_16x16x32_bf16 v[188:191], v[28:31], v[92:95], v[188:191]
  s_waitcnt lgkmcnt(6)
  s_waitcnt lgkmcnt(4)
  global_load_lds_dwordx4 v4, s[34:35] offset:1024
  v_mfma_f32_16x16x32_bf16 v[128:131], v[16:19], v[64:67], v[128:131]
  ds_read_b64_tr_b16 v[28:29], v15 offset:8192
  v_mfma_f32_16x16x32_bf16 v[132:135], v[16:19], v[68:71], v[132:135]
  s_add_u32 s42, s38, 131072
  s_add_u32 s44, s16, s42
  s_addc_u32 s45, s17, 0
  s_add_u32 m0, s36, 2048
  ds_read_b64_tr_b16 v[30:31], v15 offset:10240
  v_mfma_f32_16x16x32_bf16 v[136:139], v[16:19], v[72:75], v[136:139]
  global_load_lds_dwordx4 v4, s[44:45] offset:0
  v_mfma_f32_16x16x32_bf16 v[140:143], v[16:19], v[76:79], v[140:143]
  s_waitcnt lgkmcnt(4)
  global_load_lds_dwordx4 v4, s[44:45] offset:1024
  v_mfma_f32_16x16x32_bf16 v[144:147], v[20:23], v[64:67], v[144:147]
  s_waitcnt vmcnt(8)
  s_barrier
  v_mfma_f32_16x16x32_bf16 v[148:151], v[20:23], v[68:71], v[148:151]
  ds_read_b64_tr_b16 v[16:17], v12 offset:32768
  v_mfma_f32_16x16x32_bf16 v[152:155], v[20:23], v[72:75], v[152:155]
  ds_read_b64_tr_b16 v[18:19], v12 offset:34816
  ds_read_b128 v[80:83], v57 offset:32768
  v_mfma_f32_16x16x32_bf16 v[156:159], v[20:23], v[76:79], v[156:159]
  s_waitcnt lgkmcnt(5)
  ds_read_b128 v[84:87], v57 offset:34816
  v_mfma_f32_16x16x32_bf16 v[160:163], v[24:27], v[64:67], v[160:163]
  ds_read_b64_tr_b16 v[20:21], v13 offset:32768
  v_mfma_f32_16x16x32_bf16 v[164:167], v[24:27], v[68:71], v[164:167]
  ds_read_b64_tr_b16 v[22:23], v13 offset:34816
  v_mfma_f32_16x16x32_bf16 v[168:171], v[24:27], v[72:75], v[168:171]
  s_mov_b32 s38, 30720
  s_mov_b32 s39, 983040
  ds_read_b128 v[88:91], v57 offset:36864
  v_mfma_f32_16x16x32_bf16 v[172:175], v[24:27], v[76:79], v[172:175]
  s_waitcnt lgkmcnt(7)
  ds_read_b128 v[92:95], v57 offset:38912
  v_mfma_f32_16x16x32_bf16 v[176:179], v[28:31], v[64:67], v[176:179]
  s_add_u32 s30, s8, s39
  s_addc_u32 s31, s9, 0
  ds_read_b64_tr_b16 v[24:25], v14 offset:32768
  v_mfma_f32_16x16x32_bf16 v[180:183], v[28:31], v[68:71], v[180:183]
  s_add_u32 m0, s37, 32768
  ds_read_b64_tr_b16 v[26:27], v14 offset:34816
  v_mfma_f32_16x16x32_bf16 v[184:187], v[28:31], v[72:75], v[184:187]
  global_load_lds_dwordx4 v2, s[30:31] offset:0
  s_add_u32 m0, s37, 36736
  v_mfma_f32_16x16x32_bf16 v[188:191], v[28:31], v[76:79], v[188:191]
  s_waitcnt lgkmcnt(8)
  s_waitcnt lgkmcnt(2)
  global_load_lds_dwordx4 v2, s[30:31] offset:128
  v_mfma_f32_16x16x32_bf16 v[128:131], v[16:19], v[80:83], v[128:131]
  ds_read_b64_tr_b16 v[28:29], v15 offset:32768
  v_mfma_f32_16x16x32_bf16 v[132:135], v[16:19], v[84:87], v[132:135]
  ds_read_b64_tr_b16 v[30:31], v15 offset:34816
  v_mfma_f32_16x16x32_bf16 v[136:139], v[16:19], v[88:91], v[136:139]
  ds_read_b128 v[64:67], v57 offset:33792
  v_mfma_f32_16x16x32_bf16 v[140:143], v[16:19], v[92:95], v[140:143]
  s_waitcnt lgkmcnt(7)
  ds_read_b128 v[68:71], v57 offset:35840
  v_mfma_f32_16x16x32_bf16 v[144:147], v[20:23], v[80:83], v[144:147]
  ds_read_b64_tr_b16 v[16:17], v12 offset:40960
  v_mfma_f32_16x16x32_bf16 v[148:151], v[20:23], v[84:87], v[148:151]
  ds_read_b64_tr_b16 v[18:19], v12 offset:43008
  v_mfma_f32_16x16x32_bf16 v[152:155], v[20:23], v[88:91], v[152:155]
  ds_read_b128 v[72:75], v57 offset:37888
  v_mfma_f32_16x16x32_bf16 v[156:159], v[20:23], v[92:95], v[156:159]
  s_waitcnt lgkmcnt(7)
  ds_read_b128 v[76:79], v57 offset:39936
  v_mfma_f32_16x16x32_bf16 v[160:163], v[24:27], v[80:83], v[160:163]
  ds_read_b64_tr_b16 v[20:21], v13 offset:40960
  v_mfma_f32_16x16x32_bf16 v[164:167], v[24:27], v[84:87], v[164:167]
  s_add_u32 s42, s39, 32768
  s_add_u32 s32, s8, s42
  s_addc_u32 s33, s9, 0
  s_add_u32 m0, s37, 40960
  ds_read_b64_tr_b16 v[22:23], v13 offset:43008
  v_mfma_f32_16x16x32_bf16 v[168:171], v[24:27], v[88:91], v[168:171]
  global_load_lds_dwordx4 v2, s[32:33] offset:0
  s_add_u32 m0, s37, 44928
  v_mfma_f32_16x16x32_bf16 v[172:175], v[24:27], v[92:95], v[172:175]
  s_waitcnt lgkmcnt(8)
  global_load_lds_dwordx4 v2, s[32:33] offset:128
  v_mfma_f32_16x16x32_bf16 v[176:179], v[28:31], v[80:83], v[176:179]
  ds_read_b64_tr_b16 v[24:25], v14 offset:40960
  v_mfma_f32_16x16x32_bf16 v[180:183], v[28:31], v[84:87], v[180:183]
  s_add_u32 s42, s38, 0
  s_add_u32 s34, s16, s42
  s_addc_u32 s35, s17, 0
  s_add_u32 m0, s36, 32768
  ds_read_b64_tr_b16 v[26:27], v14 offset:43008
  v_mfma_f32_16x16x32_bf16 v[184:187], v[28:31], v[88:91], v[184:187]
  global_load_lds_dwordx4 v4, s[34:35] offset:0
  v_mfma_f32_16x16x32_bf16 v[188:191], v[28:31], v[92:95], v[188:191]
  s_waitcnt lgkmcnt(6)
  s_waitcnt lgkmcnt(4)
  global_load_lds_dwordx4 v4, s[34:35] offset:1024
  v_mfma_f32_16x16x32_bf16 v[128:131], v[16:19], v[64:67], v[128:131]
  ds_read_b64_tr_b16 v[28:29], v15 offset:40960
  v_mfma_f32_16x16x32_bf16 v[132:135], v[16:19], v[68:71], v[132:135]
  s_add_u32 s42, s38, 131072
  s_add_u32 s44, s16, s42
  s_addc_u32 s45, s17, 0
  s_add_u32 m0, s36, 34816
  ds_read_b64_tr_b16 v[30:31], v15 offset:43008
  v_mfma_f32_16x16x32_bf16 v[136:139], v[16:19], v[72:75], v[136:139]
  global_load_lds_dwordx4 v4, s[44:45] offset:0
  v_mfma_f32_16x16x32_bf16 v[140:143], v[16:19], v[76:79], v[140:143]
  s_waitcnt lgkmcnt(4)
  global_load_lds_dwordx4 v4, s[44:45] offset:1024
  v_mfma_f32_16x16x32_bf16 v[144:147], v[20:23], v[64:67], v[144:147]
  s_waitcnt vmcnt(8)
  s_barrier
  v_mfma_f32_16x16x32_bf16 v[148:151], v[20:23], v[68:71], v[148:151]
  ds_read_b64_tr_b16 v[16:17], v8 offset:0
  v_mfma_f32_16x16x32_bf16 v[152:155], v[20:23], v[72:75], v[152:155]
  ds_read_b64_tr_b16 v[18:19], v8 offset:2048
  ds_read_b128 v[80:83], v5 offset:0
  v_mfma_f32_16x16x32_bf16 v[156:159], v[20:23], v[76:79], v[156:159]
  s_waitcnt lgkmcnt(5)
  ds_read_b128 v[84:87], v5 offset:2048
  v_mfma_f32_16x16x32_bf16 v[160:163], v[24:27], v[64:67], v[160:163]
  ds_read_b64_tr_b16 v[20:21], v9 offset:0
  v_mfma_f32_16x16x32_bf16 v[164:167], v[24:27], v[68:71], v[164:167]
  ds_read_b64_tr_b16 v[22:23], v9 offset:2048
  v_mfma_f32_16x16x32_bf16 v[168:171], v[24:27], v[72:75], v[168:171]
  ds_read_b128 v[88:91], v5 offset:4096
  v_mfma_f32_16x16x32_bf16 v[172:175], v[24:27], v[76:79], v[172:175]
  s_waitcnt lgkmcnt(7)
  ds_read_b128 v[92:95], v5 offset:6144
  v_mfma_f32_16x16x32_bf16 v[176:179], v[28:31], v[64:67], v[176:179]
  ds_read_b64_tr_b16 v[24:25], v10 offset:0
  v_mfma_f32_16x16x32_bf16 v[180:183], v[28:31], v[68:71], v[180:183]
  ds_read_b64_tr_b16 v[26:27], v10 offset:2048
  v_mfma_f32_16x16x32_bf16 v[184:187], v[28:31], v[72:75], v[184:187]
  v_mfma_f32_16x16x32_bf16 v[188:191], v[28:31], v[76:79], v[188:191]
  s_waitcnt lgkmcnt(8)
  s_waitcnt lgkmcnt(2)
  v_mfma_f32_16x16x32_bf16 v[128:131], v[16:19], v[80:83], v[128:131]
  ds_read_b64_tr_b16 v[28:29], v11 offset:0
  v_mfma_f32_16x16x32_bf16 v[132:135], v[16:19], v[84:87], v[132:135]
  ds_read_b64_tr_b16 v[30:31], v11 offset:2048
  v_mfma_f32_16x16x32_bf16 v[136:139], v[16:19], v[88:91], v[136:139]
  ds_read_b128 v[64:67], v5 offset:1024
  v_mfma_f32_16x16x32_bf16 v[140:143], v[16:19], v[92:95], v[140:143]
  s_waitcnt lgkmcnt(7)
  ds_read_b128 v[68:71], v5 offset:3072
  v_mfma_f32_16x16x32_bf16 v[144:147], v[20:23], v[80:83], v[144:147]
  ds_read_b64_tr_b16 v[16:17], v8 offset:8192
  v_mfma_f32_16x16x32_bf16 v[148:151], v[20:23], v[84:87], v[148:151]
  ds_read_b64_tr_b16 v[18:19], v8 offset:10240
  v_mfma_f32_16x16x32_bf16 v[152:155], v[20:23], v[88:91], v[152:155]
  ds_read_b128 v[72:75], v5 offset:5120
  v_mfma_f32_16x16x32_bf16 v[156:159], v[20:23], v[92:95], v[156:159]
  s_waitcnt lgkmcnt(7)
  ds_read_b128 v[76:79], v5 offset:7168
  v_mfma_f32_16x16x32_bf16 v[160:163], v[24:27], v[80:83], v[160:163]
  ds_read_b64_tr_b16 v[20:21], v9 offset:8192
  v_mfma_f32_16x16x32_bf16 v[164:167], v[24:27], v[84:87], v[164:167]
  ds_read_b64_tr_b16 v[22:23], v9 offset:10240
  v_mfma_f32_16x16x32_bf16 v[168:171], v[24:27], v[88:91], v[168:171]
  v_mfma_f32_16x16x32_bf16 v[172:175], v[24:27], v[92:95], v[172:175]
  s_waitcnt lgkmcnt(8)
  v_mfma_f32_16x16x32_bf16 v[176:179], v[28:31], v[80:83], v[176:179]
  ds_read_b64_tr_b16 v[24:25], v10 offset:8192
  v_mfma_f32_16x16x32_bf16 v[180:183], v[28:31], v[84:87], v[180:183]
  ds_read_b64_tr_b16 v[26:27], v10 offset:10240
  v_mfma_f32_16x16x32_bf16 v[184:187], v[28:31], v[88:91], v[184:187]
  v_mfma_f32_16x16x32_bf16 v[188:191], v[28:31], v[92:95], v[188:191]
  s_waitcnt lgkmcnt(6)
  s_waitcnt lgkmcnt(4)
  v_mfma_f32_16x16x32_bf16 v[128:131], v[16:19], v[64:67], v[128:131]
  ds_read_b64_tr_b16 v[28:29], v11 offset:8192
  v_mfma_f32_16x16x32_bf16 v[132:135], v[16:19], v[68:71], v[132:135]
  ds_read_b64_tr_b16 v[30:31], v11 offset:10240
  v_mfma_f32_16x16x32_bf16 v[136:139], v[16:19], v[72:75], v[136:139]
  v_mfma_f32_16x16x32_bf16 v[140:143], v[16:19], v[76:79], v[140:143]
  s_waitcnt lgkmcnt(4)
  v_mfma_f32_16x16x32_bf16 v[144:147], v[20:23], v[64:67], v[144:147]
  s_waitcnt vmcnt(0)
  s_barrier
  v_mfma_f32_16x16x32_bf16 v[148:151], v[20:23], v[68:71], v[148:151]
  ds_read_b64_tr_b16 v[16:17], v8 offset:32768
  v_mfma_f32_16x16x32_bf16 v[152:155], v[20:23], v[72:75], v[152:155]
  ds_read_b64_tr_b16 v[18:19], v8 offset:34816
  ds_read_b128 v[80:83], v5 offset:32768
  v_mfma_f32_16x16x32_bf16 v[156:159], v[20:23], v[76:79], v[156:159]
  s_waitcnt lgkmcnt(5)
  ds_read_b128 v[84:87], v5 offset:34816
  v_mfma_f32_16x16x32_bf16 v[160:163], v[24:27], v[64:67], v[160:163]
  ds_read_b64_tr_b16 v[20:21], v9 offset:32768
  v_mfma_f32_16x16x32_bf16 v[164:167], v[24:27], v[68:71], v[164:167]
  ds_read_b64_tr_b16 v[22:23], v9 offset:34816
  v_mfma_f32_16x16x32_bf16 v[168:171], v[24:27], v[72:75], v[168:171]
  ds_read_b128 v[88:91], v5 offset:36864
  v_mfma_f32_16x16x32_bf16 v[172:175], v[24:27], v[76:79], v[172:175]
  s_waitcnt lgkmcnt(7)
  ds_read_b128 v[92:95], v5 offset:38912
  v_mfma_f32_16x16x32_bf16 v[176:179], v[28:31], v[64:67], v[176:179]
  ds_read_b64_tr_b16 v[24:25], v10 offset:32768
  v_mfma_f32_16x16x32_bf16 v[180:183], v[28:31], v[68:71], v[180:183]
  ds_read_b64_tr_b16 v[26:27], v10 offset:34816
  v_mfma_f32_16x16x32_bf16 v[184:187], v[28:31], v[72:75], v[184:187]
  v_mfma_f32_16x16x32_bf16 v[188:191], v[28:31], v[76:79], v[188:191]
  s_waitcnt lgkmcnt(8)
  s_waitcnt lgkmcnt(2)
  v_mfma_f32_16x16x32_bf16 v[128:131], v[16:19], v[80:83], v[128:131]
  ds_read_b64_tr_b16 v[28:29], v11 offset:32768
  v_mfma_f32_16x16x32_bf16 v[132:135], v[16:19], v[84:87], v[132:135]
  ds_read_b64_tr_b16 v[30:31], v11 offset:34816
  v_mfma_f32_16x16x32_bf16 v[136:139], v[16:19], v[88:91], v[136:139]
  ds_read_b128 v[64:67], v5 offset:33792
  v_mfma_f32_16x16x32_bf16 v[140:143], v[16:19], v[92:95], v[140:143]
  s_waitcnt lgkmcnt(7)
  ds_read_b128 v[68:71], v5 offset:35840
  v_mfma_f32_16x16x32_bf16 v[144:147], v[20:23], v[80:83], v[144:147]
  ds_read_b64_tr_b16 v[16:17], v8 offset:40960
  v_mfma_f32_16x16x32_bf16 v[148:151], v[20:23], v[84:87], v[148:151]
  ds_read_b64_tr_b16 v[18:19], v8 offset:43008
  v_mfma_f32_16x16x32_bf16 v[152:155], v[20:23], v[88:91], v[152:155]
  ds_read_b128 v[72:75], v5 offset:37888
  v_mfma_f32_16x16x32_bf16 v[156:159], v[20:23], v[92:95], v[156:159]
  s_waitcnt lgkmcnt(7)
  ds_read_b128 v[76:79], v5 offset:39936
  v_mfma_f32_16x16x32_bf16 v[160:163], v[24:27], v[80:83], v[160:163]
  ds_read_b64_tr_b16 v[20:21], v9 offset:40960
  v_mfma_f32_16x16x32_bf16 v[164:167], v[24:27], v[84:87], v[164:167]
  ds_read_b64_tr_b16 v[22:23], v9 offset:43008
  v_mfma_f32_16x16x32_bf16 v[168:171], v[24:27], v[88:91], v[168:171]
  v_mfma_f32_16x16x32_bf16 v[172:175], v[24:27], v[92:95], v[172:175]
  s_waitcnt lgkmcnt(8)
  v_mfma_f32_16x16x32_bf16 v[176:179], v[28:31], v[80:83], v[176:179]
  ds_read_b64_tr_b16 v[24:25], v10 offset:40960
  v_mfma_f32_16x16x32_bf16 v[180:183], v[28:31], v[84:87], v[180:183]
  ds_read_b64_tr_b16 v[26:27], v10 offset:43008
  v_mfma_f32_16x16x32_bf16 v[184:187], v[28:31], v[88:91], v[184:187]
  v_mfma_f32_16x16x32_bf16 v[188:191], v[28:31], v[92:95], v[188:191]
  s_waitcnt lgkmcnt(6)
  s_waitcnt lgkmcnt(4)
  v_mfma_f32_16x16x32_bf16 v[128:131], v[16:19], v[64:67], v[128:131]
  ds_read_b64_tr_b16 v[28:29], v11 offset:40960
  v_mfma_f32_16x16x32_bf16 v[132:135], v[16:19], v[68:71], v[132:135]
  ds_read_b64_tr_b16 v[30:31], v11 offset:43008
  v_mfma_f32_16x16x32_bf16 v[136:139], v[16:19], v[72:75], v[136:139]
  v_mfma_f32_16x16x32_bf16 v[140:143], v[16:19], v[76:79], v[140:143]
  s_waitcnt lgkmcnt(4)
  v_mfma_f32_16x16x32_bf16 v[144:147], v[20:23], v[64:67], v[144:147]
  v_mfma_f32_16x16x32_bf16 v[148:151], v[20:23], v[68:71], v[148:151]
  v_mfma_f32_16x16x32_bf16 v[152:155], v[20:23], v[72:75], v[152:155]
  v_mfma_f32_16x16x32_bf16 v[156:159], v[20:23], v[76:79], v[156:159]
  s_waitcnt lgkmcnt(2)
  v_mfma_f32_16x16x32_bf16 v[160:163], v[24:27], v[64:67], v[160:163]
  v_mfma_f32_16x16x32_bf16 v[164:167], v[24:27], v[68:71], v[164:167]
  v_mfma_f32_16x16x32_bf16 v[168:171], v[24:27], v[72:75], v[168:171]
  v_mfma_f32_16x16x32_bf16 v[172:175], v[24:27], v[76:79], v[172:175]
  s_waitcnt lgkmcnt(0)
  v_mfma_f32_16x16x32_bf16 v[176:179], v[28:31], v[64:67], v[176:179]
  v_mfma_f32_16x16x32_bf16 v[180:183], v[28:31], v[68:71], v[180:183]
  v_mfma_f32_16x16x32_bf16 v[184:187], v[28:31], v[72:75], v[184:187]
  v_mfma_f32_16x16x32_bf16 v[188:191], v[28:31], v[76:79], v[188:191]
  s_nop 7
  v_cvt_pk_bf16_f32 v64, v128, v129
  v_cvt_pk_bf16_f32 v65, v130, v131
  v_cvt_pk_bf16_f32 v66, v144, v145
  v_cvt_pk_bf16_f32 v67, v146, v147
  v_cvt_pk_bf16_f32 v68, v160, v161
  v_cvt_pk_bf16_f32 v69, v162, v163
  v_cvt_pk_bf16_f32 v70, v176, v177
  v_cvt_pk_bf16_f32 v71, v178, v179
  s_cmp_eq_u32 s6, 0
  s_cbranch_scc1 L_px47
  s_add_u32 s30, s26, 0
  s_addc_u32 s31, s27, 0
  global_store_dwordx4 v4, v[64:67], s[30:31] offset:0 sc1
  global_store_dwordx4 v4, v[68:71], s[30:31] offset:1024 sc1
L_px47:
  v_cvt_pk_bf16_f32 v72, v132, v133
  v_cvt_pk_bf16_f32 v73, v134, v135
  v_cvt_pk_bf16_f32 v74, v148, v149
  v_cvt_pk_bf16_f32 v75, v150, v151
  v_cvt_pk_bf16_f32 v76, v164, v165
  v_cvt_pk_bf16_f32 v77, v166, v167
  v_cvt_pk_bf16_f32 v78, v180, v181
  v_cvt_pk_bf16_f32 v79, v182, v183
  s_cmp_eq_u32 s6, 1
  s_cbranch_scc1 L_px48
  s_add_u32 s30, s26, 65536
  s_addc_u32 s31, s27, 0
  global_store_dwordx4 v4, v[72:75], s[30:31] offset:0 sc1
  global_store_dwordx4 v4, v[76:79], s[30:31] offset:1024 sc1
L_px48:
  v_cvt_pk_bf16_f32 v80, v136, v137
  v_cvt_pk_bf16_f32 v81, v138, v139
  v_cvt_pk_bf16_f32 v82, v152, v153
  v_cvt_pk_bf16_f32 v83, v154, v155
  v_cvt_pk_bf16_f32 v84, v168, v169
  v_cvt_pk_bf16_f32 v85, v170, v171
  v_cvt_pk_bf16_f32 v86, v184, v185
  v_cvt_pk_bf16_f32 v87, v186, v187
  s_cmp_eq_u32 s6, 2
  s_cbranch_scc1 L_px49
  s_add_u32 s30, s26, 131072
  s_addc_u32 s31, s27, 0
  global_store_dwordx4 v4, v[80:83], s[30:31] offset:0 sc1
  global_store_dwordx4 v4, v[84:87], s[30:31] offset:1024 sc1
L_px49:
  v_cvt_pk_bf16_f32 v88, v140, v141
  v_cvt_pk_bf16_f32 v89, v142, v143
  v_cvt_pk_bf16_f32 v90, v156, v157
  v_cvt_pk_bf16_f32 v91, v158, v159
  v_cvt_pk_bf16_f32 v92, v172, v173
  v_cvt_pk_bf16_f32 v93, v174, v175
  v_cvt_pk_bf16_f32 v94, v188, v189
  v_cvt_pk_bf16_f32 v95, v190, v191
  s_cmp_eq_u32 s6, 3
  s_cbranch_scc1 L_px50
  s_add_u32 s30, s26, 196608
  s_addc_u32 s31, s27, 0
  global_store_dwordx4 v4, v[88:91], s[30:31] offset:0 sc1
  global_store_dwordx4 v4, v[92:95], s[30:31] offset:1024 sc1
L_px50:
  s_cmp_eq_u32 s6, 0
  s_cbranch_scc0 L_po51
  v_mov_b32 v112, v128
  v_mov_b32 v113, v129
  v_mov_b32 v114, v130
  v_mov_b32 v115, v131
  v_mov_b32 v116, v144
  v_mov_b32 v117, v145
  v_mov_b32 v118, v146
  v_mov_b32 v119, v147
  v_mov_b32 v120, v160
  v_mov_b32 v121, v161
  v_mov_b32 v122, v162
  v_mov_b32 v123, v163
  v_mov_b32 v124, v176
  v_mov_b32 v125, v177
  v_mov_b32 v126, v178
  v_mov_b32 v127, v179
L_po51:
  s_cmp_eq_u32 s6, 1
  s_cbranch_scc0 L_po52
  v_mov_b32 v112, v132
  v_mov_b32 v113, v133
  v_mov_b32 v114, v134
  v_mov_b32 v115, v135
  v_mov_b32 v116, v148
  v_mov_b32 v117, v149
  v_mov_b32 v118, v150
  v_mov_b32 v119, v151
  v_mov_b32 v120, v164
  v_mov_b32 v121, v165
  v_mov_b32 v122, v166
  v_mov_b32 v123, v167
  v_mov_b32 v124, v180
  v_mov_b32 v125, v181
  v_mov_b32 v126, v182
  v_mov_b32 v127, v183
L_po52:
  s_cmp_eq_u32 s6, 2
  s_cbranch_scc0 L_po53
  v_mov_b32 v112, v136
  v_mov_b32 v113, v137
  v_mov_b32 v114, v138
  v_mov_b32 v115, v139
  v_mov_b32 v116, v152
  v_mov_b32 v117, v153
  v_mov_b32 v118, v154
  v_mov_b32 v119, v155
  v_mov_b32 v120, v168
  v_mov_b32 v121, v169
  v_mov_b32 v122, v170
  v_mov_b32 v123, v171
  v_mov_b32 v124, v184
  v_mov_b32 v125, v185
  v_mov_b32 v126, v186
  v_mov_b32 v127, v187
L_po53:
  s_cmp_eq_u32 s6, 3
  s_cbranch_scc0 L_po54
  v_mov_b32 v112, v140
  v_mov_b32 v113, v141
  v_mov_b32 v114, v142
  v_mov_b32 v115, v143
  v_mov_b32 v116, v156
  v_mov_b32 v117, v157
  v_mov_b32 v118, v158
  v_mov_b32 v119, v159
  v_mov_b32 v120, v172
  v_mov_b32 v121, v173
  v_mov_b32 v122, v174
  v_mov_b32 v123, v175
  v_mov_b32 v124, v188
  v_mov_b32 v125, v189
  v_mov_b32 v126, v190
  v_mov_b32 v127, v191
L_po54:
  s_lshl_b32 s40, s21, 3
  s_and_b32 s41, s20, 7
  s_add_u32 s40, s40, s41
  s_lshl_b32 s40, s40, 2
  s_add_u32 s40, s40, s22
  s_lshl_b32 s40, s40, 7
  s_add_u32 s40, s40, 16384
  s_lshl_b32 s41, s6, 2
  s_add_u32 s41, s41, s40
  v_mov_b32 v62, s41
  v_mov_b32 v63, s71
  v_and_b32 v60, 3, v1
  v_lshlrev_b32 v60, 2, v60
  v_add_u32 v60, s40, v60
  s_waitcnt vmcnt(0)
  s_mov_b64 exec, 1
  global_store_dword v62, v63, s[68:69] sc1
  s_mov_b64 exec, -1
  global_load_dword v61, v60, s[68:69] sc1
  s_waitcnt vmcnt(0)
  v_cmp_ne_u32 vcc, s71, v61
  s_nop 3
  s_cmp_eq_u64 vcc, 0
  s_cbranch_scc0 L_spin55
L_back55:
  s_add_u32 s40, s6, 1
  s_and_b32 s40, s40, 3
  s_lshl_b32 s40, s40, 14
  s_add_u32 s30, s28, s40
  s_addc_u32 s31, s29, 0
  global_load_dwordx4 v[64:67], v4, s[30:31] offset:0 sc1
  global_load_dwordx4 v[68:71], v4, s[30:31] offset:1024 sc1
  s_add_u32 s40, s6, 2
  s_and_b32 s40, s40, 3
  s_lshl_b32 s40, s40, 14
  s_add_u32 s30, s28, s40
  s_addc_u32 s31, s29, 0
  global_load_dwordx4 v[72:75], v4, s[30:31] offset:0 sc1
  global_load_dwordx4 v[76:79], v4, s[30:31] offset:1024 sc1
  s_add_u32 s40, s6, 3
  s_and_b32 s40, s40, 3
  s_lshl_b32 s40, s40, 14
  s_add_u32 s30, s28, s40
  s_addc_u32 s31, s29, 0
  global_load_dwordx4 v[80:83], v4, s[30:31] offset:0 sc1
  global_load_dwordx4 v[84:87], v4, s[30:31] offset:1024 sc1
  s_waitcnt vmcnt(0)
  v_lshlrev_b32 v56, 16, v64
  v_and_b32 v57, 0xffff0000, v64
  v_lshlrev_b32 v58, 16, v65
  v_and_b32 v59, 0xffff0000, v65
  v_add_f32 v112, v112, v56
  v_add_f32 v113, v113, v57
  v_add_f32 v114, v114, v58
  v_add_f32 v115, v115, v59
  v_lshlrev_b32 v56, 16, v66
  v_and_b32 v57, 0xffff0000, v66
  v_lshlrev_b32 v58, 16, v67
  v_and_b32 v59, 0xffff0000, v67
  v_add_f32 v116, v116, v56
  v_add_f32 v117, v117, v57
  v_add_f32 v118, v118, v58
  v_add_f32 v119, v119, v59
  v_lshlrev_b32 v56, 16, v68
  v_and_b32 v57, 0xffff0000, v68
  v_lshlrev_b32 v58, 16, v69
  v_and_b32 v59, 0xffff0000, v69
  v_add_f32 v120, v120, v56
  v_add_f32 v121, v121, v57
  v_add_f32 v122, v122, v58
  v_add_f32 v123, v123, v59
  v_lshlrev_b32 v56, 16, v70
  v_and_b32 v57, 0xffff0000, v70
  v_lshlrev_b32 v58, 16, v71
  v_and_b32 v59, 0xffff0000, v71
  v_add_f32 v124, v124, v56
  v_add_f32 v125, v125, v57
  v_add_f32 v126, v126, v58
  v_add_f32 v127, v127, v59
  v_lshlrev_b32 v56, 16, v72
  v_and_b32 v57, 0xffff0000, v72
  v_lshlrev_b32 v58, 16, v73
  v_and_b32 v59, 0xffff0000, v73
  v_add_f32 v112, v112, v56
  v_add_f32 v113, v113, v57
  v_add_f32 v114, v114, v58
  v_add_f32 v115, v115, v59
  v_lshlrev_b32 v56, 16, v74
  v_and_b32 v57, 0xffff0000, v74
  v_lshlrev_b32 v58, 16, v75
  v_and_b32 v59, 0xffff0000, v75
  v_add_f32 v116, v116, v56
  v_add_f32 v117, v117, v57
  v_add_f32 v118, v118, v58
  v_add_f32 v119, v119, v59
  v_lshlrev_b32 v56, 16, v76
  v_and_b32 v57, 0xffff0000, v76
  v_lshlrev_b32 v58, 16, v77
  v_and_b32 v59, 0xffff0000, v77
  v_add_f32 v120, v120, v56
  v_add_f32 v121, v121, v57
  v_add_f32 v122, v122, v58
  v_add_f32 v123, v123, v59
  v_lshlrev_b32 v56, 16, v78
  v_and_b32 v57, 0xffff0000, v78
  v_lshlrev_b32 v58, 16, v79
  v_and_b32 v59, 0xffff0000, v79
  v_add_f32 v124, v124, v56
  v_add_f32 v125, v125, v57
  v_add_f32 v126, v126, v58
  v_add_f32 v127, v127, v59
  v_lshlrev_b32 v56, 16, v80
  v_and_b32 v57, 0xffff0000, v80
  v_lshlrev_b32 v58, 16, v81
  v_and_b32 v59, 0xffff0000, v81
  v_add_f32 v112, v112, v56
  v_add_f32 v113, v113, v57
  v_add_f32 v114, v114, v58
  v_add_f32 v115, v115, v59
  v_lshlrev_b32 v56, 16, v82
  v_and_b32 v57, 0xffff0000, v82
  v_lshlrev_b32 v58, 16, v83
  v_and_b32 v59, 0xffff0000, v83
  v_add_f32 v116, v116, v56
  v_add_f32 v117, v117, v57
  v_add_f32 v118, v118, v58
  v_add_f32 v119, v119, v59
  v_lshlrev_b32 v56, 16, v84
  v_and_b32 v57, 0xffff0000, v84
  v_lshlrev_b32 v58, 16, v85
  v_and_b32 v59, 0xffff0000, v85
  v_add_f32 v120, v120, v56
  v_add_f32 v121, v121, v57
  v_add_f32 v122, v122, v58
  v_add_f32 v123, v123, v59
  v_lshlrev_b32 v56, 16, v86
  v_and_b32 v57, 0xffff0000, v86
  v_lshlrev_b32 v58, 16, v87
  v_and_b32 v59, 0xffff0000, v87
  v_add_f32 v124, v124, v56
  v_add_f32 v125, v125, v57
  v_add_f32 v126, v126, v58
  v_add_f32 v127, v127, v59
  v_lshlrev_b32 v56, 16, v32
  v_and_b32 v57, 0xffff0000, v32
  v_lshlrev_b32 v58, 16, v33
  v_and_b32 v59, 0xffff0000, v33
  v_add_f32 v112, v112, v56
  v_add_f32 v113, v113, v57
  v_add_f32 v114, v114, v58
  v_add_f32 v115, v115, v59
  v_cvt_pk_bf16_f32 v32, v112, v113
  v_cvt_pk_bf16_f32 v33, v114, v115
  global_store_dwordx2 v40, v[32:33], s[18:19] offset:0
  v_lshlrev_b32 v56, 16, v34
  v_and_b32 v57, 0xffff0000, v34
  v_lshlrev_b32 v58, 16, v35
  v_and_b32 v59, 0xffff0000, v35
  v_add_f32 v116, v116, v56
  v_add_f32 v117, v117, v57
  v_add_f32 v118, v118, v58
  v_add_f32 v119, v119, v59
  v_cvt_pk_bf16_f32 v34, v116, v117
  v_cvt_pk_bf16_f32 v35, v118, v119
  global_store_dwordx2 v40, v[34:35], s[18:19] offset:32
  v_lshlrev_b32 v56, 16, v36
  v_and_b32 v57, 0xffff0000, v36
  v_lshlrev_b32 v58, 16, v37
  v_and_b32 v59, 0xffff0000, v37
  v_add_f32 v120, v120, v56
  v_add_f32 v121, v121, v57
  v_add_f32 v122, v122, v58
  v_add_f32 v123, v123, v59
  v_cvt_pk_bf16_f32 v36, v120, v121
  v_cvt_pk_bf16_f32 v37, v122, v123
  global_store_dwordx2 v40, v[36:37], s[18:19] offset:64
  v_lshlrev_b32 v56, 16, v38
  v_and_b32 v57, 0xffff0000, v38
  v_lshlrev_b32 v58, 16, v39
  v_and_b32 v59, 0xffff0000, v39
  v_add_f32 v124, v124, v56
  v_add_f32 v125, v125, v57
  v_add_f32 v126, v126, v58
  v_add_f32 v127, v127, v59
  v_cvt_pk_bf16_f32 v38, v124, v125
  v_cvt_pk_bf16_f32 v39, v126, v127
  global_store_dwordx2 v40, v[38:39], s[18:19] offset:96
L_end:
  s_endpgm
L_spin1:
  s_mov_b32 s70, 400000
L_spin1_l:
  s_sleep 4
  v_mov_b32 v62, 0
  global_load_dword v63, v62, s[64:65] sc1
  s_waitcnt vmcnt(0)
  s_nop 0
  v_readfirstlane_b32 s71, v63
  s_nop 0
  s_cmp_lg_u32 s71, 0
  s_cbranch_scc1 L_back1
  s_sub_u32 s70, s70, 1
  s_cmp_lg_u32 s70, 0
  s_cbranch_scc1 L_spin1_l
  s_branch L_back1
L_spin3:
  s_mov_b32 s70, 400000
L_spin3_l:
  s_sleep 8
  v_and_b32 v60, 0x1fffc, v60
  global_load_dword v61, v60, s[68:69] sc1
  s_waitcnt vmcnt(0)
  v_cmp_ne_u32 vcc, s71, v61
  s_nop 3
  s_cmp_eq_u64 vcc, 0
  s_cbranch_scc1 L_back3
  s_sub_u32 s70, s70, 1
  s_cmp_lg_u32 s70, 0
  s_cbranch_scc1 L_spin3_l
  s_branch L_back3
L_spin39:
  s_mov_b32 s70, 400000
L_spin39_l:
  s_sleep 2
  v_and_b32 v60, 0x1fffc, v60
  global_load_dword v61, v60, s[68:69] sc1
  s_waitcnt vmcnt(0)
  v_cmp_ne_u32 vcc, s71, v61
  s_nop 3
  s_cmp_eq_u64 vcc, 0
  s_cbranch_scc1 L_back39
  s_sub_u32 s70, s70, 1
  s_cmp_lg_u32 s70, 0
  s_cbranch_scc1 L_spin39_l
  s_branch L_back39
L_spin41:
  s_mov_b32 s70, 400000
L_spin41_l:
  s_sleep 8
  v_and_b32 v92, 0x1fffc, v92
  global_load_dword v93, v92, s[68:69] sc1
  s_waitcnt vmcnt(0)
  v_cmp_ne_u32 vcc, s71, v93
  s_nop 3
  s_cmp_eq_u64 vcc, 0
  s_cbranch_scc1 L_back41
  s_sub_u32 s70, s70, 1
  s_cmp_lg_u32 s70, 0
  s_cbranch_scc1 L_spin41_l
  s_branch L_back41
L_spin46:
  s_mov_b32 s70, 400000
L_spin46_l:
  s_sleep 2
  v_and_b32 v60, 0x1fffc, v60
  global_load_dword v61, v60, s[68:69] sc1
  s_waitcnt vmcnt(0)
  v_cmp_ne_u32 vcc, s71, v61
  s_nop 3
  s_cmp_eq_u64 vcc, 0
  s_cbranch_scc1 L_back46
  s_sub_u32 s70, s70, 1
  s_cmp_lg_u32 s70, 0
  s_cbranch_scc1 L_spin46_l
  s_branch L_back46
L_spin55:
  s_mov_b32 s70, 400000
L_spin55_l:
  s_sleep 1
  v_and_b32 v60, 0x1fffc, v60
  global_load_dword v61, v60, s[68:69] sc1
  s_waitcnt vmcnt(0)
  v_cmp_ne_u32 vcc, s71, v61
  s_nop 3
  s_cmp_eq_u64 vcc, 0
  s_cbranch_scc1 L_back55
  s_sub_u32 s70, s70, 1
  s_cmp_lg_u32 s70, 0
  s_cbranch_scc1 L_spin55_l
  s_branch L_back55
L_fallback:
  s_lshl_b32 s40, s20, 20
  s_lshl_b32 s41, s22, 12
  s_add_u32 s40, s40, s41
  s_add_u32 s40, s40, 2097152
  s_add_u32 s34, s12, s40
  s_addc_u32 s35, s13, 0
  s_sub_u32 s38, 16, s21
  s_lshl_b32 s38, s38, 2
  s_mov_b32 s53, 0
  s_add_u32 s36, s41, 32768
  v_add_u32 v2, 0x8000, v4
  v_and_b32 v89, 15, v1
  v_lshrrev_b32 v90, 4, v1
  v_lshlrev_b32 v90, 2, v90
  v_sub_u32 v89, v89, v90
  s_lshl_b32 s40, s56, 4
  v_add_u32 v92, s40, v89
  v_mov_b32 v56, v88
  v_mov_b32 v60, 0
  s_lshl_b32 s40, s57, 4
  v_add_u32 v93, s40, v89
  v_mov_b32 v57, v88
  v_mov_b32 v61, 0
  s_lshl_b32 s40, s58, 4
  v_add_u32 v94, s40, v89
  v_mov_b32 v58, v88
  v_mov_b32 v62, 0
  s_lshl_b32 s40, s59, 4
  v_add_u32 v95, s40, v89
  v_mov_b32 v59, v88
  v_mov_b32 v63, 0
  v_mov_b32 v128, 0
  v_mov_b32 v129, 0
  v_mov_b32 v130, 0
  v_mov_b32 v131, 0
  v_mov_b32 v132, 0
  v_mov_b32 v133, 0
  v_mov_b32 v134, 0
  v_mov_b32 v135, 0
  v_mov_b32 v136, 0
  v_mov_b32 v137, 0
  v_mov_b32 v138, 0
  v_mov_b32 v139, 0
  v_mov_b32 v140, 0
  v_mov_b32 v141, 0
  v_mov_b32 v142, 0
  v_mov_b32 v143, 0
  v_mov_b32 v144, 0
  v_mov_b32 v145, 0
  v_mov_b32 v146, 0
  v_mov_b32 v147, 0
  v_mov_b32 v148, 0
  v_mov_b32 v149, 0
  v_mov_b32 v150, 0
  v_mov_b32 v151, 0
  v_mov_b32 v152, 0
  v_mov_b32 v153, 0
  v_mov_b32 v154, 0
  v_mov_b32 v155, 0
  v_mov_b32 v156, 0
  v_mov_b32 v157, 0
  v_mov_b32 v158, 0
  v_mov_b32 v159, 0
  v_mov_b32 v160, 0
  v_mov_b32 v161, 0
  v_mov_b32 v162, 0
  v_mov_b32 v163, 0
  v_mov_b32 v164, 0
  v_mov_b32 v165, 0
  v_mov_b32 v166, 0
  v_mov_b32 v167, 0
  v_mov_b32 v168, 0
  v_mov_b32 v169, 0
  v_mov_b32 v170, 0
  v_mov_b32 v171, 0
  v_mov_b32 v172, 0
  v_mov_b32 v173, 0
  v_mov_b32 v174, 0
  v_mov_b32 v175, 0
  v_mov_b32 v176, 0
  v_mov_b32 v177, 0
  v_mov_b32 v178, 0
  v_mov_b32 v179, 0
  v_mov_b32 v180, 0
  v_mov_b32 v181, 0
  v_mov_b32 v182, 0
  v_mov_b32 v183, 0
  v_mov_b32 v184, 0
  v_mov_b32 v185, 0
  v_mov_b32 v186, 0
  v_mov_b32 v187, 0
  v_mov_b32 v188, 0
  v_mov_b32 v189, 0
  v_mov_b32 v190, 0
  v_mov_b32 v191, 0
  v_mov_b32 v192, 0
  v_mov_b32 v193, 0
  v_mov_b32 v194, 0
  v_mov_b32 v195, 0
  v_mov_b32 v196, 0
  v_mov_b32 v197, 0
  v_mov_b32 v198, 0
  v_mov_b32 v199, 0
  v_mov_b32 v200, 0
  v_mov_b32 v201, 0
  v_mov_b32 v202, 0
  v_mov_b32 v203, 0
  v_mov_b32 v204, 0
  v_mov_b32 v205, 0
  v_mov_b32 v206, 0
  v_mov_b32 v207, 0
  v_mov_b32 v208, 0
  v_mov_b32 v209, 0
  v_mov_b32 v210, 0
  v_mov_b32 v211, 0
  v_mov_b32 v212, 0
  v_mov_b32 v213, 0
  v_mov_b32 v214, 0
  v_mov_b32 v215, 0
  v_mov_b32 v216, 0
  v_mov_b32 v217, 0
  v_mov_b32 v218, 0
  v_mov_b32 v219, 0
  v_mov_b32 v220, 0
  v_mov_b32 v221, 0
  v_mov_b32 v222, 0
  v_mov_b32 v223, 0
  v_mov_b32 v224, 0
  v_mov_b32 v225, 0
  v_mov_b32 v226, 0
  v_mov_b32 v227, 0
  v_mov_b32 v228, 0
  v_mov_b32 v229, 0
  v_mov_b32 v230, 0
  v_mov_b32 v231, 0
  v_mov_b32 v232, 0
  v_mov_b32 v233, 0
  v_mov_b32 v234, 0
  v_mov_b32 v235, 0
  v_mov_b32 v236, 0
  v_mov_b32 v237, 0
  v_mov_b32 v238, 0
  v_mov_b32 v239, 0
  v_mov_b32 v240, 0
  v_mov_b32 v241, 0
  v_mov_b32 v242, 0
  v_mov_b32 v243, 0
  v_mov_b32 v244, 0
  v_mov_b32 v245, 0
  v_mov_b32 v246, 0
  v_mov_b32 v247, 0
  v_mov_b32 v248, 0
  v_mov_b32 v249, 0
  v_mov_b32 v250, 0
  v_mov_b32 v251, 0
  v_mov_b32 v252, 0
  v_mov_b32 v253, 0
  v_mov_b32 v254, 0
  v_mov_b32 v255, 0
L_fb_loop:
  s_barrier
  s_mov_b32 m0, s36
  s_nop 0
  global_load_lds_dwordx4 v4, s[34:35] offset:0
  global_load_lds_dwordx4 v4, s[34:35] offset:1024
  global_load_lds_dwordx4 v4, s[34:35] offset:2048
  global_load_lds_dwordx4 v4, s[34:35] offset:3072
  s_add_u32 s34, s34, 16384
  s_addc_u32 s35, s35, 0
  s_waitcnt vmcnt(0)
  s_barrier
  ds_read_b128 a[64:67], v2 offset:0
  ds_read_b128 a[68:71], v2 offset:1024
  ds_read_b128 a[72:75], v2 offset:2048
  ds_read_b128 a[76:79], v2 offset:3072
  ds_read_b128 a[80:83], v2 offset:4096
  ds_read_b128 a[84:87], v2 offset:5120
  ds_read_b128 a[88:91], v2 offset:6144
  ds_read_b128 a[92:95], v2 offset:7168
  ds_read_b128 a[128:131], v2 offset:8192
  ds_read_b128 a[132:135], v2 offset:9216
  ds_read_b128 a[136:139], v2 offset:10240
  ds_read_b128 a[140:143], v2 offset:11264
  ds_read_b128 a[144:147], v2 offset:12288
  ds_read_b128 a[148:151], v2 offset:13312
  ds_read_b128 a[152:155], v2 offset:14336
  ds_read_b128 a[156:159], v2 offset:15360
  s_waitcnt lgkmcnt(0)
  v_mfma_f32_16x16x32_bf16 v[64:67], a[64:67], a[0:3], 0
  v_mfma_f32_16x16x32_bf16 v[64:67], a[68:71], a[4:7], v[64:67]
  v_mfma_f32_16x16x32_bf16 v[64:67], a[72:75], a[8:11], v[64:67]
  v_mfma_f32_16x16x32_bf16 v[64:67], a[76:79], a[12:15], v[64:67]
  v_mfma_f32_16x16x32_bf16 v[68:71], a[80:83], a[0:3], 0
  v_mfma_f32_16x16x32_bf16 v[68:71], a[84:87], a[4:7], v[68:71]
  v_mfma_f32_16x16x32_bf16 v[68:71], a[88:91], a[8:11], v[68:71]
  v_mfma_f32_16x16x32_bf16 v[68:71], a[92:95], a[12:15], v[68:71]
  s_nop 7
  s_lshl_b32 s40, s53, 5
  v_subrev_u32 v89, s40, v92
  v_cmp_le_i32 vcc, 0, v89
  s_nop 1
  v_cndmask_b32 v64, v88, v64, vcc
  v_cmp_le_i32 vcc, 1, v89
  s_nop 1
  v_cndmask_b32 v65, v88, v65, vcc
  v_cmp_le_i32 vcc, 2, v89
  s_nop 1
  v_cndmask_b32 v66, v88, v66, vcc
  v_cmp_le_i32 vcc, 3, v89
  s_nop 1
  v_cndmask_b32 v67, v88, v67, vcc
  v_cmp_le_i32 vcc, 16, v89
  s_nop 1
  v_cndmask_b32 v68, v88, v68, vcc
  v_cmp_le_i32 vcc, 17, v89
  s_nop 1
  v_cndmask_b32 v69, v88, v69, vcc
  v_cmp_le_i32 vcc, 18, v89
  s_nop 1
  v_cndmask_b32 v70, v88, v70, vcc
  v_cmp_le_i32 vcc, 19, v89
  s_nop 1
  v_cndmask_b32 v71, v88, v71, vcc
  v_max3_f32 v89, v64, v65, v66
  v_max3_f32 v89, v89, v67, v68
  v_max3_f32 v89, v89, v69, v70
  v_max3_f32 v89, v89, v71, v56
  v_mov_b32 v90, v89
  s_nop 1
  v_permlane16_swap_b32 v89, v90
  s_nop 1
  v_max_f32 v89, v89, v90
  v_mov_b32 v90, v89
  s_nop 1
  v_permlane32_swap_b32 v89, v90
  s_nop 1
  v_max_f32 v89, v89, v90
  v_sub_f32 v90, v56, v89
  v_exp_f32 v90, v90
  v_mov_b32 v56, v89
  v_sub_f32 v64, v64, v89
  v_sub_f32 v65, v65, v89
  v_sub_f32 v66, v66, v89
  v_sub_f32 v67, v67, v89
  v_sub_f32 v68, v68, v89
  v_sub_f32 v69, v69, v89
  v_sub_f32 v70, v70, v89
  v_sub_f32 v71, v71, v89
  v_exp_f32 v64, v64
  v_exp_f32 v65, v65
  v_exp_f32 v66, v66
  v_exp_f32 v67, v67
  v_exp_f32 v68, v68
  v_exp_f32 v69, v69
  v_exp_f32 v70, v70
  v_exp_f32 v71, v71
  v_mul_f32 v60, v60, v90
  v_add_f32 v60, v60, v64
  v_add_f32 v60, v60, v65
  v_add_f32 v60, v60, v66
  v_add_f32 v60, v60, v67
  v_add_f32 v60, v60, v68
  v_add_f32 v60, v60, v69
  v_add_f32 v60, v60, v70
  v_add_f32 v60, v60, v71
  v_cvt_pk_bf16_f32 v80, v64, v65
  v_cvt_pk_bf16_f32 v81, v66, v67
  v_cvt_pk_bf16_f32 v82, v68, v69
  v_cvt_pk_bf16_f32 v83, v70, v71
  v_mul_f32 v128, v128, v90
  v_mul_f32 v129, v129, v90
  v_mul_f32 v130, v130, v90
  v_mul_f32 v131, v131, v90
  v_mul_f32 v144, v144, v90
  v_mul_f32 v145, v145, v90
  v_mul_f32 v146, v146, v90
  v_mul_f32 v147, v147, v90
  v_mul_f32 v160, v160, v90
  v_mul_f32 v161, v161, v90
  v_mul_f32 v162, v162, v90
  v_mul_f32 v163, v163, v90
  v_mul_f32 v176, v176, v90
  v_mul_f32 v177, v177, v90
  v_mul_f32 v178, v178, v90
  v_mul_f32 v179, v179, v90
  v_mul_f32 v192, v192, v90
  v_mul_f32 v193, v193, v90
  v_mul_f32 v194, v194, v90
  v_mul_f32 v195, v195, v90
  v_mul_f32 v208, v208, v90
  v_mul_f32 v209, v209, v90
  v_mul_f32 v210, v210, v90
  v_mul_f32 v211, v211, v90
  v_mul_f32 v224, v224, v90
  v_mul_f32 v225, v225, v90
  v_mul_f32 v226, v226, v90
  v_mul_f32 v227, v227, v90
  v_mul_f32 v240, v240, v90
  v_mul_f32 v241, v241, v90
  v_mul_f32 v242, v242, v90
  v_mul_f32 v243, v243, v90
  s_nop 1
  v_mfma_f32_16x16x32_bf16 v[128:131], a[128:131], v[80:83], v[128:131]
  v_mfma_f32_16x16x32_bf16 v[144:147], a[132:135], v[80:83], v[144:147]
  v_mfma_f32_16x16x32_bf16 v[160:163], a[136:139], v[80:83], v[160:163]
  v_mfma_f32_16x16x32_bf16 v[176:179], a[140:143], v[80:83], v[176:179]
  v_mfma_f32_16x16x32_bf16 v[192:195], a[144:147], v[80:83], v[192:195]
  v_mfma_f32_16x16x32_bf16 v[208:211], a[148:151], v[80:83], v[208:211]
  v_mfma_f32_16x16x32_bf16 v[224:227], a[152:155], v[80:83], v[224:227]
  v_mfma_f32_16x16x32_bf16 v[240:243], a[156:159], v[80:83], v[240:243]
  s_nop 7
  v_mfma_f32_16x16x32_bf16 v[64:67], a[64:67], a[16:19], 0
  v_mfma_f32_16x16x32_bf16 v[64:67], a[68:71], a[20:23], v[64:67]
  v_mfma_f32_16x16x32_bf16 v[64:67], a[72:75], a[24:27], v[64:67]
  v_mfma_f32_16x16x32_bf16 v[64:67], a[76:79], a[28:31], v[64:67]
  v_mfma_f32_16x16x32_bf16 v[68:71], a[80:83], a[16:19], 0
  v_mfma_f32_16x16x32_bf16 v[68:71], a[84:87], a[20:23], v[68:71]
  v_mfma_f32_16x16x32_bf16 v[68:71], a[88:91], a[24:27], v[68:71]
  v_mfma_f32_16x16x32_bf16 v[68:71], a[92:95], a[28:31], v[68:71]
  s_nop 7
  s_lshl_b32 s40, s53, 5
  v_subrev_u32 v89, s40, v93
  v_cmp_le_i32 vcc, 0, v89
  s_nop 1
  v_cndmask_b32 v64, v88, v64, vcc
  v_cmp_le_i32 vcc, 1, v89
  s_nop 1
  v_cndmask_b32 v65, v88, v65, vcc
  v_cmp_le_i32 vcc, 2, v89
  s_nop 1
  v_cndmask_b32 v66, v88, v66, vcc
  v_cmp_le_i32 vcc, 3, v89
  s_nop 1
  v_cndmask_b32 v67, v88, v67, vcc
  v_cmp_le_i32 vcc, 16, v89
  s_nop 1
  v_cndmask_b32 v68, v88, v68, vcc
  v_cmp_le_i32 vcc, 17, v89
  s_nop 1
  v_cndmask_b32 v69, v88, v69, vcc
  v_cmp_le_i32 vcc, 18, v89
  s_nop 1
  v_cndmask_b32 v70, v88, v70, vcc
  v_cmp_le_i32 vcc, 19, v89
  s_nop 1
  v_cndmask_b32 v71, v88, v71, vcc
  v_max3_f32 v89, v64, v65, v66
  v_max3_f32 v89, v89, v67, v68
  v_max3_f32 v89, v89, v69, v70
  v_max3_f32 v89, v89, v71, v57
  v_mov_b32 v90, v89
  s_nop 1
  v_permlane16_swap_b32 v89, v90
  s_nop 1
  v_max_f32 v89, v89, v90
  v_mov_b32 v90, v89
  s_nop 1
  v_permlane32_swap_b32 v89, v90
  s_nop 1
  v_max_f32 v89, v89, v90
  v_sub_f32 v90, v57, v89
  v_exp_f32 v90, v90
  v_mov_b32 v57, v89
  v_sub_f32 v64, v64, v89
  v_sub_f32 v65, v65, v89
  v_sub_f32 v66, v66, v89
  v_sub_f32 v67, v67, v89
  v_sub_f32 v68, v68, v89
  v_sub_f32 v69, v69, v89
  v_sub_f32 v70, v70, v89
  v_sub_f32 v71, v71, v89
  v_exp_f32 v64, v64
  v_exp_f32 v65, v65
  v_exp_f32 v66, v66
  v_exp_f32 v67, v67
  v_exp_f32 v68, v68
  v_exp_f32 v69, v69
  v_exp_f32 v70, v70
  v_exp_f32 v71, v71
  v_mul_f32 v61, v61, v90
  v_add_f32 v61, v61, v64
  v_add_f32 v61, v61, v65
  v_add_f32 v61, v61, v66
  v_add_f32 v61, v61, v67
  v_add_f32 v61, v61, v68
  v_add_f32 v61, v61, v69
  v_add_f32 v61, v61, v70
  v_add_f32 v61, v61, v71
  v_cvt_pk_bf16_f32 v80, v64, v65
  v_cvt_pk_bf16_f32 v81, v66, v67
  v_cvt_pk_bf16_f32 v82, v68, v69
  v_cvt_pk_bf16_f32 v83, v70, v71
  v_mul_f32 v132, v132, v90
  v_mul_f32 v133, v133, v90
  v_mul_f32 v134, v134, v90
  v_mul_f32 v135, v135, v90
  v_mul_f32 v148, v148, v90
  v_mul_f32 v149, v149, v90
  v_mul_f32 v150, v150, v90
  v_mul_f32 v151, v151, v90
  v_mul_f32 v164, v164, v90
  v_mul_f32 v165, v165, v90
  v_mul_f32 v166, v166, v90
  v_mul_f32 v167, v167, v90
  v_mul_f32 v180, v180, v90
  v_mul_f32 v181, v181, v90
  v_mul_f32 v182, v182, v90
  v_mul_f32 v183, v183, v90
  v_mul_f32 v196, v196, v90
  v_mul_f32 v197, v197, v90
  v_mul_f32 v198, v198, v90
  v_mul_f32 v199, v199, v90
  v_mul_f32 v212, v212, v90
  v_mul_f32 v213, v213, v90
  v_mul_f32 v214, v214, v90
  v_mul_f32 v215, v215, v90
  v_mul_f32 v228, v228, v90
  v_mul_f32 v229, v229, v90
  v_mul_f32 v230, v230, v90
  v_mul_f32 v231, v231, v90
  v_mul_f32 v244, v244, v90
  v_mul_f32 v245, v245, v90
  v_mul_f32 v246, v246, v90
  v_mul_f32 v247, v247, v90
  s_nop 1
  v_mfma_f32_16x16x32_bf16 v[132:135], a[128:131], v[80:83], v[132:135]
  v_mfma_f32_16x16x32_bf16 v[148:151], a[132:135], v[80:83], v[148:151]
  v_mfma_f32_16x16x32_bf16 v[164:167], a[136:139], v[80:83], v[164:167]
  v_mfma_f32_16x16x32_bf16 v[180:183], a[140:143], v[80:83], v[180:183]
  v_mfma_f32_16x16x32_bf16 v[196:199], a[144:147], v[80:83], v[196:199]
  v_mfma_f32_16x16x32_bf16 v[212:215], a[148:151], v[80:83], v[212:215]
  v_mfma_f32_16x16x32_bf16 v[228:231], a[152:155], v[80:83], v[228:231]
  v_mfma_f32_16x16x32_bf16 v[244:247], a[156:159], v[80:83], v[244:247]
  s_nop 7
  v_mfma_f32_16x16x32_bf16 v[64:67], a[64:67], a[32:35], 0
  v_mfma_f32_16x16x32_bf16 v[64:67], a[68:71], a[36:39], v[64:67]
  v_mfma_f32_16x16x32_bf16 v[64:67], a[72:75], a[40:43], v[64:67]
  v_mfma_f32_16x16x32_bf16 v[64:67], a[76:79], a[44:47], v[64:67]
  v_mfma_f32_16x16x32_bf16 v[68:71], a[80:83], a[32:35], 0
  v_mfma_f32_16x16x32_bf16 v[68:71], a[84:87], a[36:39], v[68:71]
  v_mfma_f32_16x16x32_bf16 v[68:71], a[88:91], a[40:43], v[68:71]
  v_mfma_f32_16x16x32_bf16 v[68:71], a[92:95], a[44:47], v[68:71]
  s_nop 7
  s_lshl_b32 s40, s53, 5
  v_subrev_u32 v89, s40, v94
  v_cmp_le_i32 vcc, 0, v89
  s_nop 1
  v_cndmask_b32 v64, v88, v64, vcc
  v_cmp_le_i32 vcc, 1, v89
  s_nop 1
  v_cndmask_b32 v65, v88, v65, vcc
  v_cmp_le_i32 vcc, 2, v89
  s_nop 1
  v_cndmask_b32 v66, v88, v66, vcc
  v_cmp_le_i32 vcc, 3, v89
  s_nop 1
  v_cndmask_b32 v67, v88, v67, vcc
  v_cmp_le_i32 vcc, 16, v89
  s_nop 1
  v_cndmask_b32 v68, v88, v68, vcc
  v_cmp_le_i32 vcc, 17, v89
  s_nop 1
  v_cndmask_b32 v69, v88, v69, vcc
  v_cmp_le_i32 vcc, 18, v89
  s_nop 1
  v_cndmask_b32 v70, v88, v70, vcc
  v_cmp_le_i32 vcc, 19, v89
  s_nop 1
  v_cndmask_b32 v71, v88, v71, vcc
  v_max3_f32 v89, v64, v65, v66
  v_max3_f32 v89, v89, v67, v68
  v_max3_f32 v89, v89, v69, v70
  v_max3_f32 v89, v89, v71, v58
  v_mov_b32 v90, v89
  s_nop 1
  v_permlane16_swap_b32 v89, v90
  s_nop 1
  v_max_f32 v89, v89, v90
  v_mov_b32 v90, v89
  s_nop 1
  v_permlane32_swap_b32 v89, v90
  s_nop 1
  v_max_f32 v89, v89, v90
  v_sub_f32 v90, v58, v89
  v_exp_f32 v90, v90
  v_mov_b32 v58, v89
  v_sub_f32 v64, v64, v89
  v_sub_f32 v65, v65, v89
  v_sub_f32 v66, v66, v89
  v_sub_f32 v67, v67, v89
  v_sub_f32 v68, v68, v89
  v_sub_f32 v69, v69, v89
  v_sub_f32 v70, v70, v89
  v_sub_f32 v71, v71, v89
  v_exp_f32 v64, v64
  v_exp_f32 v65, v65
  v_exp_f32 v66, v66
  v_exp_f32 v67, v67
  v_exp_f32 v68, v68
  v_exp_f32 v69, v69
  v_exp_f32 v70, v70
  v_exp_f32 v71, v71
  v_mul_f32 v62, v62, v90
  v_add_f32 v62, v62, v64
  v_add_f32 v62, v62, v65
  v_add_f32 v62, v62, v66
  v_add_f32 v62, v62, v67
  v_add_f32 v62, v62, v68
  v_add_f32 v62, v62, v69
  v_add_f32 v62, v62, v70
  v_add_f32 v62, v62, v71
  v_cvt_pk_bf16_f32 v80, v64, v65
  v_cvt_pk_bf16_f32 v81, v66, v67
  v_cvt_pk_bf16_f32 v82, v68, v69
  v_cvt_pk_bf16_f32 v83, v70, v71
  v_mul_f32 v136, v136, v90
  v_mul_f32 v137, v137, v90
  v_mul_f32 v138, v138, v90
  v_mul_f32 v139, v139, v90
  v_mul_f32 v152, v152, v90
  v_mul_f32 v153, v153, v90
  v_mul_f32 v154, v154, v90
  v_mul_f32 v155, v155, v90
  v_mul_f32 v168, v168, v90
  v_mul_f32 v169, v169, v90
  v_mul_f32 v170, v170, v90
  v_mul_f32 v171, v171, v90
  v_mul_f32 v184, v184, v90
  v_mul_f32 v185, v185, v90
  v_mul_f32 v186, v186, v90
  v_mul_f32 v187, v187, v90
  v_mul_f32 v200, v200, v90
  v_mul_f32 v201, v201, v90
  v_mul_f32 v202, v202, v90
  v_mul_f32 v203, v203, v90
  v_mul_f32 v216, v216, v90
  v_mul_f32 v217, v217, v90
  v_mul_f32 v218, v218, v90
  v_mul_f32 v219, v219, v90
  v_mul_f32 v232, v232, v90
  v_mul_f32 v233, v233, v90
  v_mul_f32 v234, v234, v90
  v_mul_f32 v235, v235, v90
  v_mul_f32 v248, v248, v90
  v_mul_f32 v249, v249, v90
  v_mul_f32 v250, v250, v90
  v_mul_f32 v251, v251, v90
  s_nop 1
  v_mfma_f32_16x16x32_bf16 v[136:139], a[128:131], v[80:83], v[136:139]
  v_mfma_f32_16x16x32_bf16 v[152:155], a[132:135], v[80:83], v[152:155]
  v_mfma_f32_16x16x32_bf16 v[168:171], a[136:139], v[80:83], v[168:171]
  v_mfma_f32_16x16x32_bf16 v[184:187], a[140:143], v[80:83], v[184:187]
  v_mfma_f32_16x16x32_bf16 v[200:203], a[144:147], v[80:83], v[200:203]
  v_mfma_f32_16x16x32_bf16 v[216:219], a[148:151], v[80:83], v[216:219]
  v_mfma_f32_16x16x32_bf16 v[232:235], a[152:155], v[80:83], v[232:235]
  v_mfma_f32_16x16x32_bf16 v[248:251], a[156:159], v[80:83], v[248:251]
  s_nop 7
  v_mfma_f32_16x16x32_bf16 v[64:67], a[64:67], a[48:51], 0
  v_mfma_f32_16x16x32_bf16 v[64:67], a[68:71], a[52:55], v[64:67]
  v_mfma_f32_16x16x32_bf16 v[64:67], a[72:75], a[56:59], v[64:67]
  v_mfma_f32_16x16x32_bf16 v[64:67], a[76:79], a[60:63], v[64:67]
  v_mfma_f32_16x16x32_bf16 v[68:71], a[80:83], a[48:51], 0
  v_mfma_f32_16x16x32_bf16 v[68:71], a[84:87], a[52:55], v[68:71]
  v_mfma_f32_16x16x32_bf16 v[68:71], a[88:91], a[56:59], v[68:71]
  v_mfma_f32_16x16x32_bf16 v[68:71], a[92:95], a[60:63], v[68:71]
  s_nop 7
  s_lshl_b32 s40, s53, 5
  v_subrev_u32 v89, s40, v95
  v_cmp_le_i32 vcc, 0, v89
  s_nop 1
  v_cndmask_b32 v64, v88, v64, vcc
  v_cmp_le_i32 vcc, 1, v89
  s_nop 1
  v_cndmask_b32 v65, v88, v65, vcc
  v_cmp_le_i32 vcc, 2, v89
  s_nop 1
  v_cndmask_b32 v66, v88, v66, vcc
  v_cmp_le_i32 vcc, 3, v89
  s_nop 1
  v_cndmask_b32 v67, v88, v67, vcc
  v_cmp_le_i32 vcc, 16, v89
  s_nop 1
  v_cndmask_b32 v68, v88, v68, vcc
  v_cmp_le_i32 vcc, 17, v89
  s_nop 1
  v_cndmask_b32 v69, v88, v69, vcc
  v_cmp_le_i32 vcc, 18, v89
  s_nop 1
  v_cndmask_b32 v70, v88, v70, vcc
  v_cmp_le_i32 vcc, 19, v89
  s_nop 1
  v_cndmask_b32 v71, v88, v71, vcc
  v_max3_f32 v89, v64, v65, v66
  v_max3_f32 v89, v89, v67, v68
  v_max3_f32 v89, v89, v69, v70
  v_max3_f32 v89, v89, v71, v59
  v_mov_b32 v90, v89
  s_nop 1
  v_permlane16_swap_b32 v89, v90
  s_nop 1
  v_max_f32 v89, v89, v90
  v_mov_b32 v90, v89
  s_nop 1
  v_permlane32_swap_b32 v89, v90
  s_nop 1
  v_max_f32 v89, v89, v90
  v_sub_f32 v90, v59, v89
  v_exp_f32 v90, v90
  v_mov_b32 v59, v89
  v_sub_f32 v64, v64, v89
  v_sub_f32 v65, v65, v89
  v_sub_f32 v66, v66, v89
  v_sub_f32 v67, v67, v89
  v_sub_f32 v68, v68, v89
  v_sub_f32 v69, v69, v89
  v_sub_f32 v70, v70, v89
  v_sub_f32 v71, v71, v89
  v_exp_f32 v64, v64
  v_exp_f32 v65, v65
  v_exp_f32 v66, v66
  v_exp_f32 v67, v67
  v_exp_f32 v68, v68
  v_exp_f32 v69, v69
  v_exp_f32 v70, v70
  v_exp_f32 v71, v71
  v_mul_f32 v63, v63, v90
  v_add_f32 v63, v63, v64
  v_add_f32 v63, v63, v65
  v_add_f32 v63, v63, v66
  v_add_f32 v63, v63, v67
  v_add_f32 v63, v63, v68
  v_add_f32 v63, v63, v69
  v_add_f32 v63, v63, v70
  v_add_f32 v63, v63, v71
  v_cvt_pk_bf16_f32 v80, v64, v65
  v_cvt_pk_bf16_f32 v81, v66, v67
  v_cvt_pk_bf16_f32 v82, v68, v69
  v_cvt_pk_bf16_f32 v83, v70, v71
  v_mul_f32 v140, v140, v90
  v_mul_f32 v141, v141, v90
  v_mul_f32 v142, v142, v90
  v_mul_f32 v143, v143, v90
  v_mul_f32 v156, v156, v90
  v_mul_f32 v157, v157, v90
  v_mul_f32 v158, v158, v90
  v_mul_f32 v159, v159, v90
  v_mul_f32 v172, v172, v90
  v_mul_f32 v173, v173, v90
  v_mul_f32 v174, v174, v90
  v_mul_f32 v175, v175, v90
  v_mul_f32 v188, v188, v90
  v_mul_f32 v189, v189, v90
  v_mul_f32 v190, v190, v90
  v_mul_f32 v191, v191, v90
  v_mul_f32 v204, v204, v90
  v_mul_f32 v205, v205, v90
  v_mul_f32 v206, v206, v90
  v_mul_f32 v207, v207, v90
  v_mul_f32 v220, v220, v90
  v_mul_f32 v221, v221, v90
  v_mul_f32 v222, v222, v90
  v_mul_f32 v223, v223, v90
  v_mul_f32 v236, v236, v90
  v_mul_f32 v237, v237, v90
  v_mul_f32 v238, v238, v90
  v_mul_f32 v239, v239, v90
  v_mul_f32 v252, v252, v90
  v_mul_f32 v253, v253, v90
  v_mul_f32 v254, v254, v90
  v_mul_f32 v255, v255, v90
  s_nop 1
  v_mfma_f32_16x16x32_bf16 v[140:143], a[128:131], v[80:83], v[140:143]
  v_mfma_f32_16x16x32_bf16 v[156:159], a[132:135], v[80:83], v[156:159]
  v_mfma_f32_16x16x32_bf16 v[172:175], a[136:139], v[80:83], v[172:175]
  v_mfma_f32_16x16x32_bf16 v[188:191], a[140:143], v[80:83], v[188:191]
  v_mfma_f32_16x16x32_bf16 v[204:207], a[144:147], v[80:83], v[204:207]
  v_mfma_f32_16x16x32_bf16 v[220:223], a[148:151], v[80:83], v[220:223]
  v_mfma_f32_16x16x32_bf16 v[236:239], a[152:155], v[80:83], v[236:239]
  v_mfma_f32_16x16x32_bf16 v[252:255], a[156:159], v[80:83], v[252:255]
  s_nop 7
  s_add_u32 s53, s53, 1
  s_cmp_lt_u32 s53, s38
  s_cbranch_scc1 L_fb_loop
  v_mov_b32 v89, v60
  s_nop 1
  v_permlane16_swap_b32 v60, v89
  s_nop 1
  v_add_f32 v60, v60, v89
  v_mov_b32 v89, v60
  s_nop 1
  v_permlane32_swap_b32 v60, v89
  s_nop 1
  v_add_f32 v60, v60, v89
  v_mov_b32 v89, v61
  s_nop 1
  v_permlane16_swap_b32 v61, v89
  s_nop 1
  v_add_f32 v61, v61, v89
  v_mov_b32 v89, v61
  s_nop 1
  v_permlane32_swap_b32 v61, v89
  s_nop 1
  v_add_f32 v61, v61, v89
  v_mov_b32 v89, v62
  s_nop 1
  v_permlane16_swap_b32 v62, v89
  s_nop 1
  v_add_f32 v62, v62, v89
  v_mov_b32 v89, v62
  s_nop 1
  v_permlane32_swap_b32 v62, v89
  s_nop 1
  v_add_f32 v62, v62, v89
  v_mov_b32 v89, v63
  s_nop 1
  v_permlane16_swap_b32 v63, v89
  s_nop 1
  v_add_f32 v63, v63, v89
  v_mov_b32 v89, v63
  s_nop 1
  v_permlane32_swap_b32 v63, v89
  s_nop 1
  v_add_f32 v63, v63, v89
  v_rcp_f32 v60, v60
  v_rcp_f32 v61, v61
  v_rcp_f32 v62, v62
  v_rcp_f32 v63, v63
  s_nop 0
  s_lshl_b32 s40, s56, 17
  v_add_u32 v52, s40, v4
  s_lshl_b32 s40, s57, 17
  v_add_u32 v53, s40, v4
  v_mul_f32 v128, v128, v60
  v_mul_f32 v144, v144, v60
  v_mul_f32 v129, v129, v60
  v_mul_f32 v145, v145, v60
  v_mul_f32 v130, v130, v60
  v_mul_f32 v146, v146, v60
  v_mul_f32 v131, v131, v60
  v_mul_f32 v147, v147, v60
  v_cvt_pk_bf16_f32 v32, v128, v129
  v_cvt_pk_bf16_f32 v33, v130, v131
  v_cvt_pk_bf16_f32 v34, v144, v145
  v_cvt_pk_bf16_f32 v35, v146, v147
  global_store_dwordx4 v52, v[32:35], s[62:63] offset:0 sc1
  v_mul_f32 v160, v160, v60
  v_mul_f32 v176, v176, v60
  v_mul_f32 v161, v161, v60
  v_mul_f32 v177, v177, v60
  v_mul_f32 v162, v162, v60
  v_mul_f32 v178, v178, v60
  v_mul_f32 v163, v163, v60
  v_mul_f32 v179, v179, v60
  v_cvt_pk_bf16_f32 v36, v160, v161
  v_cvt_pk_bf16_f32 v37, v162, v163
  v_cvt_pk_bf16_f32 v38, v176, v177
  v_cvt_pk_bf16_f32 v39, v178, v179
  global_store_dwordx4 v52, v[36:39], s[62:63] offset:1024 sc1
  v_mul_f32 v192, v192, v60
  v_mul_f32 v208, v208, v60
  v_mul_f32 v193, v193, v60
  v_mul_f32 v209, v209, v60
  v_mul_f32 v194, v194, v60
  v_mul_f32 v210, v210, v60
  v_mul_f32 v195, v195, v60
  v_mul_f32 v211, v211, v60
  v_cvt_pk_bf16_f32 v40, v192, v193
  v_cvt_pk_bf16_f32 v41, v194, v195
  v_cvt_pk_bf16_f32 v42, v208, v209
  v_cvt_pk_bf16_f32 v43, v210, v211
  global_store_dwordx4 v52, v[40:43], s[62:63] offset:2048 sc1
  v_mul_f32 v224, v224, v60
  v_mul_f32 v240, v240, v60
  v_mul_f32 v225, v225, v60
  v_mul_f32 v241, v241, v60
  v_mul_f32 v226, v226, v60
  v_mul_f32 v242, v242, v60
  v_mul_f32 v227, v227, v60
  v_mul_f32 v243, v243, v60
  v_cvt_pk_bf16_f32 v44, v224, v225
  v_cvt_pk_bf16_f32 v45, v226, v227
  v_cvt_pk_bf16_f32 v46, v240, v241
  v_cvt_pk_bf16_f32 v47, v242, v243
  global_store_dwordx4 v52, v[44:47], s[62:63] offset:3072 sc1
  v_mul_f32 v132, v132, v61
  v_mul_f32 v148, v148, v61
  v_mul_f32 v133, v133, v61
  v_mul_f32 v149, v149, v61
  v_mul_f32 v134, v134, v61
  v_mul_f32 v150, v150, v61
  v_mul_f32 v135, v135, v61
  v_mul_f32 v151, v151, v61
  v_cvt_pk_bf16_f32 v32, v132, v133
  v_cvt_pk_bf16_f32 v33, v134, v135
  v_cvt_pk_bf16_f32 v34, v148, v149
  v_cvt_pk_bf16_f32 v35, v150, v151
  global_store_dwordx4 v53, v[32:35], s[62:63] offset:0 sc1
  v_mul_f32 v164, v164, v61
  v_mul_f32 v180, v180, v61
  v_mul_f32 v165, v165, v61
  v_mul_f32 v181, v181, v61
  v_mul_f32 v166, v166, v61
  v_mul_f32 v182, v182, v61
  v_mul_f32 v167, v167, v61
  v_mul_f32 v183, v183, v61
  v_cvt_pk_bf16_f32 v36, v164, v165
  v_cvt_pk_bf16_f32 v37, v166, v167
  v_cvt_pk_bf16_f32 v38, v180, v181
  v_cvt_pk_bf16_f32 v39, v182, v183
  global_store_dwordx4 v53, v[36:39], s[62:63] offset:1024 sc1
  v_mul_f32 v196, v196, v61
  v_mul_f32 v212, v212, v61
  v_mul_f32 v197, v197, v61
  v_mul_f32 v213, v213, v61
  v_mul_f32 v198, v198, v61
  v_mul_f32 v214, v214, v61
  v_mul_f32 v199, v199, v61
  v_mul_f32 v215, v215, v61
  v_cvt_pk_bf16_f32 v40, v196, v197
  v_cvt_pk_bf16_f32 v41, v198, v199
  v_cvt_pk_bf16_f32 v42, v212, v213
  v_cvt_pk_bf16_f32 v43, v214, v215
  global_store_dwordx4 v53, v[40:43], s[62:63] offset:2048 sc1
  v_mul_f32 v228, v228, v61
  v_mul_f32 v244, v244, v61
  v_mul_f32 v229, v229, v61
  v_mul_f32 v245, v245, v61
  v_mul_f32 v230, v230, v61
  v_mul_f32 v246, v246, v61
  v_mul_f32 v231, v231, v61
  v_mul_f32 v247, v247, v61
  v_cvt_pk_bf16_f32 v44, v228, v229
  v_cvt_pk_bf16_f32 v45, v230, v231
  v_cvt_pk_bf16_f32 v46, v244, v245
  v_cvt_pk_bf16_f32 v47, v246, v247
  global_store_dwordx4 v53, v[44:47], s[62:63] offset:3072 sc1
  s_cmp_eq_u32 s23, 1
  s_cbranch_scc1 L_fb_adone
  s_lshl_b32 s40, s58, 17
  v_add_u32 v54, s40, v4
  s_lshl_b32 s40, s59, 17
  v_add_u32 v55, s40, v4
  v_mul_f32 v136, v136, v62
  v_mul_f32 v152, v152, v62
  v_mul_f32 v137, v137, v62
  v_mul_f32 v153, v153, v62
  v_mul_f32 v138, v138, v62
  v_mul_f32 v154, v154, v62
  v_mul_f32 v139, v139, v62
  v_mul_f32 v155, v155, v62
  v_cvt_pk_bf16_f32 v32, v136, v137
  v_cvt_pk_bf16_f32 v33, v138, v139
  v_cvt_pk_bf16_f32 v34, v152, v153
  v_cvt_pk_bf16_f32 v35, v154, v155
  global_store_dwordx4 v54, v[32:35], s[62:63] offset:0 sc1
  v_mul_f32 v168, v168, v62
  v_mul_f32 v184, v184, v62
  v_mul_f32 v169, v169, v62
  v_mul_f32 v185, v185, v62
  v_mul_f32 v170, v170, v62
  v_mul_f32 v186, v186, v62
  v_mul_f32 v171, v171, v62
  v_mul_f32 v187, v187, v62
  v_cvt_pk_bf16_f32 v36, v168, v169
  v_cvt_pk_bf16_f32 v37, v170, v171
  v_cvt_pk_bf16_f32 v38, v184, v185
  v_cvt_pk_bf16_f32 v39, v186, v187
  global_store_dwordx4 v54, v[36:39], s[62:63] offset:1024 sc1
  v_mul_f32 v200, v200, v62
  v_mul_f32 v216, v216, v62
  v_mul_f32 v201, v201, v62
  v_mul_f32 v217, v217, v62
  v_mul_f32 v202, v202, v62
  v_mul_f32 v218, v218, v62
  v_mul_f32 v203, v203, v62
  v_mul_f32 v219, v219, v62
  v_cvt_pk_bf16_f32 v40, v200, v201
  v_cvt_pk_bf16_f32 v41, v202, v203
  v_cvt_pk_bf16_f32 v42, v216, v217
  v_cvt_pk_bf16_f32 v43, v218, v219
  global_store_dwordx4 v54, v[40:43], s[62:63] offset:2048 sc1
  v_mul_f32 v232, v232, v62
  v_mul_f32 v248, v248, v62
  v_mul_f32 v233, v233, v62
  v_mul_f32 v249, v249, v62
  v_mul_f32 v234, v234, v62
  v_mul_f32 v250, v250, v62
  v_mul_f32 v235, v235, v62
  v_mul_f32 v251, v251, v62
  v_cvt_pk_bf16_f32 v44, v232, v233
  v_cvt_pk_bf16_f32 v45, v234, v235
  v_cvt_pk_bf16_f32 v46, v248, v249
  v_cvt_pk_bf16_f32 v47, v250, v251
  global_store_dwordx4 v54, v[44:47], s[62:63] offset:3072 sc1
  v_mul_f32 v140, v140, v63
  v_mul_f32 v156, v156, v63
  v_mul_f32 v141, v141, v63
  v_mul_f32 v157, v157, v63
  v_mul_f32 v142, v142, v63
  v_mul_f32 v158, v158, v63
  v_mul_f32 v143, v143, v63
  v_mul_f32 v159, v159, v63
  v_cvt_pk_bf16_f32 v32, v140, v141
  v_cvt_pk_bf16_f32 v33, v142, v143
  v_cvt_pk_bf16_f32 v34, v156, v157
  v_cvt_pk_bf16_f32 v35, v158, v159
  global_store_dwordx4 v55, v[32:35], s[62:63] offset:0 sc1
  v_mul_f32 v172, v172, v63
  v_mul_f32 v188, v188, v63
  v_mul_f32 v173, v173, v63
  v_mul_f32 v189, v189, v63
  v_mul_f32 v174, v174, v63
  v_mul_f32 v190, v190, v63
  v_mul_f32 v175, v175, v63
  v_mul_f32 v191, v191, v63
  v_cvt_pk_bf16_f32 v36, v172, v173
  v_cvt_pk_bf16_f32 v37, v174, v175
  v_cvt_pk_bf16_f32 v38, v188, v189
  v_cvt_pk_bf16_f32 v39, v190, v191
  global_store_dwordx4 v55, v[36:39], s[62:63] offset:1024 sc1
  v_mul_f32 v204, v204, v63
  v_mul_f32 v220, v220, v63
  v_mul_f32 v205, v205, v63
  v_mul_f32 v221, v221, v63
  v_mul_f32 v206, v206, v63
  v_mul_f32 v222, v222, v63
  v_mul_f32 v207, v207, v63
  v_mul_f32 v223, v223, v63
  v_cvt_pk_bf16_f32 v40, v204, v205
  v_cvt_pk_bf16_f32 v41, v206, v207
  v_cvt_pk_bf16_f32 v42, v220, v221
  v_cvt_pk_bf16_f32 v43, v222, v223
  global_store_dwordx4 v55, v[40:43], s[62:63] offset:2048 sc1
  v_mul_f32 v236, v236, v63
  v_mul_f32 v252, v252, v63
  v_mul_f32 v237, v237, v63
  v_mul_f32 v253, v253, v63
  v_mul_f32 v238, v238, v63
  v_mul_f32 v254, v254, v63
  v_mul_f32 v239, v239, v63
  v_mul_f32 v255, v255, v63
  v_cvt_pk_bf16_f32 v44, v236, v237
  v_cvt_pk_bf16_f32 v45, v238, v239
  v_cvt_pk_bf16_f32 v46, v252, v253
  v_cvt_pk_bf16_f32 v47, v254, v255
  global_store_dwordx4 v55, v[44:47], s[62:63] offset:3072 sc1
  s_waitcnt vmcnt(0)
  s_barrier
  s_cmp_eq_u32 s22, 0
  s_cbranch_scc0 L_sf43
  s_lshl_b32 s40, s21, 3
  s_lshr_b32 s41, s20, 3
  s_add_u32 s40, s40, s41
  s_add_u32 s40, s40, 0
  s_lshl_b32 s40, s40, 7
  s_and_b32 s41, s20, 7
  s_lshl_b32 s41, s41, 2
  s_add_u32 s40, s40, s41
  s_add_u32 s40, s40, 8192
  v_mov_b32 v12, s40
  v_mov_b32 v13, s71
  s_mov_b64 exec, 1
  global_store_dword v12, v13, s[68:69] sc1
  s_mov_b64 exec, -1
L_sf43:
L_fb_adone:
  s_waitcnt vmcnt(0)
  s_branch L_after_ctx

.section .rodata,"a"
.p2align 6
.amdhsa_kernel parallel_sum__compressed_kv_cla__glu_gated_swiglu__prompt_kernel
  .amdhsa_next_free_vgpr 512
  .amdhsa_next_free_sgpr 100
  .amdhsa_accum_offset 256
  .amdhsa_group_segment_fixed_size 0
  .amdhsa_kernarg_size 104
  .amdhsa_user_sgpr_count 2
  .amdhsa_user_sgpr_kernarg_segment_ptr 1
  .amdhsa_system_sgpr_workgroup_id_x 1
.end_amdhsa_kernel
```
